```python
import torch

def _softmax(x, axis=-1):
    return torch.softmax(x, dim=axis)
def _gelu(x):
    return torch.nn.functional.gelu(x, approximate="tanh")
def _silu(x):
    return torch.nn.functional.silu(x)
def _sigmoid(x):
    return torch.sigmoid(x)
def _layernorm(x, axis=-1, eps=1e-5):
    m = x.mean(dim=axis, keepdim=True)
    v = x.var(dim=axis, keepdim=True, unbiased=False)
    return (x - m) / torch.sqrt(v + eps)
def _scatter_add(tgt, idx, src, axis=0):
    return tgt.clone().index_add_(axis, idx, src)
def _segment_sum(src, seg, n):
    out = torch.zeros((n,) + src.shape[1:], dtype=src.dtype)
    return out.index_add_(0, seg, src)
def _pad(x, pw):
    flat = tuple(v for pair in reversed(pw) for v in pair)
    return torch.nn.functional.pad(x, flat)

kernel_name = 'recurrent_scan__gqa_block_cached__glu_gated_geglu__prompt'

def setup_inputs():

    _w = (lambda a: (lambda t: t.to(torch.bfloat16) if t.is_floating_point() else t)(torch.as_tensor(a)))
    def _A_setup():
        B, Sq, D = 1, 2048, 576
        Hq, Hkv, Sk, Dh = 32, 16, 2048, 128
        assert Hq % Hkv == 0, (Hq, Hkv)
        return {
            "x": _w((lambda *s: torch.randn(*s, dtype=torch.bfloat16) * 0.05)(B, Sq, D)),
            "k_cache": _w((lambda *s: torch.randn(*s, dtype=torch.bfloat16) * 3.2)(B, Hkv, Sk, Dh)),
            "v_cache": _w((lambda *s: torch.randn(*s, dtype=torch.bfloat16) * 3.2)(B, Hkv, Sk, Dh)),
            "wq": _w((lambda *s: torch.randn(*s, dtype=torch.bfloat16) * 3.2)(D, Hq * Dh) * (D ** -0.5)),
            "wo": _w((lambda *s: torch.randn(*s, dtype=torch.bfloat16) * 3.2)(Hq * Dh, D) * ((Hq * Dh) ** -0.5)),
        }
    _A_in = _A_setup()

    def _B_setup():
        B, S, Dm, Df = 1, 2048, 576, 4608
        return {
            "x": _w((lambda *s: torch.randn(*s, dtype=torch.bfloat16) * 0.05)(B, S, Dm)),
            "w_gate": _w((lambda *s: torch.randn(*s, dtype=torch.bfloat16) * 0.4)(Dm, Df) * (Dm ** -0.5)),
            "w_up": _w((lambda *s: torch.randn(*s, dtype=torch.bfloat16) * 0.4)(Dm, Df) * (Dm ** -0.5)),
            "w_down": _w((lambda *s: torch.randn(*s, dtype=torch.bfloat16) * 0.4)(Df, Dm) * (Df ** -0.5)),
        }
    _B_in = _B_setup()

    return {
        "A_x": _A_in["x"],
        "A_k_cache": _A_in["k_cache"],
        "A_v_cache": _A_in["v_cache"],
        "A_wq": _A_in["wq"],
        "A_wo": _A_in["wo"],
        "B_x": _B_in["x"],
        "B_w_gate": _B_in["w_gate"],
        "B_w_up": _B_in["w_up"],
        "B_w_down": _B_in["w_down"],
    }

def reference(A_x, A_k_cache, A_v_cache, A_wq, A_wo, B_x, B_w_gate, B_w_up, B_w_down):
    def _A_ref(x, k_cache, v_cache, wq, wo):
        B, Sq, D = x.shape
        Hq, Dh = 32, 128
        Hkv = k_cache.shape[1]
        rep = Hq // Hkv
        q = (lambda x, *d: x.permute(*d))((x @ wq).reshape(B, Sq, Hq, Dh), 0, 2, 1, 3)
        k = (lambda x, n, axis: torch.repeat_interleave(x, n, dim=axis))(k_cache, rep, axis=1)
        v = (lambda x, n, axis: torch.repeat_interleave(x, n, dim=axis))(v_cache, rep, axis=1)
        scores = torch.einsum("bhqd,bhkd->bhqk", q, k) * (Dh ** -0.5)
        p = _softmax(scores, axis=-1)
        o = torch.einsum("bhqk,bhkd->bhqd", p, v)
        return (lambda x, *d: x.permute(*d))(o, 0, 2, 1, 3).reshape(B, Sq, Hq * Dh) @ wo

    def _B_ref(x, w_gate, w_up, w_down):
        g = torch.einsum("bsd,df->bsf", x, w_gate)
        u = torch.einsum("bsd,df->bsf", x, w_up)
        h = _gelu(g) * u
        return torch.einsum("bsf,fd->bsd", h, w_down)

    x = A_x
    xn = _layernorm(x, axis=-1)
    s = _A_ref(xn, A_k_cache, A_v_cache, A_wq, A_wo)
    g = _silu(_B_ref(xn, B_w_gate, B_w_up, B_w_down))
    return x + s * g
```

```asm
; @launch grid=(256,1,1) block=(256,1,1) lds=163840
.amdgcn_target "amdgcn-amd-amdhsa--gfx950"
.text
.globl recurrent_scan__gqa_block_cached__glu_gated_geglu__prompt_kernel
.p2align 8
.type recurrent_scan__gqa_block_cached__glu_gated_geglu__prompt_kernel,@function
recurrent_scan__gqa_block_cached__glu_gated_geglu__prompt_kernel:
    s_cmp_ge_u32 s2, 256
    s_cbranch_scc1 L_done
    s_load_dwordx2 s[36:37], s[0:1], 0
    s_load_dwordx4 s[68:71], s[0:1], 80
    s_getpc_b64 s[20:21]
L_pc0:
    s_and_b32 s21, s21, 0xffff
    s_mov_b32 s22, L_code_end-L_pc0
    s_mov_b32 s23, 0x20000
    s_lshr_b32 s45, s2, 3
    s_lshl_b32 s44, s45, 12
    v_lshlrev_b32 v16, 4, v0
    buffer_load_dwordx4 v[160:163], v16, s[20:23], s44 offen
    s_and_b32 s52, s2, 7
    s_lshl_b32 s52, s52, 5
    s_or_b32 s52, s52, s45
    v_lshrrev_b32 v18, 5, v0
    v_and_b32 v19, 31, v0
    s_mul_i32 s44, s52, 9216
    v_mul_u32_u24 v20, 1152, v18
    v_lshl_add_u32 v20, v19, 4, v20
    s_mov_b32 s38, 2359296
    s_mov_b32 s39, 0x20000
    s_waitcnt lgkmcnt(0)
    buffer_load_dwordx4 v[96:99], v20, s[36:39], s44 offen offset:0
    buffer_load_dwordx4 v[100:103], v20, s[36:39], s44 offen offset:384
    buffer_load_dwordx4 v[104:107], v20, s[36:39], s44 offen offset:768
    s_load_dwordx2 s[16:17], s[0:1], 24
    s_load_dwordx4 s[72:75], s[0:1], 48
    s_load_dwordx4 s[64:67], s[0:1], 8
    s_memrealtime s[76:77]
    v_lshrrev_b32 v16, 6, v0
    v_and_b32 v17, 63, v0
    v_cmp_gt_u32 vcc, 24, v19
    v_readfirstlane_b32 s40, v16
    s_mov_b32 s32, s68
    s_mov_b32 s33, s69
    s_mov_b32 s34, 256
    s_mov_b32 s35, 0x20000
    s_mov_b32 s28, s70
    s_mov_b32 s29, s71
    s_mov_b32 s30, 134217728
    s_mov_b32 s31, 0x20000
    s_mov_b64 s[50:51], vcc
    s_and_b32 s44, s2, 7
    s_and_b32 s41, s45, 3
    s_lshr_b32 s45, s45, 2
    s_and_b32 s46, s44, 1
    s_lshl_b32 s46, s46, 2
    s_add_u32 s41, s41, s46
    s_lshr_b32 s44, s44, 1
    s_lshl_b32 s42, s44, 3
    s_add_u32 s42, s42, s45
    s_mov_b32 s18, 4718592
    s_mov_b32 s19, 0x20000
    v_lshlrev_b32 v1, 4, v17
    v_mov_b32 v71, 0
    s_waitcnt lgkmcnt(0)
    s_lshl_b32 s45, s2, 2
    s_add_u32 s45, s45, s40
    s_cmp_lg_u32 s45, 1
    s_cbranch_scc1 L_noleader
    s_lshl_b64 s[76:77], s[76:77], 8
    s_or_b32 s76, s76, 128
    v_mov_b32 v30, s76
    v_mov_b32 v31, s77
    buffer_store_dwordx2 v[30:31], v71, s[32:35], 0 offen sc1
L_noleader:
    v_lshrrev_b32 v20, 4, v17
    v_and_b32 v22, 15, v17
    v_lshlrev_b32 v23, 2, v20
    v_xor_b32 v23, v23, v22
    v_lshlrev_b32 v24, 13, v20
    v_lshl_add_u32 v3, v23, 4, v24
    s_mul_i32 s3, s40, 6144
    s_mul_i32 s56, s40, 196608
    s_lshl_b32 s44, s42, 8
    s_add_u32 s56, s56, s44
    s_mov_b32 s8, s72
    s_mov_b32 s9, s73
    s_mov_b32 s10, 5308416
    s_mov_b32 s11, 0x20000
    s_mov_b32 s12, s74
    s_mov_b32 s13, s75
    s_mov_b32 s14, 5308416
    s_mov_b32 s15, 0x20000
    s_cmp_eq_u32 s40, 0
    s_cbranch_scc1 L_w0a
    s_sub_u32 s46, s40, 1
    s_lshl_b32 s59, s46, 13
    s_lshl_b32 s43, s46, 18
    s_add_u32 s43, s43, s44
    s_add_u32 m0, s59, 131072
    s_add_u32 s45, s43, 0
    buffer_load_dwordx4 v3, s[16:19], s45 offen nt lds
    s_add_u32 m0, s59, 132096
    s_add_u32 s44, s43, 32768
    buffer_load_dwordx4 v3, s[16:19], s44 offen nt lds
    s_add_u32 m0, s59, 133120
    s_add_u32 s45, s43, 65536
    buffer_load_dwordx4 v3, s[16:19], s45 offen nt lds
    s_add_u32 m0, s59, 134144
    s_add_u32 s44, s43, 98304
    buffer_load_dwordx4 v3, s[16:19], s44 offen nt lds
    s_add_u32 m0, s59, 135168
    s_add_u32 s45, s43, 131072
    buffer_load_dwordx4 v3, s[16:19], s45 offen nt lds
    s_add_u32 m0, s59, 136192
    s_add_u32 s44, s43, 163840
    buffer_load_dwordx4 v3, s[16:19], s44 offen nt lds
    s_add_u32 m0, s59, 137216
    s_add_u32 s45, s43, 196608
    buffer_load_dwordx4 v3, s[16:19], s45 offen nt lds
    s_add_u32 m0, s59, 138240
    s_add_u32 s44, s43, 229376
    buffer_load_dwordx4 v3, s[16:19], s44 offen nt lds
    s_lshr_b32 s44, s2, 3
    s_mul_i32 s44, s44, 3
    s_add_u32 s44, s44, s46
    s_and_b32 s45, s44, 1
    s_cmp_eq_u32 s45, 0
    s_cselect_b32 s24, s8, s12
    s_cselect_b32 s25, s9, s13
    s_mov_b32 s26, 5308416
    s_mov_b32 s27, 0x20000
    s_lshr_b32 s44, s44, 1
    s_mul_i32 s57, s44, 110592
    s_lshr_b32 s46, s42, 3
    s_mul_i32 s46, s46, 2304
    s_add_u32 s57, s57, s46
    s_sub_u32 s45, 384, s24
    s_sub_u32 s45, s45, s46
    s_and_b32 s45, s45, 1023
    s_add_u32 s57, s57, s45
    v_min_u32 v36, 35, v17
    v_mul_u32_u24 v27, 43, v36
    v_lshrrev_b32 v27, 7, v27
    v_mul_u32_u24 v27, 6144, v27
    v_lshl_add_u32 v36, v36, 10, v27
    buffer_load_dword v164, v36, s[24:27], s57 offen
L_w0a:
    v_lshrrev_b32 v26, 3, v17
    v_and_b32 v27, 3, v26
    v_lshrrev_b32 v26, 2, v26
    v_and_b32 v28, 7, v17
    v_lshl_add_u32 v27, v27, 4, v28
    v_lshlrev_b32 v27, 4, v27
    v_lshl_add_u32 v26, v26, 12, v27
    s_lshr_b32 s44, s52, 3
    s_mul_i32 s58, s44, 73728
    s_and_b32 s45, s52, 6
    s_lshl_b32 s45, s45, 9
    s_add_u32 s58, s58, s45
    s_and_b32 s45, s52, 1
    s_lshl_b32 s45, s45, 7
    s_add_u32 s58, s58, s45
    s_mov_b32 s73, 2621440
    s_getreg_b32 s69, hwreg(HW_REG_XCC_ID, 0, 4)
    s_lshl_b32 s69, s69, 3
    s_lshl_b32 s44, s44, 9
    s_and_b32 s45, s52, 7
    s_lshl_b32 s45, s45, 3
    s_add_u32 s44, s44, s45
    s_add_u32 s44, s44, 16384
    v_mov_b32 v31, s44
    s_lshl_b32 s44, s41, 11
    s_and_b32 s45, s42, 24
    s_lshl_b32 s45, s45, 6
    s_add_u32 s45, s45, s44
    v_lshl_add_u32 v76, v28, 3, s45
    s_and_b32 s46, s42, 7
    s_lshl_b32 s46, s46, 3
    s_add_u32 s45, s45, s46
    v_writelane_b32 v31, s45, 1
    s_cmp_eq_u32 s40, 0
    s_cselect_b32 s45, s45, 1073741824
    v_mov_b32 v0, s45
    s_add_u32 s44, s44, 16384
    v_lshl_add_u32 v30, v28, 3, s44
    v_and_b32 v27, 24, v17
    v_lshl_add_u32 v30, v27, 6, v30
    s_lshl_b32 s44, s41, 2
    s_add_u32 s44, s44, s40
    s_mul_i32 s63, s44, 73728
    s_lshl_b32 s62, s44, 14
    s_mov_b32 s46, 0xffff0000
    v_mov_b32 v140, 0
    v_mov_b32 v141, 0
    v_mov_b32 v142, 0
    v_mov_b32 v143, 0
    v_lshlrev_b32 v25, 7, v19
    v_lshl_add_u32 v25, v18, 4, v25
    s_cmp_eq_u32 s40, 0
    s_cbranch_scc0 L_w0b
    s_waitcnt vmcnt(0)
L_w0b:
    s_waitcnt vmcnt(9)
    buffer_load_dwordx2 v[72:73], v71, s[32:35], 0 offen sc1
    v_lshlrev_b32 v112, 16, v96
    v_and_b32 v113, s46, v96
    v_lshlrev_b32 v114, 16, v97
    v_and_b32 v115, s46, v97
    v_lshlrev_b32 v116, 16, v98
    v_and_b32 v117, s46, v98
    v_lshlrev_b32 v118, 16, v99
    v_and_b32 v119, s46, v99
    v_lshlrev_b32 v120, 16, v100
    v_and_b32 v121, s46, v100
    v_lshlrev_b32 v122, 16, v101
    v_and_b32 v123, s46, v101
    v_lshlrev_b32 v124, 16, v102
    v_and_b32 v125, s46, v102
    v_lshlrev_b32 v126, 16, v103
    v_and_b32 v127, s46, v103
    v_lshlrev_b32 v128, 16, v104
    v_and_b32 v129, s46, v104
    v_lshlrev_b32 v130, 16, v105
    v_and_b32 v131, s46, v105
    v_lshlrev_b32 v132, 16, v106
    v_and_b32 v133, s46, v106
    v_lshlrev_b32 v134, 16, v107
    v_and_b32 v135, s46, v107
    v_pk_add_f32 v[144:145], v[112:113], v[114:115]
    v_pk_add_f32 v[146:147], v[116:117], v[118:119]
    v_pk_add_f32 v[148:149], v[120:121], v[122:123]
    v_pk_add_f32 v[150:151], v[124:125], v[126:127]
    v_pk_add_f32 v[152:153], v[128:129], v[130:131]
    v_pk_add_f32 v[154:155], v[132:133], v[134:135]
    v_pk_add_f32 v[144:145], v[144:145], v[146:147]
    v_pk_add_f32 v[148:149], v[148:149], v[150:151]
    v_pk_add_f32 v[152:153], v[152:153], v[154:155]
    v_pk_add_f32 v[144:145], v[144:145], v[148:149]
    s_mov_b64 exec, s[50:51]
    v_pk_add_f32 v[140:141], v[144:145], v[152:153]
    s_mov_b64 exec, -1
    v_add_f32 v140, v140, v141
    s_nop 1
    v_add_f32_dpp v140, v140, v140 quad_perm:[1,0,3,2] row_mask:0xf bank_mask:0xf
    s_nop 1
    v_add_f32_dpp v140, v140, v140 quad_perm:[2,3,0,1] row_mask:0xf bank_mask:0xf
    s_nop 1
    v_add_f32_dpp v140, v140, v140 row_half_mirror row_mask:0xf bank_mask:0xf
    s_nop 1
    v_add_f32_dpp v140, v140, v140 row_mirror row_mask:0xf bank_mask:0xf
    v_mov_b32 v141, v140
    s_nop 1
    v_permlane16_swap_b32 v140, v141
    v_add_f32 v140, v140, v141
    v_mul_f32 v140, 0xbae38e39, v140
    v_pk_add_f32 v[168:169], v[112:113], v[140:141] op_sel_hi:[1,0]
    v_pk_add_f32 v[170:171], v[114:115], v[140:141] op_sel_hi:[1,0]
    v_pk_add_f32 v[172:173], v[116:117], v[140:141] op_sel_hi:[1,0]
    v_pk_add_f32 v[174:175], v[118:119], v[140:141] op_sel_hi:[1,0]
    v_pk_add_f32 v[176:177], v[120:121], v[140:141] op_sel_hi:[1,0]
    v_pk_add_f32 v[178:179], v[122:123], v[140:141] op_sel_hi:[1,0]
    v_pk_add_f32 v[180:181], v[124:125], v[140:141] op_sel_hi:[1,0]
    v_pk_add_f32 v[182:183], v[126:127], v[140:141] op_sel_hi:[1,0]
    v_pk_add_f32 v[184:185], v[128:129], v[140:141] op_sel_hi:[1,0]
    v_pk_add_f32 v[186:187], v[130:131], v[140:141] op_sel_hi:[1,0]
    v_pk_add_f32 v[188:189], v[132:133], v[140:141] op_sel_hi:[1,0]
    v_pk_add_f32 v[190:191], v[134:135], v[140:141] op_sel_hi:[1,0]
    v_cvt_pk_bf16_f32 v140, v140, v140
    v_pk_mul_f32 v[144:145], v[168:169], v[168:169]
    v_pk_mul_f32 v[146:147], v[170:171], v[170:171]
    v_and_b32 v140, s46, v140
    v_pk_fma_f32 v[144:145], v[172:173], v[172:173], v[144:145]
    v_pk_fma_f32 v[146:147], v[174:175], v[174:175], v[146:147]
    v_pk_fma_f32 v[144:145], v[176:177], v[176:177], v[144:145]
    v_pk_fma_f32 v[146:147], v[178:179], v[178:179], v[146:147]
    v_pk_fma_f32 v[144:145], v[180:181], v[180:181], v[144:145]
    v_pk_fma_f32 v[146:147], v[182:183], v[182:183], v[146:147]
    v_pk_fma_f32 v[144:145], v[184:185], v[184:185], v[144:145]
    v_pk_fma_f32 v[146:147], v[186:187], v[186:187], v[146:147]
    v_pk_fma_f32 v[144:145], v[188:189], v[188:189], v[144:145]
    v_pk_fma_f32 v[146:147], v[190:191], v[190:191], v[146:147]
    s_mov_b64 exec, s[50:51]
    v_pk_add_f32 v[142:143], v[144:145], v[146:147]
    s_mov_b64 exec, -1
    v_add_f32 v142, v142, v143
    v_pk_add_f32 v[112:113], v[112:113], v[140:141] op_sel_hi:[1,0]
    v_pk_add_f32 v[114:115], v[114:115], v[140:141] op_sel_hi:[1,0]
    v_add_f32_dpp v142, v142, v142 quad_perm:[1,0,3,2] row_mask:0xf bank_mask:0xf
    v_pk_add_f32 v[116:117], v[116:117], v[140:141] op_sel_hi:[1,0]
    v_pk_add_f32 v[118:119], v[118:119], v[140:141] op_sel_hi:[1,0]
    v_add_f32_dpp v142, v142, v142 quad_perm:[2,3,0,1] row_mask:0xf bank_mask:0xf
    v_pk_add_f32 v[120:121], v[120:121], v[140:141] op_sel_hi:[1,0]
    v_pk_add_f32 v[122:123], v[122:123], v[140:141] op_sel_hi:[1,0]
    v_add_f32_dpp v142, v142, v142 row_half_mirror row_mask:0xf bank_mask:0xf
    v_pk_add_f32 v[124:125], v[124:125], v[140:141] op_sel_hi:[1,0]
    v_pk_add_f32 v[126:127], v[126:127], v[140:141] op_sel_hi:[1,0]
    v_add_f32_dpp v142, v142, v142 row_mirror row_mask:0xf bank_mask:0xf
    v_pk_add_f32 v[128:129], v[128:129], v[140:141] op_sel_hi:[1,0]
    v_pk_add_f32 v[130:131], v[130:131], v[140:141] op_sel_hi:[1,0]
    v_mov_b32 v143, v142
    v_pk_add_f32 v[132:133], v[132:133], v[140:141] op_sel_hi:[1,0]
    v_pk_add_f32 v[134:135], v[134:135], v[140:141] op_sel_hi:[1,0]
    v_permlane16_swap_b32 v142, v143
    v_cvt_pk_bf16_f32 v113, v112, v113
    v_cvt_pk_bf16_f32 v115, v114, v115
    v_add_f32 v142, v142, v143
    v_cvt_pk_bf16_f32 v117, v116, v117
    v_cvt_pk_bf16_f32 v119, v118, v119
    v_mul_f32 v142, 0x3ae38e39, v142
    v_cvt_pk_bf16_f32 v121, v120, v121
    v_cvt_pk_bf16_f32 v123, v122, v123
    v_cvt_pk_bf16_f32 v142, v142, v142
    v_cvt_pk_bf16_f32 v125, v124, v125
    v_cvt_pk_bf16_f32 v127, v126, v127
    v_and_b32 v142, s46, v142
    v_cvt_pk_bf16_f32 v129, v128, v129
    v_cvt_pk_bf16_f32 v131, v130, v131
    v_add_f32 v142, 0x3727c5ac, v142
    v_cvt_pk_bf16_f32 v133, v132, v133
    v_cvt_pk_bf16_f32 v135, v134, v135
    v_cvt_pk_bf16_f32 v142, v142, v142
    v_lshlrev_b32 v112, 16, v113
    v_and_b32 v113, s46, v113
    v_and_b32 v142, s46, v142
    v_lshlrev_b32 v114, 16, v115
    v_and_b32 v115, s46, v115
    v_sqrt_f32 v142, v142
    v_lshlrev_b32 v116, 16, v117
    v_and_b32 v117, s46, v117
    v_cvt_pk_bf16_f32 v142, v142, v142
    v_lshlrev_b32 v118, 16, v119
    v_and_b32 v119, s46, v119
    v_and_b32 v142, s46, v142
    v_lshlrev_b32 v120, 16, v121
    v_and_b32 v121, s46, v121
    v_rcp_f32 v143, v142
    v_lshlrev_b32 v122, 16, v123
    v_and_b32 v123, s46, v123
    v_fma_f32 v144, -v142, v143, 1.0
    v_lshlrev_b32 v124, 16, v125
    v_and_b32 v125, s46, v125
    v_fma_f32 v142, v144, v143, v143
    v_lshlrev_b32 v126, 16, v127
    v_and_b32 v127, s46, v127
    v_lshlrev_b32 v128, 16, v129
    v_and_b32 v129, s46, v129
    v_lshlrev_b32 v130, 16, v131
    v_and_b32 v131, s46, v131
    v_lshlrev_b32 v132, 16, v133
    v_and_b32 v133, s46, v133
    v_lshlrev_b32 v134, 16, v135
    v_and_b32 v135, s46, v135
    v_pk_mul_f32 v[112:113], v[112:113], v[142:143] op_sel_hi:[1,0]
    v_pk_mul_f32 v[114:115], v[114:115], v[142:143] op_sel_hi:[1,0]
    v_pk_mul_f32 v[116:117], v[116:117], v[142:143] op_sel_hi:[1,0]
    v_pk_mul_f32 v[118:119], v[118:119], v[142:143] op_sel_hi:[1,0]
    v_pk_mul_f32 v[120:121], v[120:121], v[142:143] op_sel_hi:[1,0]
    v_pk_mul_f32 v[122:123], v[122:123], v[142:143] op_sel_hi:[1,0]
    v_pk_mul_f32 v[124:125], v[124:125], v[142:143] op_sel_hi:[1,0]
    v_pk_mul_f32 v[126:127], v[126:127], v[142:143] op_sel_hi:[1,0]
    v_pk_mul_f32 v[128:129], v[128:129], v[142:143] op_sel_hi:[1,0]
    v_pk_mul_f32 v[130:131], v[130:131], v[142:143] op_sel_hi:[1,0]
    v_pk_mul_f32 v[132:133], v[132:133], v[142:143] op_sel_hi:[1,0]
    v_pk_mul_f32 v[134:135], v[134:135], v[142:143] op_sel_hi:[1,0]
    v_cvt_pk_bf16_f32 v96, v112, v113
    v_cvt_pk_bf16_f32 v97, v114, v115
    v_cvt_pk_bf16_f32 v98, v116, v117
    v_cvt_pk_bf16_f32 v99, v118, v119
    v_cvt_pk_bf16_f32 v100, v120, v121
    v_cvt_pk_bf16_f32 v101, v122, v123
    v_cvt_pk_bf16_f32 v102, v124, v125
    v_cvt_pk_bf16_f32 v103, v126, v127
    v_cvt_pk_bf16_f32 v104, v128, v129
    v_cvt_pk_bf16_f32 v105, v130, v131
    v_cvt_pk_bf16_f32 v106, v132, v133
    v_cvt_pk_bf16_f32 v107, v134, v135
    s_mov_b64 exec, s[50:51]
    ds_write_b128 v25, v[96:99] offset:0
    ds_write_b128 v25, v[100:103] offset:3072
    ds_write_b128 v25, v[104:107] offset:6144
    s_mov_b64 exec, -1
    s_waitcnt lgkmcnt(0)
    s_barrier
    s_cmp_lg_u32 s40, 0
    s_cbranch_scc1 L_noxs
    ds_read_b128 v[96:99], v1 offset:0
    ds_read_b128 v[100:103], v1 offset:1024
    ds_read_b128 v[104:107], v1 offset:2048
    ds_read_b128 v[108:111], v1 offset:3072
    ds_read_b128 v[112:115], v1 offset:4096
    ds_read_b128 v[116:119], v1 offset:5120
    ds_read_b128 v[120:123], v1 offset:6144
    ds_read_b128 v[124:127], v1 offset:7168
    ds_read_b128 v[128:131], v1 offset:8192
    s_waitcnt lgkmcnt(8)
    buffer_store_dwordx4 v[96:99], v26, s[28:31], s58 offen sc1
    s_add_u32 s58, s58, 8192
    s_waitcnt lgkmcnt(7)
    buffer_store_dwordx4 v[100:103], v26, s[28:31], s58 offen sc1
    s_add_u32 s58, s58, 8192
    s_waitcnt lgkmcnt(6)
    buffer_store_dwordx4 v[104:107], v26, s[28:31], s58 offen sc1
    s_add_u32 s58, s58, 8192
    s_waitcnt lgkmcnt(5)
    buffer_store_dwordx4 v[108:111], v26, s[28:31], s58 offen sc1
    s_add_u32 s58, s58, 8192
    s_waitcnt lgkmcnt(4)
    buffer_store_dwordx4 v[112:115], v26, s[28:31], s58 offen sc1
    s_add_u32 s58, s58, 8192
    s_waitcnt lgkmcnt(3)
    buffer_store_dwordx4 v[116:119], v26, s[28:31], s58 offen sc1
    s_add_u32 s58, s58, 8192
    s_waitcnt lgkmcnt(2)
    buffer_store_dwordx4 v[120:123], v26, s[28:31], s58 offen sc1
    s_add_u32 s58, s58, 8192
    s_waitcnt lgkmcnt(1)
    buffer_store_dwordx4 v[124:127], v26, s[28:31], s58 offen sc1
    s_add_u32 s58, s58, 8192
    s_waitcnt lgkmcnt(0)
    buffer_store_dwordx4 v[128:131], v26, s[28:31], s58 offen sc1
    s_waitcnt vmcnt(0)
    s_mov_b32 s75, 0x40000
L_eppolla:
    v_readfirstlane_b32 s74, v72
    v_readfirstlane_b32 s68, v73
    s_cmp_lg_u32 s74, 0
    s_cbranch_scc1 L_epoka
    buffer_load_dwordx2 v[72:73], v71, s[32:35], 0 offen sc1
    s_waitcnt vmcnt(0)
    s_sub_u32 s75, s75, 1
    s_cmp_lg_u32 s75, 0
    s_cbranch_scc1 L_eppolla
L_epoka:
    s_add_u32 s44, s69, s74
    s_add_u32 s79, s74, 1
    v_add_u32_e64 v32, s44, 1
    v_mov_b32 v33, v73
    buffer_store_dwordx2 v[32:33], v31, s[28:31], s73 offen sc1
    s_branch L_xready
L_noxs:
    s_add_u32 m0, s59, 81920
    s_add_u32 s45, s43, 786432
    buffer_load_dwordx4 v3, s[16:19], s45 offen nt lds
    s_add_u32 m0, s59, 82944
    s_add_u32 s44, s43, 819200
    buffer_load_dwordx4 v3, s[16:19], s44 offen nt lds
    s_add_u32 m0, s59, 83968
    s_add_u32 s45, s43, 851968
    buffer_load_dwordx4 v3, s[16:19], s45 offen nt lds
    s_add_u32 m0, s59, 84992
    s_add_u32 s44, s43, 884736
    buffer_load_dwordx4 v3, s[16:19], s44 offen nt lds
    s_add_u32 m0, s59, 86016
    s_add_u32 s45, s43, 917504
    buffer_load_dwordx4 v3, s[16:19], s45 offen nt lds
    s_add_u32 m0, s59, 87040
    s_add_u32 s44, s43, 950272
    buffer_load_dwordx4 v3, s[16:19], s44 offen nt lds
    s_add_u32 m0, s59, 88064
    s_add_u32 s45, s43, 983040
    buffer_load_dwordx4 v3, s[16:19], s45 offen nt lds
    s_add_u32 m0, s59, 89088
    s_add_u32 s44, s43, 1015808
    buffer_load_dwordx4 v3, s[16:19], s44 offen nt lds
    s_add_u32 m0, s59, 40960
    s_add_u32 s45, s43, 1572864
    buffer_load_dwordx4 v3, s[16:19], s45 offen nt lds
    s_add_u32 m0, s59, 41984
    s_add_u32 s44, s43, 1605632
    buffer_load_dwordx4 v3, s[16:19], s44 offen nt lds
    s_add_u32 m0, s59, 43008
    s_add_u32 s45, s43, 1638400
    buffer_load_dwordx4 v3, s[16:19], s45 offen nt lds
    s_add_u32 m0, s59, 44032
    s_add_u32 s44, s43, 1671168
    buffer_load_dwordx4 v3, s[16:19], s44 offen nt lds
    s_add_u32 m0, s59, 45056
    s_add_u32 s45, s43, 1703936
    buffer_load_dwordx4 v3, s[16:19], s45 offen nt lds
    s_add_u32 m0, s59, 46080
    s_add_u32 s44, s43, 1736704
    buffer_load_dwordx4 v3, s[16:19], s44 offen nt lds
    s_add_u32 m0, s59, 47104
    s_add_u32 s45, s43, 1769472
    buffer_load_dwordx4 v3, s[16:19], s45 offen nt lds
    s_add_u32 m0, s59, 48128
    s_add_u32 s44, s43, 1802240
    buffer_load_dwordx4 v3, s[16:19], s44 offen nt lds
    s_mov_b64 exec, 0
    s_cmp_eq_u32 s40, 1
    s_cbranch_scc1 L_pad0
    s_cmp_eq_u32 s40, 2
    s_cbranch_scc1 L_pad1
    s_branch L_pad2
L_padend:
    s_mov_b64 exec, -1
    s_branch L_xready
.p2align 12
L_xready:
    v_lshrrev_b32 v18, 2, v17
    v_and_b32 v19, 3, v17
    v_and_b32 v21, 3, v18
    s_lshl_b32 s49, s40, 10
    v_lshl_add_u32 v23, v20, 3, v21
    v_lshlrev_b32 v24, 8, v23
    v_lshl_add_u32 v24, v19, 4, v24
    v_add_u32 v24, 40960, v24
    v_xor_b32 v25, 0, v21
    v_lshl_add_u32 v88, v25, 6, v24
    v_add_u32 v92, 65536, v88
    v_xor_b32 v25, 1, v21
    v_lshl_add_u32 v89, v25, 6, v24
    v_add_u32 v93, 65536, v89
    v_xor_b32 v25, 2, v21
    v_lshl_add_u32 v90, v25, 6, v24
    v_add_u32 v94, 65536, v90
    v_xor_b32 v25, 3, v21
    v_lshl_add_u32 v91, v25, 6, v24
    v_add_u32 v95, 65536, v91
    v_lshlrev_b32 v23, 6, v23
    v_and_b32 v24, 1, v20
    v_lshlrev_b32 v24, 5, v24
    v_lshl_add_u32 v25, v19, 3, v23
    v_add_u32 v4, v25, v24
    v_add_u32 v4, 40960, v4
    v_xor_b32 v5, 32, v4
    v_add_u32 v6, 65536, v4
    v_add_u32 v7, 65536, v5
    s_and_b32 s46, s42, 1
    s_lshl_b32 s44, s46, 5
    v_xor_b32 v8, s44, v4
    v_add_u32 v9, 65536, v8
    v_lshrrev_b32 v23, 5, v17
    v_lshlrev_b32 v23, 1, v23
    v_xor_b32 v23, v23, v19
    v_mul_u32_u24 v24, 9216, v18
    v_lshl_add_u32 v2, v23, 4, v24
    v_mov_b32 v12, 0xc0135761
    v_mov_b32 v13, 0xbdd2d3e8
    s_mul_i32 s53, s40, 3072
    s_mul_i32 s55, s40, 442368
    s_mul_i32 s57, s42, 288
    s_add_u32 s57, s57, s44
    s_add_u32 s54, s55, s57
    s_lshr_b32 s44, s42, 1
    s_lshl_b32 s44, s44, 19
    s_add_u32 s20, s64, s44
    s_addc_u32 s21, s65, 0
    s_mov_b32 s22, 524288
    s_mov_b32 s23, 0x20000
    s_add_u32 s24, s66, s44
    s_addc_u32 s25, s67, 0
    s_mov_b32 s26, 524288
    s_mov_b32 s27, 0x20000
    s_lshr_b32 s44, s42, 1
    s_mul_i32 s47, s44, 576
    s_add_u32 s47, s47, 256
    s_add_u32 s55, s55, s47
    s_lshr_b32 s44, s47, 6
    s_add_u32 s44, s44, 0
    s_lshr_b32 s45, s44, 2
    s_lshl_b32 s45, s45, 19
    s_and_b32 s44, s44, 3
    s_lshl_b32 s44, s44, 10
    s_add_u32 s60, s44, s45
    s_add_u32 s60, s60, s62
    s_lshl_b32 s44, s46, 3
    s_add_u32 s60, s60, s44
    s_lshr_b32 s44, s57, 6
    s_add_u32 s44, s44, 0
    s_lshr_b32 s45, s44, 2
    s_lshl_b32 s45, s45, 19
    s_and_b32 s44, s44, 3
    s_lshl_b32 s44, s44, 10
    s_add_u32 s4, s44, s45
    s_add_u32 s4, s4, s62
    s_lshr_b32 s44, s57, 6
    s_add_u32 s44, s44, 1
    s_lshr_b32 s45, s44, 2
    s_lshl_b32 s45, s45, 19
    s_and_b32 s44, s44, 3
    s_lshl_b32 s44, s44, 10
    s_add_u32 s5, s44, s45
    s_add_u32 s5, s5, s62
    s_lshr_b32 s44, s57, 6
    s_add_u32 s44, s44, 2
    s_lshr_b32 s45, s44, 2
    s_lshl_b32 s45, s45, 19
    s_and_b32 s44, s44, 3
    s_lshl_b32 s44, s44, 10
    s_add_u32 s6, s44, s45
    s_add_u32 s6, s6, s62
    s_lshr_b32 s44, s57, 6
    s_add_u32 s44, s44, 3
    s_lshr_b32 s45, s44, 2
    s_lshl_b32 s45, s45, 19
    s_and_b32 s44, s44, 3
    s_lshl_b32 s44, s44, 10
    s_add_u32 s7, s44, s45
    s_add_u32 s7, s7, s62
    s_lshl_b32 s44, s42, 19
    s_add_u32 s62, s62, s44
    s_mov_b32 s61, 0x3c800000
    s_lshl_b32 s44, s40, 2
    v_add_u32 v23, s44, v20
    v_xor_b32 v24, v22, v23
    v_lshlrev_b32 v24, 4, v24
    v_lshl_add_u32 v14, v23, 8, v24
    v_and_b32 v24, 7, v23
    v_lshlrev_b32 v24, 1, v24
    v_xor_b32 v24, v22, v24
    v_lshlrev_b32 v24, 4, v24
    v_lshl_add_u32 v15, v23, 8, v24
    v_add_u32 v23, 8, v20
    v_xor_b32 v23, v23, v22
    v_lshlrev_b32 v23, 4, v23
    v_lshl_add_u32 v78, v22, 8, v23
    v_add_u32 v23, 12, v20
    v_xor_b32 v23, v23, v22
    v_lshlrev_b32 v23, 4, v23
    v_lshl_add_u32 v79, v22, 8, v23
    v_and_b32 v24, 7, v18
    v_lshlrev_b32 v25, 8, v18
    v_lshl_add_u32 v25, v19, 3, v25
    v_add_u32 v25, 0x10000, v25
    v_xor_b32 v23, 0, v24
    v_lshl_add_u32 v80, v23, 5, v25
    v_xor_b32 v23, 1, v24
    v_lshl_add_u32 v81, v23, 5, v25
    v_xor_b32 v23, 2, v24
    v_lshl_add_u32 v82, v23, 5, v25
    v_xor_b32 v23, 3, v24
    v_lshl_add_u32 v83, v23, 5, v25
    v_xor_b32 v23, 4, v24
    v_lshl_add_u32 v84, v23, 5, v25
    v_xor_b32 v23, 5, v24
    v_lshl_add_u32 v85, v23, 5, v25
    v_xor_b32 v23, 6, v24
    v_lshl_add_u32 v86, v23, 5, v25
    v_xor_b32 v23, 7, v24
    v_lshl_add_u32 v87, v23, 5, v25
    s_lshl_b32 s44, s40, 14
    s_cmp_eq_u32 s40, 2
    s_cselect_b32 s44, 0x10000, s44
    s_add_u32 s45, s44, 8192
    s_cmp_eq_u32 s40, 3
    s_cselect_b32 s44, 0x8000, s44
    s_cselect_b32 s45, 155648, s45
    v_add_u32 v10, s44, v1
    v_add_u32 v11, s45, v1
    s_cmp_lg_u32 s40, 0
    s_cbranch_scc1 L_xgo
    s_mov_b32 s75, 0x40000
L_xpoll:
    buffer_load_dwordx2 v[34:35], v30, s[28:31], s73 offen sc1
    s_waitcnt vmcnt(0)
    v_and_b32 v34, 0xffffff87, v34
    v_xor_b32 v35, s68, v35
    v_subrev_u32 v34, s79, v34
    v_min_u32 v35, 1, v35
    v_lshl_or_b32 v34, v35, 8, v34
    v_cmp_le_u32 vcc, 7, v34
    s_cbranch_vccz L_xgo
    s_sub_u32 s75, s75, 1
    s_cmp_lg_u32 s75, 0
    s_cbranch_scc1 L_xpoll
L_xgo:
    s_barrier
    s_add_u32 s58, s63, 0
    buffer_load_dwordx4 a[0:3], v1, s[28:31], s58 offen offset:0 sc1
    buffer_load_dwordx4 a[4:7], v1, s[28:31], s58 offen offset:1024 sc1
    buffer_load_dwordx4 a[8:11], v1, s[28:31], s58 offen offset:2048 sc1
    buffer_load_dwordx4 a[12:15], v1, s[28:31], s58 offen offset:3072 sc1
    s_add_u32 s58, s63, 4096
    buffer_load_dwordx4 a[16:19], v1, s[28:31], s58 offen offset:0 sc1
    buffer_load_dwordx4 a[20:23], v1, s[28:31], s58 offen offset:1024 sc1
    buffer_load_dwordx4 a[24:27], v1, s[28:31], s58 offen offset:2048 sc1
    buffer_load_dwordx4 a[28:31], v1, s[28:31], s58 offen offset:3072 sc1
    s_add_u32 s58, s63, 8192
    buffer_load_dwordx4 a[32:35], v1, s[28:31], s58 offen offset:0 sc1
    buffer_load_dwordx4 a[36:39], v1, s[28:31], s58 offen offset:1024 sc1
    buffer_load_dwordx4 a[40:43], v1, s[28:31], s58 offen offset:2048 sc1
    buffer_load_dwordx4 a[44:47], v1, s[28:31], s58 offen offset:3072 sc1
    s_add_u32 s58, s63, 12288
    buffer_load_dwordx4 a[48:51], v1, s[28:31], s58 offen offset:0 sc1
    buffer_load_dwordx4 a[52:55], v1, s[28:31], s58 offen offset:1024 sc1
    buffer_load_dwordx4 a[56:59], v1, s[28:31], s58 offen offset:2048 sc1
    buffer_load_dwordx4 a[60:63], v1, s[28:31], s58 offen offset:3072 sc1
    s_add_u32 s58, s63, 16384
    buffer_load_dwordx4 a[64:67], v1, s[28:31], s58 offen offset:0 sc1
    buffer_load_dwordx4 a[68:71], v1, s[28:31], s58 offen offset:1024 sc1
    buffer_load_dwordx4 a[72:75], v1, s[28:31], s58 offen offset:2048 sc1
    buffer_load_dwordx4 a[76:79], v1, s[28:31], s58 offen offset:3072 sc1
    s_add_u32 s58, s63, 20480
    buffer_load_dwordx4 a[80:83], v1, s[28:31], s58 offen offset:0 sc1
    buffer_load_dwordx4 a[84:87], v1, s[28:31], s58 offen offset:1024 sc1
    buffer_load_dwordx4 a[88:91], v1, s[28:31], s58 offen offset:2048 sc1
    buffer_load_dwordx4 a[92:95], v1, s[28:31], s58 offen offset:3072 sc1
    s_waitcnt vmcnt(12)
    s_barrier
    ds_read_b64_tr_b16 v[16:17], v92 offset:24576
    ds_read_b64_tr_b16 v[18:19], v92 offset:25600
    ds_read_b64_tr_b16 v[20:21], v92 offset:32768
    ds_read_b64_tr_b16 v[22:23], v92 offset:33792
    ds_read_b64_tr_b16 v[24:25], v92 offset:40960
    ds_read_b64_tr_b16 v[26:27], v92 offset:41984
    ds_read_b64_tr_b16 v[28:29], v92 offset:24584
    ds_read_b64_tr_b16 v[30:31], v92 offset:25608
    ds_read_b64_tr_b16 v[32:33], v92 offset:32776
    ds_read_b64_tr_b16 v[34:35], v92 offset:33800
    ds_read_b64_tr_b16 v[36:37], v92 offset:40968
    ds_read_b64_tr_b16 v[38:39], v92 offset:41992
    s_mov_b32 s75, 0x40000
L_eppollb:
    v_readfirstlane_b32 s74, v72
    v_readfirstlane_b32 s68, v73
    s_cmp_lg_u32 s74, 0
    s_cbranch_scc1 L_epokb
    buffer_load_dwordx2 v[72:73], v71, s[32:35], 0 offen sc1
    s_waitcnt vmcnt(0)
    s_sub_u32 s75, s75, 1
    s_cmp_lg_u32 s75, 0
    s_cbranch_scc1 L_eppollb
L_epokb:
    s_add_u32 s69, s69, s74
    s_waitcnt lgkmcnt(6)
    v_mfma_f32_16x16x32_bf16 v[96:99], v[16:19], a[0:3], 0
    s_add_u32 s58, s63, 24576
    ds_read_b64_tr_b16 v[40:41], v93 offset:24576
    v_mfma_f32_16x16x32_bf16 v[96:99], v[20:23], a[16:19], v[96:99]
    buffer_load_dwordx4 a[96:99], v1, s[28:31], s58 offen offset:0 sc1
    v_mfma_f32_16x16x32_bf16 v[96:99], v[24:27], a[32:35], v[96:99]
    ds_read_b64_tr_b16 v[42:43], v93 offset:25600
    v_mfma_f32_16x16x32_bf16 v[100:103], v[24:27], a[36:39], 0
    v_mfma_f32_16x16x32_bf16 v[100:103], v[20:23], a[20:23], v[100:103]
    ds_read_b64_tr_b16 v[44:45], v93 offset:32768
    v_mfma_f32_16x16x32_bf16 v[100:103], v[16:19], a[4:7], v[100:103]
    buffer_load_dwordx4 a[100:103], v1, s[28:31], s58 offen offset:1024 sc1
    v_mfma_f32_16x16x32_bf16 v[104:107], v[16:19], a[8:11], 0
    ds_read_b64_tr_b16 v[46:47], v93 offset:33792
    v_mfma_f32_16x16x32_bf16 v[104:107], v[20:23], a[24:27], v[104:107]
    v_mfma_f32_16x16x32_bf16 v[104:107], v[24:27], a[40:43], v[104:107]
    ds_read_b64_tr_b16 v[48:49], v93 offset:40960
    v_mfma_f32_16x16x32_bf16 v[108:111], v[24:27], a[44:47], 0
    buffer_load_dwordx4 a[104:107], v1, s[28:31], s58 offen offset:2048 sc1
    v_mfma_f32_16x16x32_bf16 v[108:111], v[20:23], a[28:31], v[108:111]
    ds_read_b64_tr_b16 v[50:51], v93 offset:41984
    v_mfma_f32_16x16x32_bf16 v[108:111], v[16:19], a[12:15], v[108:111]
    s_waitcnt lgkmcnt(6)
    v_mfma_f32_16x16x32_bf16 v[124:127], v[28:31], a[12:15], 0
    ds_read_b64_tr_b16 v[16:17], v93 offset:24584
    v_mfma_f32_16x16x32_bf16 v[124:127], v[32:35], a[28:31], v[124:127]
    buffer_load_dwordx4 a[108:111], v1, s[28:31], s58 offen offset:3072 sc1
    v_mfma_f32_16x16x32_bf16 v[124:127], v[36:39], a[44:47], v[124:127]
    ds_read_b64_tr_b16 v[18:19], v93 offset:25608
    v_mfma_f32_16x16x32_bf16 v[120:123], v[36:39], a[40:43], 0
    v_mfma_f32_16x16x32_bf16 v[120:123], v[32:35], a[24:27], v[120:123]
    s_add_u32 s58, s63, 28672
    ds_read_b64_tr_b16 v[20:21], v93 offset:32776
    v_mfma_f32_16x16x32_bf16 v[120:123], v[28:31], a[8:11], v[120:123]
    buffer_load_dwordx4 a[112:115], v1, s[28:31], s58 offen offset:0 sc1
    v_mfma_f32_16x16x32_bf16 v[116:119], v[28:31], a[4:7], 0
    ds_read_b64_tr_b16 v[22:23], v93 offset:33800
    v_mfma_f32_16x16x32_bf16 v[116:119], v[32:35], a[20:23], v[116:119]
    v_mfma_f32_16x16x32_bf16 v[116:119], v[36:39], a[36:39], v[116:119]
    ds_read_b64_tr_b16 v[24:25], v93 offset:40968
    v_mfma_f32_16x16x32_bf16 v[112:115], v[36:39], a[32:35], 0
    buffer_load_dwordx4 a[116:119], v1, s[28:31], s58 offen offset:1024 sc1
    v_mfma_f32_16x16x32_bf16 v[112:115], v[32:35], a[16:19], v[112:115]
    ds_read_b64_tr_b16 v[26:27], v93 offset:41992
    v_mfma_f32_16x16x32_bf16 v[112:115], v[28:31], a[0:3], v[112:115]
    s_waitcnt lgkmcnt(6)
    v_mfma_f32_16x16x32_bf16 v[128:131], v[40:43], a[0:3], 0
    ds_read_b64_tr_b16 v[28:29], v94 offset:24576
    v_mfma_f32_16x16x32_bf16 v[128:131], v[44:47], a[16:19], v[128:131]
    buffer_load_dwordx4 a[120:123], v1, s[28:31], s58 offen offset:2048 sc1
    v_mfma_f32_16x16x32_bf16 v[128:131], v[48:51], a[32:35], v[128:131]
    ds_read_b64_tr_b16 v[30:31], v94 offset:25600
    v_mfma_f32_16x16x32_bf16 v[132:135], v[48:51], a[36:39], 0
    v_mfma_f32_16x16x32_bf16 v[132:135], v[44:47], a[20:23], v[132:135]
    ds_read_b64_tr_b16 v[32:33], v94 offset:32768
    v_mfma_f32_16x16x32_bf16 v[132:135], v[40:43], a[4:7], v[132:135]
    buffer_load_dwordx4 a[124:127], v1, s[28:31], s58 offen offset:3072 sc1
    v_mfma_f32_16x16x32_bf16 v[136:139], v[40:43], a[8:11], 0
    ds_read_b64_tr_b16 v[34:35], v94 offset:33792
    v_mfma_f32_16x16x32_bf16 v[136:139], v[44:47], a[24:27], v[136:139]
    v_mfma_f32_16x16x32_bf16 v[136:139], v[48:51], a[40:43], v[136:139]
    ds_read_b64_tr_b16 v[36:37], v94 offset:40960
    v_mfma_f32_16x16x32_bf16 v[140:143], v[48:51], a[44:47], 0
    v_mfma_f32_16x16x32_bf16 v[140:143], v[44:47], a[28:31], v[140:143]
    s_add_u32 s58, s63, 32768
    ds_read_b64_tr_b16 v[38:39], v94 offset:41984
    v_mfma_f32_16x16x32_bf16 v[140:143], v[40:43], a[12:15], v[140:143]
    s_waitcnt lgkmcnt(6)
    buffer_load_dwordx4 a[128:131], v1, s[28:31], s58 offen offset:0 sc1
    v_mfma_f32_16x16x32_bf16 v[156:159], v[16:19], a[12:15], 0
    ds_read_b64_tr_b16 v[40:41], v94 offset:24584
    v_mfma_f32_16x16x32_bf16 v[156:159], v[20:23], a[28:31], v[156:159]
    v_mfma_f32_16x16x32_bf16 v[156:159], v[24:27], a[44:47], v[156:159]
    ds_read_b64_tr_b16 v[42:43], v94 offset:25608
    v_mfma_f32_16x16x32_bf16 v[152:155], v[24:27], a[40:43], 0
    buffer_load_dwordx4 a[132:135], v1, s[28:31], s58 offen offset:1024 sc1
    v_mfma_f32_16x16x32_bf16 v[152:155], v[20:23], a[24:27], v[152:155]
    ds_read_b64_tr_b16 v[44:45], v94 offset:32776
    v_mfma_f32_16x16x32_bf16 v[152:155], v[16:19], a[8:11], v[152:155]
    v_mfma_f32_16x16x32_bf16 v[148:151], v[16:19], a[4:7], 0
    ds_read_b64_tr_b16 v[46:47], v94 offset:33800
    v_mfma_f32_16x16x32_bf16 v[148:151], v[20:23], a[20:23], v[148:151]
    buffer_load_dwordx4 a[136:139], v1, s[28:31], s58 offen offset:2048 sc1
    v_mfma_f32_16x16x32_bf16 v[148:151], v[24:27], a[36:39], v[148:151]
    ds_read_b64_tr_b16 v[48:49], v94 offset:40968
    v_mfma_f32_16x16x32_bf16 v[144:147], v[24:27], a[32:35], 0
    v_mfma_f32_16x16x32_bf16 v[144:147], v[20:23], a[16:19], v[144:147]
    ds_read_b64_tr_b16 v[50:51], v94 offset:41992
    v_mfma_f32_16x16x32_bf16 v[144:147], v[16:19], a[0:3], v[144:147]
    s_waitcnt lgkmcnt(6)
    buffer_load_dwordx4 a[140:143], v1, s[28:31], s58 offen offset:3072 sc1
    v_mfma_f32_16x16x32_bf16 v[160:163], v[28:31], a[0:3], 0
    ds_read_b64_tr_b16 v[16:17], v95 offset:24576
    v_mfma_f32_16x16x32_bf16 v[160:163], v[32:35], a[16:19], v[160:163]
    s_add_u32 s45, s56, 2359296
    v_mfma_f32_16x16x32_bf16 v[160:163], v[36:39], a[32:35], v[160:163]
    s_add_u32 m0, s3, 106496
    ds_read_b64_tr_b16 v[18:19], v95 offset:25600
    v_mfma_f32_16x16x32_bf16 v[164:167], v[36:39], a[36:39], 0
    buffer_load_dwordx4 v3, s[16:19], s45 offen nt lds
    v_mfma_f32_16x16x32_bf16 v[164:167], v[32:35], a[20:23], v[164:167]
    ds_read_b64_tr_b16 v[20:21], v95 offset:32768
    v_mfma_f32_16x16x32_bf16 v[164:167], v[28:31], a[4:7], v[164:167]
    s_add_u32 s44, s56, 2392064
    v_mfma_f32_16x16x32_bf16 v[168:171], v[28:31], a[8:11], 0
    s_add_u32 m0, s3, 107520
    ds_read_b64_tr_b16 v[22:23], v95 offset:33792
    v_mfma_f32_16x16x32_bf16 v[168:171], v[32:35], a[24:27], v[168:171]
    buffer_load_dwordx4 v3, s[16:19], s44 offen nt lds
    v_mfma_f32_16x16x32_bf16 v[168:171], v[36:39], a[40:43], v[168:171]
    ds_read_b64_tr_b16 v[24:25], v95 offset:40960
    v_mfma_f32_16x16x32_bf16 v[172:175], v[36:39], a[44:47], 0
    s_add_u32 s45, s56, 2424832
    v_mfma_f32_16x16x32_bf16 v[172:175], v[32:35], a[28:31], v[172:175]
    s_add_u32 m0, s3, 108544
    ds_read_b64_tr_b16 v[26:27], v95 offset:41984
    v_mfma_f32_16x16x32_bf16 v[172:175], v[28:31], a[12:15], v[172:175]
    s_waitcnt lgkmcnt(6)
    buffer_load_dwordx4 v3, s[16:19], s45 offen nt lds
    v_mfma_f32_16x16x32_bf16 v[188:191], v[40:43], a[12:15], 0
    ds_read_b64_tr_b16 v[28:29], v95 offset:24584
    v_mfma_f32_16x16x32_bf16 v[188:191], v[44:47], a[28:31], v[188:191]
    v_mfma_f32_16x16x32_bf16 v[188:191], v[48:51], a[44:47], v[188:191]
    ds_read_b64_tr_b16 v[30:31], v95 offset:25608
    v_mfma_f32_16x16x32_bf16 v[184:187], v[48:51], a[40:43], 0
    s_add_u32 s44, s56, 2457600
    v_mfma_f32_16x16x32_bf16 v[184:187], v[44:47], a[24:27], v[184:187]
    s_add_u32 m0, s3, 109568
    ds_read_b64_tr_b16 v[32:33], v95 offset:32776
    v_mfma_f32_16x16x32_bf16 v[184:187], v[40:43], a[8:11], v[184:187]
    buffer_load_dwordx4 v3, s[16:19], s44 offen nt lds
    v_mfma_f32_16x16x32_bf16 v[180:183], v[40:43], a[4:7], 0
    ds_read_b64_tr_b16 v[34:35], v95 offset:33800
    v_mfma_f32_16x16x32_bf16 v[180:183], v[44:47], a[20:23], v[180:183]
    s_add_u32 s45, s56, 2490368
    v_mfma_f32_16x16x32_bf16 v[180:183], v[48:51], a[36:39], v[180:183]
    s_add_u32 m0, s3, 110592
    ds_read_b64_tr_b16 v[36:37], v95 offset:40968
    v_mfma_f32_16x16x32_bf16 v[176:179], v[48:51], a[32:35], 0
    buffer_load_dwordx4 v3, s[16:19], s45 offen nt lds
    v_mfma_f32_16x16x32_bf16 v[176:179], v[44:47], a[16:19], v[176:179]
    ds_read_b64_tr_b16 v[38:39], v95 offset:41992
    v_mfma_f32_16x16x32_bf16 v[176:179], v[40:43], a[0:3], v[176:179]
    s_waitcnt lgkmcnt(6)
    v_mfma_f32_16x16x32_bf16 v[192:195], v[16:19], a[0:3], 0
    s_add_u32 s44, s56, 2523136
    v_mfma_f32_16x16x32_bf16 v[192:195], v[20:23], a[16:19], v[192:195]
    s_add_u32 m0, s3, 111616
    v_mfma_f32_16x16x32_bf16 v[192:195], v[24:27], a[32:35], v[192:195]
    buffer_load_dwordx4 v3, s[16:19], s44 offen nt lds
    v_mfma_f32_16x16x32_bf16 v[196:199], v[24:27], a[36:39], 0
    v_mfma_f32_16x16x32_bf16 v[196:199], v[20:23], a[20:23], v[196:199]
    v_mfma_f32_16x16x32_bf16 v[196:199], v[16:19], a[4:7], v[196:199]
    v_mfma_f32_16x16x32_bf16 v[200:203], v[16:19], a[8:11], 0
    v_mfma_f32_16x16x32_bf16 v[200:203], v[20:23], a[24:27], v[200:203]
    v_mfma_f32_16x16x32_bf16 v[200:203], v[24:27], a[40:43], v[200:203]
    v_mfma_f32_16x16x32_bf16 v[204:207], v[24:27], a[44:47], 0
    v_mfma_f32_16x16x32_bf16 v[204:207], v[20:23], a[28:31], v[204:207]
    v_mfma_f32_16x16x32_bf16 v[204:207], v[16:19], a[12:15], v[204:207]
    s_waitcnt vmcnt(50) lgkmcnt(0)
    s_barrier
    v_mfma_f32_16x16x32_bf16 v[220:223], v[28:31], a[12:15], 0
    ds_read_b64_tr_b16 v[40:41], v88 offset:40960
    v_mfma_f32_16x16x32_bf16 v[220:223], v[32:35], a[28:31], v[220:223]
    ds_read_b64_tr_b16 v[42:43], v88 offset:41984
    v_mfma_f32_16x16x32_bf16 v[220:223], v[36:39], a[44:47], v[220:223]
    ds_read_b64_tr_b16 v[44:45], v88 offset:49152
    v_mfma_f32_16x16x32_bf16 v[216:219], v[36:39], a[40:43], 0
    ds_read_b64_tr_b16 v[46:47], v88 offset:50176
    v_mfma_f32_16x16x32_bf16 v[216:219], v[32:35], a[24:27], v[216:219]
    ds_read_b64_tr_b16 v[48:49], v88 offset:57344
    v_mfma_f32_16x16x32_bf16 v[216:219], v[28:31], a[8:11], v[216:219]
    ds_read_b64_tr_b16 v[50:51], v88 offset:58368
    v_mfma_f32_16x16x32_bf16 v[212:215], v[28:31], a[4:7], 0
    ds_read_b64_tr_b16 v[16:17], v88 offset:40968
    v_mfma_f32_16x16x32_bf16 v[212:215], v[32:35], a[20:23], v[212:215]
    ds_read_b64_tr_b16 v[18:19], v88 offset:41992
    v_mfma_f32_16x16x32_bf16 v[212:215], v[36:39], a[36:39], v[212:215]
    ds_read_b64_tr_b16 v[20:21], v88 offset:49160
    v_mfma_f32_16x16x32_bf16 v[208:211], v[36:39], a[32:35], 0
    ds_read_b64_tr_b16 v[22:23], v88 offset:50184
    v_mfma_f32_16x16x32_bf16 v[208:211], v[32:35], a[16:19], v[208:211]
    ds_read_b64_tr_b16 v[24:25], v88 offset:57352
    v_mfma_f32_16x16x32_bf16 v[208:211], v[28:31], a[0:3], v[208:211]
    s_waitcnt vmcnt(18) lgkmcnt(5)
    ds_read_b64_tr_b16 v[26:27], v88 offset:58376
    v_mfma_f32_16x16x32_bf16 v[96:99], v[40:43], a[48:51], v[96:99]
    ds_read_b64_tr_b16 v[28:29], v89 offset:40960
    v_mfma_f32_16x16x32_bf16 v[96:99], v[44:47], a[64:67], v[96:99]
    v_mfma_f32_16x16x32_bf16 v[96:99], v[48:51], a[80:83], v[96:99]
    s_add_u32 s58, s63, 36864
    ds_read_b64_tr_b16 v[30:31], v89 offset:41984
    v_mfma_f32_16x16x32_bf16 v[100:103], v[48:51], a[84:87], v[100:103]
    buffer_load_dwordx4 a[144:147], v1, s[28:31], s58 offen offset:0 sc1
    v_mfma_f32_16x16x32_bf16 v[100:103], v[44:47], a[68:71], v[100:103]
    ds_read_b64_tr_b16 v[32:33], v89 offset:49152
    v_mfma_f32_16x16x32_bf16 v[100:103], v[40:43], a[52:55], v[100:103]
    v_mfma_f32_16x16x32_bf16 v[104:107], v[40:43], a[56:59], v[104:107]
    ds_read_b64_tr_b16 v[34:35], v89 offset:50176
    v_mfma_f32_16x16x32_bf16 v[104:107], v[44:47], a[72:75], v[104:107]
    buffer_load_dwordx4 a[148:151], v1, s[28:31], s58 offen offset:1024 sc1
    v_mfma_f32_16x16x32_bf16 v[104:107], v[48:51], a[88:91], v[104:107]
    ds_read_b64_tr_b16 v[36:37], v89 offset:57344
    v_mfma_f32_16x16x32_bf16 v[108:111], v[48:51], a[92:95], v[108:111]
    v_mfma_f32_16x16x32_bf16 v[108:111], v[44:47], a[76:79], v[108:111]
    ds_read_b64_tr_b16 v[38:39], v89 offset:58368
    v_mfma_f32_16x16x32_bf16 v[108:111], v[40:43], a[60:63], v[108:111]
    s_waitcnt lgkmcnt(6)
    buffer_load_dwordx4 a[152:155], v1, s[28:31], s58 offen offset:2048 sc1
    v_mfma_f32_16x16x32_bf16 v[124:127], v[16:19], a[60:63], v[124:127]
    ds_read_b64_tr_b16 v[40:41], v89 offset:40968
    v_mfma_f32_16x16x32_bf16 v[124:127], v[20:23], a[76:79], v[124:127]
    v_mfma_f32_16x16x32_bf16 v[124:127], v[24:27], a[92:95], v[124:127]
    ds_read_b64_tr_b16 v[42:43], v89 offset:41992
    v_mfma_f32_16x16x32_bf16 v[120:123], v[24:27], a[88:91], v[120:123]
    buffer_load_dwordx4 a[156:159], v1, s[28:31], s58 offen offset:3072 sc1
    v_mfma_f32_16x16x32_bf16 v[120:123], v[20:23], a[72:75], v[120:123]
    ds_read_b64_tr_b16 v[44:45], v89 offset:49160
    v_mfma_f32_16x16x32_bf16 v[120:123], v[16:19], a[56:59], v[120:123]
    v_mfma_f32_16x16x32_bf16 v[116:119], v[16:19], a[52:55], v[116:119]
    s_add_u32 s58, s63, 40960
    ds_read_b64_tr_b16 v[46:47], v89 offset:50184
    v_mfma_f32_16x16x32_bf16 v[116:119], v[20:23], a[68:71], v[116:119]
    buffer_load_dwordx4 a[160:163], v1, s[28:31], s58 offen offset:0 sc1
    v_mfma_f32_16x16x32_bf16 v[116:119], v[24:27], a[84:87], v[116:119]
    ds_read_b64_tr_b16 v[48:49], v89 offset:57352
    v_mfma_f32_16x16x32_bf16 v[112:115], v[24:27], a[80:83], v[112:115]
    v_mfma_f32_16x16x32_bf16 v[112:115], v[20:23], a[64:67], v[112:115]
    ds_read_b64_tr_b16 v[50:51], v89 offset:58376
    v_mfma_f32_16x16x32_bf16 v[112:115], v[16:19], a[48:51], v[112:115]
    s_waitcnt lgkmcnt(6)
    buffer_load_dwordx4 a[164:167], v1, s[28:31], s58 offen offset:1024 sc1
    v_mfma_f32_16x16x32_bf16 v[128:131], v[28:31], a[48:51], v[128:131]
    ds_read_b64_tr_b16 v[16:17], v90 offset:40960
    v_mfma_f32_16x16x32_bf16 v[128:131], v[32:35], a[64:67], v[128:131]
    v_mfma_f32_16x16x32_bf16 v[128:131], v[36:39], a[80:83], v[128:131]
    ds_read_b64_tr_b16 v[18:19], v90 offset:41984
    v_mfma_f32_16x16x32_bf16 v[132:135], v[36:39], a[84:87], v[132:135]
    buffer_load_dwordx4 a[168:171], v1, s[28:31], s58 offen offset:2048 sc1
    v_mfma_f32_16x16x32_bf16 v[132:135], v[32:35], a[68:71], v[132:135]
    ds_read_b64_tr_b16 v[20:21], v90 offset:49152
    v_mfma_f32_16x16x32_bf16 v[132:135], v[28:31], a[52:55], v[132:135]
    v_mfma_f32_16x16x32_bf16 v[136:139], v[28:31], a[56:59], v[136:139]
    ds_read_b64_tr_b16 v[22:23], v90 offset:50176
    v_mfma_f32_16x16x32_bf16 v[136:139], v[32:35], a[72:75], v[136:139]
    buffer_load_dwordx4 a[172:175], v1, s[28:31], s58 offen offset:3072 sc1
    v_mfma_f32_16x16x32_bf16 v[136:139], v[36:39], a[88:91], v[136:139]
    ds_read_b64_tr_b16 v[24:25], v90 offset:57344
    v_mfma_f32_16x16x32_bf16 v[140:143], v[36:39], a[92:95], v[140:143]
    v_mfma_f32_16x16x32_bf16 v[140:143], v[32:35], a[76:79], v[140:143]
    s_add_u32 s58, s63, 45056
    ds_read_b64_tr_b16 v[26:27], v90 offset:58368
    v_mfma_f32_16x16x32_bf16 v[140:143], v[28:31], a[60:63], v[140:143]
    s_waitcnt lgkmcnt(6)
    buffer_load_dwordx4 a[176:179], v1, s[28:31], s58 offen offset:0 sc1
    v_mfma_f32_16x16x32_bf16 v[156:159], v[40:43], a[60:63], v[156:159]
    ds_read_b64_tr_b16 v[28:29], v90 offset:40968
    v_mfma_f32_16x16x32_bf16 v[156:159], v[44:47], a[76:79], v[156:159]
    v_mfma_f32_16x16x32_bf16 v[156:159], v[48:51], a[92:95], v[156:159]
    ds_read_b64_tr_b16 v[30:31], v90 offset:41992
    v_mfma_f32_16x16x32_bf16 v[152:155], v[48:51], a[88:91], v[152:155]
    buffer_load_dwordx4 a[180:183], v1, s[28:31], s58 offen offset:1024 sc1
    v_mfma_f32_16x16x32_bf16 v[152:155], v[44:47], a[72:75], v[152:155]
    ds_read_b64_tr_b16 v[32:33], v90 offset:49160
    v_mfma_f32_16x16x32_bf16 v[152:155], v[40:43], a[56:59], v[152:155]
    v_mfma_f32_16x16x32_bf16 v[148:151], v[40:43], a[52:55], v[148:151]
    ds_read_b64_tr_b16 v[34:35], v90 offset:50184
    v_mfma_f32_16x16x32_bf16 v[148:151], v[44:47], a[68:71], v[148:151]
    buffer_load_dwordx4 a[184:187], v1, s[28:31], s58 offen offset:2048 sc1
    v_mfma_f32_16x16x32_bf16 v[148:151], v[48:51], a[84:87], v[148:151]
    ds_read_b64_tr_b16 v[36:37], v90 offset:57352
    v_mfma_f32_16x16x32_bf16 v[144:147], v[48:51], a[80:83], v[144:147]
    v_mfma_f32_16x16x32_bf16 v[144:147], v[44:47], a[64:67], v[144:147]
    ds_read_b64_tr_b16 v[38:39], v90 offset:58376
    v_mfma_f32_16x16x32_bf16 v[144:147], v[40:43], a[48:51], v[144:147]
    s_waitcnt lgkmcnt(6)
    buffer_load_dwordx4 a[188:191], v1, s[28:31], s58 offen offset:3072 sc1
    v_mfma_f32_16x16x32_bf16 v[160:163], v[16:19], a[48:51], v[160:163]
    ds_read_b64_tr_b16 v[40:41], v91 offset:40960
    v_mfma_f32_16x16x32_bf16 v[160:163], v[20:23], a[64:67], v[160:163]
    v_mfma_f32_16x16x32_bf16 v[160:163], v[24:27], a[80:83], v[160:163]
    ds_read_b64_tr_b16 v[42:43], v91 offset:41984
    v_mfma_f32_16x16x32_bf16 v[164:167], v[24:27], a[84:87], v[164:167]
    s_add_u32 s45, s56, 3145728
    v_mfma_f32_16x16x32_bf16 v[164:167], v[20:23], a[68:71], v[164:167]
    s_add_u32 m0, s3, 131072
    ds_read_b64_tr_b16 v[44:45], v91 offset:49152
    v_mfma_f32_16x16x32_bf16 v[164:167], v[16:19], a[52:55], v[164:167]
    buffer_load_dwordx4 v3, s[16:19], s45 offen nt lds
    v_mfma_f32_16x16x32_bf16 v[168:171], v[16:19], a[56:59], v[168:171]
    ds_read_b64_tr_b16 v[46:47], v91 offset:50176
    v_mfma_f32_16x16x32_bf16 v[168:171], v[20:23], a[72:75], v[168:171]
    s_add_u32 s44, s56, 3178496
    v_mfma_f32_16x16x32_bf16 v[168:171], v[24:27], a[88:91], v[168:171]
    s_add_u32 m0, s3, 132096
    ds_read_b64_tr_b16 v[48:49], v91 offset:57344
    v_mfma_f32_16x16x32_bf16 v[172:175], v[24:27], a[92:95], v[172:175]
    buffer_load_dwordx4 v3, s[16:19], s44 offen nt lds
    v_mfma_f32_16x16x32_bf16 v[172:175], v[20:23], a[76:79], v[172:175]
    ds_read_b64_tr_b16 v[50:51], v91 offset:58368
    v_mfma_f32_16x16x32_bf16 v[172:175], v[16:19], a[60:63], v[172:175]
    s_waitcnt lgkmcnt(6)
    v_mfma_f32_16x16x32_bf16 v[188:191], v[28:31], a[60:63], v[188:191]
    ds_read_b64_tr_b16 v[16:17], v91 offset:40968
    v_mfma_f32_16x16x32_bf16 v[188:191], v[32:35], a[76:79], v[188:191]
    s_add_u32 s45, s56, 3211264
    v_mfma_f32_16x16x32_bf16 v[188:191], v[36:39], a[92:95], v[188:191]
    s_add_u32 m0, s3, 133120
    ds_read_b64_tr_b16 v[18:19], v91 offset:41992
    v_mfma_f32_16x16x32_bf16 v[184:187], v[36:39], a[88:91], v[184:187]
    buffer_load_dwordx4 v3, s[16:19], s45 offen nt lds
    v_mfma_f32_16x16x32_bf16 v[184:187], v[32:35], a[72:75], v[184:187]
    ds_read_b64_tr_b16 v[20:21], v91 offset:49160
    v_mfma_f32_16x16x32_bf16 v[184:187], v[28:31], a[56:59], v[184:187]
    s_add_u32 s44, s56, 3244032
    v_mfma_f32_16x16x32_bf16 v[180:183], v[28:31], a[52:55], v[180:183]
    s_add_u32 m0, s3, 134144
    ds_read_b64_tr_b16 v[22:23], v91 offset:50184
    v_mfma_f32_16x16x32_bf16 v[180:183], v[32:35], a[68:71], v[180:183]
    buffer_load_dwordx4 v3, s[16:19], s44 offen nt lds
    v_mfma_f32_16x16x32_bf16 v[180:183], v[36:39], a[84:87], v[180:183]
    ds_read_b64_tr_b16 v[24:25], v91 offset:57352
    v_mfma_f32_16x16x32_bf16 v[176:179], v[36:39], a[80:83], v[176:179]
    s_add_u32 s45, s56, 3276800
    v_mfma_f32_16x16x32_bf16 v[176:179], v[32:35], a[64:67], v[176:179]
    s_add_u32 m0, s3, 135168
    ds_read_b64_tr_b16 v[26:27], v91 offset:58376
    v_mfma_f32_16x16x32_bf16 v[176:179], v[28:31], a[48:51], v[176:179]
    s_waitcnt lgkmcnt(6)
    buffer_load_dwordx4 v3, s[16:19], s45 offen nt lds
    v_mfma_f32_16x16x32_bf16 v[192:195], v[40:43], a[48:51], v[192:195]
    s_add_u32 s44, s56, 3309568
    v_mfma_f32_16x16x32_bf16 v[192:195], v[44:47], a[64:67], v[192:195]
    s_add_u32 m0, s3, 136192
    v_mfma_f32_16x16x32_bf16 v[192:195], v[48:51], a[80:83], v[192:195]
    buffer_load_dwordx4 v3, s[16:19], s44 offen nt lds
    v_mfma_f32_16x16x32_bf16 v[196:199], v[48:51], a[84:87], v[196:199]
    v_mfma_f32_16x16x32_bf16 v[196:199], v[44:47], a[68:71], v[196:199]
    v_mfma_f32_16x16x32_bf16 v[196:199], v[40:43], a[52:55], v[196:199]
    v_mfma_f32_16x16x32_bf16 v[200:203], v[40:43], a[56:59], v[200:203]
    v_mfma_f32_16x16x32_bf16 v[200:203], v[44:47], a[72:75], v[200:203]
    v_mfma_f32_16x16x32_bf16 v[200:203], v[48:51], a[88:91], v[200:203]
    v_mfma_f32_16x16x32_bf16 v[204:207], v[48:51], a[92:95], v[204:207]
    v_mfma_f32_16x16x32_bf16 v[204:207], v[44:47], a[76:79], v[204:207]
    v_mfma_f32_16x16x32_bf16 v[204:207], v[40:43], a[60:63], v[204:207]
    s_waitcnt vmcnt(60) lgkmcnt(0)
    s_barrier
    v_mfma_f32_16x16x32_bf16 v[220:223], v[16:19], a[60:63], v[220:223]
    ds_read_b64_tr_b16 v[28:29], v88 offset:0
    v_mfma_f32_16x16x32_bf16 v[220:223], v[20:23], a[76:79], v[220:223]
    ds_read_b64_tr_b16 v[30:31], v88 offset:1024
    v_mfma_f32_16x16x32_bf16 v[220:223], v[24:27], a[92:95], v[220:223]
    ds_read_b64_tr_b16 v[32:33], v88 offset:8192
    v_mfma_f32_16x16x32_bf16 v[216:219], v[24:27], a[88:91], v[216:219]
    ds_read_b64_tr_b16 v[34:35], v88 offset:9216
    v_mfma_f32_16x16x32_bf16 v[216:219], v[20:23], a[72:75], v[216:219]
    ds_read_b64_tr_b16 v[36:37], v88 offset:16384
    v_mfma_f32_16x16x32_bf16 v[216:219], v[16:19], a[56:59], v[216:219]
    ds_read_b64_tr_b16 v[38:39], v88 offset:17408
    v_mfma_f32_16x16x32_bf16 v[212:215], v[16:19], a[52:55], v[212:215]
    ds_read_b64_tr_b16 v[40:41], v88 offset:8
    v_mfma_f32_16x16x32_bf16 v[212:215], v[20:23], a[68:71], v[212:215]
L_pad15:
    s_cbranch_execz L_padend
    ds_read_b64_tr_b16 v[42:43], v88 offset:1032
    v_mfma_f32_16x16x32_bf16 v[212:215], v[24:27], a[84:87], v[212:215]
    ds_read_b64_tr_b16 v[44:45], v88 offset:8200
    v_mfma_f32_16x16x32_bf16 v[208:211], v[24:27], a[80:83], v[208:211]
    ds_read_b64_tr_b16 v[46:47], v88 offset:9224
    v_mfma_f32_16x16x32_bf16 v[208:211], v[20:23], a[64:67], v[208:211]
    ds_read_b64_tr_b16 v[48:49], v88 offset:16392
    v_mfma_f32_16x16x32_bf16 v[208:211], v[16:19], a[48:51], v[208:211]
    s_waitcnt vmcnt(24) lgkmcnt(5)
    ds_read_b64_tr_b16 v[50:51], v88 offset:17416
    v_mfma_f32_16x16x32_bf16 v[96:99], v[28:31], a[96:99], v[96:99]
    ds_read_b64_tr_b16 v[16:17], v89 offset:0
    v_mfma_f32_16x16x32_bf16 v[96:99], v[32:35], a[112:115], v[96:99]
    v_mfma_f32_16x16x32_bf16 v[96:99], v[36:39], a[128:131], v[96:99]
    s_add_u32 s58, s63, 49152
    ds_read_b64_tr_b16 v[18:19], v89 offset:1024
    v_mfma_f32_16x16x32_bf16 v[100:103], v[36:39], a[132:135], v[100:103]
    buffer_load_dwordx4 a[192:195], v1, s[28:31], s58 offen offset:0 sc1
    v_mfma_f32_16x16x32_bf16 v[100:103], v[32:35], a[116:119], v[100:103]
    ds_read_b64_tr_b16 v[20:21], v89 offset:8192
    v_mfma_f32_16x16x32_bf16 v[100:103], v[28:31], a[100:103], v[100:103]
    v_mfma_f32_16x16x32_bf16 v[104:107], v[28:31], a[104:107], v[104:107]
    ds_read_b64_tr_b16 v[22:23], v89 offset:9216
    v_mfma_f32_16x16x32_bf16 v[104:107], v[32:35], a[120:123], v[104:107]
    buffer_load_dwordx4 a[196:199], v1, s[28:31], s58 offen offset:1024 sc1
    v_mfma_f32_16x16x32_bf16 v[104:107], v[36:39], a[136:139], v[104:107]
    ds_read_b64_tr_b16 v[24:25], v89 offset:16384
    v_mfma_f32_16x16x32_bf16 v[108:111], v[36:39], a[140:143], v[108:111]
    v_mfma_f32_16x16x32_bf16 v[108:111], v[32:35], a[124:127], v[108:111]
    ds_read_b64_tr_b16 v[26:27], v89 offset:17408
    v_mfma_f32_16x16x32_bf16 v[108:111], v[28:31], a[108:111], v[108:111]
    s_waitcnt lgkmcnt(6)
    buffer_load_dwordx4 a[200:203], v1, s[28:31], s58 offen offset:2048 sc1
    v_mfma_f32_16x16x32_bf16 v[124:127], v[40:43], a[108:111], v[124:127]
    ds_read_b64_tr_b16 v[28:29], v89 offset:8
    v_mfma_f32_16x16x32_bf16 v[124:127], v[44:47], a[124:127], v[124:127]
    v_mfma_f32_16x16x32_bf16 v[124:127], v[48:51], a[140:143], v[124:127]
    ds_read_b64_tr_b16 v[30:31], v89 offset:1032
    v_mfma_f32_16x16x32_bf16 v[120:123], v[48:51], a[136:139], v[120:123]
    buffer_load_dwordx4 a[204:207], v1, s[28:31], s58 offen offset:3072 sc1
    v_mfma_f32_16x16x32_bf16 v[120:123], v[44:47], a[120:123], v[120:123]
    ds_read_b64_tr_b16 v[32:33], v89 offset:8200
    v_mfma_f32_16x16x32_bf16 v[120:123], v[40:43], a[104:107], v[120:123]
    v_mfma_f32_16x16x32_bf16 v[116:119], v[40:43], a[100:103], v[116:119]
    s_add_u32 s58, s63, 53248
    ds_read_b64_tr_b16 v[34:35], v89 offset:9224
    v_mfma_f32_16x16x32_bf16 v[116:119], v[44:47], a[116:119], v[116:119]
    buffer_load_dwordx4 a[208:211], v1, s[28:31], s58 offen offset:0 sc1
    v_mfma_f32_16x16x32_bf16 v[116:119], v[48:51], a[132:135], v[116:119]
    ds_read_b64_tr_b16 v[36:37], v89 offset:16392
    v_mfma_f32_16x16x32_bf16 v[112:115], v[48:51], a[128:131], v[112:115]
    v_mfma_f32_16x16x32_bf16 v[112:115], v[44:47], a[112:115], v[112:115]
    ds_read_b64_tr_b16 v[38:39], v89 offset:17416
    v_mfma_f32_16x16x32_bf16 v[112:115], v[40:43], a[96:99], v[112:115]
    s_waitcnt lgkmcnt(6)
    buffer_load_dwordx4 a[212:215], v1, s[28:31], s58 offen offset:1024 sc1
    v_mfma_f32_16x16x32_bf16 v[128:131], v[16:19], a[96:99], v[128:131]
    ds_read_b64_tr_b16 v[40:41], v90 offset:0
    v_mfma_f32_16x16x32_bf16 v[128:131], v[20:23], a[112:115], v[128:131]
    v_mfma_f32_16x16x32_bf16 v[128:131], v[24:27], a[128:131], v[128:131]
    ds_read_b64_tr_b16 v[42:43], v90 offset:1024
    v_mfma_f32_16x16x32_bf16 v[132:135], v[24:27], a[132:135], v[132:135]
    buffer_load_dwordx4 a[216:219], v1, s[28:31], s58 offen offset:2048 sc1
    v_mfma_f32_16x16x32_bf16 v[132:135], v[20:23], a[116:119], v[132:135]
    ds_read_b64_tr_b16 v[44:45], v90 offset:8192
    v_mfma_f32_16x16x32_bf16 v[132:135], v[16:19], a[100:103], v[132:135]
    v_mfma_f32_16x16x32_bf16 v[136:139], v[16:19], a[104:107], v[136:139]
    ds_read_b64_tr_b16 v[46:47], v90 offset:9216
    v_mfma_f32_16x16x32_bf16 v[136:139], v[20:23], a[120:123], v[136:139]
    buffer_load_dwordx4 a[220:223], v1, s[28:31], s58 offen offset:3072 sc1
    v_mfma_f32_16x16x32_bf16 v[136:139], v[24:27], a[136:139], v[136:139]
    ds_read_b64_tr_b16 v[48:49], v90 offset:16384
    v_mfma_f32_16x16x32_bf16 v[140:143], v[24:27], a[140:143], v[140:143]
    v_mfma_f32_16x16x32_bf16 v[140:143], v[20:23], a[124:127], v[140:143]
    s_add_u32 s58, s63, 57344
    ds_read_b64_tr_b16 v[50:51], v90 offset:17408
    v_mfma_f32_16x16x32_bf16 v[140:143], v[16:19], a[108:111], v[140:143]
    s_waitcnt lgkmcnt(6)
    buffer_load_dwordx4 a[224:227], v1, s[28:31], s58 offen offset:0 sc1
    v_mfma_f32_16x16x32_bf16 v[156:159], v[28:31], a[108:111], v[156:159]
    ds_read_b64_tr_b16 v[16:17], v90 offset:8
    v_mfma_f32_16x16x32_bf16 v[156:159], v[32:35], a[124:127], v[156:159]
    v_mfma_f32_16x16x32_bf16 v[156:159], v[36:39], a[140:143], v[156:159]
    ds_read_b64_tr_b16 v[18:19], v90 offset:1032
    v_mfma_f32_16x16x32_bf16 v[152:155], v[36:39], a[136:139], v[152:155]
    buffer_load_dwordx4 a[228:231], v1, s[28:31], s58 offen offset:1024 sc1
    v_mfma_f32_16x16x32_bf16 v[152:155], v[32:35], a[120:123], v[152:155]
    ds_read_b64_tr_b16 v[20:21], v90 offset:8200
    v_mfma_f32_16x16x32_bf16 v[152:155], v[28:31], a[104:107], v[152:155]
    v_mfma_f32_16x16x32_bf16 v[148:151], v[28:31], a[100:103], v[148:151]
    ds_read_b64_tr_b16 v[22:23], v90 offset:9224
    v_mfma_f32_16x16x32_bf16 v[148:151], v[32:35], a[116:119], v[148:151]
    buffer_load_dwordx4 a[232:235], v1, s[28:31], s58 offen offset:2048 sc1
    v_mfma_f32_16x16x32_bf16 v[148:151], v[36:39], a[132:135], v[148:151]
    ds_read_b64_tr_b16 v[24:25], v90 offset:16392
    v_mfma_f32_16x16x32_bf16 v[144:147], v[36:39], a[128:131], v[144:147]
    v_mfma_f32_16x16x32_bf16 v[144:147], v[32:35], a[112:115], v[144:147]
    ds_read_b64_tr_b16 v[26:27], v90 offset:17416
    v_mfma_f32_16x16x32_bf16 v[144:147], v[28:31], a[96:99], v[144:147]
    s_waitcnt lgkmcnt(6)
    buffer_load_dwordx4 a[236:239], v1, s[28:31], s58 offen offset:3072 sc1
    v_mfma_f32_16x16x32_bf16 v[160:163], v[40:43], a[96:99], v[160:163]
    ds_read_b64_tr_b16 v[28:29], v91 offset:0
    v_mfma_f32_16x16x32_bf16 v[160:163], v[44:47], a[112:115], v[160:163]
    v_mfma_f32_16x16x32_bf16 v[160:163], v[48:51], a[128:131], v[160:163]
    ds_read_b64_tr_b16 v[30:31], v91 offset:1024
    v_mfma_f32_16x16x32_bf16 v[164:167], v[48:51], a[132:135], v[164:167]
    s_add_u32 s45, s56, 3932160
    v_mfma_f32_16x16x32_bf16 v[164:167], v[44:47], a[116:119], v[164:167]
    s_add_u32 m0, s3, 81920
    ds_read_b64_tr_b16 v[32:33], v91 offset:8192
    v_mfma_f32_16x16x32_bf16 v[164:167], v[40:43], a[100:103], v[164:167]
    buffer_load_dwordx4 v3, s[16:19], s45 offen nt lds
    v_mfma_f32_16x16x32_bf16 v[168:171], v[40:43], a[104:107], v[168:171]
    ds_read_b64_tr_b16 v[34:35], v91 offset:9216
    v_mfma_f32_16x16x32_bf16 v[168:171], v[44:47], a[120:123], v[168:171]
    s_add_u32 s44, s56, 3964928
    v_mfma_f32_16x16x32_bf16 v[168:171], v[48:51], a[136:139], v[168:171]
    s_add_u32 m0, s3, 82944
    ds_read_b64_tr_b16 v[36:37], v91 offset:16384
    v_mfma_f32_16x16x32_bf16 v[172:175], v[48:51], a[140:143], v[172:175]
    buffer_load_dwordx4 v3, s[16:19], s44 offen nt lds
    v_mfma_f32_16x16x32_bf16 v[172:175], v[44:47], a[124:127], v[172:175]
    ds_read_b64_tr_b16 v[38:39], v91 offset:17408
    v_mfma_f32_16x16x32_bf16 v[172:175], v[40:43], a[108:111], v[172:175]
    s_waitcnt lgkmcnt(6)
    v_mfma_f32_16x16x32_bf16 v[188:191], v[16:19], a[108:111], v[188:191]
    ds_read_b64_tr_b16 v[40:41], v91 offset:8
    v_mfma_f32_16x16x32_bf16 v[188:191], v[20:23], a[124:127], v[188:191]
    s_add_u32 s45, s56, 3997696
    v_mfma_f32_16x16x32_bf16 v[188:191], v[24:27], a[140:143], v[188:191]
    s_add_u32 m0, s3, 83968
    ds_read_b64_tr_b16 v[42:43], v91 offset:1032
    v_mfma_f32_16x16x32_bf16 v[184:187], v[24:27], a[136:139], v[184:187]
    buffer_load_dwordx4 v3, s[16:19], s45 offen nt lds
    v_mfma_f32_16x16x32_bf16 v[184:187], v[20:23], a[120:123], v[184:187]
    ds_read_b64_tr_b16 v[44:45], v91 offset:8200
    v_mfma_f32_16x16x32_bf16 v[184:187], v[16:19], a[104:107], v[184:187]
    s_add_u32 s44, s56, 4030464
    v_mfma_f32_16x16x32_bf16 v[180:183], v[16:19], a[100:103], v[180:183]
    s_add_u32 m0, s3, 84992
    ds_read_b64_tr_b16 v[46:47], v91 offset:9224
    v_mfma_f32_16x16x32_bf16 v[180:183], v[20:23], a[116:119], v[180:183]
    buffer_load_dwordx4 v3, s[16:19], s44 offen nt lds
    v_mfma_f32_16x16x32_bf16 v[180:183], v[24:27], a[132:135], v[180:183]
    ds_read_b64_tr_b16 v[48:49], v91 offset:16392
    v_mfma_f32_16x16x32_bf16 v[176:179], v[24:27], a[128:131], v[176:179]
    s_add_u32 s45, s56, 4063232
    v_mfma_f32_16x16x32_bf16 v[176:179], v[20:23], a[112:115], v[176:179]
    s_add_u32 m0, s3, 86016
    ds_read_b64_tr_b16 v[50:51], v91 offset:17416
    v_mfma_f32_16x16x32_bf16 v[176:179], v[16:19], a[96:99], v[176:179]
    s_waitcnt lgkmcnt(6)
    buffer_load_dwordx4 v3, s[16:19], s45 offen nt lds
    v_mfma_f32_16x16x32_bf16 v[192:195], v[28:31], a[96:99], v[192:195]
    s_add_u32 s44, s56, 4096000
    v_mfma_f32_16x16x32_bf16 v[192:195], v[32:35], a[112:115], v[192:195]
    s_add_u32 m0, s3, 87040
    v_mfma_f32_16x16x32_bf16 v[192:195], v[36:39], a[128:131], v[192:195]
    buffer_load_dwordx4 v3, s[16:19], s44 offen nt lds
    v_mfma_f32_16x16x32_bf16 v[196:199], v[36:39], a[132:135], v[196:199]
    v_mfma_f32_16x16x32_bf16 v[196:199], v[32:35], a[116:119], v[196:199]
    v_mfma_f32_16x16x32_bf16 v[196:199], v[28:31], a[100:103], v[196:199]
    v_mfma_f32_16x16x32_bf16 v[200:203], v[28:31], a[104:107], v[200:203]
    v_mfma_f32_16x16x32_bf16 v[200:203], v[32:35], a[120:123], v[200:203]
    v_mfma_f32_16x16x32_bf16 v[200:203], v[36:39], a[136:139], v[200:203]
    v_mfma_f32_16x16x32_bf16 v[204:207], v[36:39], a[140:143], v[204:207]
    v_mfma_f32_16x16x32_bf16 v[204:207], v[32:35], a[124:127], v[204:207]
    v_mfma_f32_16x16x32_bf16 v[204:207], v[28:31], a[108:111], v[204:207]
    s_waitcnt vmcnt(36) lgkmcnt(0)
    s_barrier
    v_mfma_f32_16x16x32_bf16 v[220:223], v[40:43], a[108:111], v[220:223]
    ds_read_b64_tr_b16 v[16:17], v92 offset:0
    v_mfma_f32_16x16x32_bf16 v[220:223], v[44:47], a[124:127], v[220:223]
    ds_read_b64_tr_b16 v[18:19], v92 offset:1024
    v_mfma_f32_16x16x32_bf16 v[220:223], v[48:51], a[140:143], v[220:223]
    ds_read_b64_tr_b16 v[20:21], v92 offset:8192
    v_mfma_f32_16x16x32_bf16 v[216:219], v[48:51], a[136:139], v[216:219]
    ds_read_b64_tr_b16 v[22:23], v92 offset:9216
    v_mfma_f32_16x16x32_bf16 v[216:219], v[44:47], a[120:123], v[216:219]
    ds_read_b64_tr_b16 v[24:25], v92 offset:16384
    v_mfma_f32_16x16x32_bf16 v[216:219], v[40:43], a[104:107], v[216:219]
    ds_read_b64_tr_b16 v[26:27], v92 offset:17408
    v_mfma_f32_16x16x32_bf16 v[212:215], v[40:43], a[100:103], v[212:215]
    ds_read_b64_tr_b16 v[28:29], v92 offset:8
    v_mfma_f32_16x16x32_bf16 v[212:215], v[44:47], a[116:119], v[212:215]
    ds_read_b64_tr_b16 v[30:31], v92 offset:1032
    v_mfma_f32_16x16x32_bf16 v[212:215], v[48:51], a[132:135], v[212:215]
    ds_read_b64_tr_b16 v[32:33], v92 offset:8200
    v_mfma_f32_16x16x32_bf16 v[208:211], v[48:51], a[128:131], v[208:211]
    ds_read_b64_tr_b16 v[34:35], v92 offset:9224
    v_mfma_f32_16x16x32_bf16 v[208:211], v[44:47], a[112:115], v[208:211]
    ds_read_b64_tr_b16 v[36:37], v92 offset:16392
    v_mfma_f32_16x16x32_bf16 v[208:211], v[40:43], a[96:99], v[208:211]
    s_waitcnt vmcnt(24) lgkmcnt(5)
    ds_read_b64_tr_b16 v[38:39], v92 offset:17416
    v_mfma_f32_16x16x32_bf16 v[96:99], v[16:19], a[144:147], v[96:99]
    ds_read_b64_tr_b16 v[40:41], v93 offset:0
    v_mfma_f32_16x16x32_bf16 v[96:99], v[20:23], a[160:163], v[96:99]
    v_mfma_f32_16x16x32_bf16 v[96:99], v[24:27], a[176:179], v[96:99]
    s_add_u32 s58, s63, 61440
    ds_read_b64_tr_b16 v[42:43], v93 offset:1024
    v_mfma_f32_16x16x32_bf16 v[100:103], v[24:27], a[180:183], v[100:103]
    buffer_load_dwordx4 a[240:243], v1, s[28:31], s58 offen offset:0 sc1
    v_mfma_f32_16x16x32_bf16 v[100:103], v[20:23], a[164:167], v[100:103]
    ds_read_b64_tr_b16 v[44:45], v93 offset:8192
    v_mfma_f32_16x16x32_bf16 v[100:103], v[16:19], a[148:151], v[100:103]
    v_mfma_f32_16x16x32_bf16 v[104:107], v[16:19], a[152:155], v[104:107]
    ds_read_b64_tr_b16 v[46:47], v93 offset:9216
    v_mfma_f32_16x16x32_bf16 v[104:107], v[20:23], a[168:171], v[104:107]
    buffer_load_dwordx4 a[244:247], v1, s[28:31], s58 offen offset:1024 sc1
    v_mfma_f32_16x16x32_bf16 v[104:107], v[24:27], a[184:187], v[104:107]
    ds_read_b64_tr_b16 v[48:49], v93 offset:16384
    v_mfma_f32_16x16x32_bf16 v[108:111], v[24:27], a[188:191], v[108:111]
    v_mfma_f32_16x16x32_bf16 v[108:111], v[20:23], a[172:175], v[108:111]
    ds_read_b64_tr_b16 v[50:51], v93 offset:17408
    v_mfma_f32_16x16x32_bf16 v[108:111], v[16:19], a[156:159], v[108:111]
    s_waitcnt lgkmcnt(6)
    buffer_load_dwordx4 a[248:251], v1, s[28:31], s58 offen offset:2048 sc1
    v_mfma_f32_16x16x32_bf16 v[124:127], v[28:31], a[156:159], v[124:127]
    ds_read_b64_tr_b16 v[16:17], v93 offset:8
    v_mfma_f32_16x16x32_bf16 v[124:127], v[32:35], a[172:175], v[124:127]
    v_mfma_f32_16x16x32_bf16 v[124:127], v[36:39], a[188:191], v[124:127]
    ds_read_b64_tr_b16 v[18:19], v93 offset:1032
    v_mfma_f32_16x16x32_bf16 v[120:123], v[36:39], a[184:187], v[120:123]
    buffer_load_dwordx4 a[252:255], v1, s[28:31], s58 offen offset:3072 sc1
    v_mfma_f32_16x16x32_bf16 v[120:123], v[32:35], a[168:171], v[120:123]
    ds_read_b64_tr_b16 v[20:21], v93 offset:8200
    v_mfma_f32_16x16x32_bf16 v[120:123], v[28:31], a[152:155], v[120:123]
    v_mfma_f32_16x16x32_bf16 v[116:119], v[28:31], a[148:151], v[116:119]
    s_add_u32 s58, s63, 65536
    ds_read_b64_tr_b16 v[22:23], v93 offset:9224
    v_mfma_f32_16x16x32_bf16 v[116:119], v[32:35], a[164:167], v[116:119]
    buffer_load_dwordx4 v[224:227], v1, s[28:31], s58 offen offset:0 sc1
    v_mfma_f32_16x16x32_bf16 v[116:119], v[36:39], a[180:183], v[116:119]
    ds_read_b64_tr_b16 v[24:25], v93 offset:16392
    v_mfma_f32_16x16x32_bf16 v[112:115], v[36:39], a[176:179], v[112:115]
    v_mfma_f32_16x16x32_bf16 v[112:115], v[32:35], a[160:163], v[112:115]
    ds_read_b64_tr_b16 v[26:27], v93 offset:17416
    v_mfma_f32_16x16x32_bf16 v[112:115], v[28:31], a[144:147], v[112:115]
    s_waitcnt lgkmcnt(6)
    buffer_load_dwordx4 v[228:231], v1, s[28:31], s58 offen offset:1024 sc1
    v_mfma_f32_16x16x32_bf16 v[128:131], v[40:43], a[144:147], v[128:131]
    ds_read_b64_tr_b16 v[28:29], v94 offset:0
    v_mfma_f32_16x16x32_bf16 v[128:131], v[44:47], a[160:163], v[128:131]
    v_mfma_f32_16x16x32_bf16 v[128:131], v[48:51], a[176:179], v[128:131]
    ds_read_b64_tr_b16 v[30:31], v94 offset:1024
    v_mfma_f32_16x16x32_bf16 v[132:135], v[48:51], a[180:183], v[132:135]
    buffer_load_dwordx4 v[232:235], v1, s[28:31], s58 offen offset:2048 sc1
    v_mfma_f32_16x16x32_bf16 v[132:135], v[44:47], a[164:167], v[132:135]
    ds_read_b64_tr_b16 v[32:33], v94 offset:8192
    v_mfma_f32_16x16x32_bf16 v[132:135], v[40:43], a[148:151], v[132:135]
    v_mfma_f32_16x16x32_bf16 v[136:139], v[40:43], a[152:155], v[136:139]
    ds_read_b64_tr_b16 v[34:35], v94 offset:9216
    v_mfma_f32_16x16x32_bf16 v[136:139], v[44:47], a[168:171], v[136:139]
    buffer_load_dwordx4 v[236:239], v1, s[28:31], s58 offen offset:3072 sc1
    v_mfma_f32_16x16x32_bf16 v[136:139], v[48:51], a[184:187], v[136:139]
    ds_read_b64_tr_b16 v[36:37], v94 offset:16384
    v_mfma_f32_16x16x32_bf16 v[140:143], v[48:51], a[188:191], v[140:143]
    v_mfma_f32_16x16x32_bf16 v[140:143], v[44:47], a[172:175], v[140:143]
    s_add_u32 s58, s63, 69632
    ds_read_b64_tr_b16 v[38:39], v94 offset:17408
    v_mfma_f32_16x16x32_bf16 v[140:143], v[40:43], a[156:159], v[140:143]
    s_waitcnt lgkmcnt(6)
    buffer_load_dwordx4 v[240:243], v1, s[28:31], s58 offen offset:0 sc1
    v_mfma_f32_16x16x32_bf16 v[156:159], v[16:19], a[156:159], v[156:159]
    ds_read_b64_tr_b16 v[40:41], v94 offset:8
    v_mfma_f32_16x16x32_bf16 v[156:159], v[20:23], a[172:175], v[156:159]
    v_mfma_f32_16x16x32_bf16 v[156:159], v[24:27], a[188:191], v[156:159]
    ds_read_b64_tr_b16 v[42:43], v94 offset:1032
    v_mfma_f32_16x16x32_bf16 v[152:155], v[24:27], a[184:187], v[152:155]
    buffer_load_dwordx4 v[244:247], v1, s[28:31], s58 offen offset:1024 sc1
    v_mfma_f32_16x16x32_bf16 v[152:155], v[20:23], a[168:171], v[152:155]
    ds_read_b64_tr_b16 v[44:45], v94 offset:8200
    v_mfma_f32_16x16x32_bf16 v[152:155], v[16:19], a[152:155], v[152:155]
    v_mfma_f32_16x16x32_bf16 v[148:151], v[16:19], a[148:151], v[148:151]
    ds_read_b64_tr_b16 v[46:47], v94 offset:9224
    v_mfma_f32_16x16x32_bf16 v[148:151], v[20:23], a[164:167], v[148:151]
    buffer_load_dwordx4 v[248:251], v1, s[28:31], s58 offen offset:2048 sc1
    v_mfma_f32_16x16x32_bf16 v[148:151], v[24:27], a[180:183], v[148:151]
    ds_read_b64_tr_b16 v[48:49], v94 offset:16392
    v_mfma_f32_16x16x32_bf16 v[144:147], v[24:27], a[176:179], v[144:147]
    v_mfma_f32_16x16x32_bf16 v[144:147], v[20:23], a[160:163], v[144:147]
    ds_read_b64_tr_b16 v[50:51], v94 offset:17416
    v_mfma_f32_16x16x32_bf16 v[144:147], v[16:19], a[144:147], v[144:147]
    s_waitcnt lgkmcnt(6)
    buffer_load_dwordx4 v[252:255], v1, s[28:31], s58 offen offset:3072 sc1
    v_mfma_f32_16x16x32_bf16 v[160:163], v[28:31], a[144:147], v[160:163]
    ds_read_b64_tr_b16 v[16:17], v95 offset:0
    v_mfma_f32_16x16x32_bf16 v[160:163], v[32:35], a[160:163], v[160:163]
    v_mfma_f32_16x16x32_bf16 v[160:163], v[36:39], a[176:179], v[160:163]
    ds_read_b64_tr_b16 v[18:19], v95 offset:1024
    v_mfma_f32_16x16x32_bf16 v[164:167], v[36:39], a[180:183], v[164:167]
    s_add_u32 s45, s55, 0
    v_mfma_f32_16x16x32_bf16 v[164:167], v[32:35], a[164:167], v[164:167]
    s_add_u32 m0, s53, 40960
    ds_read_b64_tr_b16 v[20:21], v95 offset:8192
    v_mfma_f32_16x16x32_bf16 v[164:167], v[28:31], a[148:151], v[164:167]
    buffer_load_dwordx4 v2, s[8:11], s45 offen nt lds
    v_mfma_f32_16x16x32_bf16 v[168:171], v[28:31], a[152:155], v[168:171]
    ds_read_b64_tr_b16 v[22:23], v95 offset:9216
    v_mfma_f32_16x16x32_bf16 v[168:171], v[32:35], a[168:171], v[168:171]
    s_add_u32 s44, s55, 147456
    v_mfma_f32_16x16x32_bf16 v[168:171], v[36:39], a[184:187], v[168:171]
    s_add_u32 m0, s53, 41984
    ds_read_b64_tr_b16 v[24:25], v95 offset:16384
    v_mfma_f32_16x16x32_bf16 v[172:175], v[36:39], a[188:191], v[172:175]
    buffer_load_dwordx4 v2, s[8:11], s44 offen nt lds
    v_mfma_f32_16x16x32_bf16 v[172:175], v[32:35], a[172:175], v[172:175]
    ds_read_b64_tr_b16 v[26:27], v95 offset:17408
    v_mfma_f32_16x16x32_bf16 v[172:175], v[28:31], a[156:159], v[172:175]
    s_waitcnt lgkmcnt(6)
    v_mfma_f32_16x16x32_bf16 v[188:191], v[40:43], a[156:159], v[188:191]
    ds_read_b64_tr_b16 v[28:29], v95 offset:8
    v_mfma_f32_16x16x32_bf16 v[188:191], v[44:47], a[172:175], v[188:191]
    s_add_u32 s45, s55, 294912
    v_mfma_f32_16x16x32_bf16 v[188:191], v[48:51], a[188:191], v[188:191]
    s_add_u32 m0, s53, 43008
    ds_read_b64_tr_b16 v[30:31], v95 offset:1032
    v_mfma_f32_16x16x32_bf16 v[184:187], v[48:51], a[184:187], v[184:187]
    buffer_load_dwordx4 v2, s[8:11], s45 offen nt lds
    v_mfma_f32_16x16x32_bf16 v[184:187], v[44:47], a[168:171], v[184:187]
    ds_read_b64_tr_b16 v[32:33], v95 offset:8200
    v_mfma_f32_16x16x32_bf16 v[184:187], v[40:43], a[152:155], v[184:187]
    s_add_u32 s44, s55, 0
    v_mfma_f32_16x16x32_bf16 v[180:183], v[40:43], a[148:151], v[180:183]
    s_add_u32 m0, s53, 53248
    ds_read_b64_tr_b16 v[34:35], v95 offset:9224
    v_mfma_f32_16x16x32_bf16 v[180:183], v[44:47], a[164:167], v[180:183]
    buffer_load_dwordx4 v2, s[12:15], s44 offen nt lds
    v_mfma_f32_16x16x32_bf16 v[180:183], v[48:51], a[180:183], v[180:183]
    ds_read_b64_tr_b16 v[36:37], v95 offset:16392
    v_mfma_f32_16x16x32_bf16 v[176:179], v[48:51], a[176:179], v[176:179]
    s_add_u32 s45, s55, 147456
    v_mfma_f32_16x16x32_bf16 v[176:179], v[44:47], a[160:163], v[176:179]
    s_add_u32 m0, s53, 54272
    ds_read_b64_tr_b16 v[38:39], v95 offset:17416
    v_mfma_f32_16x16x32_bf16 v[176:179], v[40:43], a[144:147], v[176:179]
    s_waitcnt lgkmcnt(6)
    buffer_load_dwordx4 v2, s[12:15], s45 offen nt lds
    v_mfma_f32_16x16x32_bf16 v[192:195], v[16:19], a[144:147], v[192:195]
    s_add_u32 s44, s55, 294912
    v_mfma_f32_16x16x32_bf16 v[192:195], v[20:23], a[160:163], v[192:195]
    s_add_u32 m0, s53, 55296
    v_mfma_f32_16x16x32_bf16 v[192:195], v[24:27], a[176:179], v[192:195]
    buffer_load_dwordx4 v2, s[12:15], s44 offen nt lds
    v_mfma_f32_16x16x32_bf16 v[196:199], v[24:27], a[180:183], v[196:199]
    v_mfma_f32_16x16x32_bf16 v[196:199], v[20:23], a[164:167], v[196:199]
    v_mfma_f32_16x16x32_bf16 v[196:199], v[16:19], a[148:151], v[196:199]
    v_mfma_f32_16x16x32_bf16 v[200:203], v[16:19], a[152:155], v[200:203]
    v_mfma_f32_16x16x32_bf16 v[200:203], v[20:23], a[168:171], v[200:203]
    v_mfma_f32_16x16x32_bf16 v[200:203], v[24:27], a[184:187], v[200:203]
    v_mfma_f32_16x16x32_bf16 v[204:207], v[24:27], a[188:191], v[204:207]
    v_mfma_f32_16x16x32_bf16 v[204:207], v[20:23], a[172:175], v[204:207]
    v_mfma_f32_16x16x32_bf16 v[204:207], v[16:19], a[156:159], v[204:207]
    s_waitcnt vmcnt(36) lgkmcnt(0)
    s_barrier
    v_mfma_f32_16x16x32_bf16 v[220:223], v[28:31], a[156:159], v[220:223]
    ds_read_b64_tr_b16 v[40:41], v92 offset:24576
    v_mfma_f32_16x16x32_bf16 v[220:223], v[32:35], a[172:175], v[220:223]
    ds_read_b64_tr_b16 v[42:43], v92 offset:25600
    v_mfma_f32_16x16x32_bf16 v[220:223], v[36:39], a[188:191], v[220:223]
    ds_read_b64_tr_b16 v[44:45], v92 offset:32768
    v_mfma_f32_16x16x32_bf16 v[216:219], v[36:39], a[184:187], v[216:219]
    ds_read_b64_tr_b16 v[46:47], v92 offset:33792
    v_mfma_f32_16x16x32_bf16 v[216:219], v[32:35], a[168:171], v[216:219]
    ds_read_b64_tr_b16 v[48:49], v92 offset:40960
    v_mfma_f32_16x16x32_bf16 v[216:219], v[28:31], a[152:155], v[216:219]
    ds_read_b64_tr_b16 v[50:51], v92 offset:41984
    v_mfma_f32_16x16x32_bf16 v[212:215], v[28:31], a[148:151], v[212:215]
    ds_read_b64_tr_b16 v[16:17], v92 offset:24584
    v_mfma_f32_16x16x32_bf16 v[212:215], v[32:35], a[164:167], v[212:215]
    ds_read_b64_tr_b16 v[18:19], v92 offset:25608
    v_mfma_f32_16x16x32_bf16 v[212:215], v[36:39], a[180:183], v[212:215]
    ds_read_b64_tr_b16 v[20:21], v92 offset:32776
    v_mfma_f32_16x16x32_bf16 v[208:211], v[36:39], a[176:179], v[208:211]
    ds_read_b64_tr_b16 v[22:23], v92 offset:33800
    v_mfma_f32_16x16x32_bf16 v[208:211], v[32:35], a[160:163], v[208:211]
    ds_read_b64_tr_b16 v[24:25], v92 offset:40968
    v_mfma_f32_16x16x32_bf16 v[208:211], v[28:31], a[144:147], v[208:211]
    s_waitcnt vmcnt(24) lgkmcnt(5)
    ds_read_b64_tr_b16 v[26:27], v92 offset:41992
    v_mfma_f32_16x16x32_bf16 v[96:99], v[40:43], a[192:195], v[96:99]
    ds_read_b64_tr_b16 v[28:29], v93 offset:24576
    v_mfma_f32_16x16x32_bf16 v[96:99], v[44:47], a[208:211], v[96:99]
    v_mfma_f32_16x16x32_bf16 v[96:99], v[48:51], a[224:227], v[96:99]
    ds_read_b64_tr_b16 v[30:31], v93 offset:25600
    v_mfma_f32_16x16x32_bf16 v[100:103], v[48:51], a[228:231], v[100:103]
    buffer_load_dwordx2 v[74:75], v76, s[28:31], s73 offen sc1
    v_mfma_f32_16x16x32_bf16 v[100:103], v[44:47], a[212:215], v[100:103]
    ds_read_b64_tr_b16 v[32:33], v93 offset:32768
    v_mfma_f32_16x16x32_bf16 v[100:103], v[40:43], a[196:199], v[100:103]
    v_mfma_f32_16x16x32_bf16 v[104:107], v[40:43], a[200:203], v[104:107]
    ds_read_b64_tr_b16 v[34:35], v93 offset:33792
    v_mfma_f32_16x16x32_bf16 v[104:107], v[44:47], a[216:219], v[104:107]
    v_mfma_f32_16x16x32_bf16 v[104:107], v[48:51], a[232:235], v[104:107]
    ds_read_b64_tr_b16 v[36:37], v93 offset:40960
    v_mfma_f32_16x16x32_bf16 v[108:111], v[48:51], a[236:239], v[108:111]
    v_mfma_f32_16x16x32_bf16 v[108:111], v[44:47], a[220:223], v[108:111]
    ds_read_b64_tr_b16 v[38:39], v93 offset:41984
    v_mfma_f32_16x16x32_bf16 v[108:111], v[40:43], a[204:207], v[108:111]
    s_waitcnt lgkmcnt(6)
    v_mfma_f32_16x16x32_bf16 v[124:127], v[16:19], a[204:207], v[124:127]
    ds_read_b64_tr_b16 v[40:41], v93 offset:24584
    v_mfma_f32_16x16x32_bf16 v[124:127], v[20:23], a[220:223], v[124:127]
    s_add_u32 s45, s55, 1769472
    v_mfma_f32_16x16x32_bf16 v[124:127], v[24:27], a[236:239], v[124:127]
    s_add_u32 m0, s53, 106496
    ds_read_b64_tr_b16 v[42:43], v93 offset:25608
    v_mfma_f32_16x16x32_bf16 v[120:123], v[24:27], a[232:235], v[120:123]
    buffer_load_dwordx4 v2, s[8:11], s45 offen nt lds
    v_mfma_f32_16x16x32_bf16 v[120:123], v[20:23], a[216:219], v[120:123]
    ds_read_b64_tr_b16 v[44:45], v93 offset:32776
    v_mfma_f32_16x16x32_bf16 v[120:123], v[16:19], a[200:203], v[120:123]
    v_mfma_f32_16x16x32_bf16 v[116:119], v[16:19], a[196:199], v[116:119]
    ds_read_b64_tr_b16 v[46:47], v93 offset:33800
    v_mfma_f32_16x16x32_bf16 v[116:119], v[20:23], a[212:215], v[116:119]
    v_mfma_f32_16x16x32_bf16 v[116:119], v[24:27], a[228:231], v[116:119]
    ds_read_b64_tr_b16 v[48:49], v93 offset:40968
    v_mfma_f32_16x16x32_bf16 v[112:115], v[24:27], a[224:227], v[112:115]
    s_add_u32 s44, s55, 1916928
    v_mfma_f32_16x16x32_bf16 v[112:115], v[20:23], a[208:211], v[112:115]
    s_add_u32 m0, s53, 107520
    ds_read_b64_tr_b16 v[50:51], v93 offset:41992
    v_mfma_f32_16x16x32_bf16 v[112:115], v[16:19], a[192:195], v[112:115]
    s_waitcnt lgkmcnt(6)
    buffer_load_dwordx4 v2, s[8:11], s44 offen nt lds
    v_mfma_f32_16x16x32_bf16 v[128:131], v[28:31], a[192:195], v[128:131]
    ds_read_b64_tr_b16 v[16:17], v94 offset:24576
    v_mfma_f32_16x16x32_bf16 v[128:131], v[32:35], a[208:211], v[128:131]
    v_mfma_f32_16x16x32_bf16 v[128:131], v[36:39], a[224:227], v[128:131]
    ds_read_b64_tr_b16 v[18:19], v94 offset:25600
    v_mfma_f32_16x16x32_bf16 v[132:135], v[36:39], a[228:231], v[132:135]
    v_mfma_f32_16x16x32_bf16 v[132:135], v[32:35], a[212:215], v[132:135]
    ds_read_b64_tr_b16 v[20:21], v94 offset:32768
    v_mfma_f32_16x16x32_bf16 v[132:135], v[28:31], a[196:199], v[132:135]
    v_mfma_f32_16x16x32_bf16 v[136:139], v[28:31], a[200:203], v[136:139]
    ds_read_b64_tr_b16 v[22:23], v94 offset:33792
    v_mfma_f32_16x16x32_bf16 v[136:139], v[32:35], a[216:219], v[136:139]
    v_mfma_f32_16x16x32_bf16 v[136:139], v[36:39], a[232:235], v[136:139]
    ds_read_b64_tr_b16 v[24:25], v94 offset:40960
    v_mfma_f32_16x16x32_bf16 v[140:143], v[36:39], a[236:239], v[140:143]
    s_add_u32 s45, s55, 2064384
    v_mfma_f32_16x16x32_bf16 v[140:143], v[32:35], a[220:223], v[140:143]
    s_add_u32 m0, s53, 108544
    ds_read_b64_tr_b16 v[26:27], v94 offset:41984
    v_mfma_f32_16x16x32_bf16 v[140:143], v[28:31], a[204:207], v[140:143]
    s_waitcnt lgkmcnt(6)
    buffer_load_dwordx4 v2, s[8:11], s45 offen nt lds
    v_mfma_f32_16x16x32_bf16 v[156:159], v[40:43], a[204:207], v[156:159]
    ds_read_b64_tr_b16 v[28:29], v94 offset:24584
    v_mfma_f32_16x16x32_bf16 v[156:159], v[44:47], a[220:223], v[156:159]
    v_mfma_f32_16x16x32_bf16 v[156:159], v[48:51], a[236:239], v[156:159]
    ds_read_b64_tr_b16 v[30:31], v94 offset:25608
    v_mfma_f32_16x16x32_bf16 v[152:155], v[48:51], a[232:235], v[152:155]
    v_mfma_f32_16x16x32_bf16 v[152:155], v[44:47], a[216:219], v[152:155]
    ds_read_b64_tr_b16 v[32:33], v94 offset:32776
    v_mfma_f32_16x16x32_bf16 v[152:155], v[40:43], a[200:203], v[152:155]
    v_mfma_f32_16x16x32_bf16 v[148:151], v[40:43], a[196:199], v[148:151]
    ds_read_b64_tr_b16 v[34:35], v94 offset:33800
    v_mfma_f32_16x16x32_bf16 v[148:151], v[44:47], a[212:215], v[148:151]
    s_add_u32 s44, s55, 1769472
    v_mfma_f32_16x16x32_bf16 v[148:151], v[48:51], a[228:231], v[148:151]
    s_add_u32 m0, s53, 118784
    ds_read_b64_tr_b16 v[36:37], v94 offset:40968
    v_mfma_f32_16x16x32_bf16 v[144:147], v[48:51], a[224:227], v[144:147]
    buffer_load_dwordx4 v2, s[12:15], s44 offen nt lds
    v_mfma_f32_16x16x32_bf16 v[144:147], v[44:47], a[208:211], v[144:147]
    ds_read_b64_tr_b16 v[38:39], v94 offset:41992
    v_mfma_f32_16x16x32_bf16 v[144:147], v[40:43], a[192:195], v[144:147]
    s_waitcnt lgkmcnt(6)
    v_mfma_f32_16x16x32_bf16 v[160:163], v[16:19], a[192:195], v[160:163]
    ds_read_b64_tr_b16 v[40:41], v95 offset:24576
    v_mfma_f32_16x16x32_bf16 v[160:163], v[20:23], a[208:211], v[160:163]
    v_mfma_f32_16x16x32_bf16 v[160:163], v[24:27], a[224:227], v[160:163]
    ds_read_b64_tr_b16 v[42:43], v95 offset:25600
    v_mfma_f32_16x16x32_bf16 v[164:167], v[24:27], a[228:231], v[164:167]
    v_mfma_f32_16x16x32_bf16 v[164:167], v[20:23], a[212:215], v[164:167]
    ds_read_b64_tr_b16 v[44:45], v95 offset:32768
    v_mfma_f32_16x16x32_bf16 v[164:167], v[16:19], a[196:199], v[164:167]
    s_add_u32 s45, s55, 1916928
    v_mfma_f32_16x16x32_bf16 v[168:171], v[16:19], a[200:203], v[168:171]
    s_add_u32 m0, s53, 119808
    ds_read_b64_tr_b16 v[46:47], v95 offset:33792
    v_mfma_f32_16x16x32_bf16 v[168:171], v[20:23], a[216:219], v[168:171]
    buffer_load_dwordx4 v2, s[12:15], s45 offen nt lds
    v_mfma_f32_16x16x32_bf16 v[168:171], v[24:27], a[232:235], v[168:171]
    ds_read_b64_tr_b16 v[48:49], v95 offset:40960
    v_mfma_f32_16x16x32_bf16 v[172:175], v[24:27], a[236:239], v[172:175]
    v_mfma_f32_16x16x32_bf16 v[172:175], v[20:23], a[220:223], v[172:175]
    ds_read_b64_tr_b16 v[50:51], v95 offset:41984
    v_mfma_f32_16x16x32_bf16 v[172:175], v[16:19], a[204:207], v[172:175]
    s_waitcnt lgkmcnt(6)
    v_mfma_f32_16x16x32_bf16 v[188:191], v[28:31], a[204:207], v[188:191]
    ds_read_b64_tr_b16 v[16:17], v95 offset:24584
    v_mfma_f32_16x16x32_bf16 v[188:191], v[32:35], a[220:223], v[188:191]
    v_mfma_f32_16x16x32_bf16 v[188:191], v[36:39], a[236:239], v[188:191]
    ds_read_b64_tr_b16 v[18:19], v95 offset:25608
    v_mfma_f32_16x16x32_bf16 v[184:187], v[36:39], a[232:235], v[184:187]
    v_mfma_f32_16x16x32_bf16 v[184:187], v[32:35], a[216:219], v[184:187]
    ds_read_b64_tr_b16 v[20:21], v95 offset:32776
    v_mfma_f32_16x16x32_bf16 v[184:187], v[28:31], a[200:203], v[184:187]
    s_add_u32 s44, s55, 2064384
    v_mfma_f32_16x16x32_bf16 v[180:183], v[28:31], a[196:199], v[180:183]
    s_add_u32 m0, s53, 120832
    ds_read_b64_tr_b16 v[22:23], v95 offset:33800
    v_mfma_f32_16x16x32_bf16 v[180:183], v[32:35], a[212:215], v[180:183]
    buffer_load_dwordx4 v2, s[12:15], s44 offen nt lds
    v_mfma_f32_16x16x32_bf16 v[180:183], v[36:39], a[228:231], v[180:183]
    ds_read_b64_tr_b16 v[24:25], v95 offset:40968
    v_mfma_f32_16x16x32_bf16 v[176:179], v[36:39], a[224:227], v[176:179]
    v_mfma_f32_16x16x32_bf16 v[176:179], v[32:35], a[208:211], v[176:179]
    ds_read_b64_tr_b16 v[26:27], v95 offset:41992
    v_mfma_f32_16x16x32_bf16 v[176:179], v[28:31], a[192:195], v[176:179]
    s_waitcnt lgkmcnt(6)
    v_mfma_f32_16x16x32_bf16 v[192:195], v[40:43], a[192:195], v[192:195]
    v_mfma_f32_16x16x32_bf16 v[192:195], v[44:47], a[208:211], v[192:195]
    v_mfma_f32_16x16x32_bf16 v[192:195], v[48:51], a[224:227], v[192:195]
    v_mfma_f32_16x16x32_bf16 v[196:199], v[48:51], a[228:231], v[196:199]
    v_mfma_f32_16x16x32_bf16 v[196:199], v[44:47], a[212:215], v[196:199]
    v_mfma_f32_16x16x32_bf16 v[196:199], v[40:43], a[196:199], v[196:199]
    v_mfma_f32_16x16x32_bf16 v[200:203], v[40:43], a[200:203], v[200:203]
    v_mfma_f32_16x16x32_bf16 v[200:203], v[44:47], a[216:219], v[200:203]
    v_mfma_f32_16x16x32_bf16 v[200:203], v[48:51], a[232:235], v[200:203]
    v_mfma_f32_16x16x32_bf16 v[204:207], v[48:51], a[236:239], v[204:207]
L_pad14:
    s_cbranch_execz L_padend
    v_mfma_f32_16x16x32_bf16 v[204:207], v[44:47], a[220:223], v[204:207]
    v_mfma_f32_16x16x32_bf16 v[204:207], v[40:43], a[204:207], v[204:207]
    s_waitcnt vmcnt(25) lgkmcnt(0)
    s_barrier
    v_mfma_f32_16x16x32_bf16 v[220:223], v[16:19], a[204:207], v[220:223]
    ds_read_b64_tr_b16 v[28:29], v88 offset:40960
    v_mfma_f32_16x16x32_bf16 v[220:223], v[20:23], a[220:223], v[220:223]
    ds_read_b64_tr_b16 v[30:31], v88 offset:41984
    v_mfma_f32_16x16x32_bf16 v[220:223], v[24:27], a[236:239], v[220:223]
    ds_read_b64_tr_b16 v[32:33], v88 offset:49152
    v_mfma_f32_16x16x32_bf16 v[216:219], v[24:27], a[232:235], v[216:219]
    ds_read_b64_tr_b16 v[34:35], v88 offset:50176
    v_mfma_f32_16x16x32_bf16 v[216:219], v[20:23], a[216:219], v[216:219]
    ds_read_b64_tr_b16 v[36:37], v88 offset:57344
    v_mfma_f32_16x16x32_bf16 v[216:219], v[16:19], a[200:203], v[216:219]
    ds_read_b64_tr_b16 v[38:39], v88 offset:58368
    v_mfma_f32_16x16x32_bf16 v[212:215], v[16:19], a[196:199], v[212:215]
    ds_read_b64_tr_b16 v[40:41], v88 offset:40968
    v_mfma_f32_16x16x32_bf16 v[212:215], v[20:23], a[212:215], v[212:215]
    ds_read_b64_tr_b16 v[42:43], v88 offset:41992
    v_mfma_f32_16x16x32_bf16 v[212:215], v[24:27], a[228:231], v[212:215]
    ds_read_b64_tr_b16 v[44:45], v88 offset:49160
    v_mfma_f32_16x16x32_bf16 v[208:211], v[24:27], a[224:227], v[208:211]
    ds_read_b64_tr_b16 v[46:47], v88 offset:50184
    v_mfma_f32_16x16x32_bf16 v[208:211], v[20:23], a[208:211], v[208:211]
    ds_read_b64_tr_b16 v[48:49], v88 offset:57352
    v_mfma_f32_16x16x32_bf16 v[208:211], v[16:19], a[192:195], v[208:211]
    s_waitcnt vmcnt(13) lgkmcnt(5)
    ds_read_b64_tr_b16 v[50:51], v88 offset:58376
    v_mfma_f32_16x16x32_bf16 v[96:99], v[28:31], a[240:243], v[96:99]
    ds_read_b64_tr_b16 v[16:17], v89 offset:40960
    v_mfma_f32_16x16x32_bf16 v[96:99], v[32:35], v[224:227], v[96:99]
    s_add_u32 s45, s55, 3538944
    v_mfma_f32_16x16x32_bf16 v[96:99], v[36:39], v[240:243], v[96:99]
    s_add_u32 m0, s53, 131072
    ds_read_b64_tr_b16 v[18:19], v89 offset:41984
    v_mfma_f32_16x16x32_bf16 v[100:103], v[36:39], v[244:247], v[100:103]
    buffer_load_dwordx4 v2, s[8:11], s45 offen nt lds
    v_mfma_f32_16x16x32_bf16 v[100:103], v[32:35], v[228:231], v[100:103]
    ds_read_b64_tr_b16 v[20:21], v89 offset:49152
    v_mfma_f32_16x16x32_bf16 v[100:103], v[28:31], a[244:247], v[100:103]
    v_mfma_f32_16x16x32_bf16 v[104:107], v[28:31], a[248:251], v[104:107]
    ds_read_b64_tr_b16 v[22:23], v89 offset:50176
    v_mfma_f32_16x16x32_bf16 v[104:107], v[32:35], v[232:235], v[104:107]
    v_mfma_f32_16x16x32_bf16 v[104:107], v[36:39], v[248:251], v[104:107]
    ds_read_b64_tr_b16 v[24:25], v89 offset:57344
    v_mfma_f32_16x16x32_bf16 v[108:111], v[36:39], v[252:255], v[108:111]
    v_mfma_f32_16x16x32_bf16 v[108:111], v[32:35], v[236:239], v[108:111]
    ds_read_b64_tr_b16 v[26:27], v89 offset:58368
    v_mfma_f32_16x16x32_bf16 v[108:111], v[28:31], a[252:255], v[108:111]
    s_waitcnt lgkmcnt(6)
    v_mfma_f32_16x16x32_bf16 v[124:127], v[40:43], a[252:255], v[124:127]
    ds_read_b64_tr_b16 v[28:29], v89 offset:40968
    v_mfma_f32_16x16x32_bf16 v[124:127], v[44:47], v[236:239], v[124:127]
    s_add_u32 s44, s55, 3686400
    v_mfma_f32_16x16x32_bf16 v[124:127], v[48:51], v[252:255], v[124:127]
    s_add_u32 m0, s53, 132096
    ds_read_b64_tr_b16 v[30:31], v89 offset:41992
    v_mfma_f32_16x16x32_bf16 v[120:123], v[48:51], v[248:251], v[120:123]
    buffer_load_dwordx4 v2, s[8:11], s44 offen nt lds
    v_mfma_f32_16x16x32_bf16 v[120:123], v[44:47], v[232:235], v[120:123]
    ds_read_b64_tr_b16 v[32:33], v89 offset:49160
    v_mfma_f32_16x16x32_bf16 v[120:123], v[40:43], a[248:251], v[120:123]
    v_mfma_f32_16x16x32_bf16 v[116:119], v[40:43], a[244:247], v[116:119]
    ds_read_b64_tr_b16 v[34:35], v89 offset:50184
    v_mfma_f32_16x16x32_bf16 v[116:119], v[44:47], v[228:231], v[116:119]
    v_mfma_f32_16x16x32_bf16 v[116:119], v[48:51], v[244:247], v[116:119]
    ds_read_b64_tr_b16 v[36:37], v89 offset:57352
    v_mfma_f32_16x16x32_bf16 v[112:115], v[48:51], v[240:243], v[112:115]
    v_mfma_f32_16x16x32_bf16 v[112:115], v[44:47], v[224:227], v[112:115]
    ds_read_b64_tr_b16 v[38:39], v89 offset:58376
    v_mfma_f32_16x16x32_bf16 v[112:115], v[40:43], a[240:243], v[112:115]
    s_waitcnt lgkmcnt(6)
    v_mfma_f32_16x16x32_bf16 v[128:131], v[16:19], a[240:243], v[128:131]
    ds_read_b64_tr_b16 v[40:41], v90 offset:40960
    v_mfma_f32_16x16x32_bf16 v[128:131], v[20:23], v[224:227], v[128:131]
    s_add_u32 s45, s55, 3833856
    v_mfma_f32_16x16x32_bf16 v[128:131], v[24:27], v[240:243], v[128:131]
    s_add_u32 m0, s53, 133120
    ds_read_b64_tr_b16 v[42:43], v90 offset:41984
    v_mfma_f32_16x16x32_bf16 v[132:135], v[24:27], v[244:247], v[132:135]
    buffer_load_dwordx4 v2, s[8:11], s45 offen nt lds
    v_mfma_f32_16x16x32_bf16 v[132:135], v[20:23], v[228:231], v[132:135]
    ds_read_b64_tr_b16 v[44:45], v90 offset:49152
    v_mul_f32 v96, 0x3e0293ee, v96
    v_mfma_f32_16x16x32_bf16 v[132:135], v[16:19], a[244:247], v[132:135]
    v_mul_f32 v97, 0x3e0293ee, v97
    v_mul_f32 v98, 0x3e0293ee, v98
    v_mfma_f32_16x16x32_bf16 v[136:139], v[16:19], a[248:251], v[136:139]
    ds_read_b64_tr_b16 v[46:47], v90 offset:50176
    v_mul_f32 v99, 0x3e0293ee, v99
    v_mfma_f32_16x16x32_bf16 v[136:139], v[20:23], v[232:235], v[136:139]
    v_mul_f32 v112, 0x3e0293ee, v112
    v_mul_f32 v113, 0x3e0293ee, v113
    v_mfma_f32_16x16x32_bf16 v[136:139], v[24:27], v[248:251], v[136:139]
    ds_read_b64_tr_b16 v[48:49], v90 offset:57344
    v_mul_f32 v114, 0x3e0293ee, v114
    v_mfma_f32_16x16x32_bf16 v[140:143], v[24:27], v[252:255], v[140:143]
    v_mul_f32 v115, 0x3e0293ee, v115
    v_cvt_pk_bf16_f32 v52, v96, v97
    v_mfma_f32_16x16x32_bf16 v[140:143], v[20:23], v[236:239], v[140:143]
    ds_read_b64_tr_b16 v[50:51], v90 offset:58368
    v_cvt_pk_bf16_f32 v53, v98, v99
    v_mfma_f32_16x16x32_bf16 v[140:143], v[16:19], a[252:255], v[140:143]
    s_waitcnt lgkmcnt(6)
    v_cvt_pk_bf16_f32 v54, v112, v113
    v_cvt_pk_bf16_f32 v55, v114, v115
    v_mfma_f32_16x16x32_bf16 v[156:159], v[28:31], a[252:255], v[156:159]
    ds_read_b64_tr_b16 v[16:17], v90 offset:40968
    v_mul_f32 v100, 0x3e0293ee, v100
    v_mfma_f32_16x16x32_bf16 v[156:159], v[32:35], v[236:239], v[156:159]
    s_add_u32 s44, s55, 3538944
    v_mul_f32 v101, 0x3e0293ee, v101
    v_mul_f32 v102, 0x3e0293ee, v102
    v_mfma_f32_16x16x32_bf16 v[156:159], v[36:39], v[252:255], v[156:159]
    s_add_u32 m0, s53, 143360
    ds_read_b64_tr_b16 v[18:19], v90 offset:41992
    v_mul_f32 v103, 0x3e0293ee, v103
    v_mfma_f32_16x16x32_bf16 v[152:155], v[36:39], v[248:251], v[152:155]
    buffer_load_dwordx4 v2, s[12:15], s44 offen nt lds
    v_mfma_f32_16x16x32_bf16 v[152:155], v[32:35], v[232:235], v[152:155]
    ds_read_b64_tr_b16 v[20:21], v90 offset:49160
    v_mul_f32 v116, 0x3e0293ee, v116
    v_mfma_f32_16x16x32_bf16 v[152:155], v[28:31], a[248:251], v[152:155]
    ds_write_b128 v10, v[52:55] offset:0
    v_mul_f32 v117, 0x3e0293ee, v117
    v_mfma_f32_16x16x32_bf16 v[148:151], v[28:31], a[244:247], v[148:151]
    ds_read_b64_tr_b16 v[22:23], v90 offset:50184
    v_mul_f32 v118, 0x3e0293ee, v118
    v_mfma_f32_16x16x32_bf16 v[148:151], v[32:35], v[228:231], v[148:151]
    v_mul_f32 v119, 0x3e0293ee, v119
    v_cvt_pk_bf16_f32 v56, v100, v101
    v_mfma_f32_16x16x32_bf16 v[148:151], v[36:39], v[244:247], v[148:151]
    ds_read_b64_tr_b16 v[24:25], v90 offset:57352
    v_cvt_pk_bf16_f32 v57, v102, v103
    v_mfma_f32_16x16x32_bf16 v[144:147], v[36:39], v[240:243], v[144:147]
    v_cvt_pk_bf16_f32 v58, v116, v117
    v_cvt_pk_bf16_f32 v59, v118, v119
    v_mfma_f32_16x16x32_bf16 v[144:147], v[32:35], v[224:227], v[144:147]
    ds_read_b64_tr_b16 v[26:27], v90 offset:58376
    v_mul_f32 v104, 0x3e0293ee, v104
    v_mfma_f32_16x16x32_bf16 v[144:147], v[28:31], a[240:243], v[144:147]
    s_waitcnt lgkmcnt(7)
    v_mul_f32 v105, 0x3e0293ee, v105
    v_mul_f32 v106, 0x3e0293ee, v106
    v_mfma_f32_16x16x32_bf16 v[160:163], v[40:43], a[240:243], v[160:163]
    ds_read_b64_tr_b16 v[28:29], v91 offset:40960
    v_mul_f32 v107, 0x3e0293ee, v107
    v_mfma_f32_16x16x32_bf16 v[160:163], v[44:47], v[224:227], v[160:163]
    ds_write_b128 v10, v[56:59] offset:4096
    v_mul_f32 v120, 0x3e0293ee, v120
    v_mfma_f32_16x16x32_bf16 v[160:163], v[48:51], v[240:243], v[160:163]
    ds_read_b64_tr_b16 v[30:31], v91 offset:41984
    v_mul_f32 v121, 0x3e0293ee, v121
    v_mfma_f32_16x16x32_bf16 v[164:167], v[48:51], v[244:247], v[164:167]
    s_add_u32 s45, s55, 3686400
    v_mul_f32 v122, 0x3e0293ee, v122
    v_mul_f32 v123, 0x3e0293ee, v123
    v_mfma_f32_16x16x32_bf16 v[164:167], v[44:47], v[228:231], v[164:167]
    s_add_u32 m0, s53, 144384
    ds_read_b64_tr_b16 v[32:33], v91 offset:49152
    v_cvt_pk_bf16_f32 v60, v104, v105
    v_mfma_f32_16x16x32_bf16 v[164:167], v[40:43], a[244:247], v[164:167]
    buffer_load_dwordx4 v2, s[12:15], s45 offen nt lds
    v_mfma_f32_16x16x32_bf16 v[168:171], v[40:43], a[248:251], v[168:171]
    ds_read_b64_tr_b16 v[34:35], v91 offset:50176
    v_cvt_pk_bf16_f32 v61, v106, v107
    v_mfma_f32_16x16x32_bf16 v[168:171], v[44:47], v[232:235], v[168:171]
    v_cvt_pk_bf16_f32 v62, v120, v121
    v_cvt_pk_bf16_f32 v63, v122, v123
    v_mfma_f32_16x16x32_bf16 v[168:171], v[48:51], v[248:251], v[168:171]
    ds_read_b64_tr_b16 v[36:37], v91 offset:57344
    v_mul_f32 v108, 0x3e0293ee, v108
    v_mfma_f32_16x16x32_bf16 v[172:175], v[48:51], v[252:255], v[172:175]
    ds_write_b128 v11, v[60:63] offset:0
    v_mul_f32 v109, 0x3e0293ee, v109
    v_mfma_f32_16x16x32_bf16 v[172:175], v[44:47], v[236:239], v[172:175]
    ds_read_b64_tr_b16 v[38:39], v91 offset:58368
    v_mul_f32 v110, 0x3e0293ee, v110
    v_mfma_f32_16x16x32_bf16 v[172:175], v[40:43], a[252:255], v[172:175]
    s_waitcnt lgkmcnt(8)
    v_mul_f32 v111, 0x3e0293ee, v111
    v_mul_f32 v124, 0x3e0293ee, v124
    v_mfma_f32_16x16x32_bf16 v[188:191], v[16:19], a[252:255], v[188:191]
    ds_read_b64_tr_b16 v[40:41], v91 offset:40968
    v_mul_f32 v125, 0x3e0293ee, v125
    v_mfma_f32_16x16x32_bf16 v[188:191], v[20:23], v[236:239], v[188:191]
    v_mul_f32 v126, 0x3e0293ee, v126
    v_mul_f32 v127, 0x3e0293ee, v127
    v_mfma_f32_16x16x32_bf16 v[188:191], v[24:27], v[252:255], v[188:191]
    ds_read_b64_tr_b16 v[42:43], v91 offset:41992
    v_cvt_pk_bf16_f32 v64, v108, v109
    v_mfma_f32_16x16x32_bf16 v[184:187], v[24:27], v[248:251], v[184:187]
    s_add_u32 s44, s55, 3833856
    v_cvt_pk_bf16_f32 v65, v110, v111
    v_cvt_pk_bf16_f32 v66, v124, v125
    v_mfma_f32_16x16x32_bf16 v[184:187], v[20:23], v[232:235], v[184:187]
    s_add_u32 m0, s53, 145408
    ds_read_b64_tr_b16 v[44:45], v91 offset:49160
    v_cvt_pk_bf16_f32 v67, v126, v127
    v_mfma_f32_16x16x32_bf16 v[184:187], v[16:19], a[248:251], v[184:187]
    buffer_load_dwordx4 v2, s[12:15], s44 offen nt lds
    v_mfma_f32_16x16x32_bf16 v[180:183], v[16:19], a[244:247], v[180:183]
    ds_read_b64_tr_b16 v[46:47], v91 offset:50184
    v_mul_f32 v128, 0x3e0293ee, v128
    v_mfma_f32_16x16x32_bf16 v[180:183], v[20:23], v[228:231], v[180:183]
    ds_write_b128 v11, v[64:67] offset:4096
    v_mul_f32 v129, 0x3e0293ee, v129
    v_mfma_f32_16x16x32_bf16 v[180:183], v[24:27], v[244:247], v[180:183]
    ds_read_b64_tr_b16 v[48:49], v91 offset:57352
    v_mul_f32 v130, 0x3e0293ee, v130
    v_mfma_f32_16x16x32_bf16 v[176:179], v[24:27], v[240:243], v[176:179]
    v_mul_f32 v131, 0x3e0293ee, v131
    v_mul_f32 v144, 0x3e0293ee, v144
    v_mfma_f32_16x16x32_bf16 v[176:179], v[20:23], v[224:227], v[176:179]
    ds_read_b64_tr_b16 v[50:51], v91 offset:58376
    v_mul_f32 v145, 0x3e0293ee, v145
    v_mfma_f32_16x16x32_bf16 v[176:179], v[16:19], a[240:243], v[176:179]
    s_waitcnt lgkmcnt(7)
    v_mul_f32 v146, 0x3e0293ee, v146
    v_mul_f32 v147, 0x3e0293ee, v147
    v_mfma_f32_16x16x32_bf16 v[192:195], v[28:31], a[240:243], v[192:195]
    v_cvt_pk_bf16_f32 v52, v128, v129
    v_cvt_pk_bf16_f32 v53, v130, v131
    v_mfma_f32_16x16x32_bf16 v[192:195], v[32:35], v[224:227], v[192:195]
    v_cvt_pk_bf16_f32 v54, v144, v145
    v_cvt_pk_bf16_f32 v55, v146, v147
    v_mfma_f32_16x16x32_bf16 v[192:195], v[36:39], v[240:243], v[192:195]
    ds_write_b128 v10, v[52:55] offset:1024
    v_mul_f32 v132, 0x3e0293ee, v132
    v_mfma_f32_16x16x32_bf16 v[196:199], v[36:39], v[244:247], v[196:199]
    v_mul_f32 v133, 0x3e0293ee, v133
    v_mul_f32 v134, 0x3e0293ee, v134
    v_mfma_f32_16x16x32_bf16 v[196:199], v[32:35], v[228:231], v[196:199]
    v_mul_f32 v135, 0x3e0293ee, v135
    v_mul_f32 v148, 0x3e0293ee, v148
    v_mfma_f32_16x16x32_bf16 v[196:199], v[28:31], a[244:247], v[196:199]
    v_mul_f32 v149, 0x3e0293ee, v149
    v_mul_f32 v150, 0x3e0293ee, v150
    v_mfma_f32_16x16x32_bf16 v[200:203], v[28:31], a[248:251], v[200:203]
    v_mul_f32 v151, 0x3e0293ee, v151
    v_cvt_pk_bf16_f32 v56, v132, v133
    v_mfma_f32_16x16x32_bf16 v[200:203], v[32:35], v[232:235], v[200:203]
    v_cvt_pk_bf16_f32 v57, v134, v135
    v_cvt_pk_bf16_f32 v58, v148, v149
    v_mfma_f32_16x16x32_bf16 v[200:203], v[36:39], v[248:251], v[200:203]
    v_cvt_pk_bf16_f32 v59, v150, v151
    v_mul_f32 v136, 0x3e0293ee, v136
    v_mfma_f32_16x16x32_bf16 v[204:207], v[36:39], v[252:255], v[204:207]
    ds_write_b128 v10, v[56:59] offset:5120
    v_mul_f32 v137, 0x3e0293ee, v137
    v_mfma_f32_16x16x32_bf16 v[204:207], v[32:35], v[236:239], v[204:207]
    v_mul_f32 v138, 0x3e0293ee, v138
    v_mul_f32 v139, 0x3e0293ee, v139
    v_mfma_f32_16x16x32_bf16 v[204:207], v[28:31], a[252:255], v[204:207]
    s_waitcnt vmcnt(13) lgkmcnt(0)
    s_barrier
    v_mul_f32 v152, 0x3e0293ee, v152
    v_mfma_f32_16x16x32_bf16 v[220:223], v[40:43], a[252:255], v[220:223]
    ds_read_b64_tr_b16 v[16:17], v8 offset:0
    v_mul_f32 v153, 0x3e0293ee, v153
    v_mfma_f32_16x16x32_bf16 v[220:223], v[44:47], v[236:239], v[220:223]
    ds_read_b64_tr_b16 v[18:19], v8 offset:256
    v_mul_f32 v154, 0x3e0293ee, v154
    v_mfma_f32_16x16x32_bf16 v[220:223], v[48:51], v[252:255], v[220:223]
    ds_read_b64_tr_b16 v[20:21], v8 offset:2048
    v_mul_f32 v155, 0x3e0293ee, v155
    v_mfma_f32_16x16x32_bf16 v[216:219], v[48:51], v[248:251], v[216:219]
    ds_read_b64_tr_b16 v[22:23], v8 offset:2304
    v_cvt_pk_bf16_f32 v60, v136, v137
    v_mfma_f32_16x16x32_bf16 v[216:219], v[44:47], v[232:235], v[216:219]
    ds_read_b64_tr_b16 v[24:25], v8 offset:4096
    v_cvt_pk_bf16_f32 v61, v138, v139
    v_mfma_f32_16x16x32_bf16 v[216:219], v[40:43], a[248:251], v[216:219]
    ds_read_b64_tr_b16 v[26:27], v8 offset:4352
    v_cvt_pk_bf16_f32 v62, v152, v153
    v_mfma_f32_16x16x32_bf16 v[212:215], v[40:43], a[244:247], v[212:215]
    ds_read_b64_tr_b16 v[28:29], v8 offset:6144
    v_cvt_pk_bf16_f32 v63, v154, v155
    v_mfma_f32_16x16x32_bf16 v[212:215], v[44:47], v[228:231], v[212:215]
    ds_read_b64_tr_b16 v[30:31], v8 offset:6400
    v_mul_f32 v140, 0x3e0293ee, v140
    v_mfma_f32_16x16x32_bf16 v[212:215], v[48:51], v[244:247], v[212:215]
    ds_read_b64_tr_b16 v[32:33], v8 offset:8192
    v_mul_f32 v141, 0x3e0293ee, v141
    v_mfma_f32_16x16x32_bf16 v[208:211], v[48:51], v[240:243], v[208:211]
    ds_read_b64_tr_b16 v[34:35], v8 offset:8448
    v_mul_f32 v142, 0x3e0293ee, v142
    v_mfma_f32_16x16x32_bf16 v[208:211], v[44:47], v[224:227], v[208:211]
    ds_read_b64_tr_b16 v[36:37], v8 offset:10240
    v_mul_f32 v143, 0x3e0293ee, v143
    v_mfma_f32_16x16x32_bf16 v[208:211], v[40:43], a[240:243], v[208:211]
    s_waitcnt lgkmcnt(5)
    ds_read_b64_tr_b16 v[38:39], v8 offset:10496
    v_mul_f32 v156, 0x3e0293ee, v156
    v_mfma_f32_16x16x32_bf16 v[96:99], v[16:19], a[0:3], 0
    ds_read_b64_tr_b16 v[40:41], v8 offset:18432
    v_mul_f32 v157, 0x3e0293ee, v157
    v_mfma_f32_16x16x32_bf16 v[96:99], v[20:23], a[16:19], v[96:99]
    s_add_u32 s45, s54, 0
    v_mul_f32 v158, 0x3e0293ee, v158
    v_mul_f32 v159, 0x3e0293ee, v159
    v_mfma_f32_16x16x32_bf16 v[96:99], v[24:27], a[32:35], v[96:99]
    s_add_u32 m0, s53, 81920
    ds_read_b64_tr_b16 v[42:43], v8 offset:18688
    v_cvt_pk_bf16_f32 v64, v140, v141
    v_mfma_f32_16x16x32_bf16 v[100:103], v[24:27], a[36:39], 0
    buffer_load_dwordx4 v2, s[8:11], s45 offen nt lds
    v_mfma_f32_16x16x32_bf16 v[100:103], v[20:23], a[20:23], v[100:103]
    ds_read_b64_tr_b16 v[44:45], v8 offset:20480
    v_cvt_pk_bf16_f32 v65, v142, v143
    v_mfma_f32_16x16x32_bf16 v[100:103], v[16:19], a[4:7], v[100:103]
    s_add_u32 s44, s54, 147456
    v_cvt_pk_bf16_f32 v66, v156, v157
    v_cvt_pk_bf16_f32 v67, v158, v159
    v_mfma_f32_16x16x32_bf16 v[104:107], v[16:19], a[8:11], 0
    s_add_u32 m0, s53, 82944
    ds_read_b64_tr_b16 v[46:47], v8 offset:20736
    v_mul_f32 v160, 0x3e0293ee, v160
    v_mfma_f32_16x16x32_bf16 v[104:107], v[20:23], a[24:27], v[104:107]
    buffer_load_dwordx4 v2, s[8:11], s44 offen nt lds
    v_mfma_f32_16x16x32_bf16 v[104:107], v[24:27], a[40:43], v[104:107]
    ds_read_b64_tr_b16 v[48:49], v8 offset:22528
    v_mul_f32 v161, 0x3e0293ee, v161
    v_mfma_f32_16x16x32_bf16 v[108:111], v[24:27], a[44:47], 0
    s_add_u32 s45, s54, 294912
    v_mul_f32 v162, 0x3e0293ee, v162
    v_mul_f32 v163, 0x3e0293ee, v163
    v_mfma_f32_16x16x32_bf16 v[108:111], v[20:23], a[28:31], v[108:111]
    s_add_u32 m0, s53, 83968
    ds_read_b64_tr_b16 v[50:51], v8 offset:22784
    v_mul_f32 v176, 0x3e0293ee, v176
    v_mfma_f32_16x16x32_bf16 v[108:111], v[16:19], a[12:15], v[108:111]
    s_waitcnt lgkmcnt(6)
    buffer_load_dwordx4 v2, s[8:11], s45 offen nt lds
    v_mfma_f32_16x16x32_bf16 v[108:111], v[28:31], a[60:63], v[108:111]
    ds_read_b64_tr_b16 v[16:17], v8 offset:12288
    v_mul_f32 v177, 0x3e0293ee, v177
    v_mfma_f32_16x16x32_bf16 v[108:111], v[32:35], a[76:79], v[108:111]
    s_add_u32 s44, s54, 0
    v_mul_f32 v178, 0x3e0293ee, v178
    v_mul_f32 v179, 0x3e0293ee, v179
    v_mfma_f32_16x16x32_bf16 v[108:111], v[36:39], a[92:95], v[108:111]
    s_add_u32 m0, s53, 94208
    ds_read_b64_tr_b16 v[18:19], v8 offset:12544
    v_cvt_pk_bf16_f32 v52, v160, v161
    v_mfma_f32_16x16x32_bf16 v[104:107], v[36:39], a[88:91], v[104:107]
    buffer_load_dwordx4 v2, s[12:15], s44 offen nt lds
    v_mfma_f32_16x16x32_bf16 v[104:107], v[32:35], a[72:75], v[104:107]
    ds_read_b64_tr_b16 v[20:21], v8 offset:14336
    v_cvt_pk_bf16_f32 v53, v162, v163
    v_mfma_f32_16x16x32_bf16 v[104:107], v[28:31], a[56:59], v[104:107]
    ds_write_b128 v11, v[60:63] offset:1024
    v_cvt_pk_bf16_f32 v54, v176, v177
    v_mfma_f32_16x16x32_bf16 v[100:103], v[28:31], a[52:55], v[100:103]
    ds_read_b64_tr_b16 v[22:23], v8 offset:14592
    v_cvt_pk_bf16_f32 v55, v178, v179
    v_mfma_f32_16x16x32_bf16 v[100:103], v[32:35], a[68:71], v[100:103]
    s_add_u32 s45, s54, 147456
    v_mul_f32 v164, 0x3e0293ee, v164
    v_mul_f32 v165, 0x3e0293ee, v165
    v_mfma_f32_16x16x32_bf16 v[100:103], v[36:39], a[84:87], v[100:103]
    s_add_u32 m0, s53, 95232
    ds_read_b64_tr_b16 v[24:25], v8 offset:16384
    v_mul_f32 v166, 0x3e0293ee, v166
    v_mfma_f32_16x16x32_bf16 v[96:99], v[36:39], a[80:83], v[96:99]
    buffer_load_dwordx4 v2, s[12:15], s45 offen nt lds
    v_mfma_f32_16x16x32_bf16 v[96:99], v[32:35], a[64:67], v[96:99]
    ds_read_b64_tr_b16 v[26:27], v8 offset:16640
    v_mul_f32 v167, 0x3e0293ee, v167
    v_mfma_f32_16x16x32_bf16 v[96:99], v[28:31], a[48:51], v[96:99]
    s_waitcnt lgkmcnt(7)
    v_mul_f32 v180, 0x3e0293ee, v180
    v_mul_f32 v181, 0x3e0293ee, v181
    v_mfma_f32_16x16x32_bf16 v[128:131], v[40:43], a[48:51], 0
    s_add_u32 s44, s54, 294912
    v_mul_f32 v182, 0x3e0293ee, v182
    v_mul_f32 v183, 0x3e0293ee, v183
    v_mfma_f32_16x16x32_bf16 v[128:131], v[44:47], a[64:67], v[128:131]
    s_add_u32 m0, s53, 96256
    v_cvt_pk_bf16_f32 v56, v164, v165
    v_cvt_pk_bf16_f32 v57, v166, v167
    v_mfma_f32_16x16x32_bf16 v[128:131], v[48:51], a[80:83], v[128:131]
    buffer_load_dwordx4 v2, s[12:15], s44 offen nt lds
    v_mfma_f32_16x16x32_bf16 v[132:135], v[48:51], a[84:87], 0
    ds_write_b128 v11, v[64:67] offset:5120
    v_cvt_pk_bf16_f32 v58, v180, v181
    v_mfma_f32_16x16x32_bf16 v[132:135], v[44:47], a[68:71], v[132:135]
    ds_write_b128 v10, v[52:55] offset:2048
    v_cvt_pk_bf16_f32 v59, v182, v183
    v_mfma_f32_16x16x32_bf16 v[132:135], v[40:43], a[52:55], v[132:135]
    ds_write_b128 v10, v[56:59] offset:6144
    v_mul_f32 v168, 0x3e0293ee, v168
    v_mfma_f32_16x16x32_bf16 v[136:139], v[40:43], a[56:59], 0
    v_mul_f32 v169, 0x3e0293ee, v169
    v_mul_f32 v170, 0x3e0293ee, v170
    v_mfma_f32_16x16x32_bf16 v[136:139], v[44:47], a[72:75], v[136:139]
    v_mul_f32 v171, 0x3e0293ee, v171
    v_mul_f32 v184, 0x3e0293ee, v184
    v_mfma_f32_16x16x32_bf16 v[136:139], v[48:51], a[88:91], v[136:139]
    v_mul_f32 v185, 0x3e0293ee, v185
    v_mul_f32 v186, 0x3e0293ee, v186
    v_mfma_f32_16x16x32_bf16 v[140:143], v[48:51], a[92:95], 0
    v_mul_f32 v187, 0x3e0293ee, v187
    v_cvt_pk_bf16_f32 v60, v168, v169
    v_mfma_f32_16x16x32_bf16 v[140:143], v[44:47], a[76:79], v[140:143]
    v_cvt_pk_bf16_f32 v61, v170, v171
    v_cvt_pk_bf16_f32 v62, v184, v185
    v_mfma_f32_16x16x32_bf16 v[140:143], v[40:43], a[60:63], v[140:143]
    s_waitcnt vmcnt(12) lgkmcnt(0)
    s_barrier
    v_cvt_pk_bf16_f32 v63, v186, v187
    v_mfma_f32_16x16x32_bf16 v[140:143], v[16:19], a[12:15], v[140:143]
    ds_read_b64_tr_b16 v[28:29], v9 offset:0
    v_mul_f32 v172, 0x3e0293ee, v172
    v_mfma_f32_16x16x32_bf16 v[140:143], v[20:23], a[28:31], v[140:143]
    ds_read_b64_tr_b16 v[30:31], v9 offset:256
    v_mul_f32 v173, 0x3e0293ee, v173
    v_mfma_f32_16x16x32_bf16 v[140:143], v[24:27], a[44:47], v[140:143]
    ds_read_b64_tr_b16 v[32:33], v9 offset:2048
    v_mul_f32 v174, 0x3e0293ee, v174
    v_mfma_f32_16x16x32_bf16 v[136:139], v[24:27], a[40:43], v[136:139]
    ds_read_b64_tr_b16 v[34:35], v9 offset:2304
    v_mul_f32 v175, 0x3e0293ee, v175
    v_mfma_f32_16x16x32_bf16 v[136:139], v[20:23], a[24:27], v[136:139]
    ds_read_b64_tr_b16 v[36:37], v9 offset:4096
    v_mul_f32 v188, 0x3e0293ee, v188
    v_mfma_f32_16x16x32_bf16 v[136:139], v[16:19], a[8:11], v[136:139]
    ds_read_b64_tr_b16 v[38:39], v9 offset:4352
    v_mul_f32 v189, 0x3e0293ee, v189
    v_mfma_f32_16x16x32_bf16 v[132:135], v[16:19], a[4:7], v[132:135]
    ds_read_b64_tr_b16 v[40:41], v9 offset:6144
    v_mul_f32 v190, 0x3e0293ee, v190
    v_mfma_f32_16x16x32_bf16 v[132:135], v[20:23], a[20:23], v[132:135]
    ds_read_b64_tr_b16 v[42:43], v9 offset:6400
    v_mul_f32 v191, 0x3e0293ee, v191
    v_mfma_f32_16x16x32_bf16 v[132:135], v[24:27], a[36:39], v[132:135]
    ds_read_b64_tr_b16 v[44:45], v9 offset:8192
    v_cvt_pk_bf16_f32 v64, v172, v173
    v_mfma_f32_16x16x32_bf16 v[128:131], v[24:27], a[32:35], v[128:131]
    ds_read_b64_tr_b16 v[46:47], v9 offset:8448
    v_cvt_pk_bf16_f32 v65, v174, v175
    v_mfma_f32_16x16x32_bf16 v[128:131], v[20:23], a[16:19], v[128:131]
    ds_read_b64_tr_b16 v[48:49], v9 offset:10240
    v_cvt_pk_bf16_f32 v66, v188, v189
    v_mfma_f32_16x16x32_bf16 v[128:131], v[16:19], a[0:3], v[128:131]
    s_waitcnt lgkmcnt(5)
    ds_read_b64_tr_b16 v[50:51], v9 offset:10496
    v_cvt_pk_bf16_f32 v67, v190, v191
    v_mfma_f32_16x16x32_bf16 v[96:99], v[28:31], a[96:99], v[96:99]
    ds_read_b64_tr_b16 v[16:17], v9 offset:18432
    v_mul_f32 v192, 0x3e0293ee, v192
    v_mfma_f32_16x16x32_bf16 v[96:99], v[32:35], a[112:115], v[96:99]
    s_add_u32 s45, s54, 1769472
    v_mul_f32 v193, 0x3e0293ee, v193
    v_mul_f32 v194, 0x3e0293ee, v194
    v_mfma_f32_16x16x32_bf16 v[96:99], v[36:39], a[128:131], v[96:99]
    s_add_u32 m0, s53, 40960
    ds_read_b64_tr_b16 v[18:19], v9 offset:18688
    v_mul_f32 v195, 0x3e0293ee, v195
    v_mfma_f32_16x16x32_bf16 v[100:103], v[36:39], a[132:135], v[100:103]
    buffer_load_dwordx4 v2, s[8:11], s45 offen nt lds
    v_mfma_f32_16x16x32_bf16 v[100:103], v[32:35], a[116:119], v[100:103]
    ds_read_b64_tr_b16 v[20:21], v9 offset:20480
    v_mul_f32 v208, 0x3e0293ee, v208
    v_mfma_f32_16x16x32_bf16 v[100:103], v[28:31], a[100:103], v[100:103]
    s_add_u32 s44, s54, 1916928
    v_mul_f32 v209, 0x3e0293ee, v209
    v_mul_f32 v210, 0x3e0293ee, v210
    v_mfma_f32_16x16x32_bf16 v[104:107], v[28:31], a[104:107], v[104:107]
    s_add_u32 m0, s53, 41984
    ds_read_b64_tr_b16 v[22:23], v9 offset:20736
    v_mul_f32 v211, 0x3e0293ee, v211
    v_mfma_f32_16x16x32_bf16 v[104:107], v[32:35], a[120:123], v[104:107]
    buffer_load_dwordx4 v2, s[8:11], s44 offen nt lds
    v_mfma_f32_16x16x32_bf16 v[104:107], v[36:39], a[136:139], v[104:107]
    ds_read_b64_tr_b16 v[24:25], v9 offset:22528
    v_cvt_pk_bf16_f32 v52, v192, v193
    v_mfma_f32_16x16x32_bf16 v[108:111], v[36:39], a[140:143], v[108:111]
    s_add_u32 s45, s54, 2064384
    v_cvt_pk_bf16_f32 v53, v194, v195
    v_cvt_pk_bf16_f32 v54, v208, v209
    v_mfma_f32_16x16x32_bf16 v[108:111], v[32:35], a[124:127], v[108:111]
    s_add_u32 m0, s53, 43008
    ds_read_b64_tr_b16 v[26:27], v9 offset:22784
    v_cvt_pk_bf16_f32 v55, v210, v211
    v_mfma_f32_16x16x32_bf16 v[108:111], v[28:31], a[108:111], v[108:111]
    s_waitcnt lgkmcnt(6)
    buffer_load_dwordx4 v2, s[8:11], s45 offen nt lds
    v_mfma_f32_16x16x32_bf16 v[108:111], v[40:43], a[156:159], v[108:111]
    ds_read_b64_tr_b16 v[28:29], v9 offset:12288
    v_mul_f32 v196, 0x3e0293ee, v196
    v_mfma_f32_16x16x32_bf16 v[108:111], v[44:47], a[172:175], v[108:111]
    s_add_u32 s44, s54, 1769472
    v_mul_f32 v197, 0x3e0293ee, v197
    v_mul_f32 v198, 0x3e0293ee, v198
    v_mfma_f32_16x16x32_bf16 v[108:111], v[48:51], a[188:191], v[108:111]
    s_add_u32 m0, s53, 53248
    ds_read_b64_tr_b16 v[30:31], v9 offset:12544
    v_mul_f32 v199, 0x3e0293ee, v199
    v_mfma_f32_16x16x32_bf16 v[104:107], v[48:51], a[184:187], v[104:107]
    buffer_load_dwordx4 v2, s[12:15], s44 offen nt lds
    v_mfma_f32_16x16x32_bf16 v[104:107], v[44:47], a[168:171], v[104:107]
    ds_read_b64_tr_b16 v[32:33], v9 offset:14336
    v_mul_f32 v212, 0x3e0293ee, v212
    v_mfma_f32_16x16x32_bf16 v[104:107], v[40:43], a[152:155], v[104:107]
    ds_write_b128 v11, v[60:63] offset:2048
    v_mul_f32 v213, 0x3e0293ee, v213
    v_mfma_f32_16x16x32_bf16 v[100:103], v[40:43], a[148:151], v[100:103]
    ds_read_b64_tr_b16 v[34:35], v9 offset:14592
    v_mul_f32 v214, 0x3e0293ee, v214
    v_mfma_f32_16x16x32_bf16 v[100:103], v[44:47], a[164:167], v[100:103]
    s_add_u32 s45, s54, 1916928
    v_mul_f32 v215, 0x3e0293ee, v215
    v_cvt_pk_bf16_f32 v56, v196, v197
    v_mfma_f32_16x16x32_bf16 v[100:103], v[48:51], a[180:183], v[100:103]
    s_add_u32 m0, s53, 54272
    ds_read_b64_tr_b16 v[36:37], v9 offset:16384
    v_cvt_pk_bf16_f32 v57, v198, v199
    v_mfma_f32_16x16x32_bf16 v[96:99], v[48:51], a[176:179], v[96:99]
    buffer_load_dwordx4 v2, s[12:15], s45 offen nt lds
    v_mfma_f32_16x16x32_bf16 v[96:99], v[44:47], a[160:163], v[96:99]
L_pad13:
    s_cbranch_execz L_padend
    ds_read_b64_tr_b16 v[38:39], v9 offset:16640
    v_cvt_pk_bf16_f32 v58, v212, v213
    v_mfma_f32_16x16x32_bf16 v[96:99], v[40:43], a[144:147], v[96:99]
    s_waitcnt lgkmcnt(7)
    v_cvt_pk_bf16_f32 v59, v214, v215
    v_mul_f32 v200, 0x3e0293ee, v200
    v_mfma_f32_16x16x32_bf16 v[128:131], v[16:19], a[144:147], v[128:131]
    s_add_u32 s44, s54, 2064384
    v_mul_f32 v201, 0x3e0293ee, v201
    v_mul_f32 v202, 0x3e0293ee, v202
    v_mfma_f32_16x16x32_bf16 v[128:131], v[20:23], a[160:163], v[128:131]
    s_add_u32 m0, s53, 55296
    v_mul_f32 v203, 0x3e0293ee, v203
    v_mul_f32 v216, 0x3e0293ee, v216
    v_mfma_f32_16x16x32_bf16 v[128:131], v[24:27], a[176:179], v[128:131]
    buffer_load_dwordx4 v2, s[12:15], s44 offen nt lds
    v_mfma_f32_16x16x32_bf16 v[132:135], v[24:27], a[180:183], v[132:135]
    ds_write_b128 v11, v[64:67] offset:6144
    v_mul_f32 v217, 0x3e0293ee, v217
    v_mfma_f32_16x16x32_bf16 v[132:135], v[20:23], a[164:167], v[132:135]
    ds_write_b128 v10, v[52:55] offset:3072
    v_mul_f32 v218, 0x3e0293ee, v218
    v_mfma_f32_16x16x32_bf16 v[132:135], v[16:19], a[148:151], v[132:135]
    ds_write_b128 v10, v[56:59] offset:7168
    v_mul_f32 v219, 0x3e0293ee, v219
    v_mfma_f32_16x16x32_bf16 v[136:139], v[16:19], a[152:155], v[136:139]
    v_cvt_pk_bf16_f32 v60, v200, v201
    v_cvt_pk_bf16_f32 v61, v202, v203
    v_mfma_f32_16x16x32_bf16 v[136:139], v[20:23], a[168:171], v[136:139]
    v_cvt_pk_bf16_f32 v62, v216, v217
    v_cvt_pk_bf16_f32 v63, v218, v219
    v_mfma_f32_16x16x32_bf16 v[136:139], v[24:27], a[184:187], v[136:139]
    ds_write_b128 v11, v[60:63] offset:3072
    v_mul_f32 v204, 0x3e0293ee, v204
    v_mfma_f32_16x16x32_bf16 v[140:143], v[24:27], a[188:191], v[140:143]
    v_mul_f32 v205, 0x3e0293ee, v205
    v_mul_f32 v206, 0x3e0293ee, v206
    v_mfma_f32_16x16x32_bf16 v[140:143], v[20:23], a[172:175], v[140:143]
    v_mul_f32 v207, 0x3e0293ee, v207
    v_mul_f32 v220, 0x3e0293ee, v220
    v_mfma_f32_16x16x32_bf16 v[140:143], v[16:19], a[156:159], v[140:143]
    s_waitcnt vmcnt(12) lgkmcnt(0)
    s_barrier
    v_mul_f32 v221, 0x3e0293ee, v221
    v_mfma_f32_16x16x32_bf16 v[140:143], v[28:31], a[108:111], v[140:143]
    ds_read_b64_tr_b16 v[40:41], v9 offset:24576
    v_mul_f32 v222, 0x3e0293ee, v222
    v_mfma_f32_16x16x32_bf16 v[140:143], v[32:35], a[124:127], v[140:143]
    ds_read_b64_tr_b16 v[42:43], v9 offset:24832
    v_mul_f32 v223, 0x3e0293ee, v223
    v_mfma_f32_16x16x32_bf16 v[140:143], v[36:39], a[140:143], v[140:143]
    ds_read_b64_tr_b16 v[44:45], v9 offset:26624
    v_cvt_pk_bf16_f32 v64, v204, v205
    v_mfma_f32_16x16x32_bf16 v[136:139], v[36:39], a[136:139], v[136:139]
    ds_read_b64_tr_b16 v[46:47], v9 offset:26880
    v_cvt_pk_bf16_f32 v65, v206, v207
    v_mfma_f32_16x16x32_bf16 v[136:139], v[32:35], a[120:123], v[136:139]
    ds_read_b64_tr_b16 v[48:49], v9 offset:28672
    v_cvt_pk_bf16_f32 v66, v220, v221
    v_mfma_f32_16x16x32_bf16 v[136:139], v[28:31], a[104:107], v[136:139]
    ds_read_b64_tr_b16 v[50:51], v9 offset:28928
    v_cvt_pk_bf16_f32 v67, v222, v223
    v_mfma_f32_16x16x32_bf16 v[132:135], v[28:31], a[100:103], v[132:135]
    ds_read_b64_tr_b16 v[16:17], v9 offset:30720
    v_mfma_f32_16x16x32_bf16 v[132:135], v[32:35], a[116:119], v[132:135]
    ds_read_b64_tr_b16 v[18:19], v9 offset:30976
    v_mfma_f32_16x16x32_bf16 v[132:135], v[36:39], a[132:135], v[132:135]
    ds_read_b64_tr_b16 v[20:21], v9 offset:32768
    v_mfma_f32_16x16x32_bf16 v[128:131], v[36:39], a[128:131], v[128:131]
    ds_read_b64_tr_b16 v[22:23], v9 offset:33024
    v_mfma_f32_16x16x32_bf16 v[128:131], v[32:35], a[112:115], v[128:131]
    ds_read_b64_tr_b16 v[24:25], v9 offset:34816
    v_mfma_f32_16x16x32_bf16 v[128:131], v[28:31], a[96:99], v[128:131]
    s_waitcnt lgkmcnt(5)
    ds_read_b64_tr_b16 v[26:27], v9 offset:35072
    v_mfma_f32_16x16x32_bf16 v[96:99], v[40:43], a[192:195], v[96:99]
    ds_read_b64_tr_b16 v[28:29], v9 offset:43008
    v_mfma_f32_16x16x32_bf16 v[96:99], v[44:47], a[208:211], v[96:99]
    s_add_u32 s45, s54, 3538944
    s_waitcnt vmcnt(24)
    v_subrev_u32 v74, s69, v74
    v_xor_b32 v75, s68, v75
    v_min_u32 v75, 1, v75
    v_lshl_or_b32 v74, v75, 8, v74
    v_cmp_le_u32 vcc, 8, v74
    s_nop 1
    s_cmp_lg_u64 vcc, 0
    s_cselect_b32 s72, 1, 0
    v_mfma_f32_16x16x32_bf16 v[96:99], v[48:51], a[224:227], v[96:99]
    s_add_u32 m0, s53, 106496
    ds_read_b64_tr_b16 v[30:31], v9 offset:43264
    v_mfma_f32_16x16x32_bf16 v[100:103], v[48:51], a[228:231], v[100:103]
    buffer_load_dwordx4 v2, s[8:11], s45 offen nt lds
    v_mfma_f32_16x16x32_bf16 v[100:103], v[44:47], a[212:215], v[100:103]
    ds_read_b64_tr_b16 v[32:33], v9 offset:45056
    v_mfma_f32_16x16x32_bf16 v[100:103], v[40:43], a[196:199], v[100:103]
    s_add_u32 s44, s54, 3686400
    v_mfma_f32_16x16x32_bf16 v[104:107], v[40:43], a[200:203], v[104:107]
    s_add_u32 m0, s53, 107520
    ds_read_b64_tr_b16 v[34:35], v9 offset:45312
    v_mfma_f32_16x16x32_bf16 v[104:107], v[44:47], a[216:219], v[104:107]
    buffer_load_dwordx4 v2, s[8:11], s44 offen nt lds
    v_mfma_f32_16x16x32_bf16 v[104:107], v[48:51], a[232:235], v[104:107]
    ds_read_b64_tr_b16 v[36:37], v9 offset:47104
    v_mfma_f32_16x16x32_bf16 v[108:111], v[48:51], a[236:239], v[108:111]
    s_add_u32 s45, s54, 3833856
    v_mfma_f32_16x16x32_bf16 v[108:111], v[44:47], a[220:223], v[108:111]
    s_add_u32 m0, s53, 108544
    ds_read_b64_tr_b16 v[38:39], v9 offset:47360
    v_mfma_f32_16x16x32_bf16 v[108:111], v[40:43], a[204:207], v[108:111]
    s_waitcnt lgkmcnt(6)
    buffer_load_dwordx4 v2, s[8:11], s45 offen nt lds
    v_mfma_f32_16x16x32_bf16 v[108:111], v[16:19], a[252:255], v[108:111]
    ds_read_b64_tr_b16 v[40:41], v9 offset:36864
    v_mfma_f32_16x16x32_bf16 v[108:111], v[20:23], v[236:239], v[108:111]
    s_add_u32 s44, s54, 3538944
    v_mfma_f32_16x16x32_bf16 v[108:111], v[24:27], v[252:255], v[108:111]
    s_add_u32 m0, s53, 118784
    ds_read_b64_tr_b16 v[42:43], v9 offset:37120
    v_mfma_f32_16x16x32_bf16 v[104:107], v[24:27], v[248:251], v[104:107]
    buffer_load_dwordx4 v2, s[12:15], s44 offen nt lds
    v_mfma_f32_16x16x32_bf16 v[104:107], v[20:23], v[232:235], v[104:107]
    ds_read_b64_tr_b16 v[44:45], v9 offset:38912
    v_mfma_f32_16x16x32_bf16 v[104:107], v[16:19], a[248:251], v[104:107]
    ds_write_b128 v11, v[64:67] offset:7168
    v_mfma_f32_16x16x32_bf16 v[100:103], v[16:19], a[244:247], v[100:103]
    ds_read_b64_tr_b16 v[46:47], v9 offset:39168
    v_mfma_f32_16x16x32_bf16 v[100:103], v[20:23], v[228:231], v[100:103]
    s_add_u32 s45, s54, 3686400
    v_mfma_f32_16x16x32_bf16 v[100:103], v[24:27], v[244:247], v[100:103]
    s_add_u32 m0, s53, 119808
    ds_read_b64_tr_b16 v[48:49], v9 offset:40960
    v_mfma_f32_16x16x32_bf16 v[96:99], v[24:27], v[240:243], v[96:99]
    buffer_load_dwordx4 v2, s[12:15], s45 offen nt lds
    v_mfma_f32_16x16x32_bf16 v[96:99], v[20:23], v[224:227], v[96:99]
    ds_read_b64_tr_b16 v[50:51], v9 offset:41216
    v_mfma_f32_16x16x32_bf16 v[96:99], v[16:19], a[240:243], v[96:99]
    s_waitcnt lgkmcnt(7)
    v_mfma_f32_16x16x32_bf16 v[128:131], v[28:31], a[240:243], v[128:131]
    s_add_u32 s44, s54, 3833856
    v_mfma_f32_16x16x32_bf16 v[128:131], v[32:35], v[224:227], v[128:131]
    s_add_u32 m0, s53, 120832
    v_mfma_f32_16x16x32_bf16 v[128:131], v[36:39], v[240:243], v[128:131]
    buffer_load_dwordx4 v2, s[12:15], s44 offen nt lds
    v_mfma_f32_16x16x32_bf16 v[132:135], v[36:39], v[244:247], v[132:135]
    v_mfma_f32_16x16x32_bf16 v[132:135], v[32:35], v[228:231], v[132:135]
    v_mfma_f32_16x16x32_bf16 v[132:135], v[28:31], a[244:247], v[132:135]
    v_mfma_f32_16x16x32_bf16 v[136:139], v[28:31], a[248:251], v[136:139]
    v_mfma_f32_16x16x32_bf16 v[136:139], v[32:35], v[232:235], v[136:139]
    v_mfma_f32_16x16x32_bf16 v[136:139], v[36:39], v[248:251], v[136:139]
    v_mfma_f32_16x16x32_bf16 v[140:143], v[36:39], v[252:255], v[140:143]
    v_mfma_f32_16x16x32_bf16 v[140:143], v[32:35], v[236:239], v[140:143]
    v_mfma_f32_16x16x32_bf16 v[140:143], v[28:31], a[252:255], v[140:143]
    s_waitcnt vmcnt(12) lgkmcnt(0)
    s_barrier
    v_mfma_f32_16x16x32_bf16 v[140:143], v[40:43], a[204:207], v[140:143]
    ds_read_b64_tr_b16 v[16:17], v4 offset:40960
    v_mfma_f32_16x16x32_bf16 v[140:143], v[44:47], a[220:223], v[140:143]
    ds_read_b64_tr_b16 v[18:19], v4 offset:41216
    v_mfma_f32_16x16x32_bf16 v[140:143], v[48:51], a[236:239], v[140:143]
    ds_read_b64_tr_b16 v[20:21], v4 offset:43008
    v_mfma_f32_16x16x32_bf16 v[136:139], v[48:51], a[232:235], v[136:139]
    ds_read_b64_tr_b16 v[22:23], v4 offset:43264
    v_mfma_f32_16x16x32_bf16 v[136:139], v[44:47], a[216:219], v[136:139]
    ds_read_b64_tr_b16 v[24:25], v4 offset:45056
    v_mfma_f32_16x16x32_bf16 v[136:139], v[40:43], a[200:203], v[136:139]
    ds_read_b64_tr_b16 v[26:27], v4 offset:45312
    v_mfma_f32_16x16x32_bf16 v[132:135], v[40:43], a[196:199], v[132:135]
    ds_read_b64_tr_b16 v[28:29], v4 offset:47104
    v_mfma_f32_16x16x32_bf16 v[132:135], v[44:47], a[212:215], v[132:135]
    ds_read_b64_tr_b16 v[30:31], v4 offset:47360
    v_mfma_f32_16x16x32_bf16 v[132:135], v[48:51], a[228:231], v[132:135]
    ds_read_b64_tr_b16 v[32:33], v4 offset:49152
    v_mfma_f32_16x16x32_bf16 v[128:131], v[48:51], a[224:227], v[128:131]
    ds_read_b64_tr_b16 v[34:35], v4 offset:49408
    v_mfma_f32_16x16x32_bf16 v[128:131], v[44:47], a[208:211], v[128:131]
    ds_read_b64_tr_b16 v[36:37], v4 offset:51200
    v_mfma_f32_16x16x32_bf16 v[128:131], v[40:43], a[192:195], v[128:131]
    s_waitcnt lgkmcnt(5)
    ds_read_b64_tr_b16 v[38:39], v4 offset:51456
    v_mfma_f32_16x16x32_bf16 v[160:163], v[16:19], a[0:3], 0
    ds_read_b64_tr_b16 v[40:41], v5 offset:47104
    v_mfma_f32_16x16x32_bf16 v[160:163], v[20:23], a[16:19], v[160:163]
    s_add_u32 s45, s54, 64
    v_mfma_f32_16x16x32_bf16 v[160:163], v[24:27], a[32:35], v[160:163]
    s_add_u32 m0, s53, 131072
    ds_read_b64_tr_b16 v[42:43], v5 offset:47360
    v_mfma_f32_16x16x32_bf16 v[164:167], v[24:27], a[36:39], 0
    buffer_load_dwordx4 v2, s[8:11], s45 offen nt lds
    v_mfma_f32_16x16x32_bf16 v[164:167], v[20:23], a[20:23], v[164:167]
    ds_read_b64_tr_b16 v[44:45], v5 offset:49152
    v_mul_f32 v52, v96, v96
    v_mfma_f32_16x16x32_bf16 v[164:167], v[16:19], a[4:7], v[164:167]
    v_mul_f32 v53, v97, v97
    v_mul_f32 v54, v98, v98
    v_mfma_f32_16x16x32_bf16 v[168:171], v[16:19], a[8:11], 0
    ds_read_b64_tr_b16 v[46:47], v5 offset:49408
    v_mul_f32 v55, v99, v99
    v_mfma_f32_16x16x32_bf16 v[168:171], v[20:23], a[24:27], v[168:171]
    v_fma_f32 v52, v52, v13, v12
    v_fma_f32 v53, v53, v13, v12
    v_mfma_f32_16x16x32_bf16 v[168:171], v[24:27], a[40:43], v[168:171]
    ds_read_b64_tr_b16 v[48:49], v5 offset:51200
    v_fma_f32 v54, v54, v13, v12
    v_mfma_f32_16x16x32_bf16 v[172:175], v[24:27], a[44:47], 0
    v_fma_f32 v55, v55, v13, v12
    v_mul_f32 v52, v52, v96
    v_mfma_f32_16x16x32_bf16 v[172:175], v[20:23], a[28:31], v[172:175]
    ds_read_b64_tr_b16 v[50:51], v5 offset:51456
    v_mul_f32 v53, v53, v97
    v_mfma_f32_16x16x32_bf16 v[172:175], v[16:19], a[12:15], v[172:175]
    s_waitcnt lgkmcnt(6)
    v_exp_f32 v52, v52
    v_mfma_f32_16x16x32_bf16 v[172:175], v[28:31], a[60:63], v[172:175]
    ds_read_b64_tr_b16 v[16:17], v5 offset:40960
    v_mul_f32 v54, v54, v98
    v_mfma_f32_16x16x32_bf16 v[172:175], v[32:35], a[76:79], v[172:175]
    s_add_u32 s44, s54, 147520
    v_exp_f32 v53, v53
    v_mfma_f32_16x16x32_bf16 v[172:175], v[36:39], a[92:95], v[172:175]
    s_add_u32 m0, s53, 132096
    ds_read_b64_tr_b16 v[18:19], v5 offset:41216
    v_mul_f32 v55, v55, v99
    v_mfma_f32_16x16x32_bf16 v[168:171], v[36:39], a[88:91], v[168:171]
    buffer_load_dwordx4 v2, s[8:11], s44 offen nt lds
    v_mfma_f32_16x16x32_bf16 v[168:171], v[32:35], a[72:75], v[168:171]
    ds_read_b64_tr_b16 v[20:21], v5 offset:43008
    v_mul_f32 v96, v96, v128
    v_mfma_f32_16x16x32_bf16 v[168:171], v[28:31], a[56:59], v[168:171]
    v_exp_f32 v54, v54
    v_mfma_f32_16x16x32_bf16 v[164:167], v[28:31], a[52:55], v[164:167]
    ds_read_b64_tr_b16 v[22:23], v5 offset:43264
    v_mul_f32 v97, v97, v129
    v_mfma_f32_16x16x32_bf16 v[164:167], v[32:35], a[68:71], v[164:167]
    v_exp_f32 v55, v55
    v_mfma_f32_16x16x32_bf16 v[164:167], v[36:39], a[84:87], v[164:167]
    ds_read_b64_tr_b16 v[24:25], v5 offset:45056
    v_mul_f32 v98, v98, v130
    v_mfma_f32_16x16x32_bf16 v[160:163], v[36:39], a[80:83], v[160:163]
    v_mul_f32 v99, v99, v131
    v_add_f32 v52, 1.0, v52
    v_mfma_f32_16x16x32_bf16 v[160:163], v[32:35], a[64:67], v[160:163]
    ds_read_b64_tr_b16 v[26:27], v5 offset:45312
    v_add_f32 v53, 1.0, v53
    v_mfma_f32_16x16x32_bf16 v[160:163], v[28:31], a[48:51], v[160:163]
    s_waitcnt lgkmcnt(6)
    v_rcp_f32 v52, v52
    v_mfma_f32_16x16x32_bf16 v[176:179], v[40:43], a[48:51], 0
    ds_read_b64_tr_b16 v[28:29], v4 offset:53248
    v_add_f32 v54, 1.0, v54
    v_mfma_f32_16x16x32_bf16 v[176:179], v[44:47], a[64:67], v[176:179]
    s_add_u32 s45, s54, 294976
    v_rcp_f32 v53, v53
    v_mfma_f32_16x16x32_bf16 v[176:179], v[48:51], a[80:83], v[176:179]
    s_add_u32 m0, s53, 133120
    ds_read_b64_tr_b16 v[30:31], v4 offset:53504
    v_add_f32 v55, 1.0, v55
    v_mfma_f32_16x16x32_bf16 v[180:183], v[48:51], a[84:87], 0
    buffer_load_dwordx4 v2, s[8:11], s45 offen nt lds
    v_mfma_f32_16x16x32_bf16 v[180:183], v[44:47], a[68:71], v[180:183]
    ds_read_b64_tr_b16 v[32:33], v4 offset:55296
    v_mul_f32 v96, v96, v52
    v_mfma_f32_16x16x32_bf16 v[180:183], v[40:43], a[52:55], v[180:183]
    v_rcp_f32 v54, v54
    v_mfma_f32_16x16x32_bf16 v[184:187], v[40:43], a[56:59], 0
    ds_read_b64_tr_b16 v[34:35], v4 offset:55552
    v_mul_f32 v97, v97, v53
    v_mfma_f32_16x16x32_bf16 v[184:187], v[44:47], a[72:75], v[184:187]
    v_rcp_f32 v55, v55
    v_mfma_f32_16x16x32_bf16 v[184:187], v[48:51], a[88:91], v[184:187]
    ds_read_b64_tr_b16 v[36:37], v4 offset:57344
    v_mul_f32 v98, v98, v54
    v_mfma_f32_16x16x32_bf16 v[188:191], v[48:51], a[92:95], 0
    v_mul_f32 v99, v99, v55
    v_cvt_pk_bf16_f32 v68, v96, v97
    v_mfma_f32_16x16x32_bf16 v[188:191], v[44:47], a[76:79], v[188:191]
    ds_read_b64_tr_b16 v[38:39], v4 offset:57600
    v_cvt_pk_bf16_f32 v69, v98, v99
    v_mfma_f32_16x16x32_bf16 v[188:191], v[40:43], a[60:63], v[188:191]
    s_waitcnt lgkmcnt(6)
    v_mul_f32 v60, v100, v100
    v_mul_f32 v61, v101, v101
    v_mfma_f32_16x16x32_bf16 v[188:191], v[16:19], a[12:15], v[188:191]
    ds_read_b64_tr_b16 v[40:41], v4 offset:59392
    v_mul_f32 v62, v102, v102
    v_mfma_f32_16x16x32_bf16 v[188:191], v[20:23], a[28:31], v[188:191]
    s_add_u32 s44, s54, 64
    v_mul_f32 v63, v103, v103
    v_fma_f32 v60, v60, v13, v12
    v_mfma_f32_16x16x32_bf16 v[188:191], v[24:27], a[44:47], v[188:191]
    s_add_u32 m0, s53, 143360
    ds_read_b64_tr_b16 v[42:43], v4 offset:59648
    v_fma_f32 v61, v61, v13, v12
    v_mfma_f32_16x16x32_bf16 v[184:187], v[24:27], a[40:43], v[184:187]
    buffer_load_dwordx4 v2, s[12:15], s44 offen nt lds
    v_mfma_f32_16x16x32_bf16 v[184:187], v[20:23], a[24:27], v[184:187]
    ds_read_b64_tr_b16 v[44:45], v4 offset:61440
    v_fma_f32 v62, v62, v13, v12
    v_mfma_f32_16x16x32_bf16 v[184:187], v[16:19], a[8:11], v[184:187]
    s_add_u32 s46, s60, 4194304
    buffer_store_dwordx2 v[68:69], v1, s[28:31], s46 offen
    v_mfma_f32_16x16x32_bf16 v[180:183], v[16:19], a[4:7], v[180:183]
    ds_read_b64_tr_b16 v[46:47], v4 offset:61696
    v_fma_f32 v63, v63, v13, v12
    v_mfma_f32_16x16x32_bf16 v[180:183], v[20:23], a[20:23], v[180:183]
    v_mul_f32 v60, v60, v100
    v_mul_f32 v61, v61, v101
    v_mfma_f32_16x16x32_bf16 v[180:183], v[24:27], a[36:39], v[180:183]
    ds_read_b64_tr_b16 v[48:49], v4 offset:63488
    v_mul_f32 v62, v62, v102
    v_mfma_f32_16x16x32_bf16 v[176:179], v[24:27], a[32:35], v[176:179]
    v_exp_f32 v60, v60
    v_mfma_f32_16x16x32_bf16 v[176:179], v[20:23], a[16:19], v[176:179]
    ds_read_b64_tr_b16 v[50:51], v4 offset:63744
    v_mul_f32 v63, v63, v103
    v_mfma_f32_16x16x32_bf16 v[176:179], v[16:19], a[0:3], v[176:179]
    s_waitcnt lgkmcnt(6)
    v_exp_f32 v61, v61
    v_mfma_f32_16x16x32_bf16 v[192:195], v[28:31], a[0:3], 0
    ds_read_b64_tr_b16 v[16:17], v5 offset:59392
    v_mul_f32 v100, v100, v132
    v_mfma_f32_16x16x32_bf16 v[192:195], v[32:35], a[16:19], v[192:195]
    v_exp_f32 v62, v62
    v_mfma_f32_16x16x32_bf16 v[192:195], v[36:39], a[32:35], v[192:195]
    ds_read_b64_tr_b16 v[18:19], v5 offset:59648
    v_mul_f32 v101, v101, v133
    v_mfma_f32_16x16x32_bf16 v[196:199], v[36:39], a[36:39], 0
    s_add_u32 s45, s54, 147520
    v_exp_f32 v63, v63
    v_mfma_f32_16x16x32_bf16 v[196:199], v[32:35], a[20:23], v[196:199]
    s_add_u32 m0, s53, 144384
    ds_read_b64_tr_b16 v[20:21], v5 offset:61440
    v_mul_f32 v102, v102, v134
    v_mfma_f32_16x16x32_bf16 v[196:199], v[28:31], a[4:7], v[196:199]
    buffer_load_dwordx4 v2, s[12:15], s45 offen nt lds
    v_mfma_f32_16x16x32_bf16 v[200:203], v[28:31], a[8:11], 0
    ds_read_b64_tr_b16 v[22:23], v5 offset:61696
    v_mul_f32 v103, v103, v135
    v_mfma_f32_16x16x32_bf16 v[200:203], v[32:35], a[24:27], v[200:203]
    v_add_f32 v60, 1.0, v60
    v_add_f32 v61, 1.0, v61
    v_mfma_f32_16x16x32_bf16 v[200:203], v[36:39], a[40:43], v[200:203]
    ds_read_b64_tr_b16 v[24:25], v5 offset:63488
    v_add_f32 v62, 1.0, v62
    v_mfma_f32_16x16x32_bf16 v[204:207], v[36:39], a[44:47], 0
    v_rcp_f32 v60, v60
    v_mfma_f32_16x16x32_bf16 v[204:207], v[32:35], a[28:31], v[204:207]
    ds_read_b64_tr_b16 v[26:27], v5 offset:63744
    v_add_f32 v63, 1.0, v63
    v_mfma_f32_16x16x32_bf16 v[204:207], v[28:31], a[12:15], v[204:207]
    s_waitcnt lgkmcnt(6)
    v_rcp_f32 v61, v61
    v_mfma_f32_16x16x32_bf16 v[204:207], v[40:43], a[60:63], v[204:207]
    ds_read_b64_tr_b16 v[28:29], v5 offset:53248
    v_mul_f32 v100, v100, v60
    v_mfma_f32_16x16x32_bf16 v[204:207], v[44:47], a[76:79], v[204:207]
    v_rcp_f32 v62, v62
    v_mfma_f32_16x16x32_bf16 v[204:207], v[48:51], a[92:95], v[204:207]
    ds_read_b64_tr_b16 v[30:31], v5 offset:53504
    v_mul_f32 v101, v101, v61
    v_mfma_f32_16x16x32_bf16 v[200:203], v[48:51], a[88:91], v[200:203]
    s_add_u32 s44, s54, 294976
    v_rcp_f32 v63, v63
    v_mfma_f32_16x16x32_bf16 v[200:203], v[44:47], a[72:75], v[200:203]
    s_add_u32 m0, s53, 145408
    ds_read_b64_tr_b16 v[32:33], v5 offset:55296
    v_mul_f32 v102, v102, v62
    v_mfma_f32_16x16x32_bf16 v[200:203], v[40:43], a[56:59], v[200:203]
    buffer_load_dwordx4 v2, s[12:15], s44 offen nt lds
    v_mfma_f32_16x16x32_bf16 v[196:199], v[40:43], a[52:55], v[196:199]
    ds_read_b64_tr_b16 v[34:35], v5 offset:55552
    v_mul_f32 v103, v103, v63
    v_mfma_f32_16x16x32_bf16 v[196:199], v[44:47], a[68:71], v[196:199]
    v_cvt_pk_bf16_f32 v72, v100, v101
    v_cvt_pk_bf16_f32 v73, v102, v103
    v_mfma_f32_16x16x32_bf16 v[196:199], v[48:51], a[84:87], v[196:199]
    ds_read_b64_tr_b16 v[36:37], v5 offset:57344
    v_mul_f32 v52, v104, v104
    v_mfma_f32_16x16x32_bf16 v[192:195], v[48:51], a[80:83], v[192:195]
    s_add_u32 s46, s60, 4198400
    buffer_store_dwordx2 v[72:73], v1, s[28:31], s46 offen
    v_mfma_f32_16x16x32_bf16 v[192:195], v[44:47], a[64:67], v[192:195]
    ds_read_b64_tr_b16 v[38:39], v5 offset:57600
    v_mul_f32 v53, v105, v105
    v_mfma_f32_16x16x32_bf16 v[192:195], v[40:43], a[48:51], v[192:195]
    s_waitcnt lgkmcnt(6)
    v_mul_f32 v54, v106, v106
    v_mul_f32 v55, v107, v107
    v_mfma_f32_16x16x32_bf16 v[208:211], v[16:19], a[48:51], 0
    v_fma_f32 v52, v52, v13, v12
    v_fma_f32 v53, v53, v13, v12
    v_mfma_f32_16x16x32_bf16 v[208:211], v[20:23], a[64:67], v[208:211]
    v_fma_f32 v54, v54, v13, v12
    v_fma_f32 v55, v55, v13, v12
    v_mfma_f32_16x16x32_bf16 v[208:211], v[24:27], a[80:83], v[208:211]
    v_mul_f32 v52, v52, v104
    v_mul_f32 v53, v53, v105
    v_mfma_f32_16x16x32_bf16 v[212:215], v[24:27], a[84:87], 0
    v_exp_f32 v52, v52
    v_mfma_f32_16x16x32_bf16 v[212:215], v[20:23], a[68:71], v[212:215]
    v_exp_f32 v53, v53
    v_mfma_f32_16x16x32_bf16 v[212:215], v[16:19], a[52:55], v[212:215]
    v_mul_f32 v54, v54, v106
    v_mul_f32 v55, v55, v107
    v_mfma_f32_16x16x32_bf16 v[216:219], v[16:19], a[56:59], 0
    v_exp_f32 v54, v54
    v_mfma_f32_16x16x32_bf16 v[216:219], v[20:23], a[72:75], v[216:219]
    v_exp_f32 v55, v55
    v_mfma_f32_16x16x32_bf16 v[216:219], v[24:27], a[88:91], v[216:219]
    v_mul_f32 v104, v104, v136
    v_mul_f32 v105, v105, v137
    v_mfma_f32_16x16x32_bf16 v[220:223], v[24:27], a[92:95], 0
    v_mul_f32 v106, v106, v138
    v_mul_f32 v107, v107, v139
    v_mfma_f32_16x16x32_bf16 v[220:223], v[20:23], a[76:79], v[220:223]
    v_add_f32 v52, 1.0, v52
    v_add_f32 v53, 1.0, v53
    v_mfma_f32_16x16x32_bf16 v[220:223], v[16:19], a[60:63], v[220:223]
    s_waitcnt vmcnt(14) lgkmcnt(0)
    s_barrier
    v_add_f32 v54, 1.0, v54
    v_mfma_f32_16x16x32_bf16 v[220:223], v[28:31], a[12:15], v[220:223]
    ds_read_b64_tr_b16 v[40:41], v4 offset:0
    v_add_f32 v55, 1.0, v55
    v_mfma_f32_16x16x32_bf16 v[220:223], v[32:35], a[28:31], v[220:223]
    ds_read_b64_tr_b16 v[42:43], v4 offset:256
    v_mul_f32 v60, v108, v108
    v_mfma_f32_16x16x32_bf16 v[220:223], v[36:39], a[44:47], v[220:223]
    ds_read_b64_tr_b16 v[44:45], v4 offset:2048
    v_mul_f32 v61, v109, v109
    v_mfma_f32_16x16x32_bf16 v[216:219], v[36:39], a[40:43], v[216:219]
    ds_read_b64_tr_b16 v[46:47], v4 offset:2304
    v_mul_f32 v62, v110, v110
    v_mfma_f32_16x16x32_bf16 v[216:219], v[32:35], a[24:27], v[216:219]
    ds_read_b64_tr_b16 v[48:49], v4 offset:4096
    v_mul_f32 v63, v111, v111
    v_mfma_f32_16x16x32_bf16 v[216:219], v[28:31], a[8:11], v[216:219]
    ds_read_b64_tr_b16 v[50:51], v4 offset:4352
    v_fma_f32 v60, v60, v13, v12
    v_mfma_f32_16x16x32_bf16 v[212:215], v[28:31], a[4:7], v[212:215]
    ds_read_b64_tr_b16 v[16:17], v4 offset:6144
    v_fma_f32 v61, v61, v13, v12
    v_mfma_f32_16x16x32_bf16 v[212:215], v[32:35], a[20:23], v[212:215]
    ds_read_b64_tr_b16 v[18:19], v4 offset:6400
    v_fma_f32 v62, v62, v13, v12
    v_mfma_f32_16x16x32_bf16 v[212:215], v[36:39], a[36:39], v[212:215]
    ds_read_b64_tr_b16 v[20:21], v4 offset:8192
    v_fma_f32 v63, v63, v13, v12
    v_mfma_f32_16x16x32_bf16 v[208:211], v[36:39], a[32:35], v[208:211]
    ds_read_b64_tr_b16 v[22:23], v4 offset:8448
    v_mul_f32 v60, v60, v108
    v_mfma_f32_16x16x32_bf16 v[208:211], v[32:35], a[16:19], v[208:211]
    ds_read_b64_tr_b16 v[24:25], v4 offset:10240
    v_mul_f32 v61, v61, v109
    v_mfma_f32_16x16x32_bf16 v[208:211], v[28:31], a[0:3], v[208:211]
    s_waitcnt lgkmcnt(5)
    ds_read_b64_tr_b16 v[26:27], v4 offset:10496
    v_mul_f32 v62, v62, v110
    v_mfma_f32_16x16x32_bf16 v[160:163], v[40:43], a[96:99], v[160:163]
    ds_read_b64_tr_b16 v[28:29], v5 offset:6144
    v_mul_f32 v63, v63, v111
    v_mfma_f32_16x16x32_bf16 v[160:163], v[44:47], a[112:115], v[160:163]
    s_add_u32 s45, s54, 1769536
    v_rcp_f32 v52, v52
    v_mfma_f32_16x16x32_bf16 v[160:163], v[48:51], a[128:131], v[160:163]
    s_add_u32 m0, s53, 81920
    ds_read_b64_tr_b16 v[30:31], v5 offset:6400
    v_mul_f32 v104, v104, v52
    v_mfma_f32_16x16x32_bf16 v[164:167], v[48:51], a[132:135], v[164:167]
    buffer_load_dwordx4 v2, s[8:11], s45 offen nt lds
    v_mfma_f32_16x16x32_bf16 v[164:167], v[44:47], a[116:119], v[164:167]
    ds_read_b64_tr_b16 v[32:33], v5 offset:8192
    v_mul_f32 v108, v108, v140
    v_mfma_f32_16x16x32_bf16 v[164:167], v[40:43], a[100:103], v[164:167]
    v_rcp_f32 v53, v53
    v_mfma_f32_16x16x32_bf16 v[168:171], v[40:43], a[104:107], v[168:171]
    ds_read_b64_tr_b16 v[34:35], v5 offset:8448
    v_mul_f32 v105, v105, v53
    v_mfma_f32_16x16x32_bf16 v[168:171], v[44:47], a[120:123], v[168:171]
    v_rcp_f32 v54, v54
    v_mfma_f32_16x16x32_bf16 v[168:171], v[48:51], a[136:139], v[168:171]
    ds_read_b64_tr_b16 v[36:37], v5 offset:10240
    v_mul_f32 v106, v106, v54
    v_mfma_f32_16x16x32_bf16 v[172:175], v[48:51], a[140:143], v[172:175]
    v_rcp_f32 v55, v55
    v_mfma_f32_16x16x32_bf16 v[172:175], v[44:47], a[124:127], v[172:175]
    ds_read_b64_tr_b16 v[38:39], v5 offset:10496
    v_mul_f32 v107, v107, v55
    v_mfma_f32_16x16x32_bf16 v[172:175], v[40:43], a[108:111], v[172:175]
    s_waitcnt lgkmcnt(6)
    v_exp_f32 v60, v60
    v_mfma_f32_16x16x32_bf16 v[172:175], v[16:19], a[156:159], v[172:175]
    ds_read_b64_tr_b16 v[40:41], v5 offset:0
    v_cvt_pk_bf16_f32 v68, v104, v105
    v_mfma_f32_16x16x32_bf16 v[172:175], v[20:23], a[172:175], v[172:175]
    s_add_u32 s44, s54, 1916992
    v_exp_f32 v61, v61
    v_mfma_f32_16x16x32_bf16 v[172:175], v[24:27], a[188:191], v[172:175]
    s_add_u32 m0, s53, 82944
    ds_read_b64_tr_b16 v[42:43], v5 offset:256
    v_cvt_pk_bf16_f32 v69, v106, v107
    v_mfma_f32_16x16x32_bf16 v[168:171], v[24:27], a[184:187], v[168:171]
    buffer_load_dwordx4 v2, s[8:11], s44 offen nt lds
    v_mfma_f32_16x16x32_bf16 v[168:171], v[20:23], a[168:171], v[168:171]
    ds_read_b64_tr_b16 v[44:45], v5 offset:2048
    v_mul_f32 v109, v109, v141
    v_mfma_f32_16x16x32_bf16 v[168:171], v[16:19], a[152:155], v[168:171]
    s_add_u32 s46, s60, 4202496
    buffer_store_dwordx2 v[68:69], v1, s[28:31], s46 offen
    v_mfma_f32_16x16x32_bf16 v[164:167], v[16:19], a[148:151], v[164:167]
    ds_read_b64_tr_b16 v[46:47], v5 offset:2304
    v_mul_f32 v110, v110, v142
    v_mfma_f32_16x16x32_bf16 v[164:167], v[20:23], a[164:167], v[164:167]
    v_exp_f32 v62, v62
    v_mfma_f32_16x16x32_bf16 v[164:167], v[24:27], a[180:183], v[164:167]
    ds_read_b64_tr_b16 v[48:49], v5 offset:4096
    v_mul_f32 v111, v111, v143
    v_mfma_f32_16x16x32_bf16 v[160:163], v[24:27], a[176:179], v[160:163]
    v_exp_f32 v63, v63
    v_mfma_f32_16x16x32_bf16 v[160:163], v[20:23], a[160:163], v[160:163]
    ds_read_b64_tr_b16 v[50:51], v5 offset:4352
    v_add_f32 v60, 1.0, v60
    v_mfma_f32_16x16x32_bf16 v[160:163], v[16:19], a[144:147], v[160:163]
    s_waitcnt lgkmcnt(6)
    v_rcp_f32 v60, v60
    v_mfma_f32_16x16x32_bf16 v[176:179], v[28:31], a[144:147], v[176:179]
    ds_read_b64_tr_b16 v[16:17], v4 offset:12288
    v_add_f32 v61, 1.0, v61
    v_mfma_f32_16x16x32_bf16 v[176:179], v[32:35], a[160:163], v[176:179]
    s_add_u32 s45, s54, 2064448
    v_rcp_f32 v61, v61
    v_mfma_f32_16x16x32_bf16 v[176:179], v[36:39], a[176:179], v[176:179]
    s_add_u32 m0, s53, 83968
    ds_read_b64_tr_b16 v[18:19], v4 offset:12544
    v_add_f32 v62, 1.0, v62
    v_mfma_f32_16x16x32_bf16 v[180:183], v[36:39], a[180:183], v[180:183]
    buffer_load_dwordx4 v2, s[8:11], s45 offen nt lds
    v_mfma_f32_16x16x32_bf16 v[180:183], v[32:35], a[164:167], v[180:183]
    ds_read_b64_tr_b16 v[20:21], v4 offset:14336
    v_add_f32 v63, 1.0, v63
    v_mfma_f32_16x16x32_bf16 v[180:183], v[28:31], a[148:151], v[180:183]
    v_rcp_f32 v62, v62
    v_mfma_f32_16x16x32_bf16 v[184:187], v[28:31], a[152:155], v[184:187]
    ds_read_b64_tr_b16 v[22:23], v4 offset:14592
    v_mul_f32 v108, v108, v60
    v_mfma_f32_16x16x32_bf16 v[184:187], v[32:35], a[168:171], v[184:187]
    v_rcp_f32 v63, v63
    v_mfma_f32_16x16x32_bf16 v[184:187], v[36:39], a[184:187], v[184:187]
    ds_read_b64_tr_b16 v[24:25], v4 offset:16384
    v_mul_f32 v109, v109, v61
    v_mfma_f32_16x16x32_bf16 v[188:191], v[36:39], a[188:191], v[188:191]
    v_mul_f32 v110, v110, v62
    v_mul_f32 v111, v111, v63
    v_mfma_f32_16x16x32_bf16 v[188:191], v[32:35], a[172:175], v[188:191]
    ds_read_b64_tr_b16 v[26:27], v4 offset:16640
    v_cvt_pk_bf16_f32 v72, v108, v109
    v_mfma_f32_16x16x32_bf16 v[188:191], v[28:31], a[156:159], v[188:191]
    s_waitcnt lgkmcnt(6)
    v_cvt_pk_bf16_f32 v73, v110, v111
    v_mfma_f32_16x16x32_bf16 v[188:191], v[40:43], a[108:111], v[188:191]
    ds_read_b64_tr_b16 v[28:29], v4 offset:18432
    v_mfma_f32_16x16x32_bf16 v[188:191], v[44:47], a[124:127], v[188:191]
    s_add_u32 s44, s54, 1769536
    v_mfma_f32_16x16x32_bf16 v[188:191], v[48:51], a[140:143], v[188:191]
    s_add_u32 m0, s53, 94208
    ds_read_b64_tr_b16 v[30:31], v4 offset:18688
    v_mfma_f32_16x16x32_bf16 v[184:187], v[48:51], a[136:139], v[184:187]
    buffer_load_dwordx4 v2, s[12:15], s44 offen nt lds
    v_mfma_f32_16x16x32_bf16 v[184:187], v[44:47], a[120:123], v[184:187]
    ds_read_b64_tr_b16 v[32:33], v4 offset:20480
    v_mfma_f32_16x16x32_bf16 v[184:187], v[40:43], a[104:107], v[184:187]
    s_add_u32 s46, s60, 4206592
    buffer_store_dwordx2 v[72:73], v1, s[28:31], s46 offen
    v_mfma_f32_16x16x32_bf16 v[180:183], v[40:43], a[100:103], v[180:183]
    ds_read_b64_tr_b16 v[34:35], v4 offset:20736
    v_mfma_f32_16x16x32_bf16 v[180:183], v[44:47], a[116:119], v[180:183]
    v_mfma_f32_16x16x32_bf16 v[180:183], v[48:51], a[132:135], v[180:183]
    ds_read_b64_tr_b16 v[36:37], v4 offset:22528
    v_mfma_f32_16x16x32_bf16 v[176:179], v[48:51], a[128:131], v[176:179]
    v_mfma_f32_16x16x32_bf16 v[176:179], v[44:47], a[112:115], v[176:179]
    ds_read_b64_tr_b16 v[38:39], v4 offset:22784
    v_mfma_f32_16x16x32_bf16 v[176:179], v[40:43], a[96:99], v[176:179]
    s_waitcnt lgkmcnt(6)
    v_mfma_f32_16x16x32_bf16 v[192:195], v[16:19], a[96:99], v[192:195]
L_pad12:
    s_cbranch_execz L_pad15
    ds_read_b64_tr_b16 v[40:41], v5 offset:18432
    v_mfma_f32_16x16x32_bf16 v[192:195], v[20:23], a[112:115], v[192:195]
    v_mfma_f32_16x16x32_bf16 v[192:195], v[24:27], a[128:131], v[192:195]
    ds_read_b64_tr_b16 v[42:43], v5 offset:18688
    v_mfma_f32_16x16x32_bf16 v[196:199], v[24:27], a[132:135], v[196:199]
    s_add_u32 s45, s54, 1916992
    v_mfma_f32_16x16x32_bf16 v[196:199], v[20:23], a[116:119], v[196:199]
    s_add_u32 m0, s53, 95232
    ds_read_b64_tr_b16 v[44:45], v5 offset:20480
    v_mfma_f32_16x16x32_bf16 v[196:199], v[16:19], a[100:103], v[196:199]
    buffer_load_dwordx4 v2, s[12:15], s45 offen nt lds
    v_mfma_f32_16x16x32_bf16 v[200:203], v[16:19], a[104:107], v[200:203]
    ds_read_b64_tr_b16 v[46:47], v5 offset:20736
    v_mfma_f32_16x16x32_bf16 v[200:203], v[20:23], a[120:123], v[200:203]
    v_mfma_f32_16x16x32_bf16 v[200:203], v[24:27], a[136:139], v[200:203]
    ds_read_b64_tr_b16 v[48:49], v5 offset:22528
    v_mfma_f32_16x16x32_bf16 v[204:207], v[24:27], a[140:143], v[204:207]
    v_mfma_f32_16x16x32_bf16 v[204:207], v[20:23], a[124:127], v[204:207]
    ds_read_b64_tr_b16 v[50:51], v5 offset:22784
    v_mfma_f32_16x16x32_bf16 v[204:207], v[16:19], a[108:111], v[204:207]
    s_waitcnt lgkmcnt(6)
    v_mfma_f32_16x16x32_bf16 v[204:207], v[28:31], a[156:159], v[204:207]
    ds_read_b64_tr_b16 v[16:17], v5 offset:12288
    v_mfma_f32_16x16x32_bf16 v[204:207], v[32:35], a[172:175], v[204:207]
    v_mfma_f32_16x16x32_bf16 v[204:207], v[36:39], a[188:191], v[204:207]
    ds_read_b64_tr_b16 v[18:19], v5 offset:12544
    v_mfma_f32_16x16x32_bf16 v[200:203], v[36:39], a[184:187], v[200:203]
    s_add_u32 s44, s54, 2064448
    v_mfma_f32_16x16x32_bf16 v[200:203], v[32:35], a[168:171], v[200:203]
    s_add_u32 m0, s53, 96256
    ds_read_b64_tr_b16 v[20:21], v5 offset:14336
    v_mfma_f32_16x16x32_bf16 v[200:203], v[28:31], a[152:155], v[200:203]
    buffer_load_dwordx4 v2, s[12:15], s44 offen nt lds
    v_mfma_f32_16x16x32_bf16 v[196:199], v[28:31], a[148:151], v[196:199]
    ds_read_b64_tr_b16 v[22:23], v5 offset:14592
    v_mfma_f32_16x16x32_bf16 v[196:199], v[32:35], a[164:167], v[196:199]
    v_mfma_f32_16x16x32_bf16 v[196:199], v[36:39], a[180:183], v[196:199]
    ds_read_b64_tr_b16 v[24:25], v5 offset:16384
    v_mfma_f32_16x16x32_bf16 v[192:195], v[36:39], a[176:179], v[192:195]
    v_mfma_f32_16x16x32_bf16 v[192:195], v[32:35], a[160:163], v[192:195]
    ds_read_b64_tr_b16 v[26:27], v5 offset:16640
    v_mfma_f32_16x16x32_bf16 v[192:195], v[28:31], a[144:147], v[192:195]
    s_waitcnt lgkmcnt(6)
    v_mfma_f32_16x16x32_bf16 v[208:211], v[40:43], a[144:147], v[208:211]
    v_mfma_f32_16x16x32_bf16 v[208:211], v[44:47], a[160:163], v[208:211]
    v_mfma_f32_16x16x32_bf16 v[208:211], v[48:51], a[176:179], v[208:211]
    v_mfma_f32_16x16x32_bf16 v[212:215], v[48:51], a[180:183], v[212:215]
    v_mfma_f32_16x16x32_bf16 v[212:215], v[44:47], a[164:167], v[212:215]
    v_mfma_f32_16x16x32_bf16 v[212:215], v[40:43], a[148:151], v[212:215]
    v_mfma_f32_16x16x32_bf16 v[216:219], v[40:43], a[152:155], v[216:219]
    v_mfma_f32_16x16x32_bf16 v[216:219], v[44:47], a[168:171], v[216:219]
    v_mfma_f32_16x16x32_bf16 v[216:219], v[48:51], a[184:187], v[216:219]
    v_mfma_f32_16x16x32_bf16 v[220:223], v[48:51], a[188:191], v[220:223]
    v_mfma_f32_16x16x32_bf16 v[220:223], v[44:47], a[172:175], v[220:223]
    v_mfma_f32_16x16x32_bf16 v[220:223], v[40:43], a[156:159], v[220:223]
    s_waitcnt vmcnt(16) lgkmcnt(0)
    s_barrier
    v_mfma_f32_16x16x32_bf16 v[220:223], v[16:19], a[108:111], v[220:223]
    ds_read_b64_tr_b16 v[28:29], v6 offset:0
    v_mfma_f32_16x16x32_bf16 v[220:223], v[20:23], a[124:127], v[220:223]
    ds_read_b64_tr_b16 v[30:31], v6 offset:256
    v_mfma_f32_16x16x32_bf16 v[220:223], v[24:27], a[140:143], v[220:223]
    ds_read_b64_tr_b16 v[32:33], v6 offset:2048
    v_mfma_f32_16x16x32_bf16 v[216:219], v[24:27], a[136:139], v[216:219]
    ds_read_b64_tr_b16 v[34:35], v6 offset:2304
    v_mfma_f32_16x16x32_bf16 v[216:219], v[20:23], a[120:123], v[216:219]
    ds_read_b64_tr_b16 v[36:37], v6 offset:4096
    v_mfma_f32_16x16x32_bf16 v[216:219], v[16:19], a[104:107], v[216:219]
    ds_read_b64_tr_b16 v[38:39], v6 offset:4352
    v_mfma_f32_16x16x32_bf16 v[212:215], v[16:19], a[100:103], v[212:215]
    ds_read_b64_tr_b16 v[40:41], v6 offset:6144
    v_mfma_f32_16x16x32_bf16 v[212:215], v[20:23], a[116:119], v[212:215]
    ds_read_b64_tr_b16 v[42:43], v6 offset:6400
    v_mfma_f32_16x16x32_bf16 v[212:215], v[24:27], a[132:135], v[212:215]
    ds_read_b64_tr_b16 v[44:45], v6 offset:8192
    v_mfma_f32_16x16x32_bf16 v[208:211], v[24:27], a[128:131], v[208:211]
    ds_read_b64_tr_b16 v[46:47], v6 offset:8448
    v_mfma_f32_16x16x32_bf16 v[208:211], v[20:23], a[112:115], v[208:211]
    ds_read_b64_tr_b16 v[48:49], v6 offset:10240
    v_mfma_f32_16x16x32_bf16 v[208:211], v[16:19], a[96:99], v[208:211]
    s_waitcnt lgkmcnt(5)
    ds_read_b64_tr_b16 v[50:51], v6 offset:10496
    v_mfma_f32_16x16x32_bf16 v[160:163], v[28:31], a[192:195], v[160:163]
    ds_read_b64_tr_b16 v[16:17], v7 offset:6144
    v_mfma_f32_16x16x32_bf16 v[160:163], v[32:35], a[208:211], v[160:163]
    s_add_u32 s45, s54, 3539008
    v_mfma_f32_16x16x32_bf16 v[160:163], v[36:39], a[224:227], v[160:163]
    s_add_u32 m0, s53, 40960
    ds_read_b64_tr_b16 v[18:19], v7 offset:6400
    v_mfma_f32_16x16x32_bf16 v[164:167], v[36:39], a[228:231], v[164:167]
    buffer_load_dwordx4 v2, s[8:11], s45 offen nt lds
    v_mfma_f32_16x16x32_bf16 v[164:167], v[32:35], a[212:215], v[164:167]
    ds_read_b64_tr_b16 v[20:21], v7 offset:8192
    v_mfma_f32_16x16x32_bf16 v[164:167], v[28:31], a[196:199], v[164:167]
    v_mfma_f32_16x16x32_bf16 v[168:171], v[28:31], a[200:203], v[168:171]
    ds_read_b64_tr_b16 v[22:23], v7 offset:8448
    v_mfma_f32_16x16x32_bf16 v[168:171], v[32:35], a[216:219], v[168:171]
    v_mfma_f32_16x16x32_bf16 v[168:171], v[36:39], a[232:235], v[168:171]
    ds_read_b64_tr_b16 v[24:25], v7 offset:10240
    v_mfma_f32_16x16x32_bf16 v[172:175], v[36:39], a[236:239], v[172:175]
    v_mfma_f32_16x16x32_bf16 v[172:175], v[32:35], a[220:223], v[172:175]
    ds_read_b64_tr_b16 v[26:27], v7 offset:10496
    v_mfma_f32_16x16x32_bf16 v[172:175], v[28:31], a[204:207], v[172:175]
    s_waitcnt lgkmcnt(6)
    v_mfma_f32_16x16x32_bf16 v[172:175], v[40:43], a[252:255], v[172:175]
    ds_read_b64_tr_b16 v[28:29], v7 offset:0
    v_mfma_f32_16x16x32_bf16 v[172:175], v[44:47], v[236:239], v[172:175]
    s_add_u32 s44, s54, 3686464
    v_mfma_f32_16x16x32_bf16 v[172:175], v[48:51], v[252:255], v[172:175]
    s_add_u32 m0, s53, 41984
    ds_read_b64_tr_b16 v[30:31], v7 offset:256
    v_mfma_f32_16x16x32_bf16 v[168:171], v[48:51], v[248:251], v[168:171]
    buffer_load_dwordx4 v2, s[8:11], s44 offen nt lds
    v_mfma_f32_16x16x32_bf16 v[168:171], v[44:47], v[232:235], v[168:171]
    ds_read_b64_tr_b16 v[32:33], v7 offset:2048
    v_mfma_f32_16x16x32_bf16 v[168:171], v[40:43], a[248:251], v[168:171]
    v_mfma_f32_16x16x32_bf16 v[164:167], v[40:43], a[244:247], v[164:167]
    ds_read_b64_tr_b16 v[34:35], v7 offset:2304
    v_mfma_f32_16x16x32_bf16 v[164:167], v[44:47], v[228:231], v[164:167]
    v_mfma_f32_16x16x32_bf16 v[164:167], v[48:51], v[244:247], v[164:167]
    ds_read_b64_tr_b16 v[36:37], v7 offset:4096
    v_mfma_f32_16x16x32_bf16 v[160:163], v[48:51], v[240:243], v[160:163]
    v_mfma_f32_16x16x32_bf16 v[160:163], v[44:47], v[224:227], v[160:163]
    ds_read_b64_tr_b16 v[38:39], v7 offset:4352
    v_mfma_f32_16x16x32_bf16 v[160:163], v[40:43], a[240:243], v[160:163]
    s_waitcnt lgkmcnt(6)
    v_mfma_f32_16x16x32_bf16 v[176:179], v[16:19], a[240:243], v[176:179]
    ds_read_b64_tr_b16 v[40:41], v6 offset:12288
    v_mfma_f32_16x16x32_bf16 v[176:179], v[20:23], v[224:227], v[176:179]
    s_add_u32 s45, s54, 3833920
    v_mfma_f32_16x16x32_bf16 v[176:179], v[24:27], v[240:243], v[176:179]
    s_add_u32 m0, s53, 43008
    ds_read_b64_tr_b16 v[42:43], v6 offset:12544
    v_mfma_f32_16x16x32_bf16 v[180:183], v[24:27], v[244:247], v[180:183]
    buffer_load_dwordx4 v2, s[8:11], s45 offen nt lds
    v_mfma_f32_16x16x32_bf16 v[180:183], v[20:23], v[228:231], v[180:183]
    ds_read_b64_tr_b16 v[44:45], v6 offset:14336
    v_mfma_f32_16x16x32_bf16 v[180:183], v[16:19], a[244:247], v[180:183]
    v_mfma_f32_16x16x32_bf16 v[184:187], v[16:19], a[248:251], v[184:187]
    ds_read_b64_tr_b16 v[46:47], v6 offset:14592
    v_mfma_f32_16x16x32_bf16 v[184:187], v[20:23], v[232:235], v[184:187]
    v_mfma_f32_16x16x32_bf16 v[184:187], v[24:27], v[248:251], v[184:187]
    ds_read_b64_tr_b16 v[48:49], v6 offset:16384
    v_mfma_f32_16x16x32_bf16 v[188:191], v[24:27], v[252:255], v[188:191]
    v_mfma_f32_16x16x32_bf16 v[188:191], v[20:23], v[236:239], v[188:191]
    ds_read_b64_tr_b16 v[50:51], v6 offset:16640
    v_mfma_f32_16x16x32_bf16 v[188:191], v[16:19], a[252:255], v[188:191]
    s_waitcnt lgkmcnt(6)
    v_mfma_f32_16x16x32_bf16 v[188:191], v[28:31], a[204:207], v[188:191]
    ds_read_b64_tr_b16 v[16:17], v6 offset:18432
    v_mfma_f32_16x16x32_bf16 v[188:191], v[32:35], a[220:223], v[188:191]
    s_add_u32 s44, s54, 3539008
    v_mfma_f32_16x16x32_bf16 v[188:191], v[36:39], a[236:239], v[188:191]
    s_add_u32 m0, s53, 53248
    ds_read_b64_tr_b16 v[18:19], v6 offset:18688
    v_mfma_f32_16x16x32_bf16 v[184:187], v[36:39], a[232:235], v[184:187]
    buffer_load_dwordx4 v2, s[12:15], s44 offen nt lds
    v_mfma_f32_16x16x32_bf16 v[184:187], v[32:35], a[216:219], v[184:187]
    ds_read_b64_tr_b16 v[20:21], v6 offset:20480
    v_mfma_f32_16x16x32_bf16 v[184:187], v[28:31], a[200:203], v[184:187]
    v_mfma_f32_16x16x32_bf16 v[180:183], v[28:31], a[196:199], v[180:183]
    ds_read_b64_tr_b16 v[22:23], v6 offset:20736
    v_mfma_f32_16x16x32_bf16 v[180:183], v[32:35], a[212:215], v[180:183]
    v_mfma_f32_16x16x32_bf16 v[180:183], v[36:39], a[228:231], v[180:183]
    ds_read_b64_tr_b16 v[24:25], v6 offset:22528
    v_mfma_f32_16x16x32_bf16 v[176:179], v[36:39], a[224:227], v[176:179]
    v_mfma_f32_16x16x32_bf16 v[176:179], v[32:35], a[208:211], v[176:179]
    ds_read_b64_tr_b16 v[26:27], v6 offset:22784
    v_mfma_f32_16x16x32_bf16 v[176:179], v[28:31], a[192:195], v[176:179]
    s_waitcnt lgkmcnt(6)
    v_mfma_f32_16x16x32_bf16 v[192:195], v[40:43], a[192:195], v[192:195]
    ds_read_b64_tr_b16 v[28:29], v7 offset:18432
    v_mfma_f32_16x16x32_bf16 v[192:195], v[44:47], a[208:211], v[192:195]
    v_mfma_f32_16x16x32_bf16 v[192:195], v[48:51], a[224:227], v[192:195]
    ds_read_b64_tr_b16 v[30:31], v7 offset:18688
    v_mfma_f32_16x16x32_bf16 v[196:199], v[48:51], a[228:231], v[196:199]
    s_add_u32 s45, s54, 3686464
    v_mfma_f32_16x16x32_bf16 v[196:199], v[44:47], a[212:215], v[196:199]
    s_add_u32 m0, s53, 54272
    ds_read_b64_tr_b16 v[32:33], v7 offset:20480
    v_mfma_f32_16x16x32_bf16 v[196:199], v[40:43], a[196:199], v[196:199]
    buffer_load_dwordx4 v2, s[12:15], s45 offen nt lds
    v_mfma_f32_16x16x32_bf16 v[200:203], v[40:43], a[200:203], v[200:203]
    ds_read_b64_tr_b16 v[34:35], v7 offset:20736
    v_mfma_f32_16x16x32_bf16 v[200:203], v[44:47], a[216:219], v[200:203]
    v_mfma_f32_16x16x32_bf16 v[200:203], v[48:51], a[232:235], v[200:203]
    ds_read_b64_tr_b16 v[36:37], v7 offset:22528
    v_mfma_f32_16x16x32_bf16 v[204:207], v[48:51], a[236:239], v[204:207]
    v_mfma_f32_16x16x32_bf16 v[204:207], v[44:47], a[220:223], v[204:207]
    ds_read_b64_tr_b16 v[38:39], v7 offset:22784
    v_mfma_f32_16x16x32_bf16 v[204:207], v[40:43], a[204:207], v[204:207]
    s_waitcnt lgkmcnt(6)
    v_mfma_f32_16x16x32_bf16 v[204:207], v[16:19], a[252:255], v[204:207]
    ds_read_b64_tr_b16 v[40:41], v7 offset:12288
    v_mfma_f32_16x16x32_bf16 v[204:207], v[20:23], v[236:239], v[204:207]
    v_mfma_f32_16x16x32_bf16 v[204:207], v[24:27], v[252:255], v[204:207]
    ds_read_b64_tr_b16 v[42:43], v7 offset:12544
    v_mfma_f32_16x16x32_bf16 v[200:203], v[24:27], v[248:251], v[200:203]
    s_add_u32 s44, s54, 3833920
    v_mfma_f32_16x16x32_bf16 v[200:203], v[20:23], v[232:235], v[200:203]
    s_add_u32 m0, s53, 55296
    ds_read_b64_tr_b16 v[44:45], v7 offset:14336
    v_mfma_f32_16x16x32_bf16 v[200:203], v[16:19], a[248:251], v[200:203]
    buffer_load_dwordx4 v2, s[12:15], s44 offen nt lds
    v_mfma_f32_16x16x32_bf16 v[196:199], v[16:19], a[244:247], v[196:199]
    ds_read_b64_tr_b16 v[46:47], v7 offset:14592
    v_mfma_f32_16x16x32_bf16 v[196:199], v[20:23], v[228:231], v[196:199]
    v_mfma_f32_16x16x32_bf16 v[196:199], v[24:27], v[244:247], v[196:199]
    ds_read_b64_tr_b16 v[48:49], v7 offset:16384
    v_mfma_f32_16x16x32_bf16 v[192:195], v[24:27], v[240:243], v[192:195]
    v_mfma_f32_16x16x32_bf16 v[192:195], v[20:23], v[224:227], v[192:195]
    ds_read_b64_tr_b16 v[50:51], v7 offset:16640
    v_mfma_f32_16x16x32_bf16 v[192:195], v[16:19], a[240:243], v[192:195]
    s_waitcnt lgkmcnt(6)
    v_mfma_f32_16x16x32_bf16 v[208:211], v[28:31], a[240:243], v[208:211]
    v_mfma_f32_16x16x32_bf16 v[208:211], v[32:35], v[224:227], v[208:211]
    v_mfma_f32_16x16x32_bf16 v[208:211], v[36:39], v[240:243], v[208:211]
    v_mfma_f32_16x16x32_bf16 v[212:215], v[36:39], v[244:247], v[212:215]
    v_mfma_f32_16x16x32_bf16 v[212:215], v[32:35], v[228:231], v[212:215]
    v_mfma_f32_16x16x32_bf16 v[212:215], v[28:31], a[244:247], v[212:215]
    v_mfma_f32_16x16x32_bf16 v[216:219], v[28:31], a[248:251], v[216:219]
    v_mfma_f32_16x16x32_bf16 v[216:219], v[32:35], v[232:235], v[216:219]
    v_mfma_f32_16x16x32_bf16 v[216:219], v[36:39], v[248:251], v[216:219]
    v_mfma_f32_16x16x32_bf16 v[220:223], v[36:39], v[252:255], v[220:223]
    v_mfma_f32_16x16x32_bf16 v[220:223], v[32:35], v[236:239], v[220:223]
    v_mfma_f32_16x16x32_bf16 v[220:223], v[28:31], a[252:255], v[220:223]
    s_waitcnt vmcnt(15) lgkmcnt(0)
    s_barrier
    v_mfma_f32_16x16x32_bf16 v[220:223], v[40:43], a[204:207], v[220:223]
    ds_read_b64_tr_b16 v[16:17], v6 offset:24576
    v_mfma_f32_16x16x32_bf16 v[220:223], v[44:47], a[220:223], v[220:223]
    ds_read_b64_tr_b16 v[18:19], v6 offset:24832
    v_mfma_f32_16x16x32_bf16 v[220:223], v[48:51], a[236:239], v[220:223]
    ds_read_b64_tr_b16 v[20:21], v6 offset:26624
    v_mfma_f32_16x16x32_bf16 v[216:219], v[48:51], a[232:235], v[216:219]
    ds_read_b64_tr_b16 v[22:23], v6 offset:26880
    v_mfma_f32_16x16x32_bf16 v[216:219], v[44:47], a[216:219], v[216:219]
    ds_read_b64_tr_b16 v[24:25], v6 offset:28672
    v_mfma_f32_16x16x32_bf16 v[216:219], v[40:43], a[200:203], v[216:219]
    ds_read_b64_tr_b16 v[26:27], v6 offset:28928
    v_mfma_f32_16x16x32_bf16 v[212:215], v[40:43], a[196:199], v[212:215]
    ds_read_b64_tr_b16 v[28:29], v6 offset:30720
    v_mfma_f32_16x16x32_bf16 v[212:215], v[44:47], a[212:215], v[212:215]
    ds_read_b64_tr_b16 v[30:31], v6 offset:30976
    v_mfma_f32_16x16x32_bf16 v[212:215], v[48:51], a[228:231], v[212:215]
    ds_read_b64_tr_b16 v[32:33], v6 offset:32768
    v_mfma_f32_16x16x32_bf16 v[208:211], v[48:51], a[224:227], v[208:211]
    ds_read_b64_tr_b16 v[34:35], v6 offset:33024
    v_mfma_f32_16x16x32_bf16 v[208:211], v[44:47], a[208:211], v[208:211]
    ds_read_b64_tr_b16 v[36:37], v6 offset:34816
    v_mfma_f32_16x16x32_bf16 v[208:211], v[40:43], a[192:195], v[208:211]
    s_waitcnt lgkmcnt(5)
    ds_read_b64_tr_b16 v[38:39], v6 offset:35072
    v_mfma_f32_16x16x32_bf16 v[96:99], v[16:19], a[0:3], 0
    ds_read_b64_tr_b16 v[40:41], v7 offset:30720
    v_mfma_f32_16x16x32_bf16 v[96:99], v[20:23], a[16:19], v[96:99]
    s_add_u32 s45, s54, 128
    v_mfma_f32_16x16x32_bf16 v[96:99], v[24:27], a[32:35], v[96:99]
    s_add_u32 m0, s53, 106496
    ds_read_b64_tr_b16 v[42:43], v7 offset:30976
    v_mfma_f32_16x16x32_bf16 v[100:103], v[24:27], a[36:39], 0
    buffer_load_dwordx4 v2, s[8:11], s45 offen nt lds
    v_mfma_f32_16x16x32_bf16 v[100:103], v[20:23], a[20:23], v[100:103]
    ds_read_b64_tr_b16 v[44:45], v7 offset:32768
    v_mul_f32 v52, v160, v160
    v_mfma_f32_16x16x32_bf16 v[100:103], v[16:19], a[4:7], v[100:103]
    v_mul_f32 v53, v161, v161
    v_mul_f32 v54, v162, v162
    v_mfma_f32_16x16x32_bf16 v[104:107], v[16:19], a[8:11], 0
    ds_read_b64_tr_b16 v[46:47], v7 offset:33024
    v_mul_f32 v55, v163, v163
    v_mfma_f32_16x16x32_bf16 v[104:107], v[20:23], a[24:27], v[104:107]
    v_mul_f32 v56, v176, v176
    v_mul_f32 v57, v177, v177
    v_mfma_f32_16x16x32_bf16 v[104:107], v[24:27], a[40:43], v[104:107]
    ds_read_b64_tr_b16 v[48:49], v7 offset:34816
    v_mul_f32 v58, v178, v178
    v_mfma_f32_16x16x32_bf16 v[108:111], v[24:27], a[44:47], 0
    v_mul_f32 v59, v179, v179
    v_fma_f32 v52, v52, v13, v12
    v_mfma_f32_16x16x32_bf16 v[108:111], v[20:23], a[28:31], v[108:111]
    ds_read_b64_tr_b16 v[50:51], v7 offset:35072
    v_fma_f32 v53, v53, v13, v12
    v_mfma_f32_16x16x32_bf16 v[108:111], v[16:19], a[12:15], v[108:111]
    s_waitcnt lgkmcnt(6)
    v_fma_f32 v54, v54, v13, v12
    v_fma_f32 v55, v55, v13, v12
    v_mfma_f32_16x16x32_bf16 v[108:111], v[28:31], a[60:63], v[108:111]
    ds_read_b64_tr_b16 v[16:17], v7 offset:24576
    v_fma_f32 v56, v56, v13, v12
    v_mfma_f32_16x16x32_bf16 v[108:111], v[32:35], a[76:79], v[108:111]
    s_add_u32 s44, s54, 147584
    v_fma_f32 v57, v57, v13, v12
    v_fma_f32 v58, v58, v13, v12
    v_mfma_f32_16x16x32_bf16 v[108:111], v[36:39], a[92:95], v[108:111]
    s_add_u32 m0, s53, 107520
    ds_read_b64_tr_b16 v[18:19], v7 offset:24832
    v_fma_f32 v59, v59, v13, v12
    v_mfma_f32_16x16x32_bf16 v[104:107], v[36:39], a[88:91], v[104:107]
    buffer_load_dwordx4 v2, s[8:11], s44 offen nt lds
    v_mfma_f32_16x16x32_bf16 v[104:107], v[32:35], a[72:75], v[104:107]
    ds_read_b64_tr_b16 v[20:21], v7 offset:26624
    v_mul_f32 v52, v52, v160
    v_mfma_f32_16x16x32_bf16 v[104:107], v[28:31], a[56:59], v[104:107]
    v_exp_f32 v52, v52
    v_mfma_f32_16x16x32_bf16 v[100:103], v[28:31], a[52:55], v[100:103]
    ds_read_b64_tr_b16 v[22:23], v7 offset:26880
    v_mul_f32 v53, v53, v161
    v_mfma_f32_16x16x32_bf16 v[100:103], v[32:35], a[68:71], v[100:103]
    v_exp_f32 v53, v53
    v_mfma_f32_16x16x32_bf16 v[100:103], v[36:39], a[84:87], v[100:103]
    ds_read_b64_tr_b16 v[24:25], v7 offset:28672
    v_mul_f32 v54, v54, v162
    v_mfma_f32_16x16x32_bf16 v[96:99], v[36:39], a[80:83], v[96:99]
    v_exp_f32 v54, v54
    v_mfma_f32_16x16x32_bf16 v[96:99], v[32:35], a[64:67], v[96:99]
    ds_read_b64_tr_b16 v[26:27], v7 offset:28928
    v_mul_f32 v55, v55, v163
    v_mfma_f32_16x16x32_bf16 v[96:99], v[28:31], a[48:51], v[96:99]
    s_waitcnt lgkmcnt(6)
    v_exp_f32 v55, v55
    v_mfma_f32_16x16x32_bf16 v[112:115], v[40:43], a[48:51], 0
    ds_read_b64_tr_b16 v[28:29], v6 offset:36864
    v_mul_f32 v56, v56, v176
    v_mfma_f32_16x16x32_bf16 v[112:115], v[44:47], a[64:67], v[112:115]
    s_add_u32 s45, s54, 295040
    v_exp_f32 v56, v56
    v_mfma_f32_16x16x32_bf16 v[112:115], v[48:51], a[80:83], v[112:115]
    s_add_u32 m0, s53, 108544
    ds_read_b64_tr_b16 v[30:31], v6 offset:37120
    v_mul_f32 v57, v57, v177
    v_mfma_f32_16x16x32_bf16 v[116:119], v[48:51], a[84:87], 0
    buffer_load_dwordx4 v2, s[8:11], s45 offen nt lds
    v_mfma_f32_16x16x32_bf16 v[116:119], v[44:47], a[68:71], v[116:119]
    ds_read_b64_tr_b16 v[32:33], v6 offset:38912
    v_mul_f32 v58, v58, v178
    v_mfma_f32_16x16x32_bf16 v[116:119], v[40:43], a[52:55], v[116:119]
    v_exp_f32 v57, v57
    v_mfma_f32_16x16x32_bf16 v[120:123], v[40:43], a[56:59], 0
    ds_read_b64_tr_b16 v[34:35], v6 offset:39168
    v_mul_f32 v59, v59, v179
    v_mfma_f32_16x16x32_bf16 v[120:123], v[44:47], a[72:75], v[120:123]
    v_exp_f32 v58, v58
    v_mfma_f32_16x16x32_bf16 v[120:123], v[48:51], a[88:91], v[120:123]
    ds_read_b64_tr_b16 v[36:37], v6 offset:40960
    v_mul_f32 v160, v160, v192
    v_mfma_f32_16x16x32_bf16 v[124:127], v[48:51], a[92:95], 0
    v_exp_f32 v59, v59
    v_mfma_f32_16x16x32_bf16 v[124:127], v[44:47], a[76:79], v[124:127]
    ds_read_b64_tr_b16 v[38:39], v6 offset:41216
    v_mul_f32 v161, v161, v193
    v_mfma_f32_16x16x32_bf16 v[124:127], v[40:43], a[60:63], v[124:127]
    s_waitcnt lgkmcnt(6)
    v_mul_f32 v162, v162, v194
    v_mul_f32 v163, v163, v195
    v_mfma_f32_16x16x32_bf16 v[124:127], v[16:19], a[12:15], v[124:127]
    ds_read_b64_tr_b16 v[40:41], v6 offset:43008
    v_mul_f32 v176, v176, v208
    v_mfma_f32_16x16x32_bf16 v[124:127], v[20:23], a[28:31], v[124:127]
    s_add_u32 s44, s54, 128
    v_mul_f32 v177, v177, v209
    v_mul_f32 v178, v178, v210
    v_mfma_f32_16x16x32_bf16 v[124:127], v[24:27], a[44:47], v[124:127]
    s_add_u32 m0, s53, 118784
    ds_read_b64_tr_b16 v[42:43], v6 offset:43264
    v_mul_f32 v179, v179, v211
    v_mfma_f32_16x16x32_bf16 v[120:123], v[24:27], a[40:43], v[120:123]
    buffer_load_dwordx4 v2, s[12:15], s44 offen nt lds
    v_mfma_f32_16x16x32_bf16 v[120:123], v[20:23], a[24:27], v[120:123]
    ds_read_b64_tr_b16 v[44:45], v6 offset:45056
    v_add_f32 v52, 1.0, v52
    v_mfma_f32_16x16x32_bf16 v[120:123], v[16:19], a[8:11], v[120:123]
    v_rcp_f32 v52, v52
    v_mfma_f32_16x16x32_bf16 v[116:119], v[16:19], a[4:7], v[116:119]
    ds_read_b64_tr_b16 v[46:47], v6 offset:45312
    v_add_f32 v53, 1.0, v53
    v_mfma_f32_16x16x32_bf16 v[116:119], v[20:23], a[20:23], v[116:119]
    v_rcp_f32 v53, v53
    v_mfma_f32_16x16x32_bf16 v[116:119], v[24:27], a[36:39], v[116:119]
    ds_read_b64_tr_b16 v[48:49], v6 offset:47104
    v_add_f32 v54, 1.0, v54
    v_mfma_f32_16x16x32_bf16 v[112:115], v[24:27], a[32:35], v[112:115]
    v_rcp_f32 v54, v54
    v_mfma_f32_16x16x32_bf16 v[112:115], v[20:23], a[16:19], v[112:115]
    ds_read_b64_tr_b16 v[50:51], v6 offset:47360
    v_add_f32 v55, 1.0, v55
    v_mfma_f32_16x16x32_bf16 v[112:115], v[16:19], a[0:3], v[112:115]
    s_waitcnt lgkmcnt(6)
    v_rcp_f32 v55, v55
    v_mfma_f32_16x16x32_bf16 v[128:131], v[28:31], a[0:3], 0
    ds_read_b64_tr_b16 v[16:17], v7 offset:43008
    v_add_f32 v56, 1.0, v56
    v_mfma_f32_16x16x32_bf16 v[128:131], v[32:35], a[16:19], v[128:131]
    v_rcp_f32 v56, v56
    v_mfma_f32_16x16x32_bf16 v[128:131], v[36:39], a[32:35], v[128:131]
    ds_read_b64_tr_b16 v[18:19], v7 offset:43264
    v_add_f32 v57, 1.0, v57
    v_mfma_f32_16x16x32_bf16 v[132:135], v[36:39], a[36:39], 0
    s_add_u32 s45, s54, 147584
    v_rcp_f32 v57, v57
    v_mfma_f32_16x16x32_bf16 v[132:135], v[32:35], a[20:23], v[132:135]
    s_add_u32 m0, s53, 119808
    ds_read_b64_tr_b16 v[20:21], v7 offset:45056
    v_add_f32 v58, 1.0, v58
    v_mfma_f32_16x16x32_bf16 v[132:135], v[28:31], a[4:7], v[132:135]
    buffer_load_dwordx4 v2, s[12:15], s45 offen nt lds
    v_mfma_f32_16x16x32_bf16 v[136:139], v[28:31], a[8:11], 0
    ds_read_b64_tr_b16 v[22:23], v7 offset:45312
    v_add_f32 v59, 1.0, v59
    v_mfma_f32_16x16x32_bf16 v[136:139], v[32:35], a[24:27], v[136:139]
    v_rcp_f32 v58, v58
    v_mfma_f32_16x16x32_bf16 v[136:139], v[36:39], a[40:43], v[136:139]
    ds_read_b64_tr_b16 v[24:25], v7 offset:47104
    v_mul_f32 v160, v160, v52
    v_mfma_f32_16x16x32_bf16 v[140:143], v[36:39], a[44:47], 0
    v_rcp_f32 v59, v59
    v_mfma_f32_16x16x32_bf16 v[140:143], v[32:35], a[28:31], v[140:143]
    ds_read_b64_tr_b16 v[26:27], v7 offset:47360
    v_mul_f32 v161, v161, v53
    v_mfma_f32_16x16x32_bf16 v[140:143], v[28:31], a[12:15], v[140:143]
    s_waitcnt lgkmcnt(6)
    v_mul_f32 v162, v162, v54
    v_mul_f32 v163, v163, v55
    v_mfma_f32_16x16x32_bf16 v[140:143], v[40:43], a[60:63], v[140:143]
    ds_read_b64_tr_b16 v[28:29], v7 offset:36864
    v_mul_f32 v176, v176, v56
    v_mfma_f32_16x16x32_bf16 v[140:143], v[44:47], a[76:79], v[140:143]
    v_mul_f32 v177, v177, v57
    v_mul_f32 v178, v178, v58
    v_mfma_f32_16x16x32_bf16 v[140:143], v[48:51], a[92:95], v[140:143]
    ds_read_b64_tr_b16 v[30:31], v7 offset:37120
    v_mul_f32 v179, v179, v59
    v_mfma_f32_16x16x32_bf16 v[136:139], v[48:51], a[88:91], v[136:139]
    s_add_u32 s44, s54, 295040
    v_cvt_pk_bf16_f32 v68, v160, v161
    v_cvt_pk_bf16_f32 v69, v162, v163
    v_mfma_f32_16x16x32_bf16 v[136:139], v[44:47], a[72:75], v[136:139]
    s_add_u32 m0, s53, 120832
    ds_read_b64_tr_b16 v[32:33], v7 offset:38912
    v_cvt_pk_bf16_f32 v70, v176, v177
    v_mfma_f32_16x16x32_bf16 v[136:139], v[40:43], a[56:59], v[136:139]
    buffer_load_dwordx4 v2, s[12:15], s44 offen nt lds
    v_mfma_f32_16x16x32_bf16 v[132:135], v[40:43], a[52:55], v[132:135]
    ds_read_b64_tr_b16 v[34:35], v7 offset:39168
    v_cvt_pk_bf16_f32 v71, v178, v179
    v_mfma_f32_16x16x32_bf16 v[132:135], v[44:47], a[68:71], v[132:135]
    s_add_u32 s46, s4, 4194304
    buffer_store_dwordx4 v[68:71], v1, s[28:31], s46 offen
    v_mfma_f32_16x16x32_bf16 v[132:135], v[48:51], a[84:87], v[132:135]
    ds_read_b64_tr_b16 v[36:37], v7 offset:40960
    v_mul_f32 v60, v164, v164
    v_mfma_f32_16x16x32_bf16 v[128:131], v[48:51], a[80:83], v[128:131]
    v_mul_f32 v61, v165, v165
    v_mul_f32 v62, v166, v166
    v_mfma_f32_16x16x32_bf16 v[128:131], v[44:47], a[64:67], v[128:131]
    ds_read_b64_tr_b16 v[38:39], v7 offset:41216
    v_mul_f32 v63, v167, v167
    v_mfma_f32_16x16x32_bf16 v[128:131], v[40:43], a[48:51], v[128:131]
    s_waitcnt lgkmcnt(6)
    v_mul_f32 v64, v180, v180
    v_mul_f32 v65, v181, v181
    v_mfma_f32_16x16x32_bf16 v[144:147], v[16:19], a[48:51], 0
    v_mul_f32 v66, v182, v182
    v_mul_f32 v67, v183, v183
    v_mfma_f32_16x16x32_bf16 v[144:147], v[20:23], a[64:67], v[144:147]
    v_fma_f32 v60, v60, v13, v12
    v_fma_f32 v61, v61, v13, v12
    v_mfma_f32_16x16x32_bf16 v[144:147], v[24:27], a[80:83], v[144:147]
    v_fma_f32 v62, v62, v13, v12
    v_fma_f32 v63, v63, v13, v12
    v_mfma_f32_16x16x32_bf16 v[148:151], v[24:27], a[84:87], 0
    v_fma_f32 v64, v64, v13, v12
    v_fma_f32 v65, v65, v13, v12
    v_mfma_f32_16x16x32_bf16 v[148:151], v[20:23], a[68:71], v[148:151]
    v_fma_f32 v66, v66, v13, v12
    v_fma_f32 v67, v67, v13, v12
    v_mfma_f32_16x16x32_bf16 v[148:151], v[16:19], a[52:55], v[148:151]
    v_mul_f32 v60, v60, v164
    v_mul_f32 v61, v61, v165
    v_mfma_f32_16x16x32_bf16 v[152:155], v[16:19], a[56:59], 0
    v_exp_f32 v60, v60
    v_mfma_f32_16x16x32_bf16 v[152:155], v[20:23], a[72:75], v[152:155]
    v_exp_f32 v61, v61
    v_mfma_f32_16x16x32_bf16 v[152:155], v[24:27], a[88:91], v[152:155]
    v_mul_f32 v62, v62, v166
    v_mul_f32 v63, v63, v167
    v_mfma_f32_16x16x32_bf16 v[156:159], v[24:27], a[92:95], 0
    v_exp_f32 v62, v62
    v_mfma_f32_16x16x32_bf16 v[156:159], v[20:23], a[76:79], v[156:159]
    v_exp_f32 v63, v63
    v_mfma_f32_16x16x32_bf16 v[156:159], v[16:19], a[60:63], v[156:159]
    s_waitcnt vmcnt(13) lgkmcnt(0)
    s_barrier
    v_mul_f32 v64, v64, v180
    v_mfma_f32_16x16x32_bf16 v[156:159], v[28:31], a[12:15], v[156:159]
    ds_read_b64_tr_b16 v[40:41], v4 offset:40960
    v_mul_f32 v65, v65, v181
    v_mfma_f32_16x16x32_bf16 v[156:159], v[32:35], a[28:31], v[156:159]
    ds_read_b64_tr_b16 v[42:43], v4 offset:41216
    v_mul_f32 v66, v66, v182
    v_mfma_f32_16x16x32_bf16 v[156:159], v[36:39], a[44:47], v[156:159]
    ds_read_b64_tr_b16 v[44:45], v4 offset:43008
    v_mul_f32 v67, v67, v183
    v_mfma_f32_16x16x32_bf16 v[152:155], v[36:39], a[40:43], v[152:155]
    ds_read_b64_tr_b16 v[46:47], v4 offset:43264
    v_mul_f32 v164, v164, v196
    v_mfma_f32_16x16x32_bf16 v[152:155], v[32:35], a[24:27], v[152:155]
    ds_read_b64_tr_b16 v[48:49], v4 offset:45056
    v_mul_f32 v165, v165, v197
    v_mfma_f32_16x16x32_bf16 v[152:155], v[28:31], a[8:11], v[152:155]
    ds_read_b64_tr_b16 v[50:51], v4 offset:45312
    v_mul_f32 v166, v166, v198
    v_mfma_f32_16x16x32_bf16 v[148:151], v[28:31], a[4:7], v[148:151]
    ds_read_b64_tr_b16 v[16:17], v4 offset:47104
    v_mul_f32 v167, v167, v199
    v_mfma_f32_16x16x32_bf16 v[148:151], v[32:35], a[20:23], v[148:151]
    ds_read_b64_tr_b16 v[18:19], v4 offset:47360
    v_mul_f32 v180, v180, v212
    v_mfma_f32_16x16x32_bf16 v[148:151], v[36:39], a[36:39], v[148:151]
    ds_read_b64_tr_b16 v[20:21], v4 offset:49152
    v_mul_f32 v181, v181, v213
    v_mfma_f32_16x16x32_bf16 v[144:147], v[36:39], a[32:35], v[144:147]
    ds_read_b64_tr_b16 v[22:23], v4 offset:49408
    v_mul_f32 v182, v182, v214
    v_mfma_f32_16x16x32_bf16 v[144:147], v[32:35], a[16:19], v[144:147]
    ds_read_b64_tr_b16 v[24:25], v4 offset:51200
    v_mul_f32 v183, v183, v215
    v_mfma_f32_16x16x32_bf16 v[144:147], v[28:31], a[0:3], v[144:147]
    s_waitcnt lgkmcnt(5)
    ds_read_b64_tr_b16 v[26:27], v4 offset:51456
    v_add_f32 v60, 1.0, v60
    v_mfma_f32_16x16x32_bf16 v[96:99], v[40:43], a[96:99], v[96:99]
    ds_read_b64_tr_b16 v[28:29], v5 offset:47104
    v_add_f32 v61, 1.0, v61
    v_mfma_f32_16x16x32_bf16 v[96:99], v[44:47], a[112:115], v[96:99]
    s_add_u32 s45, s54, 1769600
    v_exp_f32 v64, v64
    v_mfma_f32_16x16x32_bf16 v[96:99], v[48:51], a[128:131], v[96:99]
    s_add_u32 m0, s53, 131072
    ds_read_b64_tr_b16 v[30:31], v5 offset:47360
    v_add_f32 v62, 1.0, v62
    v_mfma_f32_16x16x32_bf16 v[100:103], v[48:51], a[132:135], v[100:103]
    buffer_load_dwordx4 v2, s[8:11], s45 offen nt lds
    v_mfma_f32_16x16x32_bf16 v[100:103], v[44:47], a[116:119], v[100:103]
    ds_read_b64_tr_b16 v[32:33], v5 offset:49152
    v_add_f32 v63, 1.0, v63
    v_mfma_f32_16x16x32_bf16 v[100:103], v[40:43], a[100:103], v[100:103]
    v_exp_f32 v65, v65
    v_mfma_f32_16x16x32_bf16 v[104:107], v[40:43], a[104:107], v[104:107]
    ds_read_b64_tr_b16 v[34:35], v5 offset:49408
    v_add_f32 v64, 1.0, v64
    v_mfma_f32_16x16x32_bf16 v[104:107], v[44:47], a[120:123], v[104:107]
    v_exp_f32 v66, v66
    v_mfma_f32_16x16x32_bf16 v[104:107], v[48:51], a[136:139], v[104:107]
    ds_read_b64_tr_b16 v[36:37], v5 offset:51200
    v_add_f32 v65, 1.0, v65
    v_mfma_f32_16x16x32_bf16 v[108:111], v[48:51], a[140:143], v[108:111]
    v_exp_f32 v67, v67
    v_mfma_f32_16x16x32_bf16 v[108:111], v[44:47], a[124:127], v[108:111]
    ds_read_b64_tr_b16 v[38:39], v5 offset:51456
    v_add_f32 v66, 1.0, v66
    v_mfma_f32_16x16x32_bf16 v[108:111], v[40:43], a[108:111], v[108:111]
    s_waitcnt lgkmcnt(6)
    v_rcp_f32 v60, v60
    v_mfma_f32_16x16x32_bf16 v[108:111], v[16:19], a[156:159], v[108:111]
    ds_read_b64_tr_b16 v[40:41], v5 offset:40960
    v_add_f32 v67, 1.0, v67
    v_mfma_f32_16x16x32_bf16 v[108:111], v[20:23], a[172:175], v[108:111]
    s_add_u32 s44, s54, 1917056
    v_rcp_f32 v61, v61
    v_mfma_f32_16x16x32_bf16 v[108:111], v[24:27], a[188:191], v[108:111]
    s_add_u32 m0, s53, 132096
    ds_read_b64_tr_b16 v[42:43], v5 offset:41216
    v_mul_f32 v164, v164, v60
    v_mfma_f32_16x16x32_bf16 v[104:107], v[24:27], a[184:187], v[104:107]
L_pad11:
    s_cbranch_execz L_pad14
    buffer_load_dwordx4 v2, s[8:11], s44 offen nt lds
    v_mfma_f32_16x16x32_bf16 v[104:107], v[20:23], a[168:171], v[104:107]
    ds_read_b64_tr_b16 v[44:45], v5 offset:43008
    v_mul_f32 v165, v165, v61
    v_mfma_f32_16x16x32_bf16 v[104:107], v[16:19], a[152:155], v[104:107]
    v_rcp_f32 v62, v62
    v_mfma_f32_16x16x32_bf16 v[100:103], v[16:19], a[148:151], v[100:103]
    ds_read_b64_tr_b16 v[46:47], v5 offset:43264
    v_mul_f32 v166, v166, v62
    v_mfma_f32_16x16x32_bf16 v[100:103], v[20:23], a[164:167], v[100:103]
    v_rcp_f32 v63, v63
    v_mfma_f32_16x16x32_bf16 v[100:103], v[24:27], a[180:183], v[100:103]
    ds_read_b64_tr_b16 v[48:49], v5 offset:45056
    v_mul_f32 v167, v167, v63
    v_mfma_f32_16x16x32_bf16 v[96:99], v[24:27], a[176:179], v[96:99]
    v_rcp_f32 v64, v64
    v_mfma_f32_16x16x32_bf16 v[96:99], v[20:23], a[160:163], v[96:99]
    ds_read_b64_tr_b16 v[50:51], v5 offset:45312
    v_mul_f32 v180, v180, v64
    v_mfma_f32_16x16x32_bf16 v[96:99], v[16:19], a[144:147], v[96:99]
    s_waitcnt lgkmcnt(6)
    v_rcp_f32 v65, v65
    v_mfma_f32_16x16x32_bf16 v[112:115], v[28:31], a[144:147], v[112:115]
    ds_read_b64_tr_b16 v[16:17], v4 offset:53248
    v_mul_f32 v181, v181, v65
    v_mfma_f32_16x16x32_bf16 v[112:115], v[32:35], a[160:163], v[112:115]
    s_add_u32 s45, s54, 2064512
    v_rcp_f32 v66, v66
    v_mfma_f32_16x16x32_bf16 v[112:115], v[36:39], a[176:179], v[112:115]
    s_add_u32 m0, s53, 133120
    ds_read_b64_tr_b16 v[18:19], v4 offset:53504
    v_mul_f32 v182, v182, v66
    v_mfma_f32_16x16x32_bf16 v[116:119], v[36:39], a[180:183], v[116:119]
    buffer_load_dwordx4 v2, s[8:11], s45 offen nt lds
    v_mfma_f32_16x16x32_bf16 v[116:119], v[32:35], a[164:167], v[116:119]
    ds_read_b64_tr_b16 v[20:21], v4 offset:55296
    v_cvt_pk_bf16_f32 v72, v164, v165
    v_mfma_f32_16x16x32_bf16 v[116:119], v[28:31], a[148:151], v[116:119]
    v_rcp_f32 v67, v67
    v_mfma_f32_16x16x32_bf16 v[120:123], v[28:31], a[152:155], v[120:123]
    ds_read_b64_tr_b16 v[22:23], v4 offset:55552
    v_mul_f32 v183, v183, v67
    v_mfma_f32_16x16x32_bf16 v[120:123], v[32:35], a[168:171], v[120:123]
    v_cvt_pk_bf16_f32 v73, v166, v167
    v_cvt_pk_bf16_f32 v74, v180, v181
    v_mfma_f32_16x16x32_bf16 v[120:123], v[36:39], a[184:187], v[120:123]
    ds_read_b64_tr_b16 v[24:25], v4 offset:57344
    v_cvt_pk_bf16_f32 v75, v182, v183
    v_mfma_f32_16x16x32_bf16 v[124:127], v[36:39], a[188:191], v[124:127]
    s_add_u32 s46, s4, 4198400
    buffer_store_dwordx4 v[72:75], v1, s[28:31], s46 offen
    v_mfma_f32_16x16x32_bf16 v[124:127], v[32:35], a[172:175], v[124:127]
    ds_read_b64_tr_b16 v[26:27], v4 offset:57600
    v_mul_f32 v52, v168, v168
    v_mfma_f32_16x16x32_bf16 v[124:127], v[28:31], a[156:159], v[124:127]
    s_waitcnt lgkmcnt(6)
    v_mul_f32 v53, v169, v169
    v_mul_f32 v54, v170, v170
    v_mfma_f32_16x16x32_bf16 v[124:127], v[40:43], a[108:111], v[124:127]
    ds_read_b64_tr_b16 v[28:29], v4 offset:59392
    v_mul_f32 v55, v171, v171
    v_mfma_f32_16x16x32_bf16 v[124:127], v[44:47], a[124:127], v[124:127]
    s_add_u32 s44, s54, 1769600
    v_mul_f32 v56, v184, v184
    v_mul_f32 v57, v185, v185
    v_mfma_f32_16x16x32_bf16 v[124:127], v[48:51], a[140:143], v[124:127]
    s_add_u32 m0, s53, 143360
    ds_read_b64_tr_b16 v[30:31], v4 offset:59648
    v_mul_f32 v58, v186, v186
    v_mfma_f32_16x16x32_bf16 v[120:123], v[48:51], a[136:139], v[120:123]
    buffer_load_dwordx4 v2, s[12:15], s44 offen nt lds
    v_mfma_f32_16x16x32_bf16 v[120:123], v[44:47], a[120:123], v[120:123]
    ds_read_b64_tr_b16 v[32:33], v4 offset:61440
    v_mul_f32 v59, v187, v187
    v_mfma_f32_16x16x32_bf16 v[120:123], v[40:43], a[104:107], v[120:123]
    v_fma_f32 v52, v52, v13, v12
    v_fma_f32 v53, v53, v13, v12
    v_mfma_f32_16x16x32_bf16 v[116:119], v[40:43], a[100:103], v[116:119]
    ds_read_b64_tr_b16 v[34:35], v4 offset:61696
    v_fma_f32 v54, v54, v13, v12
    v_mfma_f32_16x16x32_bf16 v[116:119], v[44:47], a[116:119], v[116:119]
    v_fma_f32 v55, v55, v13, v12
    v_fma_f32 v56, v56, v13, v12
    v_mfma_f32_16x16x32_bf16 v[116:119], v[48:51], a[132:135], v[116:119]
    ds_read_b64_tr_b16 v[36:37], v4 offset:63488
    v_fma_f32 v57, v57, v13, v12
    v_mfma_f32_16x16x32_bf16 v[112:115], v[48:51], a[128:131], v[112:115]
    v_fma_f32 v58, v58, v13, v12
    v_fma_f32 v59, v59, v13, v12
    v_mfma_f32_16x16x32_bf16 v[112:115], v[44:47], a[112:115], v[112:115]
    ds_read_b64_tr_b16 v[38:39], v4 offset:63744
    v_mul_f32 v52, v52, v168
    v_mfma_f32_16x16x32_bf16 v[112:115], v[40:43], a[96:99], v[112:115]
    s_waitcnt lgkmcnt(6)
    v_exp_f32 v52, v52
    v_mfma_f32_16x16x32_bf16 v[128:131], v[16:19], a[96:99], v[128:131]
    ds_read_b64_tr_b16 v[40:41], v5 offset:59392
    v_mul_f32 v53, v53, v169
    v_mfma_f32_16x16x32_bf16 v[128:131], v[20:23], a[112:115], v[128:131]
    v_exp_f32 v53, v53
    v_mfma_f32_16x16x32_bf16 v[128:131], v[24:27], a[128:131], v[128:131]
    ds_read_b64_tr_b16 v[42:43], v5 offset:59648
    v_mul_f32 v54, v54, v170
    v_mfma_f32_16x16x32_bf16 v[132:135], v[24:27], a[132:135], v[132:135]
    s_add_u32 s45, s54, 1917056
    v_exp_f32 v54, v54
    v_mfma_f32_16x16x32_bf16 v[132:135], v[20:23], a[116:119], v[132:135]
    s_add_u32 m0, s53, 144384
    ds_read_b64_tr_b16 v[44:45], v5 offset:61440
    v_mul_f32 v55, v55, v171
    v_mfma_f32_16x16x32_bf16 v[132:135], v[16:19], a[100:103], v[132:135]
    buffer_load_dwordx4 v2, s[12:15], s45 offen nt lds
    v_mfma_f32_16x16x32_bf16 v[136:139], v[16:19], a[104:107], v[136:139]
    ds_read_b64_tr_b16 v[46:47], v5 offset:61696
    v_mul_f32 v56, v56, v184
    v_mfma_f32_16x16x32_bf16 v[136:139], v[20:23], a[120:123], v[136:139]
    v_exp_f32 v55, v55
    v_mfma_f32_16x16x32_bf16 v[136:139], v[24:27], a[136:139], v[136:139]
    ds_read_b64_tr_b16 v[48:49], v5 offset:63488
    v_mul_f32 v57, v57, v185
    v_mfma_f32_16x16x32_bf16 v[140:143], v[24:27], a[140:143], v[140:143]
    v_exp_f32 v56, v56
    v_mfma_f32_16x16x32_bf16 v[140:143], v[20:23], a[124:127], v[140:143]
    ds_read_b64_tr_b16 v[50:51], v5 offset:63744
    v_mul_f32 v58, v58, v186
    v_mfma_f32_16x16x32_bf16 v[140:143], v[16:19], a[108:111], v[140:143]
    s_waitcnt lgkmcnt(6)
    v_exp_f32 v57, v57
    v_mfma_f32_16x16x32_bf16 v[140:143], v[28:31], a[156:159], v[140:143]
    ds_read_b64_tr_b16 v[16:17], v5 offset:53248
    v_mul_f32 v59, v59, v187
    v_mfma_f32_16x16x32_bf16 v[140:143], v[32:35], a[172:175], v[140:143]
    v_exp_f32 v58, v58
    v_mfma_f32_16x16x32_bf16 v[140:143], v[36:39], a[188:191], v[140:143]
    ds_read_b64_tr_b16 v[18:19], v5 offset:53504
    v_mul_f32 v168, v168, v200
    v_mfma_f32_16x16x32_bf16 v[136:139], v[36:39], a[184:187], v[136:139]
    s_add_u32 s44, s54, 2064512
    v_exp_f32 v59, v59
    v_mfma_f32_16x16x32_bf16 v[136:139], v[32:35], a[168:171], v[136:139]
    s_add_u32 m0, s53, 145408
    ds_read_b64_tr_b16 v[20:21], v5 offset:55296
    v_mul_f32 v169, v169, v201
    v_mfma_f32_16x16x32_bf16 v[136:139], v[28:31], a[152:155], v[136:139]
    buffer_load_dwordx4 v2, s[12:15], s44 offen nt lds
    v_mfma_f32_16x16x32_bf16 v[132:135], v[28:31], a[148:151], v[132:135]
    ds_read_b64_tr_b16 v[22:23], v5 offset:55552
    v_mul_f32 v170, v170, v202
    v_mfma_f32_16x16x32_bf16 v[132:135], v[32:35], a[164:167], v[132:135]
    v_mul_f32 v171, v171, v203
    v_mul_f32 v184, v184, v216
    v_mfma_f32_16x16x32_bf16 v[132:135], v[36:39], a[180:183], v[132:135]
    ds_read_b64_tr_b16 v[24:25], v5 offset:57344
    v_mul_f32 v185, v185, v217
    v_mfma_f32_16x16x32_bf16 v[128:131], v[36:39], a[176:179], v[128:131]
    v_mul_f32 v186, v186, v218
    v_mul_f32 v187, v187, v219
    v_mfma_f32_16x16x32_bf16 v[128:131], v[32:35], a[160:163], v[128:131]
    ds_read_b64_tr_b16 v[26:27], v5 offset:57600
    v_add_f32 v52, 1.0, v52
    v_mfma_f32_16x16x32_bf16 v[128:131], v[28:31], a[144:147], v[128:131]
    s_waitcnt lgkmcnt(6)
    v_rcp_f32 v52, v52
    v_mfma_f32_16x16x32_bf16 v[144:147], v[40:43], a[144:147], v[144:147]
    v_add_f32 v53, 1.0, v53
    v_add_f32 v54, 1.0, v54
    v_mfma_f32_16x16x32_bf16 v[144:147], v[44:47], a[160:163], v[144:147]
    v_rcp_f32 v53, v53
    v_mfma_f32_16x16x32_bf16 v[144:147], v[48:51], a[176:179], v[144:147]
    v_rcp_f32 v54, v54
    v_mfma_f32_16x16x32_bf16 v[148:151], v[48:51], a[180:183], v[148:151]
    v_add_f32 v55, 1.0, v55
    v_add_f32 v56, 1.0, v56
    v_mfma_f32_16x16x32_bf16 v[148:151], v[44:47], a[164:167], v[148:151]
    v_rcp_f32 v55, v55
    v_mfma_f32_16x16x32_bf16 v[148:151], v[40:43], a[148:151], v[148:151]
    v_rcp_f32 v56, v56
    v_mfma_f32_16x16x32_bf16 v[152:155], v[40:43], a[152:155], v[152:155]
    v_add_f32 v57, 1.0, v57
    v_add_f32 v58, 1.0, v58
    v_mfma_f32_16x16x32_bf16 v[152:155], v[44:47], a[168:171], v[152:155]
    v_rcp_f32 v57, v57
    v_mfma_f32_16x16x32_bf16 v[152:155], v[48:51], a[184:187], v[152:155]
    v_rcp_f32 v58, v58
    v_mfma_f32_16x16x32_bf16 v[156:159], v[48:51], a[188:191], v[156:159]
    v_add_f32 v59, 1.0, v59
    v_mul_f32 v168, v168, v52
    v_mfma_f32_16x16x32_bf16 v[156:159], v[44:47], a[172:175], v[156:159]
    v_rcp_f32 v59, v59
    v_mfma_f32_16x16x32_bf16 v[156:159], v[40:43], a[156:159], v[156:159]
    s_waitcnt vmcnt(14) lgkmcnt(0)
    s_barrier
    v_mul_f32 v169, v169, v53
    v_mfma_f32_16x16x32_bf16 v[156:159], v[16:19], a[108:111], v[156:159]
    ds_read_b64_tr_b16 v[28:29], v4 offset:0
    v_mul_f32 v170, v170, v54
    v_mfma_f32_16x16x32_bf16 v[156:159], v[20:23], a[124:127], v[156:159]
    ds_read_b64_tr_b16 v[30:31], v4 offset:256
    v_mul_f32 v171, v171, v55
    v_mfma_f32_16x16x32_bf16 v[156:159], v[24:27], a[140:143], v[156:159]
    ds_read_b64_tr_b16 v[32:33], v4 offset:2048
    v_mul_f32 v184, v184, v56
    v_mfma_f32_16x16x32_bf16 v[152:155], v[24:27], a[136:139], v[152:155]
    ds_read_b64_tr_b16 v[34:35], v4 offset:2304
    v_mul_f32 v185, v185, v57
    v_mfma_f32_16x16x32_bf16 v[152:155], v[20:23], a[120:123], v[152:155]
    ds_read_b64_tr_b16 v[36:37], v4 offset:4096
    v_mul_f32 v186, v186, v58
    v_mfma_f32_16x16x32_bf16 v[152:155], v[16:19], a[104:107], v[152:155]
    ds_read_b64_tr_b16 v[38:39], v4 offset:4352
    v_mul_f32 v187, v187, v59
    v_mfma_f32_16x16x32_bf16 v[148:151], v[16:19], a[100:103], v[148:151]
    ds_read_b64_tr_b16 v[40:41], v4 offset:6144
    v_cvt_pk_bf16_f32 v68, v168, v169
    v_mfma_f32_16x16x32_bf16 v[148:151], v[20:23], a[116:119], v[148:151]
    ds_read_b64_tr_b16 v[42:43], v4 offset:6400
    v_cvt_pk_bf16_f32 v69, v170, v171
    v_mfma_f32_16x16x32_bf16 v[148:151], v[24:27], a[132:135], v[148:151]
    ds_read_b64_tr_b16 v[44:45], v4 offset:8192
    v_cvt_pk_bf16_f32 v70, v184, v185
    v_mfma_f32_16x16x32_bf16 v[144:147], v[24:27], a[128:131], v[144:147]
    ds_read_b64_tr_b16 v[46:47], v4 offset:8448
    v_cvt_pk_bf16_f32 v71, v186, v187
    v_mfma_f32_16x16x32_bf16 v[144:147], v[20:23], a[112:115], v[144:147]
    ds_read_b64_tr_b16 v[48:49], v4 offset:10240
    v_mul_f32 v60, v172, v172
    v_mfma_f32_16x16x32_bf16 v[144:147], v[16:19], a[96:99], v[144:147]
    s_waitcnt lgkmcnt(5)
    ds_read_b64_tr_b16 v[50:51], v4 offset:10496
    v_mul_f32 v61, v173, v173
    v_mfma_f32_16x16x32_bf16 v[96:99], v[28:31], a[192:195], v[96:99]
    ds_read_b64_tr_b16 v[16:17], v5 offset:6144
    v_mul_f32 v62, v174, v174
    v_mfma_f32_16x16x32_bf16 v[96:99], v[32:35], a[208:211], v[96:99]
    s_add_u32 s45, s54, 3539072
    v_mul_f32 v63, v175, v175
    v_mul_f32 v64, v188, v188
    v_mfma_f32_16x16x32_bf16 v[96:99], v[36:39], a[224:227], v[96:99]
    s_add_u32 m0, s53, 81920
    ds_read_b64_tr_b16 v[18:19], v5 offset:6400
    v_mul_f32 v65, v189, v189
    v_mfma_f32_16x16x32_bf16 v[100:103], v[36:39], a[228:231], v[100:103]
    buffer_load_dwordx4 v2, s[8:11], s45 offen nt lds
    v_mfma_f32_16x16x32_bf16 v[100:103], v[32:35], a[212:215], v[100:103]
    ds_read_b64_tr_b16 v[20:21], v5 offset:8192
    v_mul_f32 v66, v190, v190
    v_mfma_f32_16x16x32_bf16 v[100:103], v[28:31], a[196:199], v[100:103]
    s_add_u32 s46, s4, 4202496
    buffer_store_dwordx4 v[68:71], v1, s[28:31], s46 offen
    v_mfma_f32_16x16x32_bf16 v[104:107], v[28:31], a[200:203], v[104:107]
    ds_read_b64_tr_b16 v[22:23], v5 offset:8448
    v_mul_f32 v67, v191, v191
    v_mfma_f32_16x16x32_bf16 v[104:107], v[32:35], a[216:219], v[104:107]
    v_fma_f32 v60, v60, v13, v12
    v_fma_f32 v61, v61, v13, v12
    v_mfma_f32_16x16x32_bf16 v[104:107], v[36:39], a[232:235], v[104:107]
    ds_read_b64_tr_b16 v[24:25], v5 offset:10240
    v_fma_f32 v62, v62, v13, v12
    v_mfma_f32_16x16x32_bf16 v[108:111], v[36:39], a[236:239], v[108:111]
    v_fma_f32 v63, v63, v13, v12
    v_fma_f32 v64, v64, v13, v12
    v_mfma_f32_16x16x32_bf16 v[108:111], v[32:35], a[220:223], v[108:111]
    ds_read_b64_tr_b16 v[26:27], v5 offset:10496
    v_fma_f32 v65, v65, v13, v12
    v_mfma_f32_16x16x32_bf16 v[108:111], v[28:31], a[204:207], v[108:111]
    s_waitcnt lgkmcnt(6)
    v_fma_f32 v66, v66, v13, v12
    v_fma_f32 v67, v67, v13, v12
    v_mfma_f32_16x16x32_bf16 v[108:111], v[40:43], a[252:255], v[108:111]
    ds_read_b64_tr_b16 v[28:29], v5 offset:0
    v_mul_f32 v60, v60, v172
    v_mfma_f32_16x16x32_bf16 v[108:111], v[44:47], v[236:239], v[108:111]
    s_add_u32 s44, s54, 3686528
    v_exp_f32 v60, v60
    v_mfma_f32_16x16x32_bf16 v[108:111], v[48:51], v[252:255], v[108:111]
    s_add_u32 m0, s53, 82944
    ds_read_b64_tr_b16 v[30:31], v5 offset:256
    v_mul_f32 v61, v61, v173
    v_mfma_f32_16x16x32_bf16 v[104:107], v[48:51], v[248:251], v[104:107]
    buffer_load_dwordx4 v2, s[8:11], s44 offen nt lds
    v_mfma_f32_16x16x32_bf16 v[104:107], v[44:47], v[232:235], v[104:107]
    ds_read_b64_tr_b16 v[32:33], v5 offset:2048
    v_mul_f32 v62, v62, v174
    v_mfma_f32_16x16x32_bf16 v[104:107], v[40:43], a[248:251], v[104:107]
    v_exp_f32 v61, v61
    v_mfma_f32_16x16x32_bf16 v[100:103], v[40:43], a[244:247], v[100:103]
    ds_read_b64_tr_b16 v[34:35], v5 offset:2304
    v_mul_f32 v63, v63, v175
    v_mfma_f32_16x16x32_bf16 v[100:103], v[44:47], v[228:231], v[100:103]
    v_exp_f32 v62, v62
    v_mfma_f32_16x16x32_bf16 v[100:103], v[48:51], v[244:247], v[100:103]
    ds_read_b64_tr_b16 v[36:37], v5 offset:4096
    v_mul_f32 v64, v64, v188
    v_mfma_f32_16x16x32_bf16 v[96:99], v[48:51], v[240:243], v[96:99]
    v_exp_f32 v63, v63
    v_mfma_f32_16x16x32_bf16 v[96:99], v[44:47], v[224:227], v[96:99]
    ds_read_b64_tr_b16 v[38:39], v5 offset:4352
    v_mul_f32 v65, v65, v189
    v_mfma_f32_16x16x32_bf16 v[96:99], v[40:43], a[240:243], v[96:99]
    s_waitcnt lgkmcnt(6)
    v_exp_f32 v64, v64
    v_mfma_f32_16x16x32_bf16 v[112:115], v[16:19], a[240:243], v[112:115]
    ds_read_b64_tr_b16 v[40:41], v4 offset:12288
    v_mul_f32 v66, v66, v190
    v_mfma_f32_16x16x32_bf16 v[112:115], v[20:23], v[224:227], v[112:115]
    s_add_u32 s45, s54, 3833984
    v_exp_f32 v65, v65
    v_mfma_f32_16x16x32_bf16 v[112:115], v[24:27], v[240:243], v[112:115]
    s_add_u32 m0, s53, 83968
    ds_read_b64_tr_b16 v[42:43], v4 offset:12544
    v_mul_f32 v67, v67, v191
    v_mfma_f32_16x16x32_bf16 v[116:119], v[24:27], v[244:247], v[116:119]
    buffer_load_dwordx4 v2, s[8:11], s45 offen nt lds
    v_mfma_f32_16x16x32_bf16 v[116:119], v[20:23], v[228:231], v[116:119]
    ds_read_b64_tr_b16 v[44:45], v4 offset:14336
    v_mul_f32 v172, v172, v204
    v_mfma_f32_16x16x32_bf16 v[116:119], v[16:19], a[244:247], v[116:119]
    v_exp_f32 v66, v66
    v_mfma_f32_16x16x32_bf16 v[120:123], v[16:19], a[248:251], v[120:123]
    ds_read_b64_tr_b16 v[46:47], v4 offset:14592
    v_mul_f32 v173, v173, v205
    v_mfma_f32_16x16x32_bf16 v[120:123], v[20:23], v[232:235], v[120:123]
    v_exp_f32 v67, v67
    v_mfma_f32_16x16x32_bf16 v[120:123], v[24:27], v[248:251], v[120:123]
    ds_read_b64_tr_b16 v[48:49], v4 offset:16384
    v_mul_f32 v174, v174, v206
    v_mfma_f32_16x16x32_bf16 v[124:127], v[24:27], v[252:255], v[124:127]
    v_mul_f32 v175, v175, v207
    v_mul_f32 v188, v188, v220
    v_mfma_f32_16x16x32_bf16 v[124:127], v[20:23], v[236:239], v[124:127]
    ds_read_b64_tr_b16 v[50:51], v4 offset:16640
    v_mul_f32 v189, v189, v221
    v_mfma_f32_16x16x32_bf16 v[124:127], v[16:19], a[252:255], v[124:127]
    s_waitcnt lgkmcnt(6)
    v_mul_f32 v190, v190, v222
    v_mul_f32 v191, v191, v223
    v_mfma_f32_16x16x32_bf16 v[124:127], v[28:31], a[204:207], v[124:127]
    ds_read_b64_tr_b16 v[16:17], v4 offset:18432
    v_add_f32 v60, 1.0, v60
    v_mfma_f32_16x16x32_bf16 v[124:127], v[32:35], a[220:223], v[124:127]
    s_add_u32 s44, s54, 3539072
    v_rcp_f32 v60, v60
    v_mfma_f32_16x16x32_bf16 v[124:127], v[36:39], a[236:239], v[124:127]
    s_add_u32 m0, s53, 94208
    ds_read_b64_tr_b16 v[18:19], v4 offset:18688
    v_add_f32 v61, 1.0, v61
    v_mfma_f32_16x16x32_bf16 v[120:123], v[36:39], a[232:235], v[120:123]
    buffer_load_dwordx4 v2, s[12:15], s44 offen nt lds
    v_mfma_f32_16x16x32_bf16 v[120:123], v[32:35], a[216:219], v[120:123]
    ds_read_b64_tr_b16 v[20:21], v4 offset:20480
    v_add_f32 v62, 1.0, v62
    v_mfma_f32_16x16x32_bf16 v[120:123], v[28:31], a[200:203], v[120:123]
    v_rcp_f32 v61, v61
    v_mfma_f32_16x16x32_bf16 v[116:119], v[28:31], a[196:199], v[116:119]
    ds_read_b64_tr_b16 v[22:23], v4 offset:20736
    v_add_f32 v63, 1.0, v63
    v_mfma_f32_16x16x32_bf16 v[116:119], v[32:35], a[212:215], v[116:119]
    v_rcp_f32 v62, v62
    v_mfma_f32_16x16x32_bf16 v[116:119], v[36:39], a[228:231], v[116:119]
    ds_read_b64_tr_b16 v[24:25], v4 offset:22528
    v_add_f32 v64, 1.0, v64
    v_mfma_f32_16x16x32_bf16 v[112:115], v[36:39], a[224:227], v[112:115]
    v_rcp_f32 v63, v63
    v_mfma_f32_16x16x32_bf16 v[112:115], v[32:35], a[208:211], v[112:115]
    ds_read_b64_tr_b16 v[26:27], v4 offset:22784
    v_add_f32 v65, 1.0, v65
    v_mfma_f32_16x16x32_bf16 v[112:115], v[28:31], a[192:195], v[112:115]
    s_waitcnt lgkmcnt(6)
    v_rcp_f32 v64, v64
    v_mfma_f32_16x16x32_bf16 v[128:131], v[40:43], a[192:195], v[128:131]
    ds_read_b64_tr_b16 v[28:29], v5 offset:18432
    v_add_f32 v66, 1.0, v66
    v_mfma_f32_16x16x32_bf16 v[128:131], v[44:47], a[208:211], v[128:131]
    v_rcp_f32 v65, v65
    v_mfma_f32_16x16x32_bf16 v[128:131], v[48:51], a[224:227], v[128:131]
    ds_read_b64_tr_b16 v[30:31], v5 offset:18688
    v_add_f32 v67, 1.0, v67
    v_mfma_f32_16x16x32_bf16 v[132:135], v[48:51], a[228:231], v[132:135]
    s_add_u32 s45, s54, 3686528
    v_rcp_f32 v66, v66
    v_mfma_f32_16x16x32_bf16 v[132:135], v[44:47], a[212:215], v[132:135]
    s_add_u32 m0, s53, 95232
    ds_read_b64_tr_b16 v[32:33], v5 offset:20480
    v_mul_f32 v172, v172, v60
    v_mfma_f32_16x16x32_bf16 v[132:135], v[40:43], a[196:199], v[132:135]
    buffer_load_dwordx4 v2, s[12:15], s45 offen nt lds
    v_mfma_f32_16x16x32_bf16 v[136:139], v[40:43], a[200:203], v[136:139]
    ds_read_b64_tr_b16 v[34:35], v5 offset:20736
    v_mul_f32 v173, v173, v61
    v_mfma_f32_16x16x32_bf16 v[136:139], v[44:47], a[216:219], v[136:139]
    v_rcp_f32 v67, v67
    v_mfma_f32_16x16x32_bf16 v[136:139], v[48:51], a[232:235], v[136:139]
    ds_read_b64_tr_b16 v[36:37], v5 offset:22528
    v_mul_f32 v174, v174, v62
    v_mfma_f32_16x16x32_bf16 v[140:143], v[48:51], a[236:239], v[140:143]
    v_mul_f32 v175, v175, v63
    v_mul_f32 v188, v188, v64
    v_mfma_f32_16x16x32_bf16 v[140:143], v[44:47], a[220:223], v[140:143]
    ds_read_b64_tr_b16 v[38:39], v5 offset:22784
    v_mul_f32 v189, v189, v65
    v_mfma_f32_16x16x32_bf16 v[140:143], v[40:43], a[204:207], v[140:143]
    s_waitcnt lgkmcnt(6)
    v_mul_f32 v190, v190, v66
    v_mul_f32 v191, v191, v67
    v_mfma_f32_16x16x32_bf16 v[140:143], v[16:19], a[252:255], v[140:143]
    ds_read_b64_tr_b16 v[40:41], v5 offset:12288
    v_cvt_pk_bf16_f32 v72, v172, v173
    v_mfma_f32_16x16x32_bf16 v[140:143], v[20:23], v[236:239], v[140:143]
    v_cvt_pk_bf16_f32 v73, v174, v175
    v_cvt_pk_bf16_f32 v74, v188, v189
    v_mfma_f32_16x16x32_bf16 v[140:143], v[24:27], v[252:255], v[140:143]
    ds_read_b64_tr_b16 v[42:43], v5 offset:12544
    v_cvt_pk_bf16_f32 v75, v190, v191
    v_mfma_f32_16x16x32_bf16 v[136:139], v[24:27], v[248:251], v[136:139]
    s_add_u32 s44, s54, 3833984
    v_mfma_f32_16x16x32_bf16 v[136:139], v[20:23], v[232:235], v[136:139]
    s_add_u32 m0, s53, 96256
    ds_read_b64_tr_b16 v[44:45], v5 offset:14336
    v_mfma_f32_16x16x32_bf16 v[136:139], v[16:19], a[248:251], v[136:139]
    buffer_load_dwordx4 v2, s[12:15], s44 offen nt lds
    v_mfma_f32_16x16x32_bf16 v[132:135], v[16:19], a[244:247], v[132:135]
    ds_read_b64_tr_b16 v[46:47], v5 offset:14592
    v_mfma_f32_16x16x32_bf16 v[132:135], v[20:23], v[228:231], v[132:135]
    s_add_u32 s46, s4, 4206592
    buffer_store_dwordx4 v[72:75], v1, s[28:31], s46 offen
    v_mfma_f32_16x16x32_bf16 v[132:135], v[24:27], v[244:247], v[132:135]
    ds_read_b64_tr_b16 v[48:49], v5 offset:16384
    v_mfma_f32_16x16x32_bf16 v[128:131], v[24:27], v[240:243], v[128:131]
    v_mfma_f32_16x16x32_bf16 v[128:131], v[20:23], v[224:227], v[128:131]
    ds_read_b64_tr_b16 v[50:51], v5 offset:16640
    v_mfma_f32_16x16x32_bf16 v[128:131], v[16:19], a[240:243], v[128:131]
    s_waitcnt lgkmcnt(6)
    v_mfma_f32_16x16x32_bf16 v[144:147], v[28:31], a[240:243], v[144:147]
    v_mfma_f32_16x16x32_bf16 v[144:147], v[32:35], v[224:227], v[144:147]
    v_mfma_f32_16x16x32_bf16 v[144:147], v[36:39], v[240:243], v[144:147]
    v_mfma_f32_16x16x32_bf16 v[148:151], v[36:39], v[244:247], v[148:151]
    v_mfma_f32_16x16x32_bf16 v[148:151], v[32:35], v[228:231], v[148:151]
    v_mfma_f32_16x16x32_bf16 v[148:151], v[28:31], a[244:247], v[148:151]
    v_mfma_f32_16x16x32_bf16 v[152:155], v[28:31], a[248:251], v[152:155]
    v_mfma_f32_16x16x32_bf16 v[152:155], v[32:35], v[232:235], v[152:155]
    v_mfma_f32_16x16x32_bf16 v[152:155], v[36:39], v[248:251], v[152:155]
    v_mfma_f32_16x16x32_bf16 v[156:159], v[36:39], v[252:255], v[156:159]
    v_mfma_f32_16x16x32_bf16 v[156:159], v[32:35], v[236:239], v[156:159]
    v_mfma_f32_16x16x32_bf16 v[156:159], v[28:31], a[252:255], v[156:159]
    s_waitcnt vmcnt(16) lgkmcnt(0)
    s_barrier
    v_mfma_f32_16x16x32_bf16 v[156:159], v[40:43], a[204:207], v[156:159]
    ds_read_b64_tr_b16 v[16:17], v6 offset:0
    v_mfma_f32_16x16x32_bf16 v[156:159], v[44:47], a[220:223], v[156:159]
    ds_read_b64_tr_b16 v[18:19], v6 offset:256
    v_mfma_f32_16x16x32_bf16 v[156:159], v[48:51], a[236:239], v[156:159]
    ds_read_b64_tr_b16 v[20:21], v6 offset:2048
    v_mfma_f32_16x16x32_bf16 v[152:155], v[48:51], a[232:235], v[152:155]
    ds_read_b64_tr_b16 v[22:23], v6 offset:2304
    v_mfma_f32_16x16x32_bf16 v[152:155], v[44:47], a[216:219], v[152:155]
    ds_read_b64_tr_b16 v[24:25], v6 offset:4096
    v_mfma_f32_16x16x32_bf16 v[152:155], v[40:43], a[200:203], v[152:155]
    ds_read_b64_tr_b16 v[26:27], v6 offset:4352
    v_mfma_f32_16x16x32_bf16 v[148:151], v[40:43], a[196:199], v[148:151]
    ds_read_b64_tr_b16 v[28:29], v6 offset:6144
    v_mfma_f32_16x16x32_bf16 v[148:151], v[44:47], a[212:215], v[148:151]
    ds_read_b64_tr_b16 v[30:31], v6 offset:6400
    v_mfma_f32_16x16x32_bf16 v[148:151], v[48:51], a[228:231], v[148:151]
    ds_read_b64_tr_b16 v[32:33], v6 offset:8192
    v_mfma_f32_16x16x32_bf16 v[144:147], v[48:51], a[224:227], v[144:147]
    ds_read_b64_tr_b16 v[34:35], v6 offset:8448
    v_mfma_f32_16x16x32_bf16 v[144:147], v[44:47], a[208:211], v[144:147]
    ds_read_b64_tr_b16 v[36:37], v6 offset:10240
    v_mfma_f32_16x16x32_bf16 v[144:147], v[40:43], a[192:195], v[144:147]
    s_waitcnt lgkmcnt(5)
    ds_read_b64_tr_b16 v[38:39], v6 offset:10496
    v_mfma_f32_16x16x32_bf16 v[160:163], v[16:19], a[0:3], 0
    ds_read_b64_tr_b16 v[40:41], v7 offset:6144
    v_mfma_f32_16x16x32_bf16 v[160:163], v[20:23], a[16:19], v[160:163]
    s_add_u32 s45, s54, 192
    v_mfma_f32_16x16x32_bf16 v[160:163], v[24:27], a[32:35], v[160:163]
    s_add_u32 m0, s53, 40960
    ds_read_b64_tr_b16 v[42:43], v7 offset:6400
    v_mfma_f32_16x16x32_bf16 v[164:167], v[24:27], a[36:39], 0
    buffer_load_dwordx4 v2, s[8:11], s45 offen nt lds
    v_mfma_f32_16x16x32_bf16 v[164:167], v[20:23], a[20:23], v[164:167]
    ds_read_b64_tr_b16 v[44:45], v7 offset:8192
    v_mul_f32 v52, v96, v96
    v_mfma_f32_16x16x32_bf16 v[164:167], v[16:19], a[4:7], v[164:167]
    v_mul_f32 v53, v97, v97
    v_mul_f32 v54, v98, v98
    v_mfma_f32_16x16x32_bf16 v[168:171], v[16:19], a[8:11], 0
    ds_read_b64_tr_b16 v[46:47], v7 offset:8448
    v_mul_f32 v55, v99, v99
    v_mfma_f32_16x16x32_bf16 v[168:171], v[20:23], a[24:27], v[168:171]
    v_mul_f32 v56, v112, v112
    v_mul_f32 v57, v113, v113
    v_mfma_f32_16x16x32_bf16 v[168:171], v[24:27], a[40:43], v[168:171]
    ds_read_b64_tr_b16 v[48:49], v7 offset:10240
    v_mul_f32 v58, v114, v114
    v_mfma_f32_16x16x32_bf16 v[172:175], v[24:27], a[44:47], 0
    v_mul_f32 v59, v115, v115
    v_fma_f32 v52, v52, v13, v12
    v_mfma_f32_16x16x32_bf16 v[172:175], v[20:23], a[28:31], v[172:175]
    ds_read_b64_tr_b16 v[50:51], v7 offset:10496
    v_fma_f32 v53, v53, v13, v12
    v_mfma_f32_16x16x32_bf16 v[172:175], v[16:19], a[12:15], v[172:175]
    s_waitcnt lgkmcnt(6)
    v_fma_f32 v54, v54, v13, v12
    v_fma_f32 v55, v55, v13, v12
    v_mfma_f32_16x16x32_bf16 v[172:175], v[28:31], a[60:63], v[172:175]
    ds_read_b64_tr_b16 v[16:17], v7 offset:0
    v_fma_f32 v56, v56, v13, v12
    v_mfma_f32_16x16x32_bf16 v[172:175], v[32:35], a[76:79], v[172:175]
    s_add_u32 s44, s54, 147648
    v_fma_f32 v57, v57, v13, v12
    v_fma_f32 v58, v58, v13, v12
    v_mfma_f32_16x16x32_bf16 v[172:175], v[36:39], a[92:95], v[172:175]
    s_add_u32 m0, s53, 41984
    ds_read_b64_tr_b16 v[18:19], v7 offset:256
    v_fma_f32 v59, v59, v13, v12
    v_mfma_f32_16x16x32_bf16 v[168:171], v[36:39], a[88:91], v[168:171]
    buffer_load_dwordx4 v2, s[8:11], s44 offen nt lds
    v_mfma_f32_16x16x32_bf16 v[168:171], v[32:35], a[72:75], v[168:171]
    ds_read_b64_tr_b16 v[20:21], v7 offset:2048
    v_mul_f32 v52, v52, v96
    v_mfma_f32_16x16x32_bf16 v[168:171], v[28:31], a[56:59], v[168:171]
    v_exp_f32 v52, v52
    v_mfma_f32_16x16x32_bf16 v[164:167], v[28:31], a[52:55], v[164:167]
    ds_read_b64_tr_b16 v[22:23], v7 offset:2304
    v_mul_f32 v53, v53, v97
    v_mfma_f32_16x16x32_bf16 v[164:167], v[32:35], a[68:71], v[164:167]
    v_exp_f32 v53, v53
    v_mfma_f32_16x16x32_bf16 v[164:167], v[36:39], a[84:87], v[164:167]
    ds_read_b64_tr_b16 v[24:25], v7 offset:4096
    v_mul_f32 v54, v54, v98
    v_mfma_f32_16x16x32_bf16 v[160:163], v[36:39], a[80:83], v[160:163]
    v_exp_f32 v54, v54
    v_mfma_f32_16x16x32_bf16 v[160:163], v[32:35], a[64:67], v[160:163]
    ds_read_b64_tr_b16 v[26:27], v7 offset:4352
    v_mul_f32 v55, v55, v99
    v_mfma_f32_16x16x32_bf16 v[160:163], v[28:31], a[48:51], v[160:163]
    s_waitcnt lgkmcnt(6)
    v_exp_f32 v55, v55
    v_mfma_f32_16x16x32_bf16 v[176:179], v[40:43], a[48:51], 0
    ds_read_b64_tr_b16 v[28:29], v6 offset:12288
    v_mul_f32 v56, v56, v112
    v_mfma_f32_16x16x32_bf16 v[176:179], v[44:47], a[64:67], v[176:179]
    s_add_u32 s45, s54, 295104
    v_exp_f32 v56, v56
    v_mfma_f32_16x16x32_bf16 v[176:179], v[48:51], a[80:83], v[176:179]
    s_add_u32 m0, s53, 43008
    ds_read_b64_tr_b16 v[30:31], v6 offset:12544
    v_mul_f32 v57, v57, v113
    v_mfma_f32_16x16x32_bf16 v[180:183], v[48:51], a[84:87], 0
    buffer_load_dwordx4 v2, s[8:11], s45 offen nt lds
    v_mfma_f32_16x16x32_bf16 v[180:183], v[44:47], a[68:71], v[180:183]
    ds_read_b64_tr_b16 v[32:33], v6 offset:14336
    v_mul_f32 v58, v58, v114
    v_mfma_f32_16x16x32_bf16 v[180:183], v[40:43], a[52:55], v[180:183]
    v_exp_f32 v57, v57
    v_mfma_f32_16x16x32_bf16 v[184:187], v[40:43], a[56:59], 0
    ds_read_b64_tr_b16 v[34:35], v6 offset:14592
    v_mul_f32 v59, v59, v115
    v_mfma_f32_16x16x32_bf16 v[184:187], v[44:47], a[72:75], v[184:187]
    v_exp_f32 v58, v58
    v_mfma_f32_16x16x32_bf16 v[184:187], v[48:51], a[88:91], v[184:187]
    ds_read_b64_tr_b16 v[36:37], v6 offset:16384
    v_mul_f32 v96, v96, v128
    v_mfma_f32_16x16x32_bf16 v[188:191], v[48:51], a[92:95], 0
    v_exp_f32 v59, v59
    v_mfma_f32_16x16x32_bf16 v[188:191], v[44:47], a[76:79], v[188:191]
    ds_read_b64_tr_b16 v[38:39], v6 offset:16640
    v_mul_f32 v97, v97, v129
    v_mfma_f32_16x16x32_bf16 v[188:191], v[40:43], a[60:63], v[188:191]
    s_waitcnt lgkmcnt(6)
    v_mul_f32 v98, v98, v130
    v_mul_f32 v99, v99, v131
    v_mfma_f32_16x16x32_bf16 v[188:191], v[16:19], a[12:15], v[188:191]
    ds_read_b64_tr_b16 v[40:41], v6 offset:18432
    v_mul_f32 v112, v112, v144
    v_mfma_f32_16x16x32_bf16 v[188:191], v[20:23], a[28:31], v[188:191]
    s_add_u32 s44, s54, 192
    v_mul_f32 v113, v113, v145
    v_mul_f32 v114, v114, v146
    v_mfma_f32_16x16x32_bf16 v[188:191], v[24:27], a[44:47], v[188:191]
    s_add_u32 m0, s53, 53248
    ds_read_b64_tr_b16 v[42:43], v6 offset:18688
    v_mul_f32 v115, v115, v147
    v_mfma_f32_16x16x32_bf16 v[184:187], v[24:27], a[40:43], v[184:187]
    buffer_load_dwordx4 v2, s[12:15], s44 offen nt lds
    v_mfma_f32_16x16x32_bf16 v[184:187], v[20:23], a[24:27], v[184:187]
    ds_read_b64_tr_b16 v[44:45], v6 offset:20480
    v_add_f32 v52, 1.0, v52
    v_mfma_f32_16x16x32_bf16 v[184:187], v[16:19], a[8:11], v[184:187]
    v_rcp_f32 v52, v52
    v_mfma_f32_16x16x32_bf16 v[180:183], v[16:19], a[4:7], v[180:183]
    ds_read_b64_tr_b16 v[46:47], v6 offset:20736
    v_add_f32 v53, 1.0, v53
    v_mfma_f32_16x16x32_bf16 v[180:183], v[20:23], a[20:23], v[180:183]
    v_rcp_f32 v53, v53
    v_mfma_f32_16x16x32_bf16 v[180:183], v[24:27], a[36:39], v[180:183]
    ds_read_b64_tr_b16 v[48:49], v6 offset:22528
    v_add_f32 v54, 1.0, v54
    v_mfma_f32_16x16x32_bf16 v[176:179], v[24:27], a[32:35], v[176:179]
L_pad10:
    s_cbranch_execz L_pad13
    v_rcp_f32 v54, v54
    v_mfma_f32_16x16x32_bf16 v[176:179], v[20:23], a[16:19], v[176:179]
    ds_read_b64_tr_b16 v[50:51], v6 offset:22784
    v_add_f32 v55, 1.0, v55
    v_mfma_f32_16x16x32_bf16 v[176:179], v[16:19], a[0:3], v[176:179]
    s_waitcnt lgkmcnt(6)
    v_rcp_f32 v55, v55
    v_mfma_f32_16x16x32_bf16 v[192:195], v[28:31], a[0:3], 0
    ds_read_b64_tr_b16 v[16:17], v7 offset:18432
    v_add_f32 v56, 1.0, v56
    v_mfma_f32_16x16x32_bf16 v[192:195], v[32:35], a[16:19], v[192:195]
    v_rcp_f32 v56, v56
    v_mfma_f32_16x16x32_bf16 v[192:195], v[36:39], a[32:35], v[192:195]
    ds_read_b64_tr_b16 v[18:19], v7 offset:18688
    v_add_f32 v57, 1.0, v57
    v_mfma_f32_16x16x32_bf16 v[196:199], v[36:39], a[36:39], 0
    s_add_u32 s45, s54, 147648
    v_rcp_f32 v57, v57
    v_mfma_f32_16x16x32_bf16 v[196:199], v[32:35], a[20:23], v[196:199]
    s_add_u32 m0, s53, 54272
    ds_read_b64_tr_b16 v[20:21], v7 offset:20480
    v_add_f32 v58, 1.0, v58
    v_mfma_f32_16x16x32_bf16 v[196:199], v[28:31], a[4:7], v[196:199]
    buffer_load_dwordx4 v2, s[12:15], s45 offen nt lds
    v_mfma_f32_16x16x32_bf16 v[200:203], v[28:31], a[8:11], 0
    ds_read_b64_tr_b16 v[22:23], v7 offset:20736
    v_add_f32 v59, 1.0, v59
    v_mfma_f32_16x16x32_bf16 v[200:203], v[32:35], a[24:27], v[200:203]
    v_rcp_f32 v58, v58
    v_mfma_f32_16x16x32_bf16 v[200:203], v[36:39], a[40:43], v[200:203]
    ds_read_b64_tr_b16 v[24:25], v7 offset:22528
    v_mul_f32 v96, v96, v52
    v_mfma_f32_16x16x32_bf16 v[204:207], v[36:39], a[44:47], 0
    v_rcp_f32 v59, v59
    v_mfma_f32_16x16x32_bf16 v[204:207], v[32:35], a[28:31], v[204:207]
    ds_read_b64_tr_b16 v[26:27], v7 offset:22784
    v_mul_f32 v97, v97, v53
    v_mfma_f32_16x16x32_bf16 v[204:207], v[28:31], a[12:15], v[204:207]
    s_waitcnt lgkmcnt(6)
    v_mul_f32 v98, v98, v54
    v_mul_f32 v99, v99, v55
    v_mfma_f32_16x16x32_bf16 v[204:207], v[40:43], a[60:63], v[204:207]
    ds_read_b64_tr_b16 v[28:29], v7 offset:12288
    v_mul_f32 v112, v112, v56
    v_mfma_f32_16x16x32_bf16 v[204:207], v[44:47], a[76:79], v[204:207]
    v_mul_f32 v113, v113, v57
    v_mul_f32 v114, v114, v58
    v_mfma_f32_16x16x32_bf16 v[204:207], v[48:51], a[92:95], v[204:207]
    ds_read_b64_tr_b16 v[30:31], v7 offset:12544
    v_mul_f32 v115, v115, v59
    v_mfma_f32_16x16x32_bf16 v[200:203], v[48:51], a[88:91], v[200:203]
    s_add_u32 s44, s54, 295104
    v_cvt_pk_bf16_f32 v68, v96, v97
    v_cvt_pk_bf16_f32 v69, v98, v99
    v_mfma_f32_16x16x32_bf16 v[200:203], v[44:47], a[72:75], v[200:203]
    s_add_u32 m0, s53, 55296
    ds_read_b64_tr_b16 v[32:33], v7 offset:14336
    v_cvt_pk_bf16_f32 v70, v112, v113
    v_mfma_f32_16x16x32_bf16 v[200:203], v[40:43], a[56:59], v[200:203]
    buffer_load_dwordx4 v2, s[12:15], s44 offen nt lds
    v_mfma_f32_16x16x32_bf16 v[196:199], v[40:43], a[52:55], v[196:199]
    ds_read_b64_tr_b16 v[34:35], v7 offset:14592
    v_cvt_pk_bf16_f32 v71, v114, v115
    v_mfma_f32_16x16x32_bf16 v[196:199], v[44:47], a[68:71], v[196:199]
    s_add_u32 s46, s5, 4194304
    buffer_store_dwordx4 v[68:71], v1, s[28:31], s46 offen
    v_mfma_f32_16x16x32_bf16 v[196:199], v[48:51], a[84:87], v[196:199]
    ds_read_b64_tr_b16 v[36:37], v7 offset:16384
    v_mul_f32 v60, v100, v100
    v_mfma_f32_16x16x32_bf16 v[192:195], v[48:51], a[80:83], v[192:195]
    v_mul_f32 v61, v101, v101
    v_mul_f32 v62, v102, v102
    v_mfma_f32_16x16x32_bf16 v[192:195], v[44:47], a[64:67], v[192:195]
    ds_read_b64_tr_b16 v[38:39], v7 offset:16640
    v_mul_f32 v63, v103, v103
    v_mfma_f32_16x16x32_bf16 v[192:195], v[40:43], a[48:51], v[192:195]
    s_waitcnt lgkmcnt(6)
    v_mul_f32 v64, v116, v116
    v_mul_f32 v65, v117, v117
    v_mfma_f32_16x16x32_bf16 v[208:211], v[16:19], a[48:51], 0
    v_mul_f32 v66, v118, v118
    v_mul_f32 v67, v119, v119
    v_mfma_f32_16x16x32_bf16 v[208:211], v[20:23], a[64:67], v[208:211]
    v_fma_f32 v60, v60, v13, v12
    v_fma_f32 v61, v61, v13, v12
    v_mfma_f32_16x16x32_bf16 v[208:211], v[24:27], a[80:83], v[208:211]
    v_fma_f32 v62, v62, v13, v12
    v_fma_f32 v63, v63, v13, v12
    v_mfma_f32_16x16x32_bf16 v[212:215], v[24:27], a[84:87], 0
    v_fma_f32 v64, v64, v13, v12
    v_fma_f32 v65, v65, v13, v12
    v_mfma_f32_16x16x32_bf16 v[212:215], v[20:23], a[68:71], v[212:215]
    v_fma_f32 v66, v66, v13, v12
    v_fma_f32 v67, v67, v13, v12
    v_mfma_f32_16x16x32_bf16 v[212:215], v[16:19], a[52:55], v[212:215]
    v_mul_f32 v60, v60, v100
    v_mul_f32 v61, v61, v101
    v_mfma_f32_16x16x32_bf16 v[216:219], v[16:19], a[56:59], 0
    v_exp_f32 v60, v60
    v_mfma_f32_16x16x32_bf16 v[216:219], v[20:23], a[72:75], v[216:219]
    v_exp_f32 v61, v61
    v_mfma_f32_16x16x32_bf16 v[216:219], v[24:27], a[88:91], v[216:219]
    v_mul_f32 v62, v62, v102
    v_mul_f32 v63, v63, v103
    v_mfma_f32_16x16x32_bf16 v[220:223], v[24:27], a[92:95], 0
    v_exp_f32 v62, v62
    v_mfma_f32_16x16x32_bf16 v[220:223], v[20:23], a[76:79], v[220:223]
    v_exp_f32 v63, v63
    v_mfma_f32_16x16x32_bf16 v[220:223], v[16:19], a[60:63], v[220:223]
    s_waitcnt vmcnt(15) lgkmcnt(0)
    s_barrier
    v_mul_f32 v64, v64, v116
    v_mfma_f32_16x16x32_bf16 v[220:223], v[28:31], a[12:15], v[220:223]
    ds_read_b64_tr_b16 v[40:41], v6 offset:24576
    v_mul_f32 v65, v65, v117
    v_mfma_f32_16x16x32_bf16 v[220:223], v[32:35], a[28:31], v[220:223]
    ds_read_b64_tr_b16 v[42:43], v6 offset:24832
    v_mul_f32 v66, v66, v118
    v_mfma_f32_16x16x32_bf16 v[220:223], v[36:39], a[44:47], v[220:223]
    ds_read_b64_tr_b16 v[44:45], v6 offset:26624
    v_mul_f32 v67, v67, v119
    v_mfma_f32_16x16x32_bf16 v[216:219], v[36:39], a[40:43], v[216:219]
    ds_read_b64_tr_b16 v[46:47], v6 offset:26880
    v_mul_f32 v100, v100, v132
    v_mfma_f32_16x16x32_bf16 v[216:219], v[32:35], a[24:27], v[216:219]
    ds_read_b64_tr_b16 v[48:49], v6 offset:28672
    v_mul_f32 v101, v101, v133
    v_mfma_f32_16x16x32_bf16 v[216:219], v[28:31], a[8:11], v[216:219]
    ds_read_b64_tr_b16 v[50:51], v6 offset:28928
    v_mul_f32 v102, v102, v134
    v_mfma_f32_16x16x32_bf16 v[212:215], v[28:31], a[4:7], v[212:215]
    ds_read_b64_tr_b16 v[16:17], v6 offset:30720
    v_mul_f32 v103, v103, v135
    v_mfma_f32_16x16x32_bf16 v[212:215], v[32:35], a[20:23], v[212:215]
    ds_read_b64_tr_b16 v[18:19], v6 offset:30976
    v_mul_f32 v116, v116, v148
    v_mfma_f32_16x16x32_bf16 v[212:215], v[36:39], a[36:39], v[212:215]
    ds_read_b64_tr_b16 v[20:21], v6 offset:32768
    v_mul_f32 v117, v117, v149
    v_mfma_f32_16x16x32_bf16 v[208:211], v[36:39], a[32:35], v[208:211]
    ds_read_b64_tr_b16 v[22:23], v6 offset:33024
    v_mul_f32 v118, v118, v150
    v_mfma_f32_16x16x32_bf16 v[208:211], v[32:35], a[16:19], v[208:211]
    ds_read_b64_tr_b16 v[24:25], v6 offset:34816
    v_mul_f32 v119, v119, v151
    v_mfma_f32_16x16x32_bf16 v[208:211], v[28:31], a[0:3], v[208:211]
    s_waitcnt lgkmcnt(5)
    ds_read_b64_tr_b16 v[26:27], v6 offset:35072
    v_add_f32 v60, 1.0, v60
    v_mfma_f32_16x16x32_bf16 v[160:163], v[40:43], a[96:99], v[160:163]
    ds_read_b64_tr_b16 v[28:29], v7 offset:30720
    v_add_f32 v61, 1.0, v61
    v_mfma_f32_16x16x32_bf16 v[160:163], v[44:47], a[112:115], v[160:163]
    s_add_u32 s45, s54, 1769664
    v_exp_f32 v64, v64
    v_mfma_f32_16x16x32_bf16 v[160:163], v[48:51], a[128:131], v[160:163]
    s_add_u32 m0, s53, 106496
    ds_read_b64_tr_b16 v[30:31], v7 offset:30976
    v_add_f32 v62, 1.0, v62
    v_mfma_f32_16x16x32_bf16 v[164:167], v[48:51], a[132:135], v[164:167]
    buffer_load_dwordx4 v2, s[8:11], s45 offen nt lds
    v_mfma_f32_16x16x32_bf16 v[164:167], v[44:47], a[116:119], v[164:167]
    ds_read_b64_tr_b16 v[32:33], v7 offset:32768
    v_add_f32 v63, 1.0, v63
    v_mfma_f32_16x16x32_bf16 v[164:167], v[40:43], a[100:103], v[164:167]
    v_exp_f32 v65, v65
    v_mfma_f32_16x16x32_bf16 v[168:171], v[40:43], a[104:107], v[168:171]
    ds_read_b64_tr_b16 v[34:35], v7 offset:33024
    v_add_f32 v64, 1.0, v64
    v_mfma_f32_16x16x32_bf16 v[168:171], v[44:47], a[120:123], v[168:171]
    v_exp_f32 v66, v66
    v_mfma_f32_16x16x32_bf16 v[168:171], v[48:51], a[136:139], v[168:171]
    ds_read_b64_tr_b16 v[36:37], v7 offset:34816
    v_add_f32 v65, 1.0, v65
    v_mfma_f32_16x16x32_bf16 v[172:175], v[48:51], a[140:143], v[172:175]
    v_exp_f32 v67, v67
    v_mfma_f32_16x16x32_bf16 v[172:175], v[44:47], a[124:127], v[172:175]
    ds_read_b64_tr_b16 v[38:39], v7 offset:35072
    v_add_f32 v66, 1.0, v66
    v_mfma_f32_16x16x32_bf16 v[172:175], v[40:43], a[108:111], v[172:175]
    s_waitcnt lgkmcnt(6)
    v_rcp_f32 v60, v60
    v_mfma_f32_16x16x32_bf16 v[172:175], v[16:19], a[156:159], v[172:175]
    ds_read_b64_tr_b16 v[40:41], v7 offset:24576
    v_add_f32 v67, 1.0, v67
    v_mfma_f32_16x16x32_bf16 v[172:175], v[20:23], a[172:175], v[172:175]
    s_add_u32 s44, s54, 1917120
    v_rcp_f32 v61, v61
    v_mfma_f32_16x16x32_bf16 v[172:175], v[24:27], a[188:191], v[172:175]
    s_add_u32 m0, s53, 107520
    ds_read_b64_tr_b16 v[42:43], v7 offset:24832
    v_mul_f32 v100, v100, v60
    v_mfma_f32_16x16x32_bf16 v[168:171], v[24:27], a[184:187], v[168:171]
    buffer_load_dwordx4 v2, s[8:11], s44 offen nt lds
    v_mfma_f32_16x16x32_bf16 v[168:171], v[20:23], a[168:171], v[168:171]
    ds_read_b64_tr_b16 v[44:45], v7 offset:26624
    v_mul_f32 v101, v101, v61
    v_mfma_f32_16x16x32_bf16 v[168:171], v[16:19], a[152:155], v[168:171]
    v_rcp_f32 v62, v62
    v_mfma_f32_16x16x32_bf16 v[164:167], v[16:19], a[148:151], v[164:167]
    ds_read_b64_tr_b16 v[46:47], v7 offset:26880
    v_mul_f32 v102, v102, v62
    v_mfma_f32_16x16x32_bf16 v[164:167], v[20:23], a[164:167], v[164:167]
    v_rcp_f32 v63, v63
    v_mfma_f32_16x16x32_bf16 v[164:167], v[24:27], a[180:183], v[164:167]
    ds_read_b64_tr_b16 v[48:49], v7 offset:28672
    v_mul_f32 v103, v103, v63
    v_mfma_f32_16x16x32_bf16 v[160:163], v[24:27], a[176:179], v[160:163]
    v_rcp_f32 v64, v64
    v_mfma_f32_16x16x32_bf16 v[160:163], v[20:23], a[160:163], v[160:163]
    ds_read_b64_tr_b16 v[50:51], v7 offset:28928
    v_mul_f32 v116, v116, v64
    v_mfma_f32_16x16x32_bf16 v[160:163], v[16:19], a[144:147], v[160:163]
    s_waitcnt lgkmcnt(6)
    v_rcp_f32 v65, v65
    v_mfma_f32_16x16x32_bf16 v[176:179], v[28:31], a[144:147], v[176:179]
    ds_read_b64_tr_b16 v[16:17], v6 offset:36864
    v_mul_f32 v117, v117, v65
    v_mfma_f32_16x16x32_bf16 v[176:179], v[32:35], a[160:163], v[176:179]
    s_add_u32 s45, s54, 2064576
    v_rcp_f32 v66, v66
    v_mfma_f32_16x16x32_bf16 v[176:179], v[36:39], a[176:179], v[176:179]
    s_add_u32 m0, s53, 108544
    ds_read_b64_tr_b16 v[18:19], v6 offset:37120
    v_mul_f32 v118, v118, v66
    v_mfma_f32_16x16x32_bf16 v[180:183], v[36:39], a[180:183], v[180:183]
    buffer_load_dwordx4 v2, s[8:11], s45 offen nt lds
    v_mfma_f32_16x16x32_bf16 v[180:183], v[32:35], a[164:167], v[180:183]
    ds_read_b64_tr_b16 v[20:21], v6 offset:38912
    v_cvt_pk_bf16_f32 v72, v100, v101
    v_mfma_f32_16x16x32_bf16 v[180:183], v[28:31], a[148:151], v[180:183]
    v_rcp_f32 v67, v67
    v_mfma_f32_16x16x32_bf16 v[184:187], v[28:31], a[152:155], v[184:187]
    ds_read_b64_tr_b16 v[22:23], v6 offset:39168
    v_mul_f32 v119, v119, v67
    v_mfma_f32_16x16x32_bf16 v[184:187], v[32:35], a[168:171], v[184:187]
    v_cvt_pk_bf16_f32 v73, v102, v103
    v_cvt_pk_bf16_f32 v74, v116, v117
    v_mfma_f32_16x16x32_bf16 v[184:187], v[36:39], a[184:187], v[184:187]
    ds_read_b64_tr_b16 v[24:25], v6 offset:40960
    v_cvt_pk_bf16_f32 v75, v118, v119
    v_mfma_f32_16x16x32_bf16 v[188:191], v[36:39], a[188:191], v[188:191]
    s_add_u32 s46, s5, 4198400
    buffer_store_dwordx4 v[72:75], v1, s[28:31], s46 offen
    v_mfma_f32_16x16x32_bf16 v[188:191], v[32:35], a[172:175], v[188:191]
    ds_read_b64_tr_b16 v[26:27], v6 offset:41216
    v_mul_f32 v52, v104, v104
    v_mfma_f32_16x16x32_bf16 v[188:191], v[28:31], a[156:159], v[188:191]
    s_waitcnt lgkmcnt(6)
    v_mul_f32 v53, v105, v105
    v_mul_f32 v54, v106, v106
    v_mfma_f32_16x16x32_bf16 v[188:191], v[40:43], a[108:111], v[188:191]
    ds_read_b64_tr_b16 v[28:29], v6 offset:43008
    v_mul_f32 v55, v107, v107
    v_mfma_f32_16x16x32_bf16 v[188:191], v[44:47], a[124:127], v[188:191]
    s_add_u32 s44, s54, 1769664
    v_mul_f32 v56, v120, v120
    v_mul_f32 v57, v121, v121
    v_mfma_f32_16x16x32_bf16 v[188:191], v[48:51], a[140:143], v[188:191]
    s_add_u32 m0, s53, 118784
    ds_read_b64_tr_b16 v[30:31], v6 offset:43264
    v_mul_f32 v58, v122, v122
    v_mfma_f32_16x16x32_bf16 v[184:187], v[48:51], a[136:139], v[184:187]
    buffer_load_dwordx4 v2, s[12:15], s44 offen nt lds
    v_mfma_f32_16x16x32_bf16 v[184:187], v[44:47], a[120:123], v[184:187]
    ds_read_b64_tr_b16 v[32:33], v6 offset:45056
    v_mul_f32 v59, v123, v123
    v_mfma_f32_16x16x32_bf16 v[184:187], v[40:43], a[104:107], v[184:187]
    v_fma_f32 v52, v52, v13, v12
    v_fma_f32 v53, v53, v13, v12
    v_mfma_f32_16x16x32_bf16 v[180:183], v[40:43], a[100:103], v[180:183]
    ds_read_b64_tr_b16 v[34:35], v6 offset:45312
    v_fma_f32 v54, v54, v13, v12
    v_mfma_f32_16x16x32_bf16 v[180:183], v[44:47], a[116:119], v[180:183]
    v_fma_f32 v55, v55, v13, v12
    v_fma_f32 v56, v56, v13, v12
    v_mfma_f32_16x16x32_bf16 v[180:183], v[48:51], a[132:135], v[180:183]
    ds_read_b64_tr_b16 v[36:37], v6 offset:47104
    v_fma_f32 v57, v57, v13, v12
    v_mfma_f32_16x16x32_bf16 v[176:179], v[48:51], a[128:131], v[176:179]
    v_fma_f32 v58, v58, v13, v12
    v_fma_f32 v59, v59, v13, v12
    v_mfma_f32_16x16x32_bf16 v[176:179], v[44:47], a[112:115], v[176:179]
    ds_read_b64_tr_b16 v[38:39], v6 offset:47360
    v_mul_f32 v52, v52, v104
    v_mfma_f32_16x16x32_bf16 v[176:179], v[40:43], a[96:99], v[176:179]
    s_waitcnt lgkmcnt(6)
    v_exp_f32 v52, v52
    v_mfma_f32_16x16x32_bf16 v[192:195], v[16:19], a[96:99], v[192:195]
    ds_read_b64_tr_b16 v[40:41], v7 offset:43008
    v_mul_f32 v53, v53, v105
    v_mfma_f32_16x16x32_bf16 v[192:195], v[20:23], a[112:115], v[192:195]
    v_exp_f32 v53, v53
    v_mfma_f32_16x16x32_bf16 v[192:195], v[24:27], a[128:131], v[192:195]
    ds_read_b64_tr_b16 v[42:43], v7 offset:43264
    v_mul_f32 v54, v54, v106
    v_mfma_f32_16x16x32_bf16 v[196:199], v[24:27], a[132:135], v[196:199]
    s_add_u32 s45, s54, 1917120
    v_exp_f32 v54, v54
    v_mfma_f32_16x16x32_bf16 v[196:199], v[20:23], a[116:119], v[196:199]
    s_add_u32 m0, s53, 119808
    ds_read_b64_tr_b16 v[44:45], v7 offset:45056
    v_mul_f32 v55, v55, v107
    v_mfma_f32_16x16x32_bf16 v[196:199], v[16:19], a[100:103], v[196:199]
    buffer_load_dwordx4 v2, s[12:15], s45 offen nt lds
    v_mfma_f32_16x16x32_bf16 v[200:203], v[16:19], a[104:107], v[200:203]
    ds_read_b64_tr_b16 v[46:47], v7 offset:45312
    v_mul_f32 v56, v56, v120
    v_mfma_f32_16x16x32_bf16 v[200:203], v[20:23], a[120:123], v[200:203]
    v_exp_f32 v55, v55
    v_mfma_f32_16x16x32_bf16 v[200:203], v[24:27], a[136:139], v[200:203]
    ds_read_b64_tr_b16 v[48:49], v7 offset:47104
    v_mul_f32 v57, v57, v121
    v_mfma_f32_16x16x32_bf16 v[204:207], v[24:27], a[140:143], v[204:207]
    v_exp_f32 v56, v56
    v_mfma_f32_16x16x32_bf16 v[204:207], v[20:23], a[124:127], v[204:207]
    ds_read_b64_tr_b16 v[50:51], v7 offset:47360
    v_mul_f32 v58, v58, v122
    v_mfma_f32_16x16x32_bf16 v[204:207], v[16:19], a[108:111], v[204:207]
    s_waitcnt lgkmcnt(6)
    v_exp_f32 v57, v57
    v_mfma_f32_16x16x32_bf16 v[204:207], v[28:31], a[156:159], v[204:207]
    ds_read_b64_tr_b16 v[16:17], v7 offset:36864
    v_mul_f32 v59, v59, v123
    v_mfma_f32_16x16x32_bf16 v[204:207], v[32:35], a[172:175], v[204:207]
    v_exp_f32 v58, v58
    v_mfma_f32_16x16x32_bf16 v[204:207], v[36:39], a[188:191], v[204:207]
    ds_read_b64_tr_b16 v[18:19], v7 offset:37120
    v_mul_f32 v104, v104, v136
    v_mfma_f32_16x16x32_bf16 v[200:203], v[36:39], a[184:187], v[200:203]
    s_add_u32 s44, s54, 2064576
    v_exp_f32 v59, v59
    v_mfma_f32_16x16x32_bf16 v[200:203], v[32:35], a[168:171], v[200:203]
    s_add_u32 m0, s53, 120832
    ds_read_b64_tr_b16 v[20:21], v7 offset:38912
    v_mul_f32 v105, v105, v137
    v_mfma_f32_16x16x32_bf16 v[200:203], v[28:31], a[152:155], v[200:203]
    buffer_load_dwordx4 v2, s[12:15], s44 offen nt lds
    v_mfma_f32_16x16x32_bf16 v[196:199], v[28:31], a[148:151], v[196:199]
    ds_read_b64_tr_b16 v[22:23], v7 offset:39168
    v_mul_f32 v106, v106, v138
    v_mfma_f32_16x16x32_bf16 v[196:199], v[32:35], a[164:167], v[196:199]
    v_mul_f32 v107, v107, v139
    v_mul_f32 v120, v120, v152
    v_mfma_f32_16x16x32_bf16 v[196:199], v[36:39], a[180:183], v[196:199]
    ds_read_b64_tr_b16 v[24:25], v7 offset:40960
    v_mul_f32 v121, v121, v153
    v_mfma_f32_16x16x32_bf16 v[192:195], v[36:39], a[176:179], v[192:195]
    v_mul_f32 v122, v122, v154
    v_mul_f32 v123, v123, v155
    v_mfma_f32_16x16x32_bf16 v[192:195], v[32:35], a[160:163], v[192:195]
    ds_read_b64_tr_b16 v[26:27], v7 offset:41216
    v_add_f32 v52, 1.0, v52
    v_mfma_f32_16x16x32_bf16 v[192:195], v[28:31], a[144:147], v[192:195]
    s_waitcnt lgkmcnt(6)
    v_rcp_f32 v52, v52
    v_mfma_f32_16x16x32_bf16 v[208:211], v[40:43], a[144:147], v[208:211]
    v_add_f32 v53, 1.0, v53
    v_add_f32 v54, 1.0, v54
    v_mfma_f32_16x16x32_bf16 v[208:211], v[44:47], a[160:163], v[208:211]
    v_rcp_f32 v53, v53
    v_mfma_f32_16x16x32_bf16 v[208:211], v[48:51], a[176:179], v[208:211]
    v_rcp_f32 v54, v54
    v_mfma_f32_16x16x32_bf16 v[212:215], v[48:51], a[180:183], v[212:215]
    v_add_f32 v55, 1.0, v55
    v_add_f32 v56, 1.0, v56
    v_mfma_f32_16x16x32_bf16 v[212:215], v[44:47], a[164:167], v[212:215]
    v_rcp_f32 v55, v55
    v_mfma_f32_16x16x32_bf16 v[212:215], v[40:43], a[148:151], v[212:215]
    v_rcp_f32 v56, v56
    v_mfma_f32_16x16x32_bf16 v[216:219], v[40:43], a[152:155], v[216:219]
    v_add_f32 v57, 1.0, v57
    v_add_f32 v58, 1.0, v58
    v_mfma_f32_16x16x32_bf16 v[216:219], v[44:47], a[168:171], v[216:219]
    v_rcp_f32 v57, v57
    v_mfma_f32_16x16x32_bf16 v[216:219], v[48:51], a[184:187], v[216:219]
    v_rcp_f32 v58, v58
    v_mfma_f32_16x16x32_bf16 v[220:223], v[48:51], a[188:191], v[220:223]
    v_add_f32 v59, 1.0, v59
    v_mul_f32 v104, v104, v52
    v_mfma_f32_16x16x32_bf16 v[220:223], v[44:47], a[172:175], v[220:223]
    v_rcp_f32 v59, v59
    v_mfma_f32_16x16x32_bf16 v[220:223], v[40:43], a[156:159], v[220:223]
    s_waitcnt vmcnt(15) lgkmcnt(0)
    s_barrier
    v_mul_f32 v105, v105, v53
    v_mfma_f32_16x16x32_bf16 v[220:223], v[16:19], a[108:111], v[220:223]
    ds_read_b64_tr_b16 v[28:29], v4 offset:40960
    v_mul_f32 v106, v106, v54
    v_mfma_f32_16x16x32_bf16 v[220:223], v[20:23], a[124:127], v[220:223]
    ds_read_b64_tr_b16 v[30:31], v4 offset:41216
    v_mul_f32 v107, v107, v55
    v_mfma_f32_16x16x32_bf16 v[220:223], v[24:27], a[140:143], v[220:223]
    ds_read_b64_tr_b16 v[32:33], v4 offset:43008
    v_mul_f32 v120, v120, v56
    v_mfma_f32_16x16x32_bf16 v[216:219], v[24:27], a[136:139], v[216:219]
    ds_read_b64_tr_b16 v[34:35], v4 offset:43264
    v_mul_f32 v121, v121, v57
    v_mfma_f32_16x16x32_bf16 v[216:219], v[20:23], a[120:123], v[216:219]
    ds_read_b64_tr_b16 v[36:37], v4 offset:45056
    v_mul_f32 v122, v122, v58
    v_mfma_f32_16x16x32_bf16 v[216:219], v[16:19], a[104:107], v[216:219]
    ds_read_b64_tr_b16 v[38:39], v4 offset:45312
    v_mul_f32 v123, v123, v59
    v_mfma_f32_16x16x32_bf16 v[212:215], v[16:19], a[100:103], v[212:215]
    ds_read_b64_tr_b16 v[40:41], v4 offset:47104
    v_cvt_pk_bf16_f32 v68, v104, v105
    v_mfma_f32_16x16x32_bf16 v[212:215], v[20:23], a[116:119], v[212:215]
    ds_read_b64_tr_b16 v[42:43], v4 offset:47360
    v_cvt_pk_bf16_f32 v69, v106, v107
    v_mfma_f32_16x16x32_bf16 v[212:215], v[24:27], a[132:135], v[212:215]
    ds_read_b64_tr_b16 v[44:45], v4 offset:49152
    v_cvt_pk_bf16_f32 v70, v120, v121
    v_mfma_f32_16x16x32_bf16 v[208:211], v[24:27], a[128:131], v[208:211]
    ds_read_b64_tr_b16 v[46:47], v4 offset:49408
    v_cvt_pk_bf16_f32 v71, v122, v123
    v_mfma_f32_16x16x32_bf16 v[208:211], v[20:23], a[112:115], v[208:211]
    ds_read_b64_tr_b16 v[48:49], v4 offset:51200
    v_mul_f32 v60, v108, v108
    v_mfma_f32_16x16x32_bf16 v[208:211], v[16:19], a[96:99], v[208:211]
    s_waitcnt lgkmcnt(5)
    ds_read_b64_tr_b16 v[50:51], v4 offset:51456
    v_mul_f32 v61, v109, v109
    v_mfma_f32_16x16x32_bf16 v[160:163], v[28:31], a[192:195], v[160:163]
    ds_read_b64_tr_b16 v[16:17], v5 offset:47104
    v_mul_f32 v62, v110, v110
    v_mfma_f32_16x16x32_bf16 v[160:163], v[32:35], a[208:211], v[160:163]
    s_add_u32 s45, s54, 3539136
    v_mul_f32 v63, v111, v111
    v_mul_f32 v64, v124, v124
    v_mfma_f32_16x16x32_bf16 v[160:163], v[36:39], a[224:227], v[160:163]
    s_add_u32 m0, s53, 131072
    ds_read_b64_tr_b16 v[18:19], v5 offset:47360
    v_mul_f32 v65, v125, v125
    v_mfma_f32_16x16x32_bf16 v[164:167], v[36:39], a[228:231], v[164:167]
    buffer_load_dwordx4 v2, s[8:11], s45 offen nt lds
    v_mfma_f32_16x16x32_bf16 v[164:167], v[32:35], a[212:215], v[164:167]
    ds_read_b64_tr_b16 v[20:21], v5 offset:49152
    v_mul_f32 v66, v126, v126
    v_mfma_f32_16x16x32_bf16 v[164:167], v[28:31], a[196:199], v[164:167]
    s_add_u32 s46, s5, 4202496
    buffer_store_dwordx4 v[68:71], v1, s[28:31], s46 offen
    v_mfma_f32_16x16x32_bf16 v[168:171], v[28:31], a[200:203], v[168:171]
    ds_read_b64_tr_b16 v[22:23], v5 offset:49408
    v_mul_f32 v67, v127, v127
    v_mfma_f32_16x16x32_bf16 v[168:171], v[32:35], a[216:219], v[168:171]
    v_fma_f32 v60, v60, v13, v12
    v_fma_f32 v61, v61, v13, v12
    v_mfma_f32_16x16x32_bf16 v[168:171], v[36:39], a[232:235], v[168:171]
    ds_read_b64_tr_b16 v[24:25], v5 offset:51200
    v_fma_f32 v62, v62, v13, v12
    v_mfma_f32_16x16x32_bf16 v[172:175], v[36:39], a[236:239], v[172:175]
    v_fma_f32 v63, v63, v13, v12
    v_fma_f32 v64, v64, v13, v12
    v_mfma_f32_16x16x32_bf16 v[172:175], v[32:35], a[220:223], v[172:175]
    ds_read_b64_tr_b16 v[26:27], v5 offset:51456
    v_fma_f32 v65, v65, v13, v12
    v_mfma_f32_16x16x32_bf16 v[172:175], v[28:31], a[204:207], v[172:175]
    s_waitcnt lgkmcnt(6)
    v_fma_f32 v66, v66, v13, v12
    v_fma_f32 v67, v67, v13, v12
    v_mfma_f32_16x16x32_bf16 v[172:175], v[40:43], a[252:255], v[172:175]
    ds_read_b64_tr_b16 v[28:29], v5 offset:40960
    v_mul_f32 v60, v60, v108
    v_mfma_f32_16x16x32_bf16 v[172:175], v[44:47], v[236:239], v[172:175]
    s_add_u32 s44, s54, 3686592
    v_exp_f32 v60, v60
    v_mfma_f32_16x16x32_bf16 v[172:175], v[48:51], v[252:255], v[172:175]
    s_add_u32 m0, s53, 132096
    ds_read_b64_tr_b16 v[30:31], v5 offset:41216
    v_mul_f32 v61, v61, v109
    v_mfma_f32_16x16x32_bf16 v[168:171], v[48:51], v[248:251], v[168:171]
    buffer_load_dwordx4 v2, s[8:11], s44 offen nt lds
    v_mfma_f32_16x16x32_bf16 v[168:171], v[44:47], v[232:235], v[168:171]
    ds_read_b64_tr_b16 v[32:33], v5 offset:43008
    v_mul_f32 v62, v62, v110
    v_mfma_f32_16x16x32_bf16 v[168:171], v[40:43], a[248:251], v[168:171]
    v_exp_f32 v61, v61
    v_mfma_f32_16x16x32_bf16 v[164:167], v[40:43], a[244:247], v[164:167]
    ds_read_b64_tr_b16 v[34:35], v5 offset:43264
    v_mul_f32 v63, v63, v111
    v_mfma_f32_16x16x32_bf16 v[164:167], v[44:47], v[228:231], v[164:167]
    v_exp_f32 v62, v62
    v_mfma_f32_16x16x32_bf16 v[164:167], v[48:51], v[244:247], v[164:167]
    ds_read_b64_tr_b16 v[36:37], v5 offset:45056
    v_mul_f32 v64, v64, v124
    v_mfma_f32_16x16x32_bf16 v[160:163], v[48:51], v[240:243], v[160:163]
    v_exp_f32 v63, v63
    v_mfma_f32_16x16x32_bf16 v[160:163], v[44:47], v[224:227], v[160:163]
    ds_read_b64_tr_b16 v[38:39], v5 offset:45312
    v_mul_f32 v65, v65, v125
    v_mfma_f32_16x16x32_bf16 v[160:163], v[40:43], a[240:243], v[160:163]
    s_waitcnt lgkmcnt(6)
    v_exp_f32 v64, v64
    v_mfma_f32_16x16x32_bf16 v[176:179], v[16:19], a[240:243], v[176:179]
    ds_read_b64_tr_b16 v[40:41], v4 offset:53248
    v_mul_f32 v66, v66, v126
    v_mfma_f32_16x16x32_bf16 v[176:179], v[20:23], v[224:227], v[176:179]
    s_add_u32 s45, s54, 3834048
    v_exp_f32 v65, v65
    v_mfma_f32_16x16x32_bf16 v[176:179], v[24:27], v[240:243], v[176:179]
    s_add_u32 m0, s53, 133120
    ds_read_b64_tr_b16 v[42:43], v4 offset:53504
    v_mul_f32 v67, v67, v127
    v_mfma_f32_16x16x32_bf16 v[180:183], v[24:27], v[244:247], v[180:183]
    buffer_load_dwordx4 v2, s[8:11], s45 offen nt lds
    v_mfma_f32_16x16x32_bf16 v[180:183], v[20:23], v[228:231], v[180:183]
    ds_read_b64_tr_b16 v[44:45], v4 offset:55296
    v_mul_f32 v108, v108, v140
    v_mfma_f32_16x16x32_bf16 v[180:183], v[16:19], a[244:247], v[180:183]
    v_exp_f32 v66, v66
    v_mfma_f32_16x16x32_bf16 v[184:187], v[16:19], a[248:251], v[184:187]
    ds_read_b64_tr_b16 v[46:47], v4 offset:55552
    v_mul_f32 v109, v109, v141
    v_mfma_f32_16x16x32_bf16 v[184:187], v[20:23], v[232:235], v[184:187]
    v_exp_f32 v67, v67
    v_mfma_f32_16x16x32_bf16 v[184:187], v[24:27], v[248:251], v[184:187]
    ds_read_b64_tr_b16 v[48:49], v4 offset:57344
    v_mul_f32 v110, v110, v142
    v_mfma_f32_16x16x32_bf16 v[188:191], v[24:27], v[252:255], v[188:191]
    v_mul_f32 v111, v111, v143
    v_mul_f32 v124, v124, v156
    v_mfma_f32_16x16x32_bf16 v[188:191], v[20:23], v[236:239], v[188:191]
    ds_read_b64_tr_b16 v[50:51], v4 offset:57600
    v_mul_f32 v125, v125, v157
    v_mfma_f32_16x16x32_bf16 v[188:191], v[16:19], a[252:255], v[188:191]
    s_waitcnt lgkmcnt(6)
    v_mul_f32 v126, v126, v158
    v_mul_f32 v127, v127, v159
    v_mfma_f32_16x16x32_bf16 v[188:191], v[28:31], a[204:207], v[188:191]
    ds_read_b64_tr_b16 v[16:17], v4 offset:59392
    v_add_f32 v60, 1.0, v60
    v_mfma_f32_16x16x32_bf16 v[188:191], v[32:35], a[220:223], v[188:191]
    s_add_u32 s44, s54, 3539136
    v_rcp_f32 v60, v60
    v_mfma_f32_16x16x32_bf16 v[188:191], v[36:39], a[236:239], v[188:191]
    s_add_u32 m0, s53, 143360
    ds_read_b64_tr_b16 v[18:19], v4 offset:59648
    v_add_f32 v61, 1.0, v61
    v_mfma_f32_16x16x32_bf16 v[184:187], v[36:39], a[232:235], v[184:187]
    buffer_load_dwordx4 v2, s[12:15], s44 offen nt lds
    v_mfma_f32_16x16x32_bf16 v[184:187], v[32:35], a[216:219], v[184:187]
    ds_read_b64_tr_b16 v[20:21], v4 offset:61440
    v_add_f32 v62, 1.0, v62
    v_mfma_f32_16x16x32_bf16 v[184:187], v[28:31], a[200:203], v[184:187]
    v_rcp_f32 v61, v61
    v_mfma_f32_16x16x32_bf16 v[180:183], v[28:31], a[196:199], v[180:183]
    ds_read_b64_tr_b16 v[22:23], v4 offset:61696
    v_add_f32 v63, 1.0, v63
    v_mfma_f32_16x16x32_bf16 v[180:183], v[32:35], a[212:215], v[180:183]
    v_rcp_f32 v62, v62
    v_mfma_f32_16x16x32_bf16 v[180:183], v[36:39], a[228:231], v[180:183]
    ds_read_b64_tr_b16 v[24:25], v4 offset:63488
    v_add_f32 v64, 1.0, v64
    v_mfma_f32_16x16x32_bf16 v[176:179], v[36:39], a[224:227], v[176:179]
    v_rcp_f32 v63, v63
    v_mfma_f32_16x16x32_bf16 v[176:179], v[32:35], a[208:211], v[176:179]
    ds_read_b64_tr_b16 v[26:27], v4 offset:63744
    v_add_f32 v65, 1.0, v65
    v_mfma_f32_16x16x32_bf16 v[176:179], v[28:31], a[192:195], v[176:179]
    s_waitcnt lgkmcnt(6)
    v_rcp_f32 v64, v64
    v_mfma_f32_16x16x32_bf16 v[192:195], v[40:43], a[192:195], v[192:195]
    ds_read_b64_tr_b16 v[28:29], v5 offset:59392
    v_add_f32 v66, 1.0, v66
    v_mfma_f32_16x16x32_bf16 v[192:195], v[44:47], a[208:211], v[192:195]
    v_rcp_f32 v65, v65
    v_mfma_f32_16x16x32_bf16 v[192:195], v[48:51], a[224:227], v[192:195]
    ds_read_b64_tr_b16 v[30:31], v5 offset:59648
    v_add_f32 v67, 1.0, v67
    v_mfma_f32_16x16x32_bf16 v[196:199], v[48:51], a[228:231], v[196:199]
    s_add_u32 s45, s54, 3686592
    v_rcp_f32 v66, v66
    v_mfma_f32_16x16x32_bf16 v[196:199], v[44:47], a[212:215], v[196:199]
    s_add_u32 m0, s53, 144384
    ds_read_b64_tr_b16 v[32:33], v5 offset:61440
    v_mul_f32 v108, v108, v60
    v_mfma_f32_16x16x32_bf16 v[196:199], v[40:43], a[196:199], v[196:199]
    buffer_load_dwordx4 v2, s[12:15], s45 offen nt lds
    v_mfma_f32_16x16x32_bf16 v[200:203], v[40:43], a[200:203], v[200:203]
    ds_read_b64_tr_b16 v[34:35], v5 offset:61696
    v_mul_f32 v109, v109, v61
    v_mfma_f32_16x16x32_bf16 v[200:203], v[44:47], a[216:219], v[200:203]
    v_rcp_f32 v67, v67
    v_mfma_f32_16x16x32_bf16 v[200:203], v[48:51], a[232:235], v[200:203]
    ds_read_b64_tr_b16 v[36:37], v5 offset:63488
    v_mul_f32 v110, v110, v62
    v_mfma_f32_16x16x32_bf16 v[204:207], v[48:51], a[236:239], v[204:207]
    v_mul_f32 v111, v111, v63
    v_mul_f32 v124, v124, v64
    v_mfma_f32_16x16x32_bf16 v[204:207], v[44:47], a[220:223], v[204:207]
    ds_read_b64_tr_b16 v[38:39], v5 offset:63744
    v_mul_f32 v125, v125, v65
    v_mfma_f32_16x16x32_bf16 v[204:207], v[40:43], a[204:207], v[204:207]
    s_waitcnt lgkmcnt(6)
    v_mul_f32 v126, v126, v66
    v_mul_f32 v127, v127, v67
    v_mfma_f32_16x16x32_bf16 v[204:207], v[16:19], a[252:255], v[204:207]
    ds_read_b64_tr_b16 v[40:41], v5 offset:53248
    v_cvt_pk_bf16_f32 v72, v108, v109
    v_mfma_f32_16x16x32_bf16 v[204:207], v[20:23], v[236:239], v[204:207]
    v_cvt_pk_bf16_f32 v73, v110, v111
    v_cvt_pk_bf16_f32 v74, v124, v125
    v_mfma_f32_16x16x32_bf16 v[204:207], v[24:27], v[252:255], v[204:207]
    ds_read_b64_tr_b16 v[42:43], v5 offset:53504
    v_cvt_pk_bf16_f32 v75, v126, v127
    v_mfma_f32_16x16x32_bf16 v[200:203], v[24:27], v[248:251], v[200:203]
    s_add_u32 s44, s54, 3834048
    v_mfma_f32_16x16x32_bf16 v[200:203], v[20:23], v[232:235], v[200:203]
    s_add_u32 m0, s53, 145408
    ds_read_b64_tr_b16 v[44:45], v5 offset:55296
    v_mfma_f32_16x16x32_bf16 v[200:203], v[16:19], a[248:251], v[200:203]
    buffer_load_dwordx4 v2, s[12:15], s44 offen nt lds
    v_mfma_f32_16x16x32_bf16 v[196:199], v[16:19], a[244:247], v[196:199]
    ds_read_b64_tr_b16 v[46:47], v5 offset:55552
    v_mfma_f32_16x16x32_bf16 v[196:199], v[20:23], v[228:231], v[196:199]
    s_add_u32 s46, s5, 4206592
    buffer_store_dwordx4 v[72:75], v1, s[28:31], s46 offen
    v_mfma_f32_16x16x32_bf16 v[196:199], v[24:27], v[244:247], v[196:199]
L_pad9:
    s_cbranch_execz L_pad12
    ds_read_b64_tr_b16 v[48:49], v5 offset:57344
    v_mfma_f32_16x16x32_bf16 v[192:195], v[24:27], v[240:243], v[192:195]
    v_mfma_f32_16x16x32_bf16 v[192:195], v[20:23], v[224:227], v[192:195]
    ds_read_b64_tr_b16 v[50:51], v5 offset:57600
    v_mfma_f32_16x16x32_bf16 v[192:195], v[16:19], a[240:243], v[192:195]
    s_waitcnt lgkmcnt(6)
    v_mfma_f32_16x16x32_bf16 v[208:211], v[28:31], a[240:243], v[208:211]
    v_mfma_f32_16x16x32_bf16 v[208:211], v[32:35], v[224:227], v[208:211]
    v_mfma_f32_16x16x32_bf16 v[208:211], v[36:39], v[240:243], v[208:211]
    v_mfma_f32_16x16x32_bf16 v[212:215], v[36:39], v[244:247], v[212:215]
    v_mfma_f32_16x16x32_bf16 v[212:215], v[32:35], v[228:231], v[212:215]
    v_mfma_f32_16x16x32_bf16 v[212:215], v[28:31], a[244:247], v[212:215]
    v_mfma_f32_16x16x32_bf16 v[216:219], v[28:31], a[248:251], v[216:219]
    v_mfma_f32_16x16x32_bf16 v[216:219], v[32:35], v[232:235], v[216:219]
    v_mfma_f32_16x16x32_bf16 v[216:219], v[36:39], v[248:251], v[216:219]
    v_mfma_f32_16x16x32_bf16 v[220:223], v[36:39], v[252:255], v[220:223]
    v_mfma_f32_16x16x32_bf16 v[220:223], v[32:35], v[236:239], v[220:223]
    v_mfma_f32_16x16x32_bf16 v[220:223], v[28:31], a[252:255], v[220:223]
    s_waitcnt vmcnt(16) lgkmcnt(0)
    s_barrier
    v_mfma_f32_16x16x32_bf16 v[220:223], v[40:43], a[204:207], v[220:223]
    ds_read_b64_tr_b16 v[16:17], v4 offset:0
    v_mfma_f32_16x16x32_bf16 v[220:223], v[44:47], a[220:223], v[220:223]
    ds_read_b64_tr_b16 v[18:19], v4 offset:256
    v_mfma_f32_16x16x32_bf16 v[220:223], v[48:51], a[236:239], v[220:223]
    ds_read_b64_tr_b16 v[20:21], v4 offset:2048
    v_mfma_f32_16x16x32_bf16 v[216:219], v[48:51], a[232:235], v[216:219]
    ds_read_b64_tr_b16 v[22:23], v4 offset:2304
    v_mfma_f32_16x16x32_bf16 v[216:219], v[44:47], a[216:219], v[216:219]
    ds_read_b64_tr_b16 v[24:25], v4 offset:4096
    v_mfma_f32_16x16x32_bf16 v[216:219], v[40:43], a[200:203], v[216:219]
    ds_read_b64_tr_b16 v[26:27], v4 offset:4352
    v_mfma_f32_16x16x32_bf16 v[212:215], v[40:43], a[196:199], v[212:215]
    ds_read_b64_tr_b16 v[28:29], v4 offset:6144
    v_mfma_f32_16x16x32_bf16 v[212:215], v[44:47], a[212:215], v[212:215]
    ds_read_b64_tr_b16 v[30:31], v4 offset:6400
    v_mfma_f32_16x16x32_bf16 v[212:215], v[48:51], a[228:231], v[212:215]
    ds_read_b64_tr_b16 v[32:33], v4 offset:8192
    v_mfma_f32_16x16x32_bf16 v[208:211], v[48:51], a[224:227], v[208:211]
    ds_read_b64_tr_b16 v[34:35], v4 offset:8448
    v_mfma_f32_16x16x32_bf16 v[208:211], v[44:47], a[208:211], v[208:211]
    ds_read_b64_tr_b16 v[36:37], v4 offset:10240
    v_mfma_f32_16x16x32_bf16 v[208:211], v[40:43], a[192:195], v[208:211]
    s_waitcnt lgkmcnt(5)
    ds_read_b64_tr_b16 v[38:39], v4 offset:10496
    v_mfma_f32_16x16x32_bf16 v[96:99], v[16:19], a[0:3], 0
    ds_read_b64_tr_b16 v[40:41], v5 offset:6144
    v_mfma_f32_16x16x32_bf16 v[96:99], v[20:23], a[16:19], v[96:99]
    s_mov_b32 s45, 0
    v_mfma_f32_16x16x32_bf16 v[96:99], v[24:27], a[32:35], v[96:99]
    s_add_u32 m0, s49, 81920
    ds_read_b64_tr_b16 v[42:43], v5 offset:6400
    v_mfma_f32_16x16x32_bf16 v[100:103], v[24:27], a[36:39], 0
    buffer_load_dwordx4 v15, s[24:27], s45 offen lds
    v_mfma_f32_16x16x32_bf16 v[100:103], v[20:23], a[20:23], v[100:103]
    ds_read_b64_tr_b16 v[44:45], v5 offset:8192
    v_mul_f32 v52, v160, v160
    v_mfma_f32_16x16x32_bf16 v[100:103], v[16:19], a[4:7], v[100:103]
    v_mul_f32 v53, v161, v161
    v_mul_f32 v54, v162, v162
    v_mfma_f32_16x16x32_bf16 v[104:107], v[16:19], a[8:11], 0
    ds_read_b64_tr_b16 v[46:47], v5 offset:8448
    v_mul_f32 v55, v163, v163
    v_mfma_f32_16x16x32_bf16 v[104:107], v[20:23], a[24:27], v[104:107]
    v_mul_f32 v56, v176, v176
    v_mul_f32 v57, v177, v177
    v_mfma_f32_16x16x32_bf16 v[104:107], v[24:27], a[40:43], v[104:107]
    ds_read_b64_tr_b16 v[48:49], v5 offset:10240
    v_mul_f32 v58, v178, v178
    v_mfma_f32_16x16x32_bf16 v[108:111], v[24:27], a[44:47], 0
    v_mul_f32 v59, v179, v179
    v_fma_f32 v52, v52, v13, v12
    v_mfma_f32_16x16x32_bf16 v[108:111], v[20:23], a[28:31], v[108:111]
    ds_read_b64_tr_b16 v[50:51], v5 offset:10496
    v_fma_f32 v53, v53, v13, v12
    v_mfma_f32_16x16x32_bf16 v[108:111], v[16:19], a[12:15], v[108:111]
    s_waitcnt lgkmcnt(6)
    v_fma_f32 v54, v54, v13, v12
    v_fma_f32 v55, v55, v13, v12
    v_mfma_f32_16x16x32_bf16 v[108:111], v[28:31], a[60:63], v[108:111]
    ds_read_b64_tr_b16 v[16:17], v5 offset:0
    v_fma_f32 v56, v56, v13, v12
    v_mfma_f32_16x16x32_bf16 v[108:111], v[32:35], a[76:79], v[108:111]
    v_fma_f32 v57, v57, v13, v12
    v_fma_f32 v58, v58, v13, v12
    v_mfma_f32_16x16x32_bf16 v[108:111], v[36:39], a[92:95], v[108:111]
    ds_read_b64_tr_b16 v[18:19], v5 offset:256
    v_fma_f32 v59, v59, v13, v12
    v_mfma_f32_16x16x32_bf16 v[104:107], v[36:39], a[88:91], v[104:107]
    v_mul_f32 v52, v52, v160
    v_mul_f32 v53, v53, v161
    v_mfma_f32_16x16x32_bf16 v[104:107], v[32:35], a[72:75], v[104:107]
    ds_read_b64_tr_b16 v[20:21], v5 offset:2048
    v_mul_f32 v54, v54, v162
    v_mfma_f32_16x16x32_bf16 v[104:107], v[28:31], a[56:59], v[104:107]
    v_exp_f32 v52, v52
    v_mfma_f32_16x16x32_bf16 v[100:103], v[28:31], a[52:55], v[100:103]
    ds_read_b64_tr_b16 v[22:23], v5 offset:2304
    v_mul_f32 v55, v55, v163
    v_mfma_f32_16x16x32_bf16 v[100:103], v[32:35], a[68:71], v[100:103]
    s_mov_b32 s44, 4096
    v_exp_f32 v53, v53
    v_mfma_f32_16x16x32_bf16 v[100:103], v[36:39], a[84:87], v[100:103]
    s_add_u32 m0, s49, 86016
    ds_read_b64_tr_b16 v[24:25], v5 offset:4096
    v_mul_f32 v56, v56, v176
    v_mfma_f32_16x16x32_bf16 v[96:99], v[36:39], a[80:83], v[96:99]
    buffer_load_dwordx4 v15, s[24:27], s44 offen lds
    v_mfma_f32_16x16x32_bf16 v[96:99], v[32:35], a[64:67], v[96:99]
    ds_read_b64_tr_b16 v[26:27], v5 offset:4352
    v_mul_f32 v57, v57, v177
    v_mfma_f32_16x16x32_bf16 v[96:99], v[28:31], a[48:51], v[96:99]
    s_waitcnt lgkmcnt(6)
    v_exp_f32 v54, v54
    v_mfma_f32_16x16x32_bf16 v[112:115], v[40:43], a[48:51], 0
    ds_read_b64_tr_b16 v[28:29], v4 offset:12288
    v_mul_f32 v58, v58, v178
    v_mfma_f32_16x16x32_bf16 v[112:115], v[44:47], a[64:67], v[112:115]
    v_exp_f32 v55, v55
    v_mfma_f32_16x16x32_bf16 v[112:115], v[48:51], a[80:83], v[112:115]
    ds_read_b64_tr_b16 v[30:31], v4 offset:12544
    v_mul_f32 v59, v59, v179
    v_mfma_f32_16x16x32_bf16 v[116:119], v[48:51], a[84:87], 0
    v_exp_f32 v56, v56
    v_mfma_f32_16x16x32_bf16 v[116:119], v[44:47], a[68:71], v[116:119]
    ds_read_b64_tr_b16 v[32:33], v4 offset:14336
    v_mul_f32 v160, v160, v192
    v_mfma_f32_16x16x32_bf16 v[116:119], v[40:43], a[52:55], v[116:119]
    v_exp_f32 v57, v57
    v_mfma_f32_16x16x32_bf16 v[120:123], v[40:43], a[56:59], 0
    ds_read_b64_tr_b16 v[34:35], v4 offset:14592
    v_mul_f32 v161, v161, v193
    v_mfma_f32_16x16x32_bf16 v[120:123], v[44:47], a[72:75], v[120:123]
    v_exp_f32 v58, v58
    v_mfma_f32_16x16x32_bf16 v[120:123], v[48:51], a[88:91], v[120:123]
    ds_read_b64_tr_b16 v[36:37], v4 offset:16384
    v_mul_f32 v162, v162, v194
    v_mfma_f32_16x16x32_bf16 v[124:127], v[48:51], a[92:95], 0
    v_exp_f32 v59, v59
    v_mfma_f32_16x16x32_bf16 v[124:127], v[44:47], a[76:79], v[124:127]
    ds_read_b64_tr_b16 v[38:39], v4 offset:16640
    v_mul_f32 v163, v163, v195
    v_mfma_f32_16x16x32_bf16 v[124:127], v[40:43], a[60:63], v[124:127]
    s_waitcnt lgkmcnt(6)
    v_mul_f32 v176, v176, v208
    v_mul_f32 v177, v177, v209
    v_mfma_f32_16x16x32_bf16 v[124:127], v[16:19], a[12:15], v[124:127]
    ds_read_b64_tr_b16 v[40:41], v4 offset:18432
    v_mul_f32 v178, v178, v210
    v_mfma_f32_16x16x32_bf16 v[124:127], v[20:23], a[28:31], v[124:127]
    s_mov_b32 s45, 8192
    v_mul_f32 v179, v179, v211
    v_add_f32 v52, 1.0, v52
    v_mfma_f32_16x16x32_bf16 v[124:127], v[24:27], a[44:47], v[124:127]
    s_add_u32 m0, s49, 90112
    ds_read_b64_tr_b16 v[42:43], v4 offset:18688
    v_add_f32 v53, 1.0, v53
    v_mfma_f32_16x16x32_bf16 v[120:123], v[24:27], a[40:43], v[120:123]
    buffer_load_dwordx4 v15, s[24:27], s45 offen lds
    v_mfma_f32_16x16x32_bf16 v[120:123], v[20:23], a[24:27], v[120:123]
    ds_read_b64_tr_b16 v[44:45], v4 offset:20480
    v_add_f32 v54, 1.0, v54
    v_mfma_f32_16x16x32_bf16 v[120:123], v[16:19], a[8:11], v[120:123]
    v_rcp_f32 v52, v52
    v_mfma_f32_16x16x32_bf16 v[116:119], v[16:19], a[4:7], v[116:119]
    ds_read_b64_tr_b16 v[46:47], v4 offset:20736
    v_add_f32 v55, 1.0, v55
    v_mfma_f32_16x16x32_bf16 v[116:119], v[20:23], a[20:23], v[116:119]
    v_rcp_f32 v53, v53
    v_mfma_f32_16x16x32_bf16 v[116:119], v[24:27], a[36:39], v[116:119]
    ds_read_b64_tr_b16 v[48:49], v4 offset:22528
    v_add_f32 v56, 1.0, v56
    v_mfma_f32_16x16x32_bf16 v[112:115], v[24:27], a[32:35], v[112:115]
    v_rcp_f32 v54, v54
    v_mfma_f32_16x16x32_bf16 v[112:115], v[20:23], a[16:19], v[112:115]
    ds_read_b64_tr_b16 v[50:51], v4 offset:22784
    v_add_f32 v57, 1.0, v57
    v_mfma_f32_16x16x32_bf16 v[112:115], v[16:19], a[0:3], v[112:115]
    s_waitcnt lgkmcnt(6)
    v_rcp_f32 v55, v55
    v_mfma_f32_16x16x32_bf16 v[128:131], v[28:31], a[0:3], 0
    ds_read_b64_tr_b16 v[16:17], v5 offset:18432
    v_add_f32 v58, 1.0, v58
    v_mfma_f32_16x16x32_bf16 v[128:131], v[32:35], a[16:19], v[128:131]
    v_rcp_f32 v56, v56
    v_mfma_f32_16x16x32_bf16 v[128:131], v[36:39], a[32:35], v[128:131]
    ds_read_b64_tr_b16 v[18:19], v5 offset:18688
    v_add_f32 v59, 1.0, v59
    v_mfma_f32_16x16x32_bf16 v[132:135], v[36:39], a[36:39], 0
    v_rcp_f32 v57, v57
    v_mfma_f32_16x16x32_bf16 v[132:135], v[32:35], a[20:23], v[132:135]
    ds_read_b64_tr_b16 v[20:21], v5 offset:20480
    v_mul_f32 v160, v160, v52
    v_mfma_f32_16x16x32_bf16 v[132:135], v[28:31], a[4:7], v[132:135]
    v_rcp_f32 v58, v58
    v_mfma_f32_16x16x32_bf16 v[136:139], v[28:31], a[8:11], 0
    ds_read_b64_tr_b16 v[22:23], v5 offset:20736
    v_mul_f32 v161, v161, v53
    v_mfma_f32_16x16x32_bf16 v[136:139], v[32:35], a[24:27], v[136:139]
    v_rcp_f32 v59, v59
    v_mfma_f32_16x16x32_bf16 v[136:139], v[36:39], a[40:43], v[136:139]
    ds_read_b64_tr_b16 v[24:25], v5 offset:22528
    v_mul_f32 v162, v162, v54
    v_mfma_f32_16x16x32_bf16 v[140:143], v[36:39], a[44:47], 0
    s_mov_b32 s44, 12288
    v_mul_f32 v163, v163, v55
    v_mul_f32 v176, v176, v56
    v_mfma_f32_16x16x32_bf16 v[140:143], v[32:35], a[28:31], v[140:143]
    s_add_u32 m0, s49, 94208
    ds_read_b64_tr_b16 v[26:27], v5 offset:22784
    v_mul_f32 v177, v177, v57
    v_mfma_f32_16x16x32_bf16 v[140:143], v[28:31], a[12:15], v[140:143]
    s_waitcnt lgkmcnt(6)
    buffer_load_dwordx4 v15, s[24:27], s44 offen lds
    v_mfma_f32_16x16x32_bf16 v[140:143], v[40:43], a[60:63], v[140:143]
    ds_read_b64_tr_b16 v[28:29], v5 offset:12288
    v_mul_f32 v178, v178, v58
    v_mfma_f32_16x16x32_bf16 v[140:143], v[44:47], a[76:79], v[140:143]
    v_mul_f32 v179, v179, v59
    v_cvt_pk_bf16_f32 v68, v160, v161
    v_mfma_f32_16x16x32_bf16 v[140:143], v[48:51], a[92:95], v[140:143]
    ds_read_b64_tr_b16 v[30:31], v5 offset:12544
    v_cvt_pk_bf16_f32 v69, v162, v163
    v_mfma_f32_16x16x32_bf16 v[136:139], v[48:51], a[88:91], v[136:139]
    v_cvt_pk_bf16_f32 v70, v176, v177
    v_cvt_pk_bf16_f32 v71, v178, v179
    v_mfma_f32_16x16x32_bf16 v[136:139], v[44:47], a[72:75], v[136:139]
    ds_read_b64_tr_b16 v[32:33], v5 offset:14336
    v_mul_f32 v60, v164, v164
    v_mfma_f32_16x16x32_bf16 v[136:139], v[40:43], a[56:59], v[136:139]
    s_add_u32 s46, s6, 4194304
    buffer_store_dwordx4 v[68:71], v1, s[28:31], s46 offen
    v_mfma_f32_16x16x32_bf16 v[132:135], v[40:43], a[52:55], v[132:135]
    ds_read_b64_tr_b16 v[34:35], v5 offset:14592
    v_mul_f32 v61, v165, v165
    v_mfma_f32_16x16x32_bf16 v[132:135], v[44:47], a[68:71], v[132:135]
    v_mul_f32 v62, v166, v166
    v_mul_f32 v63, v167, v167
    v_mfma_f32_16x16x32_bf16 v[132:135], v[48:51], a[84:87], v[132:135]
    ds_read_b64_tr_b16 v[36:37], v5 offset:16384
    v_mul_f32 v64, v180, v180
    v_mfma_f32_16x16x32_bf16 v[128:131], v[48:51], a[80:83], v[128:131]
    v_mul_f32 v65, v181, v181
    v_mul_f32 v66, v182, v182
    v_mfma_f32_16x16x32_bf16 v[128:131], v[44:47], a[64:67], v[128:131]
    ds_read_b64_tr_b16 v[38:39], v5 offset:16640
    v_mul_f32 v67, v183, v183
    v_mfma_f32_16x16x32_bf16 v[128:131], v[40:43], a[48:51], v[128:131]
    s_waitcnt lgkmcnt(6)
    v_fma_f32 v60, v60, v13, v12
    v_fma_f32 v61, v61, v13, v12
    v_mfma_f32_16x16x32_bf16 v[144:147], v[16:19], a[48:51], 0
    v_fma_f32 v62, v62, v13, v12
    v_fma_f32 v63, v63, v13, v12
    v_mfma_f32_16x16x32_bf16 v[144:147], v[20:23], a[64:67], v[144:147]
    v_fma_f32 v64, v64, v13, v12
    v_fma_f32 v65, v65, v13, v12
    v_mfma_f32_16x16x32_bf16 v[144:147], v[24:27], a[80:83], v[144:147]
    v_fma_f32 v66, v66, v13, v12
    v_fma_f32 v67, v67, v13, v12
    v_mfma_f32_16x16x32_bf16 v[148:151], v[24:27], a[84:87], 0
    v_mul_f32 v60, v60, v164
    v_mul_f32 v61, v61, v165
    v_mfma_f32_16x16x32_bf16 v[148:151], v[20:23], a[68:71], v[148:151]
    v_exp_f32 v60, v60
    v_mfma_f32_16x16x32_bf16 v[148:151], v[16:19], a[52:55], v[148:151]
    v_exp_f32 v61, v61
    v_mfma_f32_16x16x32_bf16 v[152:155], v[16:19], a[56:59], 0
    v_mul_f32 v62, v62, v166
    v_mul_f32 v63, v63, v167
    v_mfma_f32_16x16x32_bf16 v[152:155], v[20:23], a[72:75], v[152:155]
    v_exp_f32 v62, v62
    v_mfma_f32_16x16x32_bf16 v[152:155], v[24:27], a[88:91], v[152:155]
    v_exp_f32 v63, v63
    v_mfma_f32_16x16x32_bf16 v[156:159], v[24:27], a[92:95], 0
    v_mul_f32 v64, v64, v180
    v_mul_f32 v65, v65, v181
    v_mfma_f32_16x16x32_bf16 v[156:159], v[20:23], a[76:79], v[156:159]
    v_exp_f32 v64, v64
    v_mfma_f32_16x16x32_bf16 v[156:159], v[16:19], a[60:63], v[156:159]
    s_waitcnt vmcnt(13) lgkmcnt(0)
    s_barrier
    v_mul_f32 v66, v66, v182
    v_mfma_f32_16x16x32_bf16 v[156:159], v[28:31], a[12:15], v[156:159]
    ds_read_b64_tr_b16 v[40:41], v6 offset:0
    v_mul_f32 v67, v67, v183
    v_mfma_f32_16x16x32_bf16 v[156:159], v[32:35], a[28:31], v[156:159]
    ds_read_b64_tr_b16 v[42:43], v6 offset:256
    v_mul_f32 v164, v164, v196
    v_mfma_f32_16x16x32_bf16 v[156:159], v[36:39], a[44:47], v[156:159]
    ds_read_b64_tr_b16 v[44:45], v6 offset:2048
    v_mul_f32 v165, v165, v197
    v_mfma_f32_16x16x32_bf16 v[152:155], v[36:39], a[40:43], v[152:155]
    ds_read_b64_tr_b16 v[46:47], v6 offset:2304
    v_mul_f32 v166, v166, v198
    v_mfma_f32_16x16x32_bf16 v[152:155], v[32:35], a[24:27], v[152:155]
    ds_read_b64_tr_b16 v[48:49], v6 offset:4096
    v_mul_f32 v167, v167, v199
    v_mfma_f32_16x16x32_bf16 v[152:155], v[28:31], a[8:11], v[152:155]
    ds_read_b64_tr_b16 v[50:51], v6 offset:4352
    v_mul_f32 v180, v180, v212
    v_mfma_f32_16x16x32_bf16 v[148:151], v[28:31], a[4:7], v[148:151]
    ds_read_b64_tr_b16 v[16:17], v6 offset:6144
    v_mul_f32 v181, v181, v213
    v_mfma_f32_16x16x32_bf16 v[148:151], v[32:35], a[20:23], v[148:151]
    ds_read_b64_tr_b16 v[18:19], v6 offset:6400
    v_mul_f32 v182, v182, v214
    v_mfma_f32_16x16x32_bf16 v[148:151], v[36:39], a[36:39], v[148:151]
    ds_read_b64_tr_b16 v[20:21], v6 offset:8192
    v_mul_f32 v183, v183, v215
    v_mfma_f32_16x16x32_bf16 v[144:147], v[36:39], a[32:35], v[144:147]
    ds_read_b64_tr_b16 v[22:23], v6 offset:8448
    v_add_f32 v60, 1.0, v60
    v_mfma_f32_16x16x32_bf16 v[144:147], v[32:35], a[16:19], v[144:147]
    ds_read_b64_tr_b16 v[24:25], v6 offset:10240
    v_add_f32 v61, 1.0, v61
    v_mfma_f32_16x16x32_bf16 v[144:147], v[28:31], a[0:3], v[144:147]
    s_waitcnt lgkmcnt(5)
    ds_read_b64_tr_b16 v[26:27], v6 offset:10496
    v_add_f32 v62, 1.0, v62
    v_mfma_f32_16x16x32_bf16 v[96:99], v[40:43], a[96:99], v[96:99]
    ds_read_b64_tr_b16 v[28:29], v7 offset:6144
    v_add_f32 v63, 1.0, v63
    v_mfma_f32_16x16x32_bf16 v[96:99], v[44:47], a[112:115], v[96:99]
    s_mov_b32 s45, 0
    v_exp_f32 v65, v65
    v_mfma_f32_16x16x32_bf16 v[96:99], v[48:51], a[128:131], v[96:99]
    s_add_u32 m0, s49, 49152
    ds_read_b64_tr_b16 v[30:31], v7 offset:6400
    v_add_f32 v64, 1.0, v64
    v_mfma_f32_16x16x32_bf16 v[100:103], v[48:51], a[132:135], v[100:103]
    buffer_load_dwordx4 v14, s[20:23], s45 offen lds
    v_mfma_f32_16x16x32_bf16 v[100:103], v[44:47], a[116:119], v[100:103]
    ds_read_b64_tr_b16 v[32:33], v7 offset:8192
    v_add_f32 v65, 1.0, v65
    v_mfma_f32_16x16x32_bf16 v[100:103], v[40:43], a[100:103], v[100:103]
    ds_read_b128 a[0:3], v10 offset:0
    v_mul_f32 v52, v168, v168
    v_mfma_f32_16x16x32_bf16 v[104:107], v[40:43], a[104:107], v[104:107]
    ds_read_b64_tr_b16 v[34:35], v7 offset:8448
    v_mul_f32 v53, v169, v169
    v_mfma_f32_16x16x32_bf16 v[104:107], v[44:47], a[120:123], v[104:107]
    v_exp_f32 v66, v66
    v_mfma_f32_16x16x32_bf16 v[104:107], v[48:51], a[136:139], v[104:107]
    ds_read_b64_tr_b16 v[36:37], v7 offset:10240
    v_add_f32 v66, 1.0, v66
    v_mfma_f32_16x16x32_bf16 v[108:111], v[48:51], a[140:143], v[108:111]
    ds_read_b128 a[4:7], v10 offset:1024
    v_mul_f32 v54, v170, v170
    v_mfma_f32_16x16x32_bf16 v[108:111], v[44:47], a[124:127], v[108:111]
    ds_read_b64_tr_b16 v[38:39], v7 offset:10496
    v_mul_f32 v55, v171, v171
    v_mfma_f32_16x16x32_bf16 v[108:111], v[40:43], a[108:111], v[108:111]
    s_waitcnt lgkmcnt(8)
    v_exp_f32 v67, v67
    v_mfma_f32_16x16x32_bf16 v[108:111], v[16:19], a[156:159], v[108:111]
    ds_read_b64_tr_b16 v[40:41], v7 offset:0
    v_add_f32 v67, 1.0, v67
    v_mfma_f32_16x16x32_bf16 v[108:111], v[20:23], a[172:175], v[108:111]
    ds_read_b128 a[8:11], v10 offset:2048
    v_mul_f32 v56, v184, v184
    v_mfma_f32_16x16x32_bf16 v[108:111], v[24:27], a[188:191], v[108:111]
    ds_read_b64_tr_b16 v[42:43], v7 offset:256
    v_mul_f32 v57, v185, v185
    v_mfma_f32_16x16x32_bf16 v[104:107], v[24:27], a[184:187], v[104:107]
    v_rcp_f32 v60, v60
    v_mfma_f32_16x16x32_bf16 v[104:107], v[20:23], a[168:171], v[104:107]
    ds_read_b64_tr_b16 v[44:45], v7 offset:2048
    v_mul_f32 v164, v164, v60
    v_mfma_f32_16x16x32_bf16 v[104:107], v[16:19], a[152:155], v[104:107]
    ds_read_b128 a[12:15], v10 offset:3072
    v_mul_f32 v58, v186, v186
    v_mfma_f32_16x16x32_bf16 v[100:103], v[16:19], a[148:151], v[100:103]
    ds_read_b64_tr_b16 v[46:47], v7 offset:2304
    v_mul_f32 v59, v187, v187
    v_mfma_f32_16x16x32_bf16 v[100:103], v[20:23], a[164:167], v[100:103]
    s_mov_b32 s44, 4096
    v_rcp_f32 v61, v61
    v_mfma_f32_16x16x32_bf16 v[100:103], v[24:27], a[180:183], v[100:103]
    s_add_u32 m0, s49, 53248
    ds_read_b64_tr_b16 v[48:49], v7 offset:4096
    v_mul_f32 v165, v165, v61
    v_mfma_f32_16x16x32_bf16 v[96:99], v[24:27], a[176:179], v[96:99]
    buffer_load_dwordx4 v14, s[20:23], s44 offen lds
    v_mfma_f32_16x16x32_bf16 v[96:99], v[20:23], a[160:163], v[96:99]
    ds_read_b64_tr_b16 v[50:51], v7 offset:4352
    v_cvt_pk_bf16_f32 v72, v164, v165
    v_mfma_f32_16x16x32_bf16 v[96:99], v[16:19], a[144:147], v[96:99]
    s_waitcnt lgkmcnt(8)
    ds_read_b128 a[16:19], v10 offset:4096
    v_fma_f32 v52, v52, v13, v12
    v_mfma_f32_16x16x32_bf16 v[112:115], v[28:31], a[144:147], v[112:115]
    ds_read_b64_tr_b16 v[16:17], v6 offset:12288
    v_fma_f32 v53, v53, v13, v12
    v_mfma_f32_16x16x32_bf16 v[112:115], v[32:35], a[160:163], v[112:115]
    v_rcp_f32 v62, v62
    v_mfma_f32_16x16x32_bf16 v[112:115], v[36:39], a[176:179], v[112:115]
    ds_read_b64_tr_b16 v[18:19], v6 offset:12544
    v_mul_f32 v166, v166, v62
    v_mfma_f32_16x16x32_bf16 v[116:119], v[36:39], a[180:183], v[116:119]
    ds_read_b128 a[20:23], v10 offset:5120
    v_fma_f32 v54, v54, v13, v12
    v_mfma_f32_16x16x32_bf16 v[116:119], v[32:35], a[164:167], v[116:119]
    ds_read_b64_tr_b16 v[20:21], v6 offset:14336
    v_fma_f32 v55, v55, v13, v12
    v_mfma_f32_16x16x32_bf16 v[116:119], v[28:31], a[148:151], v[116:119]
    v_rcp_f32 v63, v63
    v_mfma_f32_16x16x32_bf16 v[120:123], v[28:31], a[152:155], v[120:123]
    ds_read_b64_tr_b16 v[22:23], v6 offset:14592
    v_mul_f32 v167, v167, v63
    v_mfma_f32_16x16x32_bf16 v[120:123], v[32:35], a[168:171], v[120:123]
    ds_read_b128 a[24:27], v10 offset:6144
    v_cvt_pk_bf16_f32 v73, v166, v167
    v_mfma_f32_16x16x32_bf16 v[120:123], v[36:39], a[184:187], v[120:123]
    ds_read_b64_tr_b16 v[24:25], v6 offset:16384
    v_fma_f32 v56, v56, v13, v12
    v_mfma_f32_16x16x32_bf16 v[124:127], v[36:39], a[188:191], v[124:127]
    v_rcp_f32 v64, v64
    v_mfma_f32_16x16x32_bf16 v[124:127], v[32:35], a[172:175], v[124:127]
    ds_read_b64_tr_b16 v[26:27], v6 offset:16640
    v_mul_f32 v180, v180, v64
    v_mfma_f32_16x16x32_bf16 v[124:127], v[28:31], a[156:159], v[124:127]
    s_waitcnt lgkmcnt(9)
    ds_read_b128 a[28:31], v10 offset:7168
    v_fma_f32 v57, v57, v13, v12
    v_mfma_f32_16x16x32_bf16 v[124:127], v[40:43], a[108:111], v[124:127]
    ds_read_b64_tr_b16 v[28:29], v6 offset:18432
    v_fma_f32 v58, v58, v13, v12
    v_mfma_f32_16x16x32_bf16 v[124:127], v[44:47], a[124:127], v[124:127]
    s_mov_b32 s45, 8192
    v_rcp_f32 v65, v65
    v_mfma_f32_16x16x32_bf16 v[124:127], v[48:51], a[140:143], v[124:127]
    s_add_u32 m0, s49, 57344
    ds_read_b64_tr_b16 v[30:31], v6 offset:18688
    v_mul_f32 v181, v181, v65
    v_mfma_f32_16x16x32_bf16 v[120:123], v[48:51], a[136:139], v[120:123]
    buffer_load_dwordx4 v14, s[20:23], s45 offen lds
    v_mfma_f32_16x16x32_bf16 v[120:123], v[44:47], a[120:123], v[120:123]
    ds_read_b64_tr_b16 v[32:33], v6 offset:20480
    v_cvt_pk_bf16_f32 v74, v180, v181
    v_mfma_f32_16x16x32_bf16 v[120:123], v[40:43], a[104:107], v[120:123]
    ds_read_b128 a[32:35], v11 offset:0
    v_fma_f32 v59, v59, v13, v12
    v_mfma_f32_16x16x32_bf16 v[116:119], v[40:43], a[100:103], v[116:119]
    ds_read_b64_tr_b16 v[34:35], v6 offset:20736
    v_mul_f32 v52, v52, v168
    v_mfma_f32_16x16x32_bf16 v[116:119], v[44:47], a[116:119], v[116:119]
    v_rcp_f32 v66, v66
    v_mfma_f32_16x16x32_bf16 v[116:119], v[48:51], a[132:135], v[116:119]
    ds_read_b64_tr_b16 v[36:37], v6 offset:22528
    v_mul_f32 v182, v182, v66
    v_mfma_f32_16x16x32_bf16 v[112:115], v[48:51], a[128:131], v[112:115]
    ds_read_b128 a[36:39], v11 offset:1024
    v_mul_f32 v53, v53, v169
    v_mfma_f32_16x16x32_bf16 v[112:115], v[44:47], a[112:115], v[112:115]
    ds_read_b64_tr_b16 v[38:39], v6 offset:22784
    v_mul_f32 v54, v54, v170
    v_mfma_f32_16x16x32_bf16 v[112:115], v[40:43], a[96:99], v[112:115]
    s_waitcnt lgkmcnt(9)
    v_rcp_f32 v67, v67
    v_mfma_f32_16x16x32_bf16 v[128:131], v[16:19], a[96:99], v[128:131]
    ds_read_b64_tr_b16 v[40:41], v7 offset:18432
    v_mul_f32 v183, v183, v67
    v_mfma_f32_16x16x32_bf16 v[128:131], v[20:23], a[112:115], v[128:131]
    ds_read_b128 a[40:43], v11 offset:2048
    v_cvt_pk_bf16_f32 v75, v182, v183
    v_mfma_f32_16x16x32_bf16 v[128:131], v[24:27], a[128:131], v[128:131]
    ds_read_b64_tr_b16 v[42:43], v7 offset:18688
    v_mul_f32 v55, v55, v171
    v_mfma_f32_16x16x32_bf16 v[132:135], v[24:27], a[132:135], v[132:135]
    s_add_u32 s46, s6, 4198400
    buffer_store_dwordx4 v[72:75], v1, s[28:31], s46 offen
    v_mfma_f32_16x16x32_bf16 v[132:135], v[20:23], a[116:119], v[132:135]
    ds_read_b64_tr_b16 v[44:45], v7 offset:20480
    v_mul_f32 v56, v56, v184
    v_mfma_f32_16x16x32_bf16 v[132:135], v[16:19], a[100:103], v[132:135]
    ds_read_b128 a[44:47], v11 offset:3072
    v_mul_f32 v57, v57, v185
    v_mfma_f32_16x16x32_bf16 v[136:139], v[16:19], a[104:107], v[136:139]
    ds_read_b64_tr_b16 v[46:47], v7 offset:20736
    v_mul_f32 v58, v58, v186
    v_mfma_f32_16x16x32_bf16 v[136:139], v[20:23], a[120:123], v[136:139]
    v_exp_f32 v52, v52
    v_mfma_f32_16x16x32_bf16 v[136:139], v[24:27], a[136:139], v[136:139]
    ds_read_b64_tr_b16 v[48:49], v7 offset:22528
    v_mul_f32 v59, v59, v187
    v_mfma_f32_16x16x32_bf16 v[140:143], v[24:27], a[140:143], v[140:143]
    s_mov_b32 s44, 12288
    ds_read_b128 a[48:51], v11 offset:4096
    v_mul_f32 v168, v168, v200
    v_mfma_f32_16x16x32_bf16 v[140:143], v[20:23], a[124:127], v[140:143]
    s_add_u32 m0, s49, 61440
    ds_read_b64_tr_b16 v[50:51], v7 offset:22784
    v_mul_f32 v169, v169, v201
    v_mfma_f32_16x16x32_bf16 v[140:143], v[16:19], a[108:111], v[140:143]
    s_waitcnt lgkmcnt(9)
    buffer_load_dwordx4 v14, s[20:23], s44 offen lds
    v_mfma_f32_16x16x32_bf16 v[140:143], v[28:31], a[156:159], v[140:143]
    ds_read_b64_tr_b16 v[16:17], v7 offset:12288
    v_mul_f32 v170, v170, v202
    v_mfma_f32_16x16x32_bf16 v[140:143], v[32:35], a[172:175], v[140:143]
    v_exp_f32 v53, v53
    v_mfma_f32_16x16x32_bf16 v[140:143], v[36:39], a[188:191], v[140:143]
    ds_read_b64_tr_b16 v[18:19], v7 offset:12544
    v_mul_f32 v171, v171, v203
    v_mfma_f32_16x16x32_bf16 v[136:139], v[36:39], a[184:187], v[136:139]
    ds_read_b128 a[52:55], v11 offset:5120
    v_mul_f32 v184, v184, v216
    v_mfma_f32_16x16x32_bf16 v[136:139], v[32:35], a[168:171], v[136:139]
    ds_read_b64_tr_b16 v[20:21], v7 offset:14336
    v_mul_f32 v185, v185, v217
    v_mfma_f32_16x16x32_bf16 v[136:139], v[28:31], a[152:155], v[136:139]
    v_exp_f32 v54, v54
    v_mfma_f32_16x16x32_bf16 v[132:135], v[28:31], a[148:151], v[132:135]
    ds_read_b64_tr_b16 v[22:23], v7 offset:14592
    v_mul_f32 v186, v186, v218
    v_mfma_f32_16x16x32_bf16 v[132:135], v[32:35], a[164:167], v[132:135]
    ds_read_b128 a[56:59], v11 offset:6144
    v_mul_f32 v187, v187, v219
    v_mfma_f32_16x16x32_bf16 v[132:135], v[36:39], a[180:183], v[132:135]
    ds_read_b64_tr_b16 v[24:25], v7 offset:16384
    v_add_f32 v52, 1.0, v52
    v_mfma_f32_16x16x32_bf16 v[128:131], v[36:39], a[176:179], v[128:131]
    v_exp_f32 v55, v55
    v_mfma_f32_16x16x32_bf16 v[128:131], v[32:35], a[160:163], v[128:131]
    ds_read_b64_tr_b16 v[26:27], v7 offset:16640
    v_add_f32 v53, 1.0, v53
    v_mfma_f32_16x16x32_bf16 v[128:131], v[28:31], a[144:147], v[128:131]
    s_waitcnt lgkmcnt(8)
    ds_read_b128 a[60:63], v11 offset:7168
    v_add_f32 v54, 1.0, v54
    v_mfma_f32_16x16x32_bf16 v[144:147], v[40:43], a[144:147], v[144:147]
    v_exp_f32 v56, v56
    s_load_dwordx2 s[64:65], s[0:1], 32
    s_load_dwordx2 s[66:67], s[0:1], 64
    s_load_dwordx2 s[16:17], s[0:1], 72
    v_mfma_f32_16x16x32_bf16 v[144:147], v[44:47], a[160:163], v[144:147]
    v_exp_f32 v57, v57
    v_mfma_f32_16x16x32_bf16 v[144:147], v[48:51], a[176:179], v[144:147]
    v_exp_f32 v58, v58
    v_mfma_f32_16x16x32_bf16 v[148:151], v[48:51], a[180:183], v[148:151]
    v_exp_f32 v59, v59
    v_mfma_f32_16x16x32_bf16 v[148:151], v[44:47], a[164:167], v[148:151]
    v_rcp_f32 v52, v52
    v_mfma_f32_16x16x32_bf16 v[148:151], v[40:43], a[148:151], v[148:151]
    v_rcp_f32 v53, v53
    v_mfma_f32_16x16x32_bf16 v[152:155], v[40:43], a[152:155], v[152:155]
    v_rcp_f32 v54, v54
    v_mfma_f32_16x16x32_bf16 v[152:155], v[44:47], a[168:171], v[152:155]
    v_add_f32 v55, 1.0, v55
    v_add_f32 v56, 1.0, v56
    v_mfma_f32_16x16x32_bf16 v[152:155], v[48:51], a[184:187], v[152:155]
    v_rcp_f32 v55, v55
    v_mfma_f32_16x16x32_bf16 v[156:159], v[48:51], a[188:191], v[156:159]
    v_rcp_f32 v56, v56
    v_mfma_f32_16x16x32_bf16 v[156:159], v[44:47], a[172:175], v[156:159]
    v_add_f32 v57, 1.0, v57
    v_add_f32 v58, 1.0, v58
    v_mfma_f32_16x16x32_bf16 v[156:159], v[40:43], a[156:159], v[156:159]
    s_waitcnt vmcnt(11) lgkmcnt(0)
    s_barrier
    v_add_f32 v59, 1.0, v59
    v_mfma_f32_16x16x32_bf16 v[156:159], v[16:19], a[108:111], v[156:159]
    ds_read_b64_tr_b16 v[28:29], v6 offset:24576
    v_mul_f32 v168, v168, v52
    v_mfma_f32_16x16x32_bf16 v[156:159], v[20:23], a[124:127], v[156:159]
    ds_read_b64_tr_b16 v[30:31], v6 offset:24832
    v_mul_f32 v169, v169, v53
    v_mfma_f32_16x16x32_bf16 v[156:159], v[24:27], a[140:143], v[156:159]
    ds_read_b64_tr_b16 v[32:33], v6 offset:26624
    v_mul_f32 v170, v170, v54
    v_mfma_f32_16x16x32_bf16 v[152:155], v[24:27], a[136:139], v[152:155]
    ds_read_b64_tr_b16 v[34:35], v6 offset:26880
    v_mul_f32 v171, v171, v55
    v_mfma_f32_16x16x32_bf16 v[152:155], v[20:23], a[120:123], v[152:155]
    ds_read_b64_tr_b16 v[36:37], v6 offset:28672
    v_mul_f32 v184, v184, v56
    v_mfma_f32_16x16x32_bf16 v[152:155], v[16:19], a[104:107], v[152:155]
    ds_read_b64_tr_b16 v[38:39], v6 offset:28928
    v_cvt_pk_bf16_f32 v68, v168, v169
    v_mfma_f32_16x16x32_bf16 v[148:151], v[16:19], a[100:103], v[148:151]
    ds_read_b64_tr_b16 v[40:41], v6 offset:30720
    v_cvt_pk_bf16_f32 v69, v170, v171
    v_mfma_f32_16x16x32_bf16 v[148:151], v[20:23], a[116:119], v[148:151]
    ds_read_b64_tr_b16 v[42:43], v6 offset:30976
    v_mul_f32 v60, v172, v172
    v_mfma_f32_16x16x32_bf16 v[148:151], v[24:27], a[132:135], v[148:151]
    ds_read_b64_tr_b16 v[44:45], v6 offset:32768
    v_mul_f32 v61, v173, v173
    v_mfma_f32_16x16x32_bf16 v[144:147], v[24:27], a[128:131], v[144:147]
    ds_read_b64_tr_b16 v[46:47], v6 offset:33024
    v_mul_f32 v62, v174, v174
    v_mfma_f32_16x16x32_bf16 v[144:147], v[20:23], a[112:115], v[144:147]
    ds_read_b64_tr_b16 v[48:49], v6 offset:34816
    v_mul_f32 v63, v175, v175
    v_mfma_f32_16x16x32_bf16 v[144:147], v[16:19], a[96:99], v[144:147]
    s_waitcnt lgkmcnt(5)
    ds_read_b64_tr_b16 v[50:51], v6 offset:35072
    v_mul_f32 v64, v188, v188
    v_mfma_f32_16x16x32_bf16 v[96:99], v[28:31], a[192:195], v[96:99]
    ds_read_b64_tr_b16 v[16:17], v7 offset:30720
    v_mul_f32 v65, v189, v189
    v_mfma_f32_16x16x32_bf16 v[96:99], v[32:35], a[208:211], v[96:99]
    s_mov_b32 s45, 16384
    v_rcp_f32 v57, v57
    v_mfma_f32_16x16x32_bf16 v[96:99], v[36:39], a[224:227], v[96:99]
    s_add_u32 m0, s49, 0
    ds_read_b64_tr_b16 v[18:19], v7 offset:30976
    v_mul_f32 v185, v185, v57
    v_mfma_f32_16x16x32_bf16 v[100:103], v[36:39], a[228:231], v[100:103]
L_pad8:
    s_cbranch_execz L_pad11
    buffer_load_dwordx4 v14, s[20:23], s45 offen lds
    v_mfma_f32_16x16x32_bf16 v[100:103], v[32:35], a[212:215], v[100:103]
    ds_read_b64_tr_b16 v[20:21], v7 offset:32768
    v_cvt_pk_bf16_f32 v70, v184, v185
    v_mfma_f32_16x16x32_bf16 v[100:103], v[28:31], a[196:199], v[100:103]
    s_mov_b32 s44, 20480
    v_rcp_f32 v58, v58
    v_mfma_f32_16x16x32_bf16 v[104:107], v[28:31], a[200:203], v[104:107]
    s_add_u32 m0, s49, 4096
    ds_read_b64_tr_b16 v[22:23], v7 offset:33024
    v_mul_f32 v186, v186, v58
    v_mfma_f32_16x16x32_bf16 v[104:107], v[32:35], a[216:219], v[104:107]
    buffer_load_dwordx4 v14, s[20:23], s44 offen lds
    v_mfma_f32_16x16x32_bf16 v[104:107], v[36:39], a[232:235], v[104:107]
    ds_read_b64_tr_b16 v[24:25], v7 offset:34816
    v_mul_f32 v66, v190, v190
    v_mfma_f32_16x16x32_bf16 v[108:111], v[36:39], a[236:239], v[108:111]
    s_mov_b32 s45, 24576
    v_rcp_f32 v59, v59
    v_mfma_f32_16x16x32_bf16 v[108:111], v[32:35], a[220:223], v[108:111]
    s_add_u32 m0, s49, 8192
    ds_read_b64_tr_b16 v[26:27], v7 offset:35072
    v_mul_f32 v187, v187, v59
    v_mfma_f32_16x16x32_bf16 v[108:111], v[28:31], a[204:207], v[108:111]
    s_waitcnt lgkmcnt(6)
    buffer_load_dwordx4 v14, s[20:23], s45 offen lds
    v_mfma_f32_16x16x32_bf16 v[108:111], v[40:43], a[252:255], v[108:111]
    ds_read_b64_tr_b16 v[28:29], v7 offset:24576
    v_cvt_pk_bf16_f32 v71, v186, v187
    v_mfma_f32_16x16x32_bf16 v[108:111], v[44:47], v[236:239], v[108:111]
    s_mov_b32 s44, 28672
    v_mul_f32 v67, v191, v191
    v_fma_f32 v60, v60, v13, v12
    v_mfma_f32_16x16x32_bf16 v[108:111], v[48:51], v[252:255], v[108:111]
    s_add_u32 m0, s49, 12288
    ds_read_b64_tr_b16 v[30:31], v7 offset:24832
    v_fma_f32 v61, v61, v13, v12
    v_mfma_f32_16x16x32_bf16 v[104:107], v[48:51], v[248:251], v[104:107]
    buffer_load_dwordx4 v14, s[20:23], s44 offen lds
    v_mfma_f32_16x16x32_bf16 v[104:107], v[44:47], v[232:235], v[104:107]
    ds_read_b64_tr_b16 v[32:33], v7 offset:26624
    v_fma_f32 v62, v62, v13, v12
    v_mfma_f32_16x16x32_bf16 v[104:107], v[40:43], a[248:251], v[104:107]
    s_mov_b32 s45, 16384
    v_fma_f32 v63, v63, v13, v12
    v_fma_f32 v64, v64, v13, v12
    v_mfma_f32_16x16x32_bf16 v[100:103], v[40:43], a[244:247], v[100:103]
    s_add_u32 m0, s49, 98304
    ds_read_b64_tr_b16 v[34:35], v7 offset:26880
    v_fma_f32 v65, v65, v13, v12
    v_mfma_f32_16x16x32_bf16 v[100:103], v[44:47], v[228:231], v[100:103]
    buffer_load_dwordx4 v15, s[24:27], s45 offen lds
    v_mfma_f32_16x16x32_bf16 v[100:103], v[48:51], v[244:247], v[100:103]
    ds_read_b64_tr_b16 v[36:37], v7 offset:28672
    v_fma_f32 v66, v66, v13, v12
    v_mfma_f32_16x16x32_bf16 v[96:99], v[48:51], v[240:243], v[96:99]
    s_mov_b32 s44, 20480
    v_fma_f32 v67, v67, v13, v12
    v_mul_f32 v60, v60, v172
    v_mfma_f32_16x16x32_bf16 v[96:99], v[44:47], v[224:227], v[96:99]
    s_add_u32 m0, s49, 102400
    ds_read_b64_tr_b16 v[38:39], v7 offset:28928
    v_mul_f32 v61, v61, v173
    v_mfma_f32_16x16x32_bf16 v[96:99], v[40:43], a[240:243], v[96:99]
    s_waitcnt lgkmcnt(6)
    buffer_load_dwordx4 v15, s[24:27], s44 offen lds
    v_mfma_f32_16x16x32_bf16 v[112:115], v[16:19], a[240:243], v[112:115]
    ds_read_b64_tr_b16 v[40:41], v6 offset:36864
    v_mul_f32 v62, v62, v174
    v_mfma_f32_16x16x32_bf16 v[112:115], v[20:23], v[224:227], v[112:115]
    s_add_u32 s46, s6, 4202496
    buffer_store_dwordx4 v[68:71], v1, s[28:31], s46 offen
    v_mfma_f32_16x16x32_bf16 v[112:115], v[24:27], v[240:243], v[112:115]
    ds_read_b64_tr_b16 v[42:43], v6 offset:37120
    v_mul_f32 v63, v63, v175
    v_mfma_f32_16x16x32_bf16 v[116:119], v[24:27], v[244:247], v[116:119]
    s_mov_b32 s45, 24576
    v_exp_f32 v60, v60
    v_mfma_f32_16x16x32_bf16 v[116:119], v[20:23], v[228:231], v[116:119]
    s_add_u32 m0, s49, 106496
    ds_read_b64_tr_b16 v[44:45], v6 offset:38912
    v_mul_f32 v64, v64, v188
    v_mfma_f32_16x16x32_bf16 v[116:119], v[16:19], a[244:247], v[116:119]
    buffer_load_dwordx4 v15, s[24:27], s45 offen lds
    v_mfma_f32_16x16x32_bf16 v[120:123], v[16:19], a[248:251], v[120:123]
    ds_read_b64_tr_b16 v[46:47], v6 offset:39168
    v_mul_f32 v65, v65, v189
    v_mfma_f32_16x16x32_bf16 v[120:123], v[20:23], v[232:235], v[120:123]
    s_mov_b32 s44, 28672
    v_exp_f32 v61, v61
    v_mfma_f32_16x16x32_bf16 v[120:123], v[24:27], v[248:251], v[120:123]
    s_add_u32 m0, s49, 110592
    ds_read_b64_tr_b16 v[48:49], v6 offset:40960
    v_mul_f32 v66, v66, v190
    v_mfma_f32_16x16x32_bf16 v[124:127], v[24:27], v[252:255], v[124:127]
    buffer_load_dwordx4 v15, s[24:27], s44 offen lds
    v_mfma_f32_16x16x32_bf16 v[124:127], v[20:23], v[236:239], v[124:127]
    ds_read_b64_tr_b16 v[50:51], v6 offset:41216
    v_mul_f32 v67, v67, v191
    v_mfma_f32_16x16x32_bf16 v[124:127], v[16:19], a[252:255], v[124:127]
    s_waitcnt lgkmcnt(6)
    v_exp_f32 v62, v62
    v_mfma_f32_16x16x32_bf16 v[124:127], v[28:31], a[204:207], v[124:127]
    ds_read_b64_tr_b16 v[16:17], v6 offset:43008
    v_mul_f32 v172, v172, v204
    v_mfma_f32_16x16x32_bf16 v[124:127], v[32:35], a[220:223], v[124:127]
    s_mov_b32 s45, 32768
    v_exp_f32 v63, v63
    v_mfma_f32_16x16x32_bf16 v[124:127], v[36:39], a[236:239], v[124:127]
    s_add_u32 m0, s49, 16384
    ds_read_b64_tr_b16 v[18:19], v6 offset:43264
    v_mul_f32 v173, v173, v205
    v_mfma_f32_16x16x32_bf16 v[120:123], v[36:39], a[232:235], v[120:123]
    buffer_load_dwordx4 v14, s[20:23], s45 offen lds
    v_mfma_f32_16x16x32_bf16 v[120:123], v[32:35], a[216:219], v[120:123]
    ds_read_b64_tr_b16 v[20:21], v6 offset:45056
    v_mul_f32 v174, v174, v206
    v_mfma_f32_16x16x32_bf16 v[120:123], v[28:31], a[200:203], v[120:123]
    s_mov_b32 s44, 36864
    v_exp_f32 v64, v64
    v_mfma_f32_16x16x32_bf16 v[116:119], v[28:31], a[196:199], v[116:119]
    s_add_u32 m0, s49, 20480
    ds_read_b64_tr_b16 v[22:23], v6 offset:45312
    v_mul_f32 v175, v175, v207
    v_mfma_f32_16x16x32_bf16 v[116:119], v[32:35], a[212:215], v[116:119]
    buffer_load_dwordx4 v14, s[20:23], s44 offen lds
    v_mfma_f32_16x16x32_bf16 v[116:119], v[36:39], a[228:231], v[116:119]
    ds_read_b64_tr_b16 v[24:25], v6 offset:47104
    v_mul_f32 v188, v188, v220
    v_mfma_f32_16x16x32_bf16 v[112:115], v[36:39], a[224:227], v[112:115]
    s_mov_b32 s45, 40960
    v_exp_f32 v65, v65
    v_mfma_f32_16x16x32_bf16 v[112:115], v[32:35], a[208:211], v[112:115]
    s_add_u32 m0, s49, 24576
    ds_read_b64_tr_b16 v[26:27], v6 offset:47360
    v_mul_f32 v189, v189, v221
    v_mfma_f32_16x16x32_bf16 v[112:115], v[28:31], a[192:195], v[112:115]
    s_waitcnt lgkmcnt(6)
    buffer_load_dwordx4 v14, s[20:23], s45 offen lds
    v_mfma_f32_16x16x32_bf16 v[128:131], v[40:43], a[192:195], v[128:131]
    ds_read_b64_tr_b16 v[28:29], v7 offset:43008
    v_mul_f32 v190, v190, v222
    v_mfma_f32_16x16x32_bf16 v[128:131], v[44:47], a[208:211], v[128:131]
    s_mov_b32 s44, 45056
    v_exp_f32 v66, v66
    v_mfma_f32_16x16x32_bf16 v[128:131], v[48:51], a[224:227], v[128:131]
    s_add_u32 m0, s49, 28672
    ds_read_b64_tr_b16 v[30:31], v7 offset:43264
    v_mul_f32 v191, v191, v223
    v_mfma_f32_16x16x32_bf16 v[132:135], v[48:51], a[228:231], v[132:135]
    buffer_load_dwordx4 v14, s[20:23], s44 offen lds
    v_mfma_f32_16x16x32_bf16 v[132:135], v[44:47], a[212:215], v[132:135]
    ds_read_b64_tr_b16 v[32:33], v7 offset:45056
    v_add_f32 v60, 1.0, v60
    v_mfma_f32_16x16x32_bf16 v[132:135], v[40:43], a[196:199], v[132:135]
    v_exp_f32 v67, v67
    v_mfma_f32_16x16x32_bf16 v[136:139], v[40:43], a[200:203], v[136:139]
    ds_read_b64_tr_b16 v[34:35], v7 offset:45312
    v_add_f32 v61, 1.0, v61
    v_mfma_f32_16x16x32_bf16 v[136:139], v[44:47], a[216:219], v[136:139]
    v_rcp_f32 v60, v60
    v_mfma_f32_16x16x32_bf16 v[136:139], v[48:51], a[232:235], v[136:139]
    ds_read_b64_tr_b16 v[36:37], v7 offset:47104
    v_add_f32 v62, 1.0, v62
    v_mfma_f32_16x16x32_bf16 v[140:143], v[48:51], a[236:239], v[140:143]
    v_rcp_f32 v61, v61
    v_mfma_f32_16x16x32_bf16 v[140:143], v[44:47], a[220:223], v[140:143]
    ds_read_b64_tr_b16 v[38:39], v7 offset:47360
    v_add_f32 v63, 1.0, v63
    v_mfma_f32_16x16x32_bf16 v[140:143], v[40:43], a[204:207], v[140:143]
    s_waitcnt lgkmcnt(6)
    v_rcp_f32 v62, v62
    v_mfma_f32_16x16x32_bf16 v[140:143], v[16:19], a[252:255], v[140:143]
    ds_read_b64_tr_b16 v[40:41], v7 offset:36864
    v_add_f32 v64, 1.0, v64
    v_mfma_f32_16x16x32_bf16 v[140:143], v[20:23], v[236:239], v[140:143]
    v_rcp_f32 v63, v63
    v_mfma_f32_16x16x32_bf16 v[140:143], v[24:27], v[252:255], v[140:143]
    ds_read_b64_tr_b16 v[42:43], v7 offset:37120
    v_add_f32 v65, 1.0, v65
    v_mfma_f32_16x16x32_bf16 v[136:139], v[24:27], v[248:251], v[136:139]
    v_rcp_f32 v64, v64
    v_mfma_f32_16x16x32_bf16 v[136:139], v[20:23], v[232:235], v[136:139]
    ds_read_b64_tr_b16 v[44:45], v7 offset:38912
    v_add_f32 v66, 1.0, v66
    v_mfma_f32_16x16x32_bf16 v[136:139], v[16:19], a[248:251], v[136:139]
    v_rcp_f32 v65, v65
    v_mfma_f32_16x16x32_bf16 v[132:135], v[16:19], a[244:247], v[132:135]
    ds_read_b64_tr_b16 v[46:47], v7 offset:39168
    v_add_f32 v67, 1.0, v67
    v_mfma_f32_16x16x32_bf16 v[132:135], v[20:23], v[228:231], v[132:135]
    v_rcp_f32 v66, v66
    v_mfma_f32_16x16x32_bf16 v[132:135], v[24:27], v[244:247], v[132:135]
    ds_read_b64_tr_b16 v[48:49], v7 offset:40960
    v_mul_f32 v172, v172, v60
    v_mfma_f32_16x16x32_bf16 v[128:131], v[24:27], v[240:243], v[128:131]
    v_rcp_f32 v67, v67
    v_mfma_f32_16x16x32_bf16 v[128:131], v[20:23], v[224:227], v[128:131]
    ds_read_b64_tr_b16 v[50:51], v7 offset:41216
    v_mul_f32 v173, v173, v61
    v_mfma_f32_16x16x32_bf16 v[128:131], v[16:19], a[240:243], v[128:131]
    s_waitcnt lgkmcnt(6)
    v_mul_f32 v174, v174, v62
    v_mul_f32 v175, v175, v63
    v_mfma_f32_16x16x32_bf16 v[144:147], v[28:31], a[240:243], v[144:147]
    v_mul_f32 v188, v188, v64
    v_mul_f32 v189, v189, v65
    v_mfma_f32_16x16x32_bf16 v[144:147], v[32:35], v[224:227], v[144:147]
    v_mul_f32 v190, v190, v66
    v_mul_f32 v191, v191, v67
    v_mfma_f32_16x16x32_bf16 v[144:147], v[36:39], v[240:243], v[144:147]
    v_cvt_pk_bf16_f32 v72, v172, v173
    v_cvt_pk_bf16_f32 v73, v174, v175
    v_mfma_f32_16x16x32_bf16 v[148:151], v[36:39], v[244:247], v[148:151]
    v_cvt_pk_bf16_f32 v74, v188, v189
    v_cvt_pk_bf16_f32 v75, v190, v191
    v_mfma_f32_16x16x32_bf16 v[148:151], v[32:35], v[228:231], v[148:151]
    s_add_u32 s46, s6, 4206592
    buffer_store_dwordx4 v[72:75], v1, s[28:31], s46 offen
    v_mfma_f32_16x16x32_bf16 v[148:151], v[28:31], a[244:247], v[148:151]
    v_xor_b32 v76, 128, v78
    v_xor_b32 v77, 128, v79
    v_mfma_f32_16x16x32_bf16 v[152:155], v[28:31], a[248:251], v[152:155]
    v_mfma_f32_16x16x32_bf16 v[152:155], v[32:35], v[232:235], v[152:155]
    v_mfma_f32_16x16x32_bf16 v[152:155], v[36:39], v[248:251], v[152:155]
    v_mfma_f32_16x16x32_bf16 v[156:159], v[36:39], v[252:255], v[156:159]
    v_mfma_f32_16x16x32_bf16 v[156:159], v[32:35], v[236:239], v[156:159]
    v_mfma_f32_16x16x32_bf16 v[156:159], v[28:31], a[252:255], v[156:159]
    s_waitcnt lgkmcnt(0)
    v_mfma_f32_16x16x32_bf16 v[156:159], v[40:43], a[204:207], v[156:159]
    v_mfma_f32_16x16x32_bf16 v[156:159], v[44:47], a[220:223], v[156:159]
    v_mfma_f32_16x16x32_bf16 v[156:159], v[48:51], a[236:239], v[156:159]
    v_mfma_f32_16x16x32_bf16 v[152:155], v[48:51], a[232:235], v[152:155]
    v_mfma_f32_16x16x32_bf16 v[152:155], v[44:47], a[216:219], v[152:155]
    v_mfma_f32_16x16x32_bf16 v[152:155], v[40:43], a[200:203], v[152:155]
    v_mfma_f32_16x16x32_bf16 v[148:151], v[40:43], a[196:199], v[148:151]
    v_mfma_f32_16x16x32_bf16 v[148:151], v[44:47], a[212:215], v[148:151]
    v_mfma_f32_16x16x32_bf16 v[148:151], v[48:51], a[228:231], v[148:151]
    v_mfma_f32_16x16x32_bf16 v[144:147], v[48:51], a[224:227], v[144:147]
    v_mfma_f32_16x16x32_bf16 v[144:147], v[44:47], a[208:211], v[144:147]
    v_mfma_f32_16x16x32_bf16 v[144:147], v[40:43], a[192:195], v[144:147]
    s_waitcnt vmcnt(14) lgkmcnt(0)
    s_barrier
    ds_read_b128 a[64:67], v76 offset:49152
    ds_read_b128 a[68:71], v77 offset:49152
    ds_read_b128 a[72:75], v78 offset:49152
    ds_read_b128 a[76:79], v79 offset:49152
    ds_read_b128 a[80:83], v76 offset:53248
    ds_read_b128 a[84:87], v77 offset:53248
    ds_read_b128 a[88:91], v78 offset:53248
    ds_read_b128 a[92:95], v79 offset:53248
    v_mul_f32 v52, v96, v96
    v_mul_f32 v53, v97, v97
    v_mul_f32 v54, v98, v98
    v_mul_f32 v55, v99, v99
    v_mul_f32 v56, v112, v112
    v_mul_f32 v57, v113, v113
    v_mul_f32 v58, v114, v114
    v_mul_f32 v59, v115, v115
    v_fma_f32 v52, v52, v13, v12
    v_fma_f32 v53, v53, v13, v12
    v_fma_f32 v54, v54, v13, v12
    v_fma_f32 v55, v55, v13, v12
    v_fma_f32 v56, v56, v13, v12
    v_fma_f32 v57, v57, v13, v12
    v_fma_f32 v58, v58, v13, v12
    v_fma_f32 v59, v59, v13, v12
    v_mul_f32 v52, v52, v96
    v_mul_f32 v53, v53, v97
    v_mul_f32 v54, v54, v98
    v_mul_f32 v55, v55, v99
    v_mul_f32 v56, v56, v112
    v_mul_f32 v57, v57, v113
    v_mul_f32 v58, v58, v114
    v_mul_f32 v59, v59, v115
    s_waitcnt lgkmcnt(0)
    v_mfma_f32_16x16x32_bf16 v[160:163], a[64:67], a[0:3], 0
    v_exp_f32 v52, v52
    v_mfma_f32_16x16x32_bf16 v[160:163], a[68:71], a[4:7], v[160:163]
    s_mov_b32 s45, 49152
    v_exp_f32 v53, v53
    v_mfma_f32_16x16x32_bf16 v[160:163], a[72:75], a[8:11], v[160:163]
    s_add_u32 m0, s49, 32768
    v_exp_f32 v54, v54
    v_mfma_f32_16x16x32_bf16 v[160:163], a[76:79], a[12:15], v[160:163]
    buffer_load_dwordx4 v14, s[20:23], s45 offen lds
    v_mfma_f32_16x16x32_bf16 v[164:167], a[76:79], a[28:31], 0
    s_mov_b32 s44, 53248
    v_exp_f32 v55, v55
    v_mfma_f32_16x16x32_bf16 v[164:167], a[72:75], a[24:27], v[164:167]
    s_add_u32 m0, s49, 36864
    v_exp_f32 v56, v56
    v_mfma_f32_16x16x32_bf16 v[164:167], a[68:71], a[20:23], v[164:167]
    buffer_load_dwordx4 v14, s[20:23], s44 offen lds
    v_mfma_f32_16x16x32_bf16 v[164:167], a[64:67], a[16:19], v[164:167]
    v_exp_f32 v57, v57
    v_mfma_f32_16x16x32_bf16 v[168:171], a[64:67], a[32:35], 0
    s_mov_b32 s45, 57344
    v_exp_f32 v58, v58
    v_mfma_f32_16x16x32_bf16 v[168:171], a[68:71], a[36:39], v[168:171]
    s_add_u32 m0, s49, 40960
    v_exp_f32 v59, v59
    v_mfma_f32_16x16x32_bf16 v[168:171], a[72:75], a[40:43], v[168:171]
    buffer_load_dwordx4 v14, s[20:23], s45 offen lds
    v_mfma_f32_16x16x32_bf16 v[168:171], a[76:79], a[44:47], v[168:171]
    v_mul_f32 v96, v96, v128
    v_mul_f32 v97, v97, v129
    v_mfma_f32_16x16x32_bf16 v[172:175], a[76:79], a[60:63], 0
    s_mov_b32 s44, 61440
    v_mul_f32 v98, v98, v130
    v_mul_f32 v99, v99, v131
    v_mfma_f32_16x16x32_bf16 v[172:175], a[72:75], a[56:59], v[172:175]
    s_add_u32 m0, s49, 45056
    v_mul_f32 v112, v112, v144
    v_mul_f32 v113, v113, v145
    v_mfma_f32_16x16x32_bf16 v[172:175], a[68:71], a[52:55], v[172:175]
    buffer_load_dwordx4 v14, s[20:23], s44 offen lds
    v_mfma_f32_16x16x32_bf16 v[172:175], a[64:67], a[48:51], v[172:175]
    v_mul_f32 v114, v114, v146
    v_mul_f32 v115, v115, v147
    v_mfma_f32_16x16x32_bf16 v[188:191], a[80:83], a[48:51], 0
    ds_read_b128 a[64:67], v76 offset:57344
    v_add_f32 v52, 1.0, v52
    v_mfma_f32_16x16x32_bf16 v[188:191], a[84:87], a[52:55], v[188:191]
    s_mov_b32 s45, 32768
    v_rcp_f32 v52, v52
    v_mfma_f32_16x16x32_bf16 v[188:191], a[88:91], a[56:59], v[188:191]
    s_add_u32 m0, s49, 114688
    ds_read_b128 a[68:71], v77 offset:57344
    v_add_f32 v53, 1.0, v53
    v_mfma_f32_16x16x32_bf16 v[188:191], a[92:95], a[60:63], v[188:191]
    buffer_load_dwordx4 v15, s[24:27], s45 offen lds
    v_mfma_f32_16x16x32_bf16 v[184:187], a[92:95], a[44:47], 0
    ds_read_b128 a[72:75], v78 offset:57344
    v_add_f32 v54, 1.0, v54
    v_mfma_f32_16x16x32_bf16 v[184:187], a[88:91], a[40:43], v[184:187]
    s_mov_b32 s44, 36864
    v_rcp_f32 v53, v53
    v_mfma_f32_16x16x32_bf16 v[184:187], a[84:87], a[36:39], v[184:187]
    s_add_u32 m0, s49, 118784
    ds_read_b128 a[76:79], v79 offset:57344
    v_add_f32 v55, 1.0, v55
    v_mfma_f32_16x16x32_bf16 v[184:187], a[80:83], a[32:35], v[184:187]
    buffer_load_dwordx4 v15, s[24:27], s44 offen lds
    v_mfma_f32_16x16x32_bf16 v[180:183], a[80:83], a[16:19], 0
    s_mov_b32 s45, 40960
    v_rcp_f32 v54, v54
    v_mfma_f32_16x16x32_bf16 v[180:183], a[84:87], a[20:23], v[180:183]
    s_add_u32 m0, s49, 122880
    v_rcp_f32 v55, v55
    v_mfma_f32_16x16x32_bf16 v[180:183], a[88:91], a[24:27], v[180:183]
    buffer_load_dwordx4 v15, s[24:27], s45 offen lds
    v_mfma_f32_16x16x32_bf16 v[180:183], a[92:95], a[28:31], v[180:183]
    v_add_f32 v56, 1.0, v56
    v_add_f32 v57, 1.0, v57
    v_mfma_f32_16x16x32_bf16 v[176:179], a[92:95], a[12:15], 0
    s_mov_b32 s44, 45056
    v_rcp_f32 v56, v56
    v_mfma_f32_16x16x32_bf16 v[176:179], a[88:91], a[8:11], v[176:179]
    s_add_u32 m0, s49, 126976
    v_rcp_f32 v57, v57
    v_mfma_f32_16x16x32_bf16 v[176:179], a[84:87], a[4:7], v[176:179]
    buffer_load_dwordx4 v15, s[24:27], s44 offen lds
    v_mfma_f32_16x16x32_bf16 v[176:179], a[80:83], a[0:3], v[176:179]
    s_waitcnt lgkmcnt(0)
    v_add_f32 v58, 1.0, v58
    v_add_f32 v59, 1.0, v59
    v_mfma_f32_16x16x32_bf16 v[192:195], a[64:67], a[0:3], 0
    ds_read_b128 a[80:83], v76 offset:61440
    v_mul_f32 v96, v96, v52
    v_mfma_f32_16x16x32_bf16 v[192:195], a[68:71], a[4:7], v[192:195]
    v_rcp_f32 v58, v58
    v_mfma_f32_16x16x32_bf16 v[192:195], a[72:75], a[8:11], v[192:195]
    ds_read_b128 a[84:87], v77 offset:61440
    v_mul_f32 v97, v97, v53
    v_mfma_f32_16x16x32_bf16 v[192:195], a[76:79], a[12:15], v[192:195]
    v_rcp_f32 v59, v59
    v_mfma_f32_16x16x32_bf16 v[196:199], a[76:79], a[28:31], 0
    ds_read_b128 a[88:91], v78 offset:61440
    v_mul_f32 v98, v98, v54
    v_mfma_f32_16x16x32_bf16 v[196:199], a[72:75], a[24:27], v[196:199]
    v_mul_f32 v99, v99, v55
    v_mul_f32 v112, v112, v56
    v_mfma_f32_16x16x32_bf16 v[196:199], a[68:71], a[20:23], v[196:199]
    ds_read_b128 a[92:95], v79 offset:61440
    v_mul_f32 v113, v113, v57
    v_mfma_f32_16x16x32_bf16 v[196:199], a[64:67], a[16:19], v[196:199]
    v_mul_f32 v114, v114, v58
    v_mul_f32 v115, v115, v59
    v_mfma_f32_16x16x32_bf16 v[200:203], a[64:67], a[32:35], 0
    v_cvt_pk_bf16_f32 v68, v96, v97
    v_cvt_pk_bf16_f32 v69, v98, v99
    v_mfma_f32_16x16x32_bf16 v[200:203], a[68:71], a[36:39], v[200:203]
    s_mov_b32 s18, 2359296
    v_cvt_pk_bf16_f32 v70, v112, v113
    v_cvt_pk_bf16_f32 v71, v114, v115
    v_mfma_f32_16x16x32_bf16 v[200:203], a[72:75], a[40:43], v[200:203]
    s_add_u32 s46, s7, 4194304
    buffer_store_dwordx4 v[68:71], v1, s[28:31], s46 offen
    v_mfma_f32_16x16x32_bf16 v[200:203], a[76:79], a[44:47], v[200:203]
    s_and_b32 s44, s42, 7
    v_mul_f32 v60, v100, v100
    v_mul_f32 v61, v101, v101
    v_mfma_f32_16x16x32_bf16 v[204:207], a[76:79], a[60:63], 0
    s_lshl_b32 s45, s41, 3
    v_mul_f32 v62, v102, v102
    v_mul_f32 v63, v103, v103
    v_mfma_f32_16x16x32_bf16 v[204:207], a[72:75], a[56:59], v[204:207]
    s_add_u32 s44, s44, s45
    v_mul_f32 v64, v116, v116
    v_mul_f32 v65, v117, v117
    v_mfma_f32_16x16x32_bf16 v[204:207], a[68:71], a[52:55], v[204:207]
    s_lshl_b32 s44, s44, 2
    v_mul_f32 v66, v118, v118
    v_mul_f32 v67, v119, v119
    v_mfma_f32_16x16x32_bf16 v[204:207], a[64:67], a[48:51], v[204:207]
    s_waitcnt lgkmcnt(0)
    v_fma_f32 v60, v60, v13, v12
    v_fma_f32 v61, v61, v13, v12
    v_mfma_f32_16x16x32_bf16 v[220:223], a[80:83], a[48:51], 0
    s_add_u32 s44, s44, s40
    v_fma_f32 v62, v62, v13, v12
    v_fma_f32 v63, v63, v13, v12
    v_mfma_f32_16x16x32_bf16 v[220:223], a[84:87], a[52:55], v[220:223]
    s_lshr_b32 s47, s42, 3
    v_fma_f32 v64, v64, v13, v12
    v_fma_f32 v65, v65, v13, v12
    v_mfma_f32_16x16x32_bf16 v[220:223], a[88:91], a[56:59], v[220:223]
    s_sub_u32 s45, s44, 120
    v_fma_f32 v66, v66, v13, v12
    v_fma_f32 v67, v67, v13, v12
    v_mfma_f32_16x16x32_bf16 v[220:223], a[92:95], a[60:63], v[220:223]
    v_mul_f32 v60, v60, v100
    v_mul_f32 v61, v61, v101
    v_mfma_f32_16x16x32_bf16 v[216:219], a[92:95], a[44:47], 0
    v_exp_f32 v60, v60
    v_mfma_f32_16x16x32_bf16 v[216:219], a[88:91], a[40:43], v[216:219]
    v_exp_f32 v61, v61
    v_mfma_f32_16x16x32_bf16 v[216:219], a[84:87], a[36:39], v[216:219]
    v_mul_f32 v62, v62, v102
    v_mul_f32 v63, v63, v103
    v_mfma_f32_16x16x32_bf16 v[216:219], a[80:83], a[32:35], v[216:219]
    v_exp_f32 v62, v62
    v_mfma_f32_16x16x32_bf16 v[212:215], a[80:83], a[16:19], 0
    v_exp_f32 v63, v63
    v_mfma_f32_16x16x32_bf16 v[212:215], a[84:87], a[20:23], v[212:215]
    v_mul_f32 v64, v64, v116
    v_mul_f32 v65, v65, v117
    v_mfma_f32_16x16x32_bf16 v[212:215], a[88:91], a[24:27], v[212:215]
    v_exp_f32 v64, v64
    v_mfma_f32_16x16x32_bf16 v[212:215], a[92:95], a[28:31], v[212:215]
    v_exp_f32 v65, v65
    v_mfma_f32_16x16x32_bf16 v[208:211], a[92:95], a[12:15], 0
    v_mul_f32 v66, v66, v118
    v_mul_f32 v67, v67, v119
    v_mfma_f32_16x16x32_bf16 v[208:211], a[88:91], a[8:11], v[208:211]
    v_exp_f32 v66, v66
    v_mfma_f32_16x16x32_bf16 v[208:211], a[84:87], a[4:7], v[208:211]
    v_exp_f32 v67, v67
    v_mfma_f32_16x16x32_bf16 v[208:211], a[80:83], a[0:3], v[208:211]
    v_mul_f32 v100, v100, v132
    v_mul_f32 v101, v101, v133
    v_mul_f32 v102, v102, v134
    v_mul_f32 v103, v103, v135
    v_mul_f32 v116, v116, v148
    v_mul_f32 v117, v117, v149
    v_mul_f32 v118, v118, v150
    v_mul_f32 v119, v119, v151
    v_add_f32 v60, 1.0, v60
    v_add_f32 v61, 1.0, v61
    v_add_f32 v62, 1.0, v62
    v_add_f32 v63, 1.0, v63
    v_add_f32 v64, 1.0, v64
    v_add_f32 v65, 1.0, v65
    v_add_f32 v66, 1.0, v66
    v_add_f32 v67, 1.0, v67
    v_rcp_f32 v60, v60
    v_rcp_f32 v61, v61
    v_rcp_f32 v62, v62
    v_rcp_f32 v63, v63
    v_rcp_f32 v64, v64
    v_rcp_f32 v65, v65
    v_rcp_f32 v66, v66
    v_rcp_f32 v67, v67
    v_mul_f32 v100, v100, v60
    v_mul_f32 v101, v101, v61
    v_mul_f32 v102, v102, v62
    v_mul_f32 v103, v103, v63
    v_mul_f32 v116, v116, v64
    v_mul_f32 v117, v117, v65
    v_mul_f32 v118, v118, v66
    v_mul_f32 v119, v119, v67
    v_cvt_pk_bf16_f32 v72, v100, v101
    v_cvt_pk_bf16_f32 v73, v102, v103
    v_cvt_pk_bf16_f32 v74, v116, v117
    v_cvt_pk_bf16_f32 v75, v118, v119
    s_add_u32 s46, s7, 4198400
    buffer_store_dwordx4 v[72:75], v1, s[28:31], s46 offen
    v_pk_mul_f32 v[52:53], v[104:105], v[104:105]
    v_pk_mul_f32 v[54:55], v[106:107], v[106:107]
    v_pk_mul_f32 v[56:57], v[120:121], v[120:121]
    v_pk_mul_f32 v[58:59], v[122:123], v[122:123]
    v_pk_fma_f32 v[52:53], v[52:53], v[12:13], v[12:13] op_sel:[0,1,0] op_sel_hi:[1,1,0]
    v_pk_fma_f32 v[54:55], v[54:55], v[12:13], v[12:13] op_sel:[0,1,0] op_sel_hi:[1,1,0]
    v_pk_fma_f32 v[56:57], v[56:57], v[12:13], v[12:13] op_sel:[0,1,0] op_sel_hi:[1,1,0]
    v_pk_fma_f32 v[58:59], v[58:59], v[12:13], v[12:13] op_sel:[0,1,0] op_sel_hi:[1,1,0]
    v_pk_mul_f32 v[52:53], v[52:53], v[104:105]
    v_pk_mul_f32 v[54:55], v[54:55], v[106:107]
    v_pk_mul_f32 v[56:57], v[56:57], v[120:121]
    v_pk_mul_f32 v[58:59], v[58:59], v[122:123]
    v_exp_f32 v52, v52
    v_exp_f32 v53, v53
    v_exp_f32 v54, v54
    v_exp_f32 v55, v55
    v_exp_f32 v56, v56
    v_exp_f32 v57, v57
    v_exp_f32 v58, v58
    v_exp_f32 v59, v59
    v_pk_mul_f32 v[104:105], v[104:105], v[136:137]
    v_pk_mul_f32 v[106:107], v[106:107], v[138:139]
    v_pk_mul_f32 v[120:121], v[120:121], v[152:153]
    v_pk_mul_f32 v[122:123], v[122:123], v[154:155]
    v_pk_add_f32 v[52:53], v[52:53], 1.0 op_sel_hi:[1,0]
    v_pk_add_f32 v[54:55], v[54:55], 1.0 op_sel_hi:[1,0]
    v_pk_add_f32 v[56:57], v[56:57], 1.0 op_sel_hi:[1,0]
    v_pk_add_f32 v[58:59], v[58:59], 1.0 op_sel_hi:[1,0]
    v_rcp_f32 v52, v52
    v_rcp_f32 v53, v53
    v_rcp_f32 v54, v54
    v_rcp_f32 v55, v55
    v_rcp_f32 v56, v56
    v_rcp_f32 v57, v57
    v_rcp_f32 v58, v58
    v_rcp_f32 v59, v59
    v_pk_mul_f32 v[104:105], v[104:105], v[52:53]
    v_pk_mul_f32 v[106:107], v[106:107], v[54:55]
    v_pk_mul_f32 v[120:121], v[120:121], v[56:57]
    v_pk_mul_f32 v[122:123], v[122:123], v[58:59]
    v_cvt_pk_bf16_f32 v68, v104, v105
    v_cvt_pk_bf16_f32 v69, v106, v107
    v_cvt_pk_bf16_f32 v70, v120, v121
    v_cvt_pk_bf16_f32 v71, v122, v123
    s_add_u32 s46, s7, 4202496
    buffer_store_dwordx4 v[68:71], v1, s[28:31], s46 offen
    v_pk_mul_f32 v[60:61], v[108:109], v[108:109]
    v_pk_mul_f32 v[62:63], v[110:111], v[110:111]
    v_pk_mul_f32 v[64:65], v[124:125], v[124:125]
    v_pk_mul_f32 v[66:67], v[126:127], v[126:127]
    v_pk_fma_f32 v[60:61], v[60:61], v[12:13], v[12:13] op_sel:[0,1,0] op_sel_hi:[1,1,0]
    v_pk_fma_f32 v[62:63], v[62:63], v[12:13], v[12:13] op_sel:[0,1,0] op_sel_hi:[1,1,0]
    v_pk_fma_f32 v[64:65], v[64:65], v[12:13], v[12:13] op_sel:[0,1,0] op_sel_hi:[1,1,0]
    v_pk_fma_f32 v[66:67], v[66:67], v[12:13], v[12:13] op_sel:[0,1,0] op_sel_hi:[1,1,0]
    v_pk_mul_f32 v[60:61], v[60:61], v[108:109]
    v_pk_mul_f32 v[62:63], v[62:63], v[110:111]
    v_pk_mul_f32 v[64:65], v[64:65], v[124:125]
    v_pk_mul_f32 v[66:67], v[66:67], v[126:127]
    v_exp_f32 v60, v60
    v_exp_f32 v61, v61
    v_exp_f32 v62, v62
    v_exp_f32 v63, v63
    v_exp_f32 v64, v64
    v_exp_f32 v65, v65
    v_exp_f32 v66, v66
    v_exp_f32 v67, v67
    v_pk_mul_f32 v[108:109], v[108:109], v[140:141]
    v_pk_mul_f32 v[110:111], v[110:111], v[142:143]
    v_pk_mul_f32 v[124:125], v[124:125], v[156:157]
    v_pk_mul_f32 v[126:127], v[126:127], v[158:159]
    v_pk_add_f32 v[60:61], v[60:61], 1.0 op_sel_hi:[1,0]
    v_pk_add_f32 v[62:63], v[62:63], 1.0 op_sel_hi:[1,0]
    v_pk_add_f32 v[64:65], v[64:65], 1.0 op_sel_hi:[1,0]
    v_pk_add_f32 v[66:67], v[66:67], 1.0 op_sel_hi:[1,0]
    v_rcp_f32 v60, v60
    v_rcp_f32 v61, v61
    v_rcp_f32 v62, v62
    v_rcp_f32 v63, v63
    v_rcp_f32 v64, v64
    v_rcp_f32 v65, v65
    v_rcp_f32 v66, v66
    v_rcp_f32 v67, v67
    v_pk_mul_f32 v[108:109], v[108:109], v[60:61]
    v_pk_mul_f32 v[110:111], v[110:111], v[62:63]
    v_pk_mul_f32 v[124:125], v[124:125], v[64:65]
    v_pk_mul_f32 v[126:127], v[126:127], v[66:67]
    v_cvt_pk_bf16_f32 v72, v108, v109
    v_cvt_pk_bf16_f32 v73, v110, v111
    v_cvt_pk_bf16_f32 v74, v124, v125
    v_cvt_pk_bf16_f32 v75, v126, v127
    s_add_u32 s46, s7, 4206592
    buffer_store_dwordx4 v[72:75], v1, s[28:31], s46 offen
    s_cmp_lt_u32 s44, 120
    s_cselect_b32 s43, s44, s45
    s_movk_i32 s59, 136
    s_cselect_b32 s59, 120, s59
    s_cselect_b32 s8, s64, s66
    s_cselect_b32 s9, s65, s67
    s_mov_b32 s10, 1327104
    s_cselect_b32 s10, 1179648, s10
    s_mov_b32 s14, s10
    s_mov_b32 s44, 80216064
    s_cselect_b32 s44, 75497472, s44
    s_mul_i32 s45, s47, s10
    s_add_u32 s8, s8, s45
    s_addc_u32 s9, s9, 0
    s_add_u32 s44, s44, s45
    s_add_u32 s12, s70, s44
    s_addc_u32 s13, s71, 0
    s_sub_u32 s43, s43, s59
    s_mov_b32 s47, 65536
    s_mov_b32 s48, 49152
    s_mov_b32 s52, 7
    s_lshl_b32 s56, s40, 11
    s_add_u32 s56, s56, 131072
    v_mov_b32 v52, 0
    v_mov_b32 v53, 0
    v_mov_b32 v54, 0
    v_mov_b32 v55, 0
    v_and_b32 v10, 48, v1
    v_min_u32 v10, 1, v10
    v_add_u32 v10, -1, v10
    v_and_b32 v10, 0x3f803f80, v10
    v_mov_b32 v11, v10
    v_mov_b32 v12, v10
    v_mov_b32 v13, v10
    s_waitcnt vmcnt(22)
    s_barrier
    ds_read_b128 a[64:67], v76 offset:0
    ds_read_b128 a[68:71], v77 offset:0
    ds_read_b128 a[72:75], v78 offset:0
L_pad7:
    s_cbranch_execz L_pad10
    ds_read_b128 a[76:79], v79 offset:0
    ds_read_b128 a[80:83], v76 offset:4096
    ds_read_b128 a[84:87], v77 offset:4096
    ds_read_b128 a[88:91], v78 offset:4096
    ds_read_b128 a[92:95], v79 offset:4096
    v_lshrrev_b32 v5, 4, v1
    v_lshrrev_b32 v2, 2, v5
    v_and_b32 v4, 3, v5
    v_lshlrev_b32 v3, 6, v2
    v_lshl_add_u32 v3, v4, 3, v3
    v_add_u32 v3, s56, v3
    v_mul_u32_u24 v2, 1152, v2
    v_lshl_add_u32 v2, v4, 4, v2
    s_and_b32 s45, s42, 24
    s_lshl_b32 s45, s45, 6
    v_and_b32 v4, 7, v5
    v_lshrrev_b32 v8, 3, v5
    v_lshlrev_b32 v8, 11, v8
    v_lshl_add_u32 v8, v4, 3, v8
    v_add_u32 v8, s45, v8
    v_mov_b32 v7, s68
    v_mfma_f32_32x32x16_bf16 a[128:143], v[52:55], v[52:55], 0
    v_max3_f32 v64, v160, v161, v162
    v_max3_f32 v64, v64, v163, v176
    v_max3_f32 v64, v64, v177, v178
    v_max3_f32 v64, v64, v179, v192
    v_max3_f32 v64, v64, v193, v194
    v_max3_f32 v64, v64, v195, v208
    v_max3_f32 v64, v64, v209, v210
    v_max_f32 v64, v64, v211
    v_mfma_f32_32x32x16_bf16 a[144:159], v[52:55], v[52:55], 0
    v_max3_f32 v65, v164, v165, v166
    v_max3_f32 v65, v65, v167, v180
    v_max3_f32 v65, v65, v181, v182
    v_max3_f32 v65, v65, v183, v196
    v_max3_f32 v65, v65, v197, v198
    v_max3_f32 v65, v65, v199, v212
    v_max3_f32 v65, v65, v213, v214
    v_max_f32 v65, v65, v215
    v_mfma_f32_32x32x16_bf16 a[160:175], v[52:55], v[52:55], 0
    v_max3_f32 v66, v168, v169, v170
    v_max3_f32 v66, v66, v171, v184
    v_max3_f32 v66, v66, v185, v186
    v_max3_f32 v66, v66, v187, v200
    v_max3_f32 v66, v66, v201, v202
    v_max3_f32 v66, v66, v203, v216
    v_max3_f32 v66, v66, v217, v218
    v_max_f32 v66, v66, v219
    v_mfma_f32_32x32x16_bf16 a[176:191], v[52:55], v[52:55], 0
    v_max3_f32 v67, v172, v173, v174
    v_max3_f32 v67, v67, v175, v188
    v_max3_f32 v67, v67, v189, v190
    v_max3_f32 v67, v67, v191, v204
    v_max3_f32 v67, v67, v205, v206
    v_max3_f32 v67, v67, v207, v220
    v_max3_f32 v67, v67, v221, v222
    v_max_f32 v67, v67, v223
    v_mfma_f32_32x32x16_bf16 a[192:207], v[52:55], v[52:55], 0
    v_mov_b32 v68, v64
    v_mov_b32 v69, v65
    v_mov_b32 v70, v66
    v_mov_b32 v71, v67
    v_permlane32_swap_b32 v64, v68
    v_permlane32_swap_b32 v65, v69
    v_permlane32_swap_b32 v66, v70
    v_permlane32_swap_b32 v67, v71
    v_mfma_f32_32x32x16_bf16 a[208:223], v[52:55], v[52:55], 0
    v_max_f32 v64, v64, v68
    v_max_f32 v65, v65, v69
    v_max_f32 v66, v66, v70
    v_max_f32 v67, v67, v71
    v_mov_b32 v68, v64
    v_mov_b32 v69, v65
    v_mov_b32 v70, v66
    v_mov_b32 v71, v67
    v_mfma_f32_32x32x16_bf16 a[224:239], v[52:55], v[52:55], 0
    v_permlane16_swap_b32 v64, v68
    v_permlane16_swap_b32 v65, v69
    v_permlane16_swap_b32 v66, v70
    v_permlane16_swap_b32 v67, v71
    v_max_f32 v64, v64, v68
    v_max_f32 v65, v65, v69
    v_max_f32 v66, v66, v70
    v_max_f32 v67, v67, v71
    v_mfma_f32_32x32x16_bf16 a[240:255], v[52:55], v[52:55], 0
    v_sub_f32 v32, 0xc2cc0000, v64
    v_sub_f32 v33, 0xc2cc0000, v64
    v_sub_f32 v34, 0xc2cc0000, v64
    v_sub_f32 v35, 0xc2cc0000, v64
    v_sub_f32 v36, 0xc2cc0000, v65
    v_sub_f32 v37, 0xc2cc0000, v65
    v_sub_f32 v38, 0xc2cc0000, v65
    v_sub_f32 v39, 0xc2cc0000, v65
    v_sub_f32 v40, 0xc2cc0000, v66
    v_sub_f32 v41, 0xc2cc0000, v66
    v_sub_f32 v42, 0xc2cc0000, v66
    v_sub_f32 v43, 0xc2cc0000, v66
    v_sub_f32 v44, 0xc2cc0000, v67
    v_sub_f32 v45, 0xc2cc0000, v67
    v_sub_f32 v46, 0xc2cc0000, v67
    v_sub_f32 v47, 0xc2cc0000, v67
    v_pk_add_f32 v[160:161], v[160:161], v[32:33]
    v_pk_add_f32 v[162:163], v[162:163], v[32:33]
    v_pk_add_f32 v[164:165], v[164:165], v[36:37]
    v_pk_add_f32 v[166:167], v[166:167], v[36:37]
    v_pk_add_f32 v[168:169], v[168:169], v[40:41]
    v_pk_add_f32 v[170:171], v[170:171], v[40:41]
    v_pk_add_f32 v[172:173], v[172:173], v[44:45]
    v_pk_add_f32 v[174:175], v[174:175], v[44:45]
    v_pk_add_f32 v[176:177], v[176:177], v[32:33]
    v_pk_add_f32 v[178:179], v[178:179], v[32:33]
    v_pk_add_f32 v[180:181], v[180:181], v[36:37]
    v_pk_add_f32 v[182:183], v[182:183], v[36:37]
    v_pk_add_f32 v[184:185], v[184:185], v[40:41]
    v_pk_add_f32 v[186:187], v[186:187], v[40:41]
    v_pk_add_f32 v[188:189], v[188:189], v[44:45]
    v_pk_add_f32 v[190:191], v[190:191], v[44:45]
    v_pk_add_f32 v[192:193], v[192:193], v[32:33]
    v_pk_add_f32 v[194:195], v[194:195], v[32:33]
    v_pk_add_f32 v[196:197], v[196:197], v[36:37]
    v_pk_add_f32 v[198:199], v[198:199], v[36:37]
    v_pk_add_f32 v[200:201], v[200:201], v[40:41]
    v_pk_add_f32 v[202:203], v[202:203], v[40:41]
    v_pk_add_f32 v[204:205], v[204:205], v[44:45]
    v_pk_add_f32 v[206:207], v[206:207], v[44:45]
    v_pk_add_f32 v[208:209], v[208:209], v[32:33]
    v_pk_add_f32 v[210:211], v[210:211], v[32:33]
    v_pk_add_f32 v[212:213], v[212:213], v[36:37]
    v_pk_add_f32 v[214:215], v[214:215], v[36:37]
    v_pk_add_f32 v[216:217], v[216:217], v[40:41]
    v_pk_add_f32 v[218:219], v[218:219], v[40:41]
    v_pk_add_f32 v[220:221], v[220:221], v[44:45]
    v_pk_add_f32 v[222:223], v[222:223], v[44:45]
    v_exp_f32 v56, v160
    v_exp_f32 v57, v161
    v_exp_f32 v58, v164
    v_cvt_pk_bf16_f32 v224, v56, v57
    v_exp_f32 v59, v165
    v_add_f32 v49, v53, v58
    v_exp_f32 v60, v162
    v_add_f32 v49, v49, v59
    v_cvt_pk_bf16_f32 v228, v58, v59
    v_exp_f32 v61, v163
    v_exp_f32 v62, v166
    v_cvt_pk_bf16_f32 v225, v60, v61
    v_exp_f32 v63, v167
    v_add_f32 v49, v49, v62
    v_exp_f32 v56, v176
    v_add_f32 v49, v49, v63
    v_cvt_pk_bf16_f32 v229, v62, v63
    v_exp_f32 v57, v177
    v_exp_f32 v58, v180
    v_cvt_pk_bf16_f32 v226, v56, v57
    v_exp_f32 v59, v181
    v_add_f32 v49, v49, v58
    v_exp_f32 v60, v178
    v_add_f32 v49, v49, v59
    v_cvt_pk_bf16_f32 v230, v58, v59
    v_exp_f32 v61, v179
    v_exp_f32 v62, v182
    v_cvt_pk_bf16_f32 v227, v60, v61
    v_exp_f32 v63, v183
    v_add_f32 v49, v49, v62
    v_exp_f32 v56, v168
    v_add_f32 v49, v49, v63
    v_cvt_pk_bf16_f32 v231, v62, v63
    v_exp_f32 v57, v169
    v_exp_f32 v58, v172
    v_cvt_pk_bf16_f32 v232, v56, v57
    v_exp_f32 v59, v173
    v_add_f32 v51, v55, v58
    v_exp_f32 v60, v170
    v_add_f32 v51, v51, v59
    v_cvt_pk_bf16_f32 v236, v58, v59
    v_exp_f32 v61, v171
    v_exp_f32 v62, v174
    v_cvt_pk_bf16_f32 v233, v60, v61
    v_exp_f32 v63, v175
    v_add_f32 v51, v51, v62
    v_exp_f32 v56, v184
    v_add_f32 v51, v51, v63
    v_cvt_pk_bf16_f32 v237, v62, v63
    v_exp_f32 v57, v185
    v_exp_f32 v58, v188
    v_cvt_pk_bf16_f32 v234, v56, v57
    v_exp_f32 v59, v189
    v_add_f32 v51, v51, v58
    v_exp_f32 v60, v186
    v_add_f32 v51, v51, v59
    v_cvt_pk_bf16_f32 v238, v58, v59
    v_exp_f32 v61, v187
    v_exp_f32 v62, v190
    v_cvt_pk_bf16_f32 v235, v60, v61
    v_exp_f32 v63, v191
    v_add_f32 v51, v51, v62
    v_exp_f32 v56, v192
    v_add_f32 v51, v51, v63
    v_cvt_pk_bf16_f32 v239, v62, v63
    v_exp_f32 v57, v193
    v_exp_f32 v58, v196
    v_cvt_pk_bf16_f32 v16, v56, v57
    v_exp_f32 v59, v197
    v_add_f32 v49, v49, v58
    s_waitcnt lgkmcnt(4)
    v_add_f32 v49, v49, v59
.p2align 6
L_att_loop:
    v_mfma_f32_16x16x32_bf16 v[96:99], a[64:67], a[0:3], v[32:35]
    s_add_u32 s43, s43, s59
    v_exp_f32 v60, v194
    v_mfma_f32_16x16x32_bf16 v[96:99], a[68:71], a[4:7], v[96:99]
    ds_read_b64_tr_b16 a[96:97], v80 offset:16384
    v_cvt_pk_bf16_f32 v20, v58, v59
    v_mfma_f32_16x16x32_bf16 v[96:99], a[72:75], a[8:11], v[96:99]
    s_mul_i32 s57, s43, 3641
    v_exp_f32 v61, v195
    v_mfma_f32_16x16x32_bf16 v[96:99], a[76:79], a[12:15], v[96:99]
    ds_read_b64_tr_b16 a[98:99], v80 offset:20480
    v_cvt_pk_bf16_f32 v17, v60, v61
    v_mfma_f32_16x16x32_bf16 v[100:103], a[76:79], a[28:31], v[36:39]
    s_lshr_b32 s57, s57, 16
    v_exp_f32 v62, v198
    v_mfma_f32_16x16x32_bf16 v[100:103], a[72:75], a[24:27], v[100:103]
    ds_read_b64_tr_b16 a[100:101], v80 offset:24576
    v_add_f32 v49, v49, v62
    v_mfma_f32_16x16x32_bf16 v[100:103], a[68:71], a[20:23], v[100:103]
    s_mul_i32 s57, s57, 35712
    v_exp_f32 v63, v199
    v_mfma_f32_16x16x32_bf16 v[100:103], a[64:67], a[16:19], v[100:103]
    ds_read_b64_tr_b16 a[102:103], v80 offset:28672
    v_add_f32 v49, v49, v63
    v_mfma_f32_16x16x32_bf16 v[104:107], a[64:67], a[32:35], v[40:43]
    s_lshl_b32 s58, s43, 6
    v_exp_f32 v56, v208
    v_mfma_f32_16x16x32_bf16 v[104:107], a[68:71], a[36:39], v[104:107]
    ds_read_b64_tr_b16 a[104:105], v81 offset:16384
    v_cvt_pk_bf16_f32 v21, v62, v63
    v_mfma_f32_16x16x32_bf16 v[104:107], a[72:75], a[40:43], v[104:107]
    s_add_u32 s57, s57, s58
    v_exp_f32 v57, v209
    v_mfma_f32_16x16x32_bf16 v[104:107], a[76:79], a[44:47], v[104:107]
    ds_read_b64_tr_b16 a[106:107], v81 offset:20480
    v_cvt_pk_bf16_f32 v18, v56, v57
    v_mfma_f32_16x16x32_bf16 v[108:111], a[76:79], a[60:63], v[44:47]
    s_lshl_b32 s58, s43, 11
    v_exp_f32 v58, v212
    v_mfma_f32_16x16x32_bf16 v[108:111], a[72:75], a[56:59], v[108:111]
    ds_read_b64_tr_b16 a[108:109], v81 offset:24576
    v_add_f32 v49, v49, v58
    v_mfma_f32_16x16x32_bf16 v[108:111], a[68:71], a[52:55], v[108:111]
    v_exp_f32 v59, v213
    v_mfma_f32_16x16x32_bf16 v[108:111], a[64:67], a[48:51], v[108:111]
    s_waitcnt lgkmcnt(7)
    ds_read_b64_tr_b16 a[110:111], v81 offset:28672
    v_add_f32 v49, v49, v59
    v_mfma_f32_16x16x32_bf16 v[124:127], a[80:83], a[48:51], v[44:47]
    v_exp_f32 v60, v210
    v_mfma_f32_16x16x32_bf16 v[124:127], a[84:87], a[52:55], v[124:127]
    ds_read_b128 a[64:67], v76 offset:8192
    v_cvt_pk_bf16_f32 v22, v58, v59
    v_mfma_f32_16x16x32_bf16 v[124:127], a[88:91], a[56:59], v[124:127]
    s_add_u32 s44, s48, -4096
    v_exp_f32 v61, v211
    v_mfma_f32_16x16x32_bf16 v[124:127], a[92:95], a[60:63], v[124:127]
    s_add_u32 m0, s49, 126976
    ds_read_b128 a[68:71], v77 offset:8192
    v_cvt_pk_bf16_f32 v19, v60, v61
    v_mfma_f32_16x16x32_bf16 v[72:75], v[10:13], v[224:227], 0
    buffer_load_dwordx4 v15, s[24:27], s44 offen lds
    v_mfma_f32_16x16x32_bf16 v[120:123], a[92:95], a[44:47], v[40:43]
    v_exp_f32 v62, v214
    v_mfma_f32_16x16x32_bf16 v[120:123], a[88:91], a[40:43], v[120:123]
    ds_read_b128 a[72:75], v78 offset:8192
    v_add_f32 v49, v49, v62
    v_mfma_f32_16x16x32_bf16 v[120:123], a[84:87], a[36:39], v[120:123]
    s_add_u32 s45, s47, 0
    v_exp_f32 v63, v215
    v_mfma_f32_16x16x32_bf16 v[120:123], a[80:83], a[32:35], v[120:123]
    s_add_u32 m0, s49, 49152
    ds_read_b128 a[76:79], v79 offset:8192
    v_add_f32 v49, v49, v63
    v_mfma_f32_16x16x32_bf16 v[72:75], v[10:13], v[16:19], v[72:75]
    buffer_load_dwordx4 v14, s[20:23], s45 offen lds
    v_mfma_f32_16x16x32_bf16 v[116:119], a[80:83], a[16:19], v[36:39]
    v_exp_f32 v56, v200
    v_mfma_f32_16x16x32_bf16 v[116:119], a[84:87], a[20:23], v[116:119]
    ds_read_b64_tr_b16 a[112:113], v82 offset:16384
    v_cvt_pk_bf16_f32 v23, v62, v63
    v_mfma_f32_16x16x32_bf16 v[116:119], a[88:91], a[24:27], v[116:119]
    v_exp_f32 v57, v201
    v_mfma_f32_16x16x32_bf16 v[116:119], a[92:95], a[28:31], v[116:119]
    ds_read_b64_tr_b16 a[114:115], v82 offset:20480
    v_cvt_pk_bf16_f32 v24, v56, v57
    v_mfma_f32_16x16x32_bf16 v[112:115], a[92:95], a[12:15], v[32:35]
    v_exp_f32 v58, v204
    v_mfma_f32_16x16x32_bf16 v[112:115], a[88:91], a[8:11], v[112:115]
    v_add_f32 v51, v51, v58
    v_add_f32 v48, v52, v72
    v_mfma_f32_16x16x32_bf16 v[112:115], a[84:87], a[4:7], v[112:115]
    v_exp_f32 v59, v205
    v_mfma_f32_16x16x32_bf16 v[112:115], a[80:83], a[0:3], v[112:115]
    s_waitcnt lgkmcnt(2)
    ds_read_b64_tr_b16 a[116:117], v82 offset:24576
    v_add_f32 v51, v51, v59
    v_mfma_f32_16x16x32_bf16 v[128:131], a[64:67], a[0:3], v[32:35]
    v_exp_f32 v60, v202
    v_mfma_f32_16x16x32_bf16 v[128:131], a[68:71], a[4:7], v[128:131]
    ds_read_b128 a[80:83], v76 offset:12288
    v_cvt_pk_bf16_f32 v28, v58, v59
    v_mfma_f32_16x16x32_bf16 v[128:131], a[72:75], a[8:11], v[128:131]
    v_exp_f32 v61, v203
    v_mfma_f32_16x16x32_bf16 v[128:131], a[76:79], a[12:15], v[128:131]
    ds_read_b128 a[84:87], v77 offset:12288
    v_cvt_pk_bf16_f32 v25, v60, v61
    v_mfma_f32_16x16x32_bf16 v[132:135], a[76:79], a[28:31], v[36:39]
    v_exp_f32 v62, v206
    v_mfma_f32_16x16x32_bf16 v[132:135], a[72:75], a[24:27], v[132:135]
    ds_read_b128 a[88:91], v78 offset:12288
    v_add_f32 v51, v51, v62
    v_mfma_f32_16x16x32_bf16 v[132:135], a[68:71], a[20:23], v[132:135]
    v_exp_f32 v63, v207
    v_mfma_f32_16x16x32_bf16 v[132:135], a[64:67], a[16:19], v[132:135]
    s_add_u32 s44, s47, 4096
    ds_read_b128 a[92:95], v79 offset:12288
    v_add_f32 v51, v51, v63
    v_mfma_f32_16x16x32_bf16 v[136:139], a[64:67], a[32:35], v[40:43]
    s_add_u32 m0, s49, 53248
    v_exp_f32 v56, v216
    v_mfma_f32_16x16x32_bf16 v[136:139], a[68:71], a[36:39], v[136:139]
    buffer_load_dwordx4 v14, s[20:23], s44 offen lds
    v_mfma_f32_16x16x32_bf16 v[136:139], a[72:75], a[40:43], v[136:139]
    v_exp_f32 v57, v217
    v_mfma_f32_16x16x32_bf16 v[136:139], a[76:79], a[44:47], v[136:139]
    v_cvt_pk_bf16_f32 v29, v62, v63
    v_cvt_pk_bf16_f32 v26, v56, v57
    v_mfma_f32_16x16x32_bf16 v[140:143], a[76:79], a[60:63], v[44:47]
    v_exp_f32 v58, v220
    v_mfma_f32_16x16x32_bf16 v[140:143], a[72:75], a[56:59], v[140:143]
    ds_read_b64_tr_b16 a[118:119], v82 offset:28672
    v_add_f32 v51, v51, v58
    v_mfma_f32_16x16x32_bf16 v[140:143], a[68:71], a[52:55], v[140:143]
    v_exp_f32 v59, v221
    v_mfma_f32_16x16x32_bf16 v[140:143], a[64:67], a[48:51], v[140:143]
    s_waitcnt lgkmcnt(1)
    ds_read_b64_tr_b16 a[120:121], v83 offset:16384
    v_add_f32 v51, v51, v59
    v_mfma_f32_16x16x32_bf16 v[156:159], a[80:83], a[48:51], v[44:47]
    v_exp_f32 v60, v218
    v_mfma_f32_16x16x32_bf16 v[156:159], a[84:87], a[52:55], v[156:159]
    ds_read_b64_tr_b16 a[122:123], v83 offset:20480
    v_cvt_pk_bf16_f32 v30, v58, v59
    v_mfma_f32_16x16x32_bf16 v[156:159], a[88:91], a[56:59], v[156:159]
    s_add_u32 s45, s47, 8192
    v_exp_f32 v61, v219
    v_mfma_f32_16x16x32_bf16 v[156:159], a[92:95], a[60:63], v[156:159]
    s_add_u32 m0, s49, 57344
    ds_read_b64_tr_b16 a[124:125], v83 offset:24576
    v_cvt_pk_bf16_f32 v27, v60, v61
    v_mfma_f32_16x16x32_bf16 v[72:75], v[10:13], v[232:235], 0
    buffer_load_dwordx4 v14, s[20:23], s45 offen lds
    v_mfma_f32_16x16x32_bf16 v[152:155], a[92:95], a[44:47], v[40:43]
    v_exp_f32 v62, v222
    v_mfma_f32_16x16x32_bf16 v[152:155], a[88:91], a[40:43], v[152:155]
    ds_read_b64_tr_b16 a[126:127], v83 offset:28672
    v_add_f32 v51, v51, v62
    v_mfma_f32_16x16x32_bf16 v[152:155], a[84:87], a[36:39], v[152:155]
    s_add_u32 s44, s47, 12288
    v_exp_f32 v63, v223
    v_mfma_f32_16x16x32_bf16 v[152:155], a[80:83], a[32:35], v[152:155]
    s_add_u32 m0, s49, 61440
    v_add_f32 v51, v51, v63
    v_mfma_f32_16x16x32_bf16 v[72:75], v[10:13], v[24:27], v[72:75]
    buffer_load_dwordx4 v14, s[20:23], s44 offen lds
    v_mfma_f32_16x16x32_bf16 v[148:151], a[80:83], a[16:19], v[36:39]
    v_exp_f32 v56, v96
    v_mfma_f32_16x16x32_bf16 v[148:151], a[84:87], a[20:23], v[148:151]
    v_cvt_pk_bf16_f32 v31, v62, v63
    v_max3_f32 v9, v48, v49, v51
    v_mfma_f32_16x16x32_bf16 v[148:151], a[88:91], a[24:27], v[148:151]
    s_mov_b32 m0, s56
    v_exp_f32 v57, v97
    v_mfma_f32_16x16x32_bf16 v[148:151], a[92:95], a[28:31], v[148:151]
    buffer_load_dwordx4 v2, s[8:11], s57 offen lds
    v_cvt_pk_bf16_f32 v240, v56, v57
    v_add_f32 v50, v54, v72
    v_mfma_f32_16x16x32_bf16 v[144:147], a[92:95], a[12:15], v[32:35]
    s_add_u32 s57, s57, 17408
    v_exp_f32 v58, v100
    v_mfma_f32_16x16x32_bf16 v[144:147], a[88:91], a[8:11], v[144:147]
    v_max_f32 v9, v9, v50
    v_cmp_lt_f32 vcc, s61, v9
    v_mfma_f32_16x16x32_bf16 v[144:147], a[84:87], a[4:7], v[144:147]
    s_waitcnt lgkmcnt(0)
    v_exp_f32 v59, v101
    v_mfma_f32_16x16x32_bf16 v[144:147], a[80:83], a[0:3], v[144:147]
    s_cbranch_vccnz L_rare_stubl0
L_rare_retl0:
    v_add_f32 v53, v49, v58
    v_add_f32 v53, v53, v59
    v_mfma_f32_16x16x32_bf16 a[140:143], a[96:99], v[236:239], a[140:143]
    s_waitcnt vmcnt(15)
    v_exp_f32 v60, v98
    v_mfma_f32_16x16x32_bf16 a[140:143], a[100:103], v[28:31], a[140:143]
    s_barrier
    v_cvt_pk_bf16_f32 v244, v58, v59
    v_mfma_f32_16x16x32_bf16 a[136:139], a[100:103], v[24:27], a[136:139]
    v_exp_f32 v61, v99
    v_mfma_f32_16x16x32_bf16 a[136:139], a[96:99], v[232:235], a[136:139]
    s_add_u32 s45, s48, 0
    buffer_load_dwordx4 v2, s[8:11], s57 offen offset:1024 lds
    v_cvt_pk_bf16_f32 v241, v60, v61
    v_mfma_f32_16x16x32_bf16 a[132:135], a[96:99], v[228:231], a[132:135]
    s_add_u32 m0, s49, 65536
    v_exp_f32 v62, v102
    v_mfma_f32_16x16x32_bf16 a[132:135], a[100:103], v[20:23], a[132:135]
    buffer_load_dwordx4 v15, s[24:27], s45 offen lds
    v_mfma_f32_16x16x32_bf16 a[128:131], a[100:103], v[16:19], a[128:131]
    v_exp_f32 v63, v103
    v_mfma_f32_16x16x32_bf16 a[128:131], a[96:99], v[224:227], a[128:131]
    v_add_f32 v53, v53, v62
    v_add_f32 v53, v53, v63
    v_mfma_f32_16x16x32_bf16 a[144:147], a[104:107], v[224:227], a[144:147]
    v_exp_f32 v56, v112
    v_mfma_f32_16x16x32_bf16 a[144:147], a[108:111], v[16:19], a[144:147]
    ds_read_b64_tr_b16 a[96:97], v84 offset:16384
    v_cvt_pk_bf16_f32 v245, v62, v63
    v_mfma_f32_16x16x32_bf16 a[148:151], a[108:111], v[20:23], a[148:151]
    v_exp_f32 v57, v113
    v_mfma_f32_16x16x32_bf16 a[148:151], a[104:107], v[228:231], a[148:151]
    ds_read_b64_tr_b16 a[98:99], v84 offset:20480
    v_cvt_pk_bf16_f32 v242, v56, v57
    v_mfma_f32_16x16x32_bf16 a[152:155], a[104:107], v[232:235], a[152:155]
    v_exp_f32 v58, v116
    v_mfma_f32_16x16x32_bf16 a[152:155], a[108:111], v[24:27], a[152:155]
    ds_read_b64_tr_b16 a[100:101], v84 offset:24576
    v_add_f32 v53, v53, v58
    v_mfma_f32_16x16x32_bf16 a[156:159], a[108:111], v[28:31], a[156:159]
    v_exp_f32 v59, v117
    v_mfma_f32_16x16x32_bf16 a[156:159], a[104:107], v[236:239], a[156:159]
    ds_read_b64_tr_b16 a[102:103], v84 offset:28672
    v_add_f32 v53, v53, v59
    v_mfma_f32_16x16x32_bf16 a[172:175], a[112:115], v[236:239], a[172:175]
    v_exp_f32 v60, v114
    v_mfma_f32_16x16x32_bf16 a[172:175], a[116:119], v[28:31], a[172:175]
    ds_read_b64_tr_b16 a[104:105], v85 offset:16384
    v_cvt_pk_bf16_f32 v246, v58, v59
    v_mfma_f32_16x16x32_bf16 a[168:171], a[116:119], v[24:27], a[168:171]
    v_exp_f32 v61, v115
    v_mfma_f32_16x16x32_bf16 a[168:171], a[112:115], v[232:235], a[168:171]
    ds_read_b64_tr_b16 a[106:107], v85 offset:20480
    v_cvt_pk_bf16_f32 v243, v60, v61
    v_mfma_f32_16x16x32_bf16 a[164:167], a[112:115], v[228:231], a[164:167]
    v_exp_f32 v62, v118
    v_mfma_f32_16x16x32_bf16 a[164:167], a[116:119], v[20:23], a[164:167]
    ds_read_b64_tr_b16 a[108:109], v85 offset:24576
    v_add_f32 v53, v53, v62
    v_mfma_f32_16x16x32_bf16 a[160:163], a[116:119], v[16:19], a[160:163]
    v_exp_f32 v63, v119
    v_mfma_f32_16x16x32_bf16 a[160:163], a[112:115], v[224:227], a[160:163]
    ds_read_b64_tr_b16 a[110:111], v85 offset:28672
    v_add_f32 v53, v53, v63
    v_mfma_f32_16x16x32_bf16 a[176:179], a[120:123], v[224:227], a[176:179]
    v_exp_f32 v56, v104
    v_mfma_f32_16x16x32_bf16 a[176:179], a[124:127], v[16:19], a[176:179]
    ds_read_b64_tr_b16 a[112:113], v86 offset:16384
    v_cvt_pk_bf16_f32 v247, v62, v63
    v_mfma_f32_16x16x32_bf16 a[180:183], a[124:127], v[20:23], a[180:183]
    v_exp_f32 v57, v105
    v_mfma_f32_16x16x32_bf16 a[180:183], a[120:123], v[228:231], a[180:183]
    ds_read_b64_tr_b16 a[114:115], v86 offset:20480
    v_cvt_pk_bf16_f32 v248, v56, v57
    v_mfma_f32_16x16x32_bf16 a[184:187], a[120:123], v[232:235], a[184:187]
    v_exp_f32 v58, v108
    v_mfma_f32_16x16x32_bf16 a[184:187], a[124:127], v[24:27], a[184:187]
    ds_read_b64_tr_b16 a[116:117], v86 offset:24576
    v_add_f32 v55, v51, v58
    v_mfma_f32_16x16x32_bf16 a[188:191], a[124:127], v[28:31], a[188:191]
    v_exp_f32 v59, v109
    v_mfma_f32_16x16x32_bf16 a[188:191], a[120:123], v[236:239], a[188:191]
    s_waitcnt lgkmcnt(7)
    ds_read_b64_tr_b16 a[118:119], v86 offset:28672
    v_add_f32 v55, v55, v59
    v_mfma_f32_16x16x32_bf16 a[204:207], a[96:99], v[236:239], a[204:207]
    v_exp_f32 v60, v106
    v_mfma_f32_16x16x32_bf16 a[204:207], a[100:103], v[28:31], a[204:207]
    ds_read_b64_tr_b16 a[120:121], v87 offset:16384
    v_cvt_pk_bf16_f32 v252, v58, v59
    v_mfma_f32_16x16x32_bf16 a[200:203], a[100:103], v[24:27], a[200:203]
    v_exp_f32 v61, v107
    v_mfma_f32_16x16x32_bf16 a[200:203], a[96:99], v[232:235], a[200:203]
    ds_read_b64_tr_b16 a[122:123], v87 offset:20480
    v_cvt_pk_bf16_f32 v249, v60, v61
    v_mfma_f32_16x16x32_bf16 a[196:199], a[96:99], v[228:231], a[196:199]
    v_exp_f32 v62, v110
    v_mfma_f32_16x16x32_bf16 a[196:199], a[100:103], v[20:23], a[196:199]
    ds_read_b64_tr_b16 a[124:125], v87 offset:24576
    v_add_f32 v55, v55, v62
    v_mfma_f32_16x16x32_bf16 a[192:195], a[100:103], v[16:19], a[192:195]
    v_exp_f32 v63, v111
    v_mfma_f32_16x16x32_bf16 a[192:195], a[96:99], v[224:227], a[192:195]
    s_waitcnt lgkmcnt(7)
    ds_read_b64_tr_b16 a[126:127], v87 offset:28672
    v_add_f32 v55, v55, v63
    v_mfma_f32_16x16x32_bf16 a[208:211], a[104:107], v[224:227], a[208:211]
    v_exp_f32 v56, v120
    v_mfma_f32_16x16x32_bf16 a[208:211], a[108:111], v[16:19], a[208:211]
    ds_read_b128 a[64:67], v76 offset:16384
    v_cvt_pk_bf16_f32 v253, v62, v63
    v_mfma_f32_16x16x32_bf16 a[212:215], a[108:111], v[20:23], a[212:215]
    v_exp_f32 v57, v121
    v_mfma_f32_16x16x32_bf16 a[212:215], a[104:107], v[228:231], a[212:215]
    ds_read_b128 a[68:71], v77 offset:16384
    v_cvt_pk_bf16_f32 v250, v56, v57
    v_mfma_f32_16x16x32_bf16 a[216:219], a[104:107], v[232:235], a[216:219]
    v_exp_f32 v58, v124
    v_mfma_f32_16x16x32_bf16 a[216:219], a[108:111], v[24:27], a[216:219]
    ds_read_b128 a[72:75], v78 offset:16384
    v_add_f32 v55, v55, v58
    v_mfma_f32_16x16x32_bf16 a[220:223], a[108:111], v[28:31], a[220:223]
    v_exp_f32 v59, v125
    v_mfma_f32_16x16x32_bf16 a[220:223], a[104:107], v[236:239], a[220:223]
    s_waitcnt lgkmcnt(7)
    ds_read_b128 a[76:79], v79 offset:16384
    v_add_f32 v55, v55, v59
    v_mfma_f32_16x16x32_bf16 a[236:239], a[112:115], v[236:239], a[236:239]
    v_exp_f32 v60, v122
    v_mfma_f32_16x16x32_bf16 a[236:239], a[116:119], v[28:31], a[236:239]
    ds_read_b128 a[80:83], v76 offset:20480
    v_cvt_pk_bf16_f32 v254, v58, v59
    v_mfma_f32_16x16x32_bf16 a[232:235], a[116:119], v[24:27], a[232:235]
    v_exp_f32 v61, v123
    v_mfma_f32_16x16x32_bf16 a[232:235], a[112:115], v[232:235], a[232:235]
    ds_read_b128 a[84:87], v77 offset:20480
    v_cvt_pk_bf16_f32 v251, v60, v61
    v_mfma_f32_16x16x32_bf16 a[228:231], a[112:115], v[228:231], a[228:231]
    v_exp_f32 v62, v126
    v_mfma_f32_16x16x32_bf16 a[228:231], a[116:119], v[20:23], a[228:231]
    ds_read_b128 a[88:91], v78 offset:20480
    v_add_f32 v55, v55, v62
    v_mfma_f32_16x16x32_bf16 a[224:227], a[116:119], v[16:19], a[224:227]
    s_add_u32 s44, s48, 4096
    v_exp_f32 v63, v127
    v_mfma_f32_16x16x32_bf16 a[224:227], a[112:115], v[224:227], a[224:227]
    s_waitcnt lgkmcnt(7)
    ds_read_b128 a[92:95], v79 offset:20480
    v_add_f32 v55, v55, v63
    v_mfma_f32_16x16x32_bf16 a[240:243], a[120:123], v[224:227], a[240:243]
    s_add_u32 m0, s49, 69632
    v_exp_f32 v56, v128
    v_mfma_f32_16x16x32_bf16 a[240:243], a[124:127], v[16:19], a[240:243]
    s_waitcnt lgkmcnt(4)
    buffer_load_dwordx4 v15, s[24:27], s44 offen lds
    v_mfma_f32_16x16x32_bf16 a[244:247], a[124:127], v[20:23], a[244:247]
    v_exp_f32 v57, v129
    v_mfma_f32_16x16x32_bf16 a[244:247], a[120:123], v[228:231], a[244:247]
    s_add_u32 s45, s48, 8192
    v_cvt_pk_bf16_f32 v255, v62, v63
    v_cvt_pk_bf16_f32 v16, v56, v57
    v_mfma_f32_16x16x32_bf16 a[248:251], a[120:123], v[232:235], a[248:251]
    s_add_u32 m0, s49, 73728
    v_exp_f32 v58, v132
    v_mfma_f32_16x16x32_bf16 a[248:251], a[124:127], v[24:27], a[248:251]
    s_add_u32 s47, s47, 16384
    buffer_load_dwordx4 v15, s[24:27], s45 offen lds
    v_mfma_f32_16x16x32_bf16 a[252:255], a[124:127], v[28:31], a[252:255]
    s_add_u32 s48, s48, 16384
    v_exp_f32 v59, v133
    v_mfma_f32_16x16x32_bf16 a[252:255], a[120:123], v[236:239], a[252:255]
    v_add_f32 v53, v53, v58
    v_add_f32 v53, v53, v59
    v_mfma_f32_16x16x32_bf16 v[160:163], a[64:67], a[0:3], v[32:35]
    v_exp_f32 v60, v130
    v_mfma_f32_16x16x32_bf16 v[160:163], a[68:71], a[4:7], v[160:163]
    ds_read_b64_tr_b16 a[96:97], v80 offset:32768
    v_cvt_pk_bf16_f32 v20, v58, v59
    v_mfma_f32_16x16x32_bf16 v[160:163], a[72:75], a[8:11], v[160:163]
    v_exp_f32 v61, v131
    v_mfma_f32_16x16x32_bf16 v[160:163], a[76:79], a[12:15], v[160:163]
    ds_read_b64_tr_b16 a[98:99], v80 offset:36864
    v_cvt_pk_bf16_f32 v17, v60, v61
    v_mfma_f32_16x16x32_bf16 v[164:167], a[76:79], a[28:31], v[36:39]
    v_exp_f32 v62, v134
    v_mfma_f32_16x16x32_bf16 v[164:167], a[72:75], a[24:27], v[164:167]
    ds_read_b64_tr_b16 a[100:101], v80 offset:40960
    v_add_f32 v53, v53, v62
    v_mfma_f32_16x16x32_bf16 v[164:167], a[68:71], a[20:23], v[164:167]
    v_exp_f32 v63, v135
    v_mfma_f32_16x16x32_bf16 v[164:167], a[64:67], a[16:19], v[164:167]
    ds_read_b64_tr_b16 a[102:103], v80 offset:45056
    v_add_f32 v53, v53, v63
    v_mfma_f32_16x16x32_bf16 v[168:171], a[64:67], a[32:35], v[40:43]
    v_exp_f32 v56, v144
    v_mfma_f32_16x16x32_bf16 v[168:171], a[68:71], a[36:39], v[168:171]
    ds_read_b64_tr_b16 a[104:105], v81 offset:32768
    v_cvt_pk_bf16_f32 v21, v62, v63
    v_mfma_f32_16x16x32_bf16 v[168:171], a[72:75], a[40:43], v[168:171]
    v_exp_f32 v57, v145
    v_mfma_f32_16x16x32_bf16 v[168:171], a[76:79], a[44:47], v[168:171]
    ds_read_b64_tr_b16 a[106:107], v81 offset:36864
    v_cvt_pk_bf16_f32 v18, v56, v57
    v_mfma_f32_16x16x32_bf16 v[172:175], a[76:79], a[60:63], v[44:47]
    v_exp_f32 v58, v148
    v_mfma_f32_16x16x32_bf16 v[172:175], a[72:75], a[56:59], v[172:175]
    ds_read_b64_tr_b16 a[108:109], v81 offset:40960
    v_add_f32 v53, v53, v58
    v_mfma_f32_16x16x32_bf16 v[172:175], a[68:71], a[52:55], v[172:175]
    v_exp_f32 v59, v149
    v_mfma_f32_16x16x32_bf16 v[172:175], a[64:67], a[48:51], v[172:175]
    s_waitcnt lgkmcnt(7)
    ds_read_b64_tr_b16 a[110:111], v81 offset:45056
    v_add_f32 v53, v53, v59
    v_mfma_f32_16x16x32_bf16 v[188:191], a[80:83], a[48:51], v[44:47]
    v_exp_f32 v60, v146
    v_mfma_f32_16x16x32_bf16 v[188:191], a[84:87], a[52:55], v[188:191]
    ds_read_b128 a[64:67], v76 offset:24576
    v_cvt_pk_bf16_f32 v22, v58, v59
    v_mfma_f32_16x16x32_bf16 v[188:191], a[88:91], a[56:59], v[188:191]
    s_add_u32 s44, s48, -4096
    v_exp_f32 v61, v147
    v_mfma_f32_16x16x32_bf16 v[188:191], a[92:95], a[60:63], v[188:191]
    s_add_u32 m0, s49, 77824
    ds_read_b128 a[68:71], v77 offset:24576
    v_cvt_pk_bf16_f32 v19, v60, v61
    v_mfma_f32_16x16x32_bf16 v[72:75], v[10:13], v[240:243], 0
L_pad6:
    s_cbranch_execz L_pad9
    buffer_load_dwordx4 v15, s[24:27], s44 offen lds
    v_mfma_f32_16x16x32_bf16 v[184:187], a[92:95], a[44:47], v[40:43]
    v_exp_f32 v62, v150
    v_mfma_f32_16x16x32_bf16 v[184:187], a[88:91], a[40:43], v[184:187]
    ds_read_b128 a[72:75], v78 offset:24576
    v_add_f32 v53, v53, v62
    v_mfma_f32_16x16x32_bf16 v[184:187], a[84:87], a[36:39], v[184:187]
    s_add_u32 s45, s47, 0
    v_exp_f32 v63, v151
    v_mfma_f32_16x16x32_bf16 v[184:187], a[80:83], a[32:35], v[184:187]
    s_add_u32 m0, s49, 0
    ds_read_b128 a[76:79], v79 offset:24576
    v_add_f32 v53, v53, v63
    v_mfma_f32_16x16x32_bf16 v[72:75], v[10:13], v[16:19], v[72:75]
    buffer_load_dwordx4 v14, s[20:23], s45 offen lds
    v_mfma_f32_16x16x32_bf16 v[180:183], a[80:83], a[16:19], v[36:39]
    v_exp_f32 v56, v136
    v_mfma_f32_16x16x32_bf16 v[180:183], a[84:87], a[20:23], v[180:183]
    ds_read_b64_tr_b16 a[112:113], v82 offset:32768
    v_cvt_pk_bf16_f32 v23, v62, v63
    v_mfma_f32_16x16x32_bf16 v[180:183], a[88:91], a[24:27], v[180:183]
    v_exp_f32 v57, v137
    v_mfma_f32_16x16x32_bf16 v[180:183], a[92:95], a[28:31], v[180:183]
    ds_read_b64_tr_b16 a[114:115], v82 offset:36864
    v_cvt_pk_bf16_f32 v24, v56, v57
    v_mfma_f32_16x16x32_bf16 v[176:179], a[92:95], a[12:15], v[32:35]
    v_exp_f32 v58, v140
    v_mfma_f32_16x16x32_bf16 v[176:179], a[88:91], a[8:11], v[176:179]
    v_add_f32 v55, v55, v58
    v_add_f32 v52, v48, v72
    v_mfma_f32_16x16x32_bf16 v[176:179], a[84:87], a[4:7], v[176:179]
    v_exp_f32 v59, v141
    v_mfma_f32_16x16x32_bf16 v[176:179], a[80:83], a[0:3], v[176:179]
    s_waitcnt lgkmcnt(2)
    ds_read_b64_tr_b16 a[116:117], v82 offset:40960
    v_add_f32 v55, v55, v59
    v_mfma_f32_16x16x32_bf16 v[192:195], a[64:67], a[0:3], v[32:35]
    v_exp_f32 v60, v138
    v_mfma_f32_16x16x32_bf16 v[192:195], a[68:71], a[4:7], v[192:195]
    ds_read_b128 a[80:83], v76 offset:28672
    v_cvt_pk_bf16_f32 v28, v58, v59
    v_mfma_f32_16x16x32_bf16 v[192:195], a[72:75], a[8:11], v[192:195]
    v_exp_f32 v61, v139
    v_mfma_f32_16x16x32_bf16 v[192:195], a[76:79], a[12:15], v[192:195]
    ds_read_b128 a[84:87], v77 offset:28672
    v_cvt_pk_bf16_f32 v25, v60, v61
    v_mfma_f32_16x16x32_bf16 v[196:199], a[76:79], a[28:31], v[36:39]
    v_exp_f32 v62, v142
    v_mfma_f32_16x16x32_bf16 v[196:199], a[72:75], a[24:27], v[196:199]
    ds_read_b128 a[88:91], v78 offset:28672
    v_add_f32 v55, v55, v62
    v_mfma_f32_16x16x32_bf16 v[196:199], a[68:71], a[20:23], v[196:199]
    v_exp_f32 v63, v143
    v_mfma_f32_16x16x32_bf16 v[196:199], a[64:67], a[16:19], v[196:199]
    s_add_u32 s44, s47, 4096
    ds_read_b128 a[92:95], v79 offset:28672
    v_add_f32 v55, v55, v63
    v_mfma_f32_16x16x32_bf16 v[200:203], a[64:67], a[32:35], v[40:43]
    s_add_u32 m0, s49, 4096
    v_exp_f32 v56, v152
    v_mfma_f32_16x16x32_bf16 v[200:203], a[68:71], a[36:39], v[200:203]
    buffer_load_dwordx4 v14, s[20:23], s44 offen lds
    v_mfma_f32_16x16x32_bf16 v[200:203], a[72:75], a[40:43], v[200:203]
    v_exp_f32 v57, v153
    v_mfma_f32_16x16x32_bf16 v[200:203], a[76:79], a[44:47], v[200:203]
    v_cvt_pk_bf16_f32 v29, v62, v63
    v_cvt_pk_bf16_f32 v26, v56, v57
    v_mfma_f32_16x16x32_bf16 v[204:207], a[76:79], a[60:63], v[44:47]
    v_exp_f32 v58, v156
    v_mfma_f32_16x16x32_bf16 v[204:207], a[72:75], a[56:59], v[204:207]
    ds_read_b64_tr_b16 a[118:119], v82 offset:45056
    v_add_f32 v55, v55, v58
    v_mfma_f32_16x16x32_bf16 v[204:207], a[68:71], a[52:55], v[204:207]
    v_exp_f32 v59, v157
    v_mfma_f32_16x16x32_bf16 v[204:207], a[64:67], a[48:51], v[204:207]
    s_waitcnt lgkmcnt(1)
    ds_read_b64_tr_b16 a[120:121], v83 offset:32768
    v_add_f32 v55, v55, v59
    v_mfma_f32_16x16x32_bf16 v[220:223], a[80:83], a[48:51], v[44:47]
    v_exp_f32 v60, v154
    v_mfma_f32_16x16x32_bf16 v[220:223], a[84:87], a[52:55], v[220:223]
    ds_read_b64_tr_b16 a[122:123], v83 offset:36864
    v_cvt_pk_bf16_f32 v30, v58, v59
    v_mfma_f32_16x16x32_bf16 v[220:223], a[88:91], a[56:59], v[220:223]
    s_add_u32 s45, s47, 8192
    v_exp_f32 v61, v155
    v_mfma_f32_16x16x32_bf16 v[220:223], a[92:95], a[60:63], v[220:223]
    s_add_u32 m0, s49, 8192
    ds_read_b64_tr_b16 a[124:125], v83 offset:40960
    v_cvt_pk_bf16_f32 v27, v60, v61
    v_mfma_f32_16x16x32_bf16 v[72:75], v[10:13], v[248:251], 0
    buffer_load_dwordx4 v14, s[20:23], s45 offen lds
    v_mfma_f32_16x16x32_bf16 v[216:219], a[92:95], a[44:47], v[40:43]
    v_exp_f32 v62, v158
    v_mfma_f32_16x16x32_bf16 v[216:219], a[88:91], a[40:43], v[216:219]
    ds_read_b64_tr_b16 a[126:127], v83 offset:45056
    v_add_f32 v55, v55, v62
    v_mfma_f32_16x16x32_bf16 v[216:219], a[84:87], a[36:39], v[216:219]
    s_add_u32 s44, s47, 12288
    v_exp_f32 v63, v159
    v_mfma_f32_16x16x32_bf16 v[216:219], a[80:83], a[32:35], v[216:219]
    s_add_u32 m0, s49, 12288
    v_add_f32 v55, v55, v63
    v_mfma_f32_16x16x32_bf16 v[72:75], v[10:13], v[24:27], v[72:75]
    buffer_load_dwordx4 v14, s[20:23], s44 offen lds
    v_mfma_f32_16x16x32_bf16 v[212:215], a[80:83], a[16:19], v[36:39]
    v_exp_f32 v56, v160
    v_mfma_f32_16x16x32_bf16 v[212:215], a[84:87], a[20:23], v[212:215]
    v_cvt_pk_bf16_f32 v31, v62, v63
    v_max3_f32 v9, v52, v53, v55
    v_mfma_f32_16x16x32_bf16 v[212:215], a[88:91], a[24:27], v[212:215]
    v_exp_f32 v57, v161
    v_mfma_f32_16x16x32_bf16 v[212:215], a[92:95], a[28:31], v[212:215]
    v_cvt_pk_bf16_f32 v224, v56, v57
    v_add_f32 v54, v50, v72
    v_mfma_f32_16x16x32_bf16 v[208:211], a[92:95], a[12:15], v[32:35]
    v_exp_f32 v58, v164
    v_mfma_f32_16x16x32_bf16 v[208:211], a[88:91], a[8:11], v[208:211]
    v_max_f32 v9, v9, v54
    v_cmp_lt_f32 vcc, s61, v9
    v_mfma_f32_16x16x32_bf16 v[208:211], a[84:87], a[4:7], v[208:211]
    s_waitcnt lgkmcnt(0)
    v_exp_f32 v59, v165
    v_mfma_f32_16x16x32_bf16 v[208:211], a[80:83], a[0:3], v[208:211]
    s_cbranch_vccnz L_rare_stubl1
L_rare_retl1:
    v_add_f32 v49, v53, v58
    v_add_f32 v49, v49, v59
    v_mfma_f32_16x16x32_bf16 a[140:143], a[96:99], v[252:255], a[140:143]
    s_waitcnt vmcnt(14)
    v_exp_f32 v60, v162
    v_mfma_f32_16x16x32_bf16 a[140:143], a[100:103], v[28:31], a[140:143]
    s_barrier
    v_cvt_pk_bf16_f32 v228, v58, v59
    v_mfma_f32_16x16x32_bf16 a[136:139], a[100:103], v[24:27], a[136:139]
    v_exp_f32 v61, v163
    v_mfma_f32_16x16x32_bf16 a[136:139], a[96:99], v[248:251], a[136:139]
    s_add_u32 s45, s48, 0
    v_cvt_pk_bf16_f32 v225, v60, v61
    v_mfma_f32_16x16x32_bf16 a[132:135], a[96:99], v[244:247], a[132:135]
    s_add_u32 m0, s49, 81920
    v_exp_f32 v62, v166
    v_mfma_f32_16x16x32_bf16 a[132:135], a[100:103], v[20:23], a[132:135]
    buffer_load_dwordx4 v15, s[24:27], s45 offen lds
    v_mfma_f32_16x16x32_bf16 a[128:131], a[100:103], v[16:19], a[128:131]
    v_exp_f32 v63, v167
    v_mfma_f32_16x16x32_bf16 a[128:131], a[96:99], v[240:243], a[128:131]
    v_add_f32 v49, v49, v62
    v_add_f32 v49, v49, v63
    v_mfma_f32_16x16x32_bf16 a[144:147], a[104:107], v[240:243], a[144:147]
    v_exp_f32 v56, v176
    v_mfma_f32_16x16x32_bf16 a[144:147], a[108:111], v[16:19], a[144:147]
    ds_read_b64_tr_b16 a[96:97], v84 offset:32768
    v_cvt_pk_bf16_f32 v229, v62, v63
    v_mfma_f32_16x16x32_bf16 a[148:151], a[108:111], v[20:23], a[148:151]
    s_cmp_le_u32 s52, 2
    v_exp_f32 v57, v177
    v_mfma_f32_16x16x32_bf16 a[148:151], a[104:107], v[244:247], a[148:151]
    s_cselect_b32 s78, 2, 1
    ds_read_b64_tr_b16 a[98:99], v84 offset:36864
    v_cvt_pk_bf16_f32 v226, v56, v57
    v_mfma_f32_16x16x32_bf16 a[152:155], a[104:107], v[248:251], a[152:155]
    s_add_u32 s78, s78, s69
    v_exp_f32 v58, v180
    v_mfma_f32_16x16x32_bf16 a[152:155], a[108:111], v[24:27], a[152:155]
    ds_read_b64_tr_b16 a[100:101], v84 offset:40960
    v_add_f32 v49, v49, v58
    v_mov_b32 v6, s78
    v_mfma_f32_16x16x32_bf16 a[156:159], a[108:111], v[28:31], a[156:159]
    v_exp_f32 v59, v181
    v_mfma_f32_16x16x32_bf16 a[156:159], a[104:107], v[252:255], a[156:159]
    ds_read_b64_tr_b16 a[102:103], v84 offset:45056
    v_add_f32 v49, v49, v59
    v_mfma_f32_16x16x32_bf16 a[172:175], a[112:115], v[252:255], a[172:175]
    s_cmp_lg_u32 s72, 0
    v_exp_f32 v60, v178
    v_mfma_f32_16x16x32_bf16 a[172:175], a[116:119], v[28:31], a[172:175]
    s_cbranch_scc1 L_stub_w2
L_ret_w2:
    ds_read_b64_tr_b16 a[104:105], v85 offset:32768
    v_cvt_pk_bf16_f32 v230, v58, v59
    v_mfma_f32_16x16x32_bf16 a[168:171], a[116:119], v[24:27], a[168:171]
    v_exp_f32 v61, v179
    v_mfma_f32_16x16x32_bf16 a[168:171], a[112:115], v[248:251], a[168:171]
    ds_read_b64_tr_b16 a[106:107], v85 offset:36864
    v_cvt_pk_bf16_f32 v227, v60, v61
    v_mfma_f32_16x16x32_bf16 a[164:167], a[112:115], v[244:247], a[164:167]
    buffer_store_dwordx2 v[6:7], v0, s[28:31], s73 offen sc1
    v_exp_f32 v62, v182
    v_mfma_f32_16x16x32_bf16 a[164:167], a[116:119], v[20:23], a[164:167]
    ds_read_b64_tr_b16 a[108:109], v85 offset:40960
    v_add_f32 v49, v49, v62
    v_mfma_f32_16x16x32_bf16 a[160:163], a[116:119], v[16:19], a[160:163]
    v_exp_f32 v63, v183
    v_mfma_f32_16x16x32_bf16 a[160:163], a[112:115], v[240:243], a[160:163]
    ds_read_b64_tr_b16 a[110:111], v85 offset:45056
    v_add_f32 v49, v49, v63
    v_mfma_f32_16x16x32_bf16 a[176:179], a[120:123], v[240:243], a[176:179]
    v_exp_f32 v56, v168
    v_mfma_f32_16x16x32_bf16 a[176:179], a[124:127], v[16:19], a[176:179]
    ds_read_b64_tr_b16 a[112:113], v86 offset:32768
    v_cvt_pk_bf16_f32 v231, v62, v63
    v_mfma_f32_16x16x32_bf16 a[180:183], a[124:127], v[20:23], a[180:183]
    v_exp_f32 v57, v169
    v_mfma_f32_16x16x32_bf16 a[180:183], a[120:123], v[244:247], a[180:183]
    ds_read_b64_tr_b16 a[114:115], v86 offset:36864
    v_cvt_pk_bf16_f32 v232, v56, v57
    v_mfma_f32_16x16x32_bf16 a[184:187], a[120:123], v[248:251], a[184:187]
    v_exp_f32 v58, v172
    v_mfma_f32_16x16x32_bf16 a[184:187], a[124:127], v[24:27], a[184:187]
    ds_read_b64_tr_b16 a[116:117], v86 offset:40960
    v_add_f32 v51, v55, v58
    v_mfma_f32_16x16x32_bf16 a[188:191], a[124:127], v[28:31], a[188:191]
    v_exp_f32 v59, v173
    v_mfma_f32_16x16x32_bf16 a[188:191], a[120:123], v[252:255], a[188:191]
    s_waitcnt lgkmcnt(7)
    ds_read_b64_tr_b16 a[118:119], v86 offset:45056
    v_add_f32 v51, v51, v59
    v_mfma_f32_16x16x32_bf16 a[204:207], a[96:99], v[252:255], a[204:207]
    v_exp_f32 v60, v170
    v_mfma_f32_16x16x32_bf16 a[204:207], a[100:103], v[28:31], a[204:207]
    ds_read_b64_tr_b16 a[120:121], v87 offset:32768
    v_cvt_pk_bf16_f32 v236, v58, v59
    v_mfma_f32_16x16x32_bf16 a[200:203], a[100:103], v[24:27], a[200:203]
    v_exp_f32 v61, v171
    v_mfma_f32_16x16x32_bf16 a[200:203], a[96:99], v[248:251], a[200:203]
    ds_read_b64_tr_b16 a[122:123], v87 offset:36864
    v_cvt_pk_bf16_f32 v233, v60, v61
    v_mfma_f32_16x16x32_bf16 a[196:199], a[96:99], v[244:247], a[196:199]
    v_exp_f32 v62, v174
    v_mfma_f32_16x16x32_bf16 a[196:199], a[100:103], v[20:23], a[196:199]
    ds_read_b64_tr_b16 a[124:125], v87 offset:40960
    v_add_f32 v51, v51, v62
    v_mfma_f32_16x16x32_bf16 a[192:195], a[100:103], v[16:19], a[192:195]
    v_exp_f32 v63, v175
    v_mfma_f32_16x16x32_bf16 a[192:195], a[96:99], v[240:243], a[192:195]
    s_waitcnt lgkmcnt(7)
    ds_read_b64_tr_b16 a[126:127], v87 offset:45056
    v_add_f32 v51, v51, v63
    v_mfma_f32_16x16x32_bf16 a[208:211], a[104:107], v[240:243], a[208:211]
    v_exp_f32 v56, v184
    v_mfma_f32_16x16x32_bf16 a[208:211], a[108:111], v[16:19], a[208:211]
    ds_read_b128 a[64:67], v76 offset:32768
    v_cvt_pk_bf16_f32 v237, v62, v63
    v_mfma_f32_16x16x32_bf16 a[212:215], a[108:111], v[20:23], a[212:215]
    v_exp_f32 v57, v185
    v_mfma_f32_16x16x32_bf16 a[212:215], a[104:107], v[244:247], a[212:215]
    ds_read_b128 a[68:71], v77 offset:32768
    v_cvt_pk_bf16_f32 v234, v56, v57
    v_mfma_f32_16x16x32_bf16 a[216:219], a[104:107], v[248:251], a[216:219]
    v_exp_f32 v58, v188
    v_mfma_f32_16x16x32_bf16 a[216:219], a[108:111], v[24:27], a[216:219]
    ds_read_b128 a[72:75], v78 offset:32768
    v_add_f32 v51, v51, v58
    v_mfma_f32_16x16x32_bf16 a[220:223], a[108:111], v[28:31], a[220:223]
    v_exp_f32 v59, v189
    v_mfma_f32_16x16x32_bf16 a[220:223], a[104:107], v[252:255], a[220:223]
    s_waitcnt lgkmcnt(7)
    ds_read_b128 a[76:79], v79 offset:32768
    v_add_f32 v51, v51, v59
    v_mfma_f32_16x16x32_bf16 a[236:239], a[112:115], v[252:255], a[236:239]
    v_exp_f32 v60, v186
    v_mfma_f32_16x16x32_bf16 a[236:239], a[116:119], v[28:31], a[236:239]
    ds_read_b128 a[80:83], v76 offset:36864
    v_cvt_pk_bf16_f32 v238, v58, v59
    v_mfma_f32_16x16x32_bf16 a[232:235], a[116:119], v[24:27], a[232:235]
    v_exp_f32 v61, v187
    v_mfma_f32_16x16x32_bf16 a[232:235], a[112:115], v[248:251], a[232:235]
    ds_read_b128 a[84:87], v77 offset:36864
    v_cvt_pk_bf16_f32 v235, v60, v61
    v_mfma_f32_16x16x32_bf16 a[228:231], a[112:115], v[244:247], a[228:231]
    v_exp_f32 v62, v190
    v_mfma_f32_16x16x32_bf16 a[228:231], a[116:119], v[20:23], a[228:231]
    ds_read_b128 a[88:91], v78 offset:36864
    v_add_f32 v51, v51, v62
    v_mfma_f32_16x16x32_bf16 a[224:227], a[116:119], v[16:19], a[224:227]
    s_add_u32 s44, s48, 4096
    v_exp_f32 v63, v191
    v_mfma_f32_16x16x32_bf16 a[224:227], a[112:115], v[240:243], a[224:227]
    s_waitcnt lgkmcnt(7)
    ds_read_b128 a[92:95], v79 offset:36864
    v_add_f32 v51, v51, v63
    v_mfma_f32_16x16x32_bf16 a[240:243], a[120:123], v[240:243], a[240:243]
    s_add_u32 m0, s49, 86016
    v_exp_f32 v56, v192
    v_mfma_f32_16x16x32_bf16 a[240:243], a[124:127], v[16:19], a[240:243]
    s_waitcnt lgkmcnt(4)
    buffer_load_dwordx4 v15, s[24:27], s44 offen lds
    v_mfma_f32_16x16x32_bf16 a[244:247], a[124:127], v[20:23], a[244:247]
    v_exp_f32 v57, v193
    v_mfma_f32_16x16x32_bf16 a[244:247], a[120:123], v[244:247], a[244:247]
    s_add_u32 s45, s48, 8192
    v_cvt_pk_bf16_f32 v239, v62, v63
    v_cvt_pk_bf16_f32 v16, v56, v57
    v_mfma_f32_16x16x32_bf16 a[248:251], a[120:123], v[248:251], a[248:251]
    s_add_u32 m0, s49, 90112
    v_exp_f32 v58, v196
    v_mfma_f32_16x16x32_bf16 a[248:251], a[124:127], v[24:27], a[248:251]
    s_add_u32 s47, s47, 16384
    buffer_load_dwordx4 v15, s[24:27], s45 offen lds
    v_mfma_f32_16x16x32_bf16 a[252:255], a[124:127], v[28:31], a[252:255]
    s_add_u32 s48, s48, 16384
    v_exp_f32 v59, v197
    v_mfma_f32_16x16x32_bf16 a[252:255], a[120:123], v[252:255], a[252:255]
    v_add_f32 v49, v49, v58
    v_add_f32 v49, v49, v59
    v_mfma_f32_16x16x32_bf16 v[96:99], a[64:67], a[0:3], v[32:35]
    v_exp_f32 v60, v194
    v_mfma_f32_16x16x32_bf16 v[96:99], a[68:71], a[4:7], v[96:99]
    ds_read_b64_tr_b16 a[96:97], v80 offset:49152
    v_cvt_pk_bf16_f32 v20, v58, v59
    v_mfma_f32_16x16x32_bf16 v[96:99], a[72:75], a[8:11], v[96:99]
    v_exp_f32 v61, v195
    v_mfma_f32_16x16x32_bf16 v[96:99], a[76:79], a[12:15], v[96:99]
    ds_read_b64_tr_b16 a[98:99], v80 offset:53248
    v_cvt_pk_bf16_f32 v17, v60, v61
    v_mfma_f32_16x16x32_bf16 v[100:103], a[76:79], a[28:31], v[36:39]
    v_exp_f32 v62, v198
    v_mfma_f32_16x16x32_bf16 v[100:103], a[72:75], a[24:27], v[100:103]
    ds_read_b64_tr_b16 a[100:101], v80 offset:57344
    v_add_f32 v49, v49, v62
    v_mfma_f32_16x16x32_bf16 v[100:103], a[68:71], a[20:23], v[100:103]
    v_exp_f32 v63, v199
    v_mfma_f32_16x16x32_bf16 v[100:103], a[64:67], a[16:19], v[100:103]
    ds_read_b64_tr_b16 a[102:103], v80 offset:61440
    v_add_f32 v49, v49, v63
    v_mfma_f32_16x16x32_bf16 v[104:107], a[64:67], a[32:35], v[40:43]
    v_exp_f32 v56, v208
    v_mfma_f32_16x16x32_bf16 v[104:107], a[68:71], a[36:39], v[104:107]
    ds_read_b64_tr_b16 a[104:105], v81 offset:49152
    v_cvt_pk_bf16_f32 v21, v62, v63
    v_mfma_f32_16x16x32_bf16 v[104:107], a[72:75], a[40:43], v[104:107]
    v_exp_f32 v57, v209
    v_mfma_f32_16x16x32_bf16 v[104:107], a[76:79], a[44:47], v[104:107]
    ds_read_b64_tr_b16 a[106:107], v81 offset:53248
    v_cvt_pk_bf16_f32 v18, v56, v57
    v_mfma_f32_16x16x32_bf16 v[108:111], a[76:79], a[60:63], v[44:47]
    v_exp_f32 v58, v212
    v_mfma_f32_16x16x32_bf16 v[108:111], a[72:75], a[56:59], v[108:111]
    ds_read_b64_tr_b16 a[108:109], v81 offset:57344
    v_add_f32 v49, v49, v58
    v_mfma_f32_16x16x32_bf16 v[108:111], a[68:71], a[52:55], v[108:111]
    v_exp_f32 v59, v213
    v_mfma_f32_16x16x32_bf16 v[108:111], a[64:67], a[48:51], v[108:111]
    s_waitcnt lgkmcnt(7)
    ds_read_b64_tr_b16 a[110:111], v81 offset:61440
    v_add_f32 v49, v49, v59
    v_mfma_f32_16x16x32_bf16 v[124:127], a[80:83], a[48:51], v[44:47]
    v_exp_f32 v60, v210
    v_mfma_f32_16x16x32_bf16 v[124:127], a[84:87], a[52:55], v[124:127]
    ds_read_b128 a[64:67], v76 offset:40960
    v_cvt_pk_bf16_f32 v22, v58, v59
    v_mfma_f32_16x16x32_bf16 v[124:127], a[88:91], a[56:59], v[124:127]
    s_add_u32 s44, s48, -4096
    v_exp_f32 v61, v211
    v_mfma_f32_16x16x32_bf16 v[124:127], a[92:95], a[60:63], v[124:127]
    s_add_u32 m0, s49, 94208
    ds_read_b128 a[68:71], v77 offset:40960
    v_cvt_pk_bf16_f32 v19, v60, v61
    v_mfma_f32_16x16x32_bf16 v[72:75], v[10:13], v[224:227], 0
    buffer_load_dwordx4 v15, s[24:27], s44 offen lds
    v_mfma_f32_16x16x32_bf16 v[120:123], a[92:95], a[44:47], v[40:43]
    v_exp_f32 v62, v214
    v_mfma_f32_16x16x32_bf16 v[120:123], a[88:91], a[40:43], v[120:123]
    ds_read_b128 a[72:75], v78 offset:40960
    v_add_f32 v49, v49, v62
    v_mfma_f32_16x16x32_bf16 v[120:123], a[84:87], a[36:39], v[120:123]
    s_add_u32 s45, s47, 0
    v_exp_f32 v63, v215
    v_mfma_f32_16x16x32_bf16 v[120:123], a[80:83], a[32:35], v[120:123]
    s_add_u32 m0, s49, 16384
    ds_read_b128 a[76:79], v79 offset:40960
    v_add_f32 v49, v49, v63
    v_mfma_f32_16x16x32_bf16 v[72:75], v[10:13], v[16:19], v[72:75]
    buffer_load_dwordx4 v14, s[20:23], s45 offen lds
    v_mfma_f32_16x16x32_bf16 v[116:119], a[80:83], a[16:19], v[36:39]
    v_exp_f32 v56, v200
    v_mfma_f32_16x16x32_bf16 v[116:119], a[84:87], a[20:23], v[116:119]
    ds_read_b64_tr_b16 a[112:113], v82 offset:49152
    v_cvt_pk_bf16_f32 v23, v62, v63
    v_mfma_f32_16x16x32_bf16 v[116:119], a[88:91], a[24:27], v[116:119]
    v_exp_f32 v57, v201
    v_mfma_f32_16x16x32_bf16 v[116:119], a[92:95], a[28:31], v[116:119]
    ds_read_b64_tr_b16 a[114:115], v82 offset:53248
    v_cvt_pk_bf16_f32 v24, v56, v57
    v_mfma_f32_16x16x32_bf16 v[112:115], a[92:95], a[12:15], v[32:35]
    v_exp_f32 v58, v204
    v_mfma_f32_16x16x32_bf16 v[112:115], a[88:91], a[8:11], v[112:115]
    v_add_f32 v51, v51, v58
    v_add_f32 v48, v52, v72
    v_mfma_f32_16x16x32_bf16 v[112:115], a[84:87], a[4:7], v[112:115]
    v_exp_f32 v59, v205
    v_mfma_f32_16x16x32_bf16 v[112:115], a[80:83], a[0:3], v[112:115]
    s_waitcnt lgkmcnt(2)
    ds_read_b64_tr_b16 a[116:117], v82 offset:57344
    v_add_f32 v51, v51, v59
    v_mfma_f32_16x16x32_bf16 v[128:131], a[64:67], a[0:3], v[32:35]
    v_exp_f32 v60, v202
    v_mfma_f32_16x16x32_bf16 v[128:131], a[68:71], a[4:7], v[128:131]
    ds_read_b128 a[80:83], v76 offset:45056
    v_cvt_pk_bf16_f32 v28, v58, v59
    v_mfma_f32_16x16x32_bf16 v[128:131], a[72:75], a[8:11], v[128:131]
    v_exp_f32 v61, v203
    v_mfma_f32_16x16x32_bf16 v[128:131], a[76:79], a[12:15], v[128:131]
    ds_read_b128 a[84:87], v77 offset:45056
    v_cvt_pk_bf16_f32 v25, v60, v61
    v_mfma_f32_16x16x32_bf16 v[132:135], a[76:79], a[28:31], v[36:39]
    v_exp_f32 v62, v206
    v_mfma_f32_16x16x32_bf16 v[132:135], a[72:75], a[24:27], v[132:135]
    ds_read_b128 a[88:91], v78 offset:45056
    v_add_f32 v51, v51, v62
    v_mfma_f32_16x16x32_bf16 v[132:135], a[68:71], a[20:23], v[132:135]
    v_exp_f32 v63, v207
    v_mfma_f32_16x16x32_bf16 v[132:135], a[64:67], a[16:19], v[132:135]
    s_add_u32 s44, s47, 4096
    ds_read_b128 a[92:95], v79 offset:45056
    v_add_f32 v51, v51, v63
    v_mfma_f32_16x16x32_bf16 v[136:139], a[64:67], a[32:35], v[40:43]
    s_add_u32 m0, s49, 20480
    v_exp_f32 v56, v216
    v_mfma_f32_16x16x32_bf16 v[136:139], a[68:71], a[36:39], v[136:139]
    buffer_load_dwordx4 v14, s[20:23], s44 offen lds
    v_mfma_f32_16x16x32_bf16 v[136:139], a[72:75], a[40:43], v[136:139]
    v_exp_f32 v57, v217
    v_mfma_f32_16x16x32_bf16 v[136:139], a[76:79], a[44:47], v[136:139]
    v_cvt_pk_bf16_f32 v29, v62, v63
    v_cvt_pk_bf16_f32 v26, v56, v57
    v_mfma_f32_16x16x32_bf16 v[140:143], a[76:79], a[60:63], v[44:47]
    v_exp_f32 v58, v220
    v_mfma_f32_16x16x32_bf16 v[140:143], a[72:75], a[56:59], v[140:143]
    ds_read_b64_tr_b16 a[118:119], v82 offset:61440
    v_add_f32 v51, v51, v58
    v_mfma_f32_16x16x32_bf16 v[140:143], a[68:71], a[52:55], v[140:143]
    v_exp_f32 v59, v221
    v_mfma_f32_16x16x32_bf16 v[140:143], a[64:67], a[48:51], v[140:143]
    s_waitcnt lgkmcnt(1)
    ds_read_b64_tr_b16 a[120:121], v83 offset:49152
    v_add_f32 v51, v51, v59
    v_mfma_f32_16x16x32_bf16 v[156:159], a[80:83], a[48:51], v[44:47]
    v_exp_f32 v60, v218
    v_mfma_f32_16x16x32_bf16 v[156:159], a[84:87], a[52:55], v[156:159]
    ds_read_b64_tr_b16 a[122:123], v83 offset:53248
    v_cvt_pk_bf16_f32 v30, v58, v59
    v_mfma_f32_16x16x32_bf16 v[156:159], a[88:91], a[56:59], v[156:159]
    s_add_u32 s45, s47, 8192
    v_exp_f32 v61, v219
    v_mfma_f32_16x16x32_bf16 v[156:159], a[92:95], a[60:63], v[156:159]
    s_add_u32 m0, s49, 24576
    ds_read_b64_tr_b16 a[124:125], v83 offset:57344
    v_cvt_pk_bf16_f32 v27, v60, v61
    v_mfma_f32_16x16x32_bf16 v[72:75], v[10:13], v[232:235], 0
    buffer_load_dwordx4 v14, s[20:23], s45 offen lds
    v_mfma_f32_16x16x32_bf16 v[152:155], a[92:95], a[44:47], v[40:43]
    v_exp_f32 v62, v222
    v_mfma_f32_16x16x32_bf16 v[152:155], a[88:91], a[40:43], v[152:155]
    ds_read_b64_tr_b16 a[126:127], v83 offset:61440
    v_add_f32 v51, v51, v62
    v_mfma_f32_16x16x32_bf16 v[152:155], a[84:87], a[36:39], v[152:155]
    s_add_u32 s44, s47, 12288
    v_exp_f32 v63, v223
    v_mfma_f32_16x16x32_bf16 v[152:155], a[80:83], a[32:35], v[152:155]
    s_add_u32 m0, s49, 28672
    v_add_f32 v51, v51, v63
    v_mfma_f32_16x16x32_bf16 v[72:75], v[10:13], v[24:27], v[72:75]
    buffer_load_dwordx4 v14, s[20:23], s44 offen lds
    v_mfma_f32_16x16x32_bf16 v[148:151], a[80:83], a[16:19], v[36:39]
    v_exp_f32 v56, v96
    v_mfma_f32_16x16x32_bf16 v[148:151], a[84:87], a[20:23], v[148:151]
    v_cvt_pk_bf16_f32 v31, v62, v63
    v_max3_f32 v9, v48, v49, v51
    v_mfma_f32_16x16x32_bf16 v[148:151], a[88:91], a[24:27], v[148:151]
    v_exp_f32 v57, v97
    v_mfma_f32_16x16x32_bf16 v[148:151], a[92:95], a[28:31], v[148:151]
    v_cvt_pk_bf16_f32 v240, v56, v57
    v_add_f32 v50, v54, v72
    v_mfma_f32_16x16x32_bf16 v[144:147], a[92:95], a[12:15], v[32:35]
    v_exp_f32 v58, v100
    v_mfma_f32_16x16x32_bf16 v[144:147], a[88:91], a[8:11], v[144:147]
    v_max_f32 v9, v9, v50
    v_cmp_lt_f32 vcc, s61, v9
    v_mfma_f32_16x16x32_bf16 v[144:147], a[84:87], a[4:7], v[144:147]
    s_waitcnt lgkmcnt(0)
    v_exp_f32 v59, v101
    v_mfma_f32_16x16x32_bf16 v[144:147], a[80:83], a[0:3], v[144:147]
    s_cbranch_vccnz L_rare_stubl2
L_rare_retl2:
    v_add_f32 v53, v49, v58
    v_add_f32 v53, v53, v59
    v_mfma_f32_16x16x32_bf16 a[140:143], a[96:99], v[236:239], a[140:143]
    s_waitcnt vmcnt(13)
    v_exp_f32 v60, v98
    v_mfma_f32_16x16x32_bf16 a[140:143], a[100:103], v[28:31], a[140:143]
    s_barrier
    v_cvt_pk_bf16_f32 v244, v58, v59
    v_mfma_f32_16x16x32_bf16 a[136:139], a[100:103], v[24:27], a[136:139]
    v_exp_f32 v61, v99
    v_mfma_f32_16x16x32_bf16 a[136:139], a[96:99], v[232:235], a[136:139]
    s_add_u32 s45, s48, 0
    ds_read_b64_tr_b16 v[88:89], v3 offset:0
    v_cvt_pk_bf16_f32 v241, v60, v61
    v_mfma_f32_16x16x32_bf16 a[132:135], a[96:99], v[228:231], a[132:135]
    s_add_u32 m0, s49, 98304
    v_exp_f32 v62, v102
    v_mfma_f32_16x16x32_bf16 a[132:135], a[100:103], v[20:23], a[132:135]
    buffer_load_dwordx4 v15, s[24:27], s45 offen lds
    v_mfma_f32_16x16x32_bf16 a[128:131], a[100:103], v[16:19], a[128:131]
    v_exp_f32 v63, v103
    v_mfma_f32_16x16x32_bf16 a[128:131], a[96:99], v[224:227], a[128:131]
    ds_read_b64_tr_b16 v[90:91], v3 offset:1024
    v_add_f32 v53, v53, v62
    v_add_f32 v53, v53, v63
    v_mfma_f32_16x16x32_bf16 a[144:147], a[104:107], v[224:227], a[144:147]
    v_exp_f32 v56, v112
    v_mfma_f32_16x16x32_bf16 a[144:147], a[108:111], v[16:19], a[144:147]
    ds_read_b64_tr_b16 a[96:97], v84 offset:49152
    v_cvt_pk_bf16_f32 v245, v62, v63
    v_mfma_f32_16x16x32_bf16 a[148:151], a[108:111], v[20:23], a[148:151]
    v_exp_f32 v57, v113
    v_mfma_f32_16x16x32_bf16 a[148:151], a[104:107], v[228:231], a[148:151]
    ds_read_b64_tr_b16 a[98:99], v84 offset:53248
    v_cvt_pk_bf16_f32 v242, v56, v57
    v_mfma_f32_16x16x32_bf16 a[152:155], a[104:107], v[232:235], a[152:155]
    v_exp_f32 v58, v116
    v_mfma_f32_16x16x32_bf16 a[152:155], a[108:111], v[24:27], a[152:155]
    ds_read_b64_tr_b16 a[100:101], v84 offset:57344
    v_add_f32 v53, v53, v58
    v_mfma_f32_16x16x32_bf16 a[156:159], a[108:111], v[28:31], a[156:159]
    v_exp_f32 v59, v117
    v_mfma_f32_16x16x32_bf16 a[156:159], a[104:107], v[236:239], a[156:159]
    ds_read_b64_tr_b16 a[102:103], v84 offset:61440
    v_add_f32 v53, v53, v59
    v_mfma_f32_16x16x32_bf16 a[172:175], a[112:115], v[236:239], a[172:175]
    v_exp_f32 v60, v114
    v_mfma_f32_16x16x32_bf16 a[172:175], a[116:119], v[28:31], a[172:175]
    ds_read_b64_tr_b16 a[104:105], v85 offset:49152
    v_cvt_pk_bf16_f32 v246, v58, v59
    v_mfma_f32_16x16x32_bf16 a[168:171], a[116:119], v[24:27], a[168:171]
    v_exp_f32 v61, v115
    v_mfma_f32_16x16x32_bf16 a[168:171], a[112:115], v[232:235], a[168:171]
    ds_read_b64_tr_b16 a[106:107], v85 offset:53248
    v_cvt_pk_bf16_f32 v243, v60, v61
    v_mfma_f32_16x16x32_bf16 a[164:167], a[112:115], v[228:231], a[164:167]
    v_exp_f32 v62, v118
    v_mfma_f32_16x16x32_bf16 a[164:167], a[116:119], v[20:23], a[164:167]
    ds_read_b64_tr_b16 a[108:109], v85 offset:57344
    v_add_f32 v53, v53, v62
    v_mfma_f32_16x16x32_bf16 a[160:163], a[116:119], v[16:19], a[160:163]
    v_exp_f32 v63, v119
    v_mfma_f32_16x16x32_bf16 a[160:163], a[112:115], v[224:227], a[160:163]
    ds_read_b64_tr_b16 a[110:111], v85 offset:61440
    v_add_f32 v53, v53, v63
    v_mfma_f32_16x16x32_bf16 a[176:179], a[120:123], v[224:227], a[176:179]
    v_exp_f32 v56, v104
    v_mfma_f32_16x16x32_bf16 a[176:179], a[124:127], v[16:19], a[176:179]
    ds_read_b64_tr_b16 a[112:113], v86 offset:49152
    v_cvt_pk_bf16_f32 v247, v62, v63
    v_mfma_f32_16x16x32_bf16 a[180:183], a[124:127], v[20:23], a[180:183]
    v_exp_f32 v57, v105
    v_mfma_f32_16x16x32_bf16 a[180:183], a[120:123], v[228:231], a[180:183]
    ds_read_b64_tr_b16 a[114:115], v86 offset:53248
    v_cvt_pk_bf16_f32 v248, v56, v57
    v_mfma_f32_16x16x32_bf16 a[184:187], a[120:123], v[232:235], a[184:187]
    v_exp_f32 v58, v108
    v_mfma_f32_16x16x32_bf16 a[184:187], a[124:127], v[24:27], a[184:187]
    ds_read_b64_tr_b16 a[116:117], v86 offset:57344
    v_add_f32 v55, v51, v58
    v_mfma_f32_16x16x32_bf16 a[188:191], a[124:127], v[28:31], a[188:191]
    v_exp_f32 v59, v109
    v_mfma_f32_16x16x32_bf16 a[188:191], a[120:123], v[236:239], a[188:191]
    s_waitcnt lgkmcnt(7)
    ds_read_b64_tr_b16 a[118:119], v86 offset:61440
    v_add_f32 v55, v55, v59
    v_mfma_f32_16x16x32_bf16 a[204:207], a[96:99], v[236:239], a[204:207]
    v_exp_f32 v60, v106
    v_mfma_f32_16x16x32_bf16 a[204:207], a[100:103], v[28:31], a[204:207]
    ds_read_b64_tr_b16 a[120:121], v87 offset:49152
    v_cvt_pk_bf16_f32 v252, v58, v59
    v_mfma_f32_16x16x32_bf16 a[200:203], a[100:103], v[24:27], a[200:203]
    v_exp_f32 v61, v107
    v_mfma_f32_16x16x32_bf16 a[200:203], a[96:99], v[232:235], a[200:203]
    ds_read_b64_tr_b16 a[122:123], v87 offset:53248
    v_cvt_pk_bf16_f32 v249, v60, v61
    v_mfma_f32_16x16x32_bf16 a[196:199], a[96:99], v[228:231], a[196:199]
    v_exp_f32 v62, v110
    v_mfma_f32_16x16x32_bf16 a[196:199], a[100:103], v[20:23], a[196:199]
    ds_read_b64_tr_b16 a[124:125], v87 offset:57344
    v_add_f32 v55, v55, v62
    v_mfma_f32_16x16x32_bf16 a[192:195], a[100:103], v[16:19], a[192:195]
    v_exp_f32 v63, v111
    v_mfma_f32_16x16x32_bf16 a[192:195], a[96:99], v[224:227], a[192:195]
    s_waitcnt lgkmcnt(7)
    ds_read_b64_tr_b16 a[126:127], v87 offset:61440
    v_add_f32 v55, v55, v63
    v_mfma_f32_16x16x32_bf16 a[208:211], a[104:107], v[224:227], a[208:211]
    v_exp_f32 v56, v120
    v_mfma_f32_16x16x32_bf16 a[208:211], a[108:111], v[16:19], a[208:211]
    ds_read_b128 a[64:67], v76 offset:49152
    v_cvt_pk_bf16_f32 v253, v62, v63
    v_mfma_f32_16x16x32_bf16 a[212:215], a[108:111], v[20:23], a[212:215]
    v_exp_f32 v57, v121
    v_mfma_f32_16x16x32_bf16 a[212:215], a[104:107], v[228:231], a[212:215]
    ds_read_b128 a[68:71], v77 offset:49152
    v_cvt_pk_bf16_f32 v250, v56, v57
    v_mfma_f32_16x16x32_bf16 a[216:219], a[104:107], v[232:235], a[216:219]
    v_exp_f32 v58, v124
    v_mfma_f32_16x16x32_bf16 a[216:219], a[108:111], v[24:27], a[216:219]
    ds_read_b128 a[72:75], v78 offset:49152
    v_add_f32 v55, v55, v58
    v_mfma_f32_16x16x32_bf16 a[220:223], a[108:111], v[28:31], a[220:223]
    v_exp_f32 v59, v125
    v_mfma_f32_16x16x32_bf16 a[220:223], a[104:107], v[236:239], a[220:223]
    s_waitcnt lgkmcnt(7)
    ds_read_b128 a[76:79], v79 offset:49152
    v_add_f32 v55, v55, v59
    v_mfma_f32_16x16x32_bf16 a[236:239], a[112:115], v[236:239], a[236:239]
L_pad5:
    s_cbranch_execz L_pad8
    v_exp_f32 v60, v122
    v_mfma_f32_16x16x32_bf16 a[236:239], a[116:119], v[28:31], a[236:239]
    ds_read_b128 a[80:83], v76 offset:53248
    v_cvt_pk_bf16_f32 v254, v58, v59
    v_mfma_f32_16x16x32_bf16 a[232:235], a[116:119], v[24:27], a[232:235]
    v_exp_f32 v61, v123
    v_mfma_f32_16x16x32_bf16 a[232:235], a[112:115], v[232:235], a[232:235]
    ds_read_b128 a[84:87], v77 offset:53248
    v_cvt_pk_bf16_f32 v251, v60, v61
    v_mfma_f32_16x16x32_bf16 a[228:231], a[112:115], v[228:231], a[228:231]
    v_exp_f32 v62, v126
    v_mfma_f32_16x16x32_bf16 a[228:231], a[116:119], v[20:23], a[228:231]
    ds_read_b128 a[88:91], v78 offset:53248
    v_add_f32 v55, v55, v62
    v_mfma_f32_16x16x32_bf16 a[224:227], a[116:119], v[16:19], a[224:227]
    s_add_u32 s44, s48, 4096
    v_exp_f32 v63, v127
    v_mfma_f32_16x16x32_bf16 a[224:227], a[112:115], v[224:227], a[224:227]
    s_waitcnt lgkmcnt(7)
    ds_read_b128 a[92:95], v79 offset:53248
    v_add_f32 v55, v55, v63
    v_mfma_f32_16x16x32_bf16 a[240:243], a[120:123], v[224:227], a[240:243]
    s_add_u32 m0, s49, 102400
    v_exp_f32 v56, v128
    v_mfma_f32_16x16x32_bf16 a[240:243], a[124:127], v[16:19], a[240:243]
    s_waitcnt lgkmcnt(4)
    buffer_load_dwordx4 v15, s[24:27], s44 offen lds
    v_mfma_f32_16x16x32_bf16 a[244:247], a[124:127], v[20:23], a[244:247]
    v_exp_f32 v57, v129
    v_mfma_f32_16x16x32_bf16 a[244:247], a[120:123], v[228:231], a[244:247]
    s_add_u32 s45, s48, 8192
    v_cvt_pk_bf16_f32 v255, v62, v63
    v_cvt_pk_bf16_f32 v16, v56, v57
    v_mfma_f32_16x16x32_bf16 a[248:251], a[120:123], v[232:235], a[248:251]
    s_add_u32 m0, s49, 106496
    v_exp_f32 v58, v132
    v_mfma_f32_16x16x32_bf16 a[248:251], a[124:127], v[24:27], a[248:251]
    s_add_u32 s47, s47, 16384
    buffer_load_dwordx4 v15, s[24:27], s45 offen lds
    v_mfma_f32_16x16x32_bf16 a[252:255], a[124:127], v[28:31], a[252:255]
    s_add_u32 s48, s48, 16384
    v_exp_f32 v59, v133
    v_mfma_f32_16x16x32_bf16 a[252:255], a[120:123], v[236:239], a[252:255]
    v_add_f32 v53, v53, v58
    v_add_f32 v53, v53, v59
    v_mfma_f32_16x16x32_bf16 v[160:163], a[64:67], a[0:3], v[32:35]
    v_exp_f32 v60, v130
    v_mfma_f32_16x16x32_bf16 v[160:163], a[68:71], a[4:7], v[160:163]
    ds_read_b64_tr_b16 a[96:97], v80 offset:0
    v_cvt_pk_bf16_f32 v20, v58, v59
    v_mfma_f32_16x16x32_bf16 v[160:163], a[72:75], a[8:11], v[160:163]
    v_exp_f32 v61, v131
    v_mfma_f32_16x16x32_bf16 v[160:163], a[76:79], a[12:15], v[160:163]
    ds_read_b64_tr_b16 a[98:99], v80 offset:4096
    v_cvt_pk_bf16_f32 v17, v60, v61
    v_mfma_f32_16x16x32_bf16 v[164:167], a[76:79], a[28:31], v[36:39]
    v_exp_f32 v62, v134
    v_mfma_f32_16x16x32_bf16 v[164:167], a[72:75], a[24:27], v[164:167]
    ds_read_b64_tr_b16 a[100:101], v80 offset:8192
    v_add_f32 v53, v53, v62
    v_mfma_f32_16x16x32_bf16 v[164:167], a[68:71], a[20:23], v[164:167]
    v_exp_f32 v63, v135
    v_mfma_f32_16x16x32_bf16 v[164:167], a[64:67], a[16:19], v[164:167]
    ds_read_b64_tr_b16 a[102:103], v80 offset:12288
    v_add_f32 v53, v53, v63
    v_mfma_f32_16x16x32_bf16 v[168:171], a[64:67], a[32:35], v[40:43]
    v_exp_f32 v56, v144
    v_mfma_f32_16x16x32_bf16 v[168:171], a[68:71], a[36:39], v[168:171]
    ds_read_b64_tr_b16 a[104:105], v81 offset:0
    v_cvt_pk_bf16_f32 v21, v62, v63
    v_mfma_f32_16x16x32_bf16 v[168:171], a[72:75], a[40:43], v[168:171]
    v_exp_f32 v57, v145
    v_mfma_f32_16x16x32_bf16 v[168:171], a[76:79], a[44:47], v[168:171]
    ds_read_b64_tr_b16 a[106:107], v81 offset:4096
    v_cvt_pk_bf16_f32 v18, v56, v57
    v_mfma_f32_16x16x32_bf16 v[172:175], a[76:79], a[60:63], v[44:47]
    v_exp_f32 v58, v148
    v_mfma_f32_16x16x32_bf16 v[172:175], a[72:75], a[56:59], v[172:175]
    ds_read_b64_tr_b16 a[108:109], v81 offset:8192
    v_add_f32 v53, v53, v58
    v_mfma_f32_16x16x32_bf16 v[172:175], a[68:71], a[52:55], v[172:175]
    v_exp_f32 v59, v149
    v_mfma_f32_16x16x32_bf16 v[172:175], a[64:67], a[48:51], v[172:175]
    s_waitcnt lgkmcnt(7)
    ds_read_b64_tr_b16 a[110:111], v81 offset:12288
    v_add_f32 v53, v53, v59
    v_mfma_f32_16x16x32_bf16 v[188:191], a[80:83], a[48:51], v[44:47]
    v_exp_f32 v60, v146
    v_mfma_f32_16x16x32_bf16 v[188:191], a[84:87], a[52:55], v[188:191]
    ds_read_b128 a[64:67], v76 offset:57344
    v_cvt_pk_bf16_f32 v22, v58, v59
    v_mfma_f32_16x16x32_bf16 v[188:191], a[88:91], a[56:59], v[188:191]
    s_add_u32 s44, s48, -4096
    v_exp_f32 v61, v147
    v_mfma_f32_16x16x32_bf16 v[188:191], a[92:95], a[60:63], v[188:191]
    s_add_u32 m0, s49, 110592
    ds_read_b128 a[68:71], v77 offset:57344
    v_cvt_pk_bf16_f32 v19, v60, v61
    v_mfma_f32_16x16x32_bf16 v[72:75], v[10:13], v[240:243], 0
    buffer_load_dwordx4 v15, s[24:27], s44 offen lds
    v_mfma_f32_16x16x32_bf16 v[184:187], a[92:95], a[44:47], v[40:43]
    v_exp_f32 v62, v150
    v_mfma_f32_16x16x32_bf16 v[184:187], a[88:91], a[40:43], v[184:187]
    ds_read_b128 a[72:75], v78 offset:57344
    v_add_f32 v53, v53, v62
    v_mfma_f32_16x16x32_bf16 v[184:187], a[84:87], a[36:39], v[184:187]
    s_add_u32 s45, s47, 0
    v_exp_f32 v63, v151
    v_mfma_f32_16x16x32_bf16 v[184:187], a[80:83], a[32:35], v[184:187]
    s_add_u32 m0, s49, 32768
    ds_read_b128 a[76:79], v79 offset:57344
    v_add_f32 v53, v53, v63
    v_mfma_f32_16x16x32_bf16 v[72:75], v[10:13], v[16:19], v[72:75]
    buffer_load_dwordx4 v14, s[20:23], s45 offen lds
    v_mfma_f32_16x16x32_bf16 v[180:183], a[80:83], a[16:19], v[36:39]
    v_exp_f32 v56, v136
    v_mfma_f32_16x16x32_bf16 v[180:183], a[84:87], a[20:23], v[180:183]
    ds_read_b64_tr_b16 a[112:113], v82 offset:0
    v_cvt_pk_bf16_f32 v23, v62, v63
    v_mfma_f32_16x16x32_bf16 v[180:183], a[88:91], a[24:27], v[180:183]
    v_exp_f32 v57, v137
    v_mfma_f32_16x16x32_bf16 v[180:183], a[92:95], a[28:31], v[180:183]
    ds_read_b64_tr_b16 a[114:115], v82 offset:4096
    v_cvt_pk_bf16_f32 v24, v56, v57
    v_mfma_f32_16x16x32_bf16 v[176:179], a[92:95], a[12:15], v[32:35]
    v_exp_f32 v58, v140
    v_mfma_f32_16x16x32_bf16 v[176:179], a[88:91], a[8:11], v[176:179]
    v_add_f32 v55, v55, v58
    v_add_f32 v52, v48, v72
    v_mfma_f32_16x16x32_bf16 v[176:179], a[84:87], a[4:7], v[176:179]
    v_exp_f32 v59, v141
    v_mfma_f32_16x16x32_bf16 v[176:179], a[80:83], a[0:3], v[176:179]
    s_waitcnt lgkmcnt(2)
    ds_read_b64_tr_b16 a[116:117], v82 offset:8192
    v_add_f32 v55, v55, v59
    v_mfma_f32_16x16x32_bf16 v[192:195], a[64:67], a[0:3], v[32:35]
    v_exp_f32 v60, v138
    v_mfma_f32_16x16x32_bf16 v[192:195], a[68:71], a[4:7], v[192:195]
    ds_read_b128 a[80:83], v76 offset:61440
    v_cvt_pk_bf16_f32 v28, v58, v59
    v_mfma_f32_16x16x32_bf16 v[192:195], a[72:75], a[8:11], v[192:195]
    v_exp_f32 v61, v139
    v_mfma_f32_16x16x32_bf16 v[192:195], a[76:79], a[12:15], v[192:195]
    ds_read_b128 a[84:87], v77 offset:61440
    v_cvt_pk_bf16_f32 v25, v60, v61
    v_mfma_f32_16x16x32_bf16 v[196:199], a[76:79], a[28:31], v[36:39]
    v_exp_f32 v62, v142
    v_mfma_f32_16x16x32_bf16 v[196:199], a[72:75], a[24:27], v[196:199]
    ds_read_b128 a[88:91], v78 offset:61440
    v_add_f32 v55, v55, v62
    v_mfma_f32_16x16x32_bf16 v[196:199], a[68:71], a[20:23], v[196:199]
    v_exp_f32 v63, v143
    v_mfma_f32_16x16x32_bf16 v[196:199], a[64:67], a[16:19], v[196:199]
    s_add_u32 s44, s47, 4096
    ds_read_b128 a[92:95], v79 offset:61440
    v_add_f32 v55, v55, v63
    v_mfma_f32_16x16x32_bf16 v[200:203], a[64:67], a[32:35], v[40:43]
    s_add_u32 m0, s49, 36864
    v_exp_f32 v56, v152
    v_mfma_f32_16x16x32_bf16 v[200:203], a[68:71], a[36:39], v[200:203]
    buffer_load_dwordx4 v14, s[20:23], s44 offen lds
    v_mfma_f32_16x16x32_bf16 v[200:203], a[72:75], a[40:43], v[200:203]
    v_exp_f32 v57, v153
    v_mfma_f32_16x16x32_bf16 v[200:203], a[76:79], a[44:47], v[200:203]
    v_cvt_pk_bf16_f32 v29, v62, v63
    v_cvt_pk_bf16_f32 v26, v56, v57
    v_mfma_f32_16x16x32_bf16 v[204:207], a[76:79], a[60:63], v[44:47]
    v_exp_f32 v58, v156
    v_mfma_f32_16x16x32_bf16 v[204:207], a[72:75], a[56:59], v[204:207]
    ds_read_b64_tr_b16 a[118:119], v82 offset:12288
    v_add_f32 v55, v55, v58
    v_mfma_f32_16x16x32_bf16 v[204:207], a[68:71], a[52:55], v[204:207]
    v_exp_f32 v59, v157
    v_mfma_f32_16x16x32_bf16 v[204:207], a[64:67], a[48:51], v[204:207]
    s_waitcnt lgkmcnt(1)
    ds_read_b64_tr_b16 a[120:121], v83 offset:0
    v_add_f32 v55, v55, v59
    v_mfma_f32_16x16x32_bf16 v[220:223], a[80:83], a[48:51], v[44:47]
    v_exp_f32 v60, v154
    v_mfma_f32_16x16x32_bf16 v[220:223], a[84:87], a[52:55], v[220:223]
    ds_read_b64_tr_b16 a[122:123], v83 offset:4096
    v_cvt_pk_bf16_f32 v30, v58, v59
    v_mfma_f32_16x16x32_bf16 v[220:223], a[88:91], a[56:59], v[220:223]
    s_add_u32 s45, s47, 8192
    v_exp_f32 v61, v155
    v_mfma_f32_16x16x32_bf16 v[220:223], a[92:95], a[60:63], v[220:223]
    s_add_u32 m0, s49, 40960
    ds_read_b64_tr_b16 a[124:125], v83 offset:8192
    v_cvt_pk_bf16_f32 v27, v60, v61
    v_mfma_f32_16x16x32_bf16 v[72:75], v[10:13], v[248:251], 0
    buffer_load_dwordx4 v14, s[20:23], s45 offen lds
    v_mfma_f32_16x16x32_bf16 v[216:219], a[92:95], a[44:47], v[40:43]
    v_exp_f32 v62, v158
    v_mfma_f32_16x16x32_bf16 v[216:219], a[88:91], a[40:43], v[216:219]
    ds_read_b64_tr_b16 a[126:127], v83 offset:12288
    v_add_f32 v55, v55, v62
    v_mfma_f32_16x16x32_bf16 v[216:219], a[84:87], a[36:39], v[216:219]
    s_add_u32 s44, s47, 12288
    v_exp_f32 v63, v159
    v_mfma_f32_16x16x32_bf16 v[216:219], a[80:83], a[32:35], v[216:219]
    s_add_u32 m0, s49, 45056
    ds_read_b64_tr_b16 v[92:93], v3 offset:32
    v_add_f32 v55, v55, v63
    v_mfma_f32_16x16x32_bf16 v[72:75], v[10:13], v[24:27], v[72:75]
    buffer_load_dwordx4 v14, s[20:23], s44 offen lds
    v_mfma_f32_16x16x32_bf16 v[212:215], a[80:83], a[16:19], v[36:39]
    v_exp_f32 v56, v160
    v_mfma_f32_16x16x32_bf16 v[212:215], a[84:87], a[20:23], v[212:215]
    ds_read_b64_tr_b16 v[94:95], v3 offset:1056
    v_cvt_pk_bf16_f32 v31, v62, v63
    v_max3_f32 v9, v52, v53, v55
    v_mfma_f32_16x16x32_bf16 v[212:215], a[88:91], a[24:27], v[212:215]
    v_exp_f32 v57, v161
    v_mfma_f32_16x16x32_bf16 v[212:215], a[92:95], a[28:31], v[212:215]
    v_cvt_pk_bf16_f32 v224, v56, v57
    v_add_f32 v54, v50, v72
    v_mfma_f32_16x16x32_bf16 v[208:211], a[92:95], a[12:15], v[32:35]
    v_exp_f32 v58, v164
    v_mfma_f32_16x16x32_bf16 v[208:211], a[88:91], a[8:11], v[208:211]
    v_max_f32 v9, v9, v54
    v_cmp_lt_f32 vcc, s61, v9
    v_mfma_f32_16x16x32_bf16 v[208:211], a[84:87], a[4:7], v[208:211]
    s_waitcnt lgkmcnt(2)
    v_exp_f32 v59, v165
    v_mfma_f32_16x16x32_bf16 v[208:211], a[80:83], a[0:3], v[208:211]
    s_cbranch_vccnz L_rare_stubl3
L_rare_retl3:
    v_add_f32 v49, v53, v58
    v_add_f32 v49, v49, v59
    v_mfma_f32_16x16x32_bf16 a[140:143], a[96:99], v[252:255], a[140:143]
    s_waitcnt vmcnt(12)
    v_exp_f32 v60, v162
    v_mfma_f32_16x16x32_bf16 a[140:143], a[100:103], v[28:31], a[140:143]
    s_barrier
    v_cvt_pk_bf16_f32 v228, v58, v59
    v_mfma_f32_16x16x32_bf16 a[136:139], a[100:103], v[24:27], a[136:139]
    v_exp_f32 v61, v163
    v_mfma_f32_16x16x32_bf16 a[136:139], a[96:99], v[248:251], a[136:139]
    s_add_u32 s45, s48, 0
    buffer_store_dwordx4 v[88:91], v1, s[12:15], s58 offen sc1
    v_cvt_pk_bf16_f32 v225, v60, v61
    v_mfma_f32_16x16x32_bf16 a[132:135], a[96:99], v[244:247], a[132:135]
    s_add_u32 m0, s49, 114688
    v_exp_f32 v62, v166
    v_mfma_f32_16x16x32_bf16 a[132:135], a[100:103], v[20:23], a[132:135]
    buffer_load_dwordx4 v15, s[24:27], s45 offen lds
    v_mfma_f32_16x16x32_bf16 a[128:131], a[100:103], v[16:19], a[128:131]
    v_exp_f32 v63, v167
    v_mfma_f32_16x16x32_bf16 a[128:131], a[96:99], v[240:243], a[128:131]
    v_add_f32 v49, v49, v62
    v_add_f32 v49, v49, v63
    v_mfma_f32_16x16x32_bf16 a[144:147], a[104:107], v[240:243], a[144:147]
    v_exp_f32 v56, v176
    v_mfma_f32_16x16x32_bf16 a[144:147], a[108:111], v[16:19], a[144:147]
    ds_read_b64_tr_b16 a[96:97], v84 offset:0
    v_cvt_pk_bf16_f32 v229, v62, v63
    v_mfma_f32_16x16x32_bf16 a[148:151], a[108:111], v[20:23], a[148:151]
    v_exp_f32 v57, v177
    v_mfma_f32_16x16x32_bf16 a[148:151], a[104:107], v[244:247], a[148:151]
    ds_read_b64_tr_b16 a[98:99], v84 offset:4096
    v_cvt_pk_bf16_f32 v226, v56, v57
    v_mfma_f32_16x16x32_bf16 a[152:155], a[104:107], v[248:251], a[152:155]
    s_waitcnt lgkmcnt(2)
    v_exp_f32 v58, v180
    v_mfma_f32_16x16x32_bf16 a[152:155], a[108:111], v[24:27], a[152:155]
    ds_read_b64_tr_b16 a[100:101], v84 offset:8192
    v_add_f32 v49, v49, v58
    v_mfma_f32_16x16x32_bf16 a[156:159], a[108:111], v[28:31], a[156:159]
    buffer_store_dwordx4 v[92:95], v1, s[12:15], s58 offen offset:1024 sc1
    v_exp_f32 v59, v181
    v_mfma_f32_16x16x32_bf16 a[156:159], a[104:107], v[252:255], a[156:159]
    ds_read_b64_tr_b16 a[102:103], v84 offset:12288
    v_add_f32 v49, v49, v59
    v_mfma_f32_16x16x32_bf16 a[172:175], a[112:115], v[252:255], a[172:175]
    v_exp_f32 v60, v178
    v_mfma_f32_16x16x32_bf16 a[172:175], a[116:119], v[28:31], a[172:175]
    ds_read_b64_tr_b16 a[104:105], v85 offset:0
    v_cvt_pk_bf16_f32 v230, v58, v59
    v_mfma_f32_16x16x32_bf16 a[168:171], a[116:119], v[24:27], a[168:171]
    v_exp_f32 v61, v179
    v_mfma_f32_16x16x32_bf16 a[168:171], a[112:115], v[248:251], a[168:171]
    ds_read_b64_tr_b16 a[106:107], v85 offset:4096
    v_cvt_pk_bf16_f32 v227, v60, v61
    v_mfma_f32_16x16x32_bf16 a[164:167], a[112:115], v[244:247], a[164:167]
    v_exp_f32 v62, v182
    v_mfma_f32_16x16x32_bf16 a[164:167], a[116:119], v[20:23], a[164:167]
    ds_read_b64_tr_b16 a[108:109], v85 offset:8192
    v_add_f32 v49, v49, v62
    v_mfma_f32_16x16x32_bf16 a[160:163], a[116:119], v[16:19], a[160:163]
    v_exp_f32 v63, v183
    v_mfma_f32_16x16x32_bf16 a[160:163], a[112:115], v[240:243], a[160:163]
    ds_read_b64_tr_b16 a[110:111], v85 offset:12288
    v_add_f32 v49, v49, v63
    v_mfma_f32_16x16x32_bf16 a[176:179], a[120:123], v[240:243], a[176:179]
    v_exp_f32 v56, v168
    v_mfma_f32_16x16x32_bf16 a[176:179], a[124:127], v[16:19], a[176:179]
    ds_read_b64_tr_b16 a[112:113], v86 offset:0
    v_cvt_pk_bf16_f32 v231, v62, v63
    v_mfma_f32_16x16x32_bf16 a[180:183], a[124:127], v[20:23], a[180:183]
    v_exp_f32 v57, v169
    v_mfma_f32_16x16x32_bf16 a[180:183], a[120:123], v[244:247], a[180:183]
    ds_read_b64_tr_b16 a[114:115], v86 offset:4096
    v_cvt_pk_bf16_f32 v232, v56, v57
    v_mfma_f32_16x16x32_bf16 a[184:187], a[120:123], v[248:251], a[184:187]
    v_exp_f32 v58, v172
    v_mfma_f32_16x16x32_bf16 a[184:187], a[124:127], v[24:27], a[184:187]
    ds_read_b64_tr_b16 a[116:117], v86 offset:8192
    v_add_f32 v51, v55, v58
    v_mfma_f32_16x16x32_bf16 a[188:191], a[124:127], v[28:31], a[188:191]
    v_exp_f32 v59, v173
    v_mfma_f32_16x16x32_bf16 a[188:191], a[120:123], v[252:255], a[188:191]
    s_waitcnt lgkmcnt(7)
    ds_read_b64_tr_b16 a[118:119], v86 offset:12288
    v_add_f32 v51, v51, v59
    v_mfma_f32_16x16x32_bf16 a[204:207], a[96:99], v[252:255], a[204:207]
    v_exp_f32 v60, v170
    v_mfma_f32_16x16x32_bf16 a[204:207], a[100:103], v[28:31], a[204:207]
    ds_read_b64_tr_b16 a[120:121], v87 offset:0
    v_cvt_pk_bf16_f32 v236, v58, v59
    v_mfma_f32_16x16x32_bf16 a[200:203], a[100:103], v[24:27], a[200:203]
    v_exp_f32 v61, v171
    v_mfma_f32_16x16x32_bf16 a[200:203], a[96:99], v[248:251], a[200:203]
    ds_read_b64_tr_b16 a[122:123], v87 offset:4096
    v_cvt_pk_bf16_f32 v233, v60, v61
    v_mfma_f32_16x16x32_bf16 a[196:199], a[96:99], v[244:247], a[196:199]
    v_exp_f32 v62, v174
    v_mfma_f32_16x16x32_bf16 a[196:199], a[100:103], v[20:23], a[196:199]
    ds_read_b64_tr_b16 a[124:125], v87 offset:8192
    v_add_f32 v51, v51, v62
    v_mfma_f32_16x16x32_bf16 a[192:195], a[100:103], v[16:19], a[192:195]
    v_exp_f32 v63, v175
    v_mfma_f32_16x16x32_bf16 a[192:195], a[96:99], v[240:243], a[192:195]
    s_waitcnt lgkmcnt(7)
    ds_read_b64_tr_b16 a[126:127], v87 offset:12288
    v_add_f32 v51, v51, v63
    v_mfma_f32_16x16x32_bf16 a[208:211], a[104:107], v[240:243], a[208:211]
    s_sub_u32 s52, s52, 1
    v_exp_f32 v56, v184
    v_mfma_f32_16x16x32_bf16 a[208:211], a[108:111], v[16:19], a[208:211]
    ds_read_b128 a[64:67], v76 offset:0
    v_cvt_pk_bf16_f32 v237, v62, v63
    v_mfma_f32_16x16x32_bf16 a[212:215], a[108:111], v[20:23], a[212:215]
    v_exp_f32 v57, v185
    v_mfma_f32_16x16x32_bf16 a[212:215], a[104:107], v[244:247], a[212:215]
    ds_read_b128 a[68:71], v77 offset:0
    v_cvt_pk_bf16_f32 v234, v56, v57
    v_mfma_f32_16x16x32_bf16 a[216:219], a[104:107], v[248:251], a[216:219]
    v_exp_f32 v58, v188
    v_mfma_f32_16x16x32_bf16 a[216:219], a[108:111], v[24:27], a[216:219]
    ds_read_b128 a[72:75], v78 offset:0
    v_add_f32 v51, v51, v58
    v_mfma_f32_16x16x32_bf16 a[220:223], a[108:111], v[28:31], a[220:223]
    v_exp_f32 v59, v189
    v_mfma_f32_16x16x32_bf16 a[220:223], a[104:107], v[252:255], a[220:223]
    s_waitcnt lgkmcnt(7)
    ds_read_b128 a[76:79], v79 offset:0
    v_add_f32 v51, v51, v59
    v_mfma_f32_16x16x32_bf16 a[236:239], a[112:115], v[252:255], a[236:239]
    v_exp_f32 v60, v186
    v_mfma_f32_16x16x32_bf16 a[236:239], a[116:119], v[28:31], a[236:239]
    ds_read_b128 a[80:83], v76 offset:4096
    v_cvt_pk_bf16_f32 v238, v58, v59
    v_mfma_f32_16x16x32_bf16 a[232:235], a[116:119], v[24:27], a[232:235]
    v_exp_f32 v61, v187
    v_mfma_f32_16x16x32_bf16 a[232:235], a[112:115], v[248:251], a[232:235]
    ds_read_b128 a[84:87], v77 offset:4096
    v_cvt_pk_bf16_f32 v235, v60, v61
    v_mfma_f32_16x16x32_bf16 a[228:231], a[112:115], v[244:247], a[228:231]
    v_exp_f32 v62, v190
    v_mfma_f32_16x16x32_bf16 a[228:231], a[116:119], v[20:23], a[228:231]
    ds_read_b128 a[88:91], v78 offset:4096
    v_add_f32 v51, v51, v62
    v_mfma_f32_16x16x32_bf16 a[224:227], a[116:119], v[16:19], a[224:227]
    s_add_u32 s44, s48, 4096
    v_exp_f32 v63, v191
    v_mfma_f32_16x16x32_bf16 a[224:227], a[112:115], v[240:243], a[224:227]
    s_waitcnt lgkmcnt(7)
    ds_read_b128 a[92:95], v79 offset:4096
    v_add_f32 v51, v51, v63
    v_mfma_f32_16x16x32_bf16 a[240:243], a[120:123], v[240:243], a[240:243]
    s_add_u32 m0, s49, 118784
    v_exp_f32 v56, v192
    v_mfma_f32_16x16x32_bf16 a[240:243], a[124:127], v[16:19], a[240:243]
    s_waitcnt lgkmcnt(4)
    buffer_load_dwordx4 v15, s[24:27], s44 offen lds
    v_mfma_f32_16x16x32_bf16 a[244:247], a[124:127], v[20:23], a[244:247]
    v_exp_f32 v57, v193
    v_mfma_f32_16x16x32_bf16 a[244:247], a[120:123], v[244:247], a[244:247]
    s_add_u32 s45, s48, 8192
    v_cvt_pk_bf16_f32 v239, v62, v63
    v_cvt_pk_bf16_f32 v16, v56, v57
    v_mfma_f32_16x16x32_bf16 a[248:251], a[120:123], v[248:251], a[248:251]
    s_add_u32 m0, s49, 122880
    v_exp_f32 v58, v196
    v_mfma_f32_16x16x32_bf16 a[248:251], a[124:127], v[24:27], a[248:251]
    s_add_u32 s47, s47, 16384
    buffer_load_dwordx4 v15, s[24:27], s45 offen lds
    v_mfma_f32_16x16x32_bf16 a[252:255], a[124:127], v[28:31], a[252:255]
    s_add_u32 s48, s48, 16384
    v_exp_f32 v59, v197
    v_mfma_f32_16x16x32_bf16 a[252:255], a[120:123], v[252:255], a[252:255]
    v_add_f32 v49, v49, v58
    v_add_f32 v49, v49, v59
    s_cmp_lg_u32 s52, 0
    s_cbranch_scc1 L_att_loop
    s_getpc_b64 s[8:9]
L_pc1:
    s_and_b32 s9, s9, 0xffff
    s_mov_b32 s10, L_code_end-L_pc1
    s_lshr_b32 s44, s2, 3
    s_lshl_b32 s44, s44, 2
    s_add_u32 s44, s44, s40
    s_lshl_b32 s44, s44, 10
    buffer_load_dwordx4 v[88:91], v1, s[8:11], s44 offen
    v_lshrrev_b32 v2, 4, v1
    v_mfma_f32_16x16x32_bf16 v[96:99], a[64:67], a[0:3], v[32:35]
    s_lshr_b32 s47, s42, 3
    v_exp_f32 v60, v194
    v_mfma_f32_16x16x32_bf16 v[96:99], a[68:71], a[4:7], v[96:99]
    s_and_b32 s43, s42, 3
    ds_read_b64_tr_b16 a[96:97], v80 offset:16384
    v_cvt_pk_bf16_f32 v20, v58, v59
    v_mfma_f32_16x16x32_bf16 v[96:99], a[72:75], a[8:11], v[96:99]
    s_mul_i32 s53, s40, 9216
    v_exp_f32 v61, v195
    v_mfma_f32_16x16x32_bf16 v[96:99], a[76:79], a[12:15], v[96:99]
    s_mul_i32 s55, s40, 36864
    ds_read_b64_tr_b16 a[98:99], v80 offset:20480
    v_cvt_pk_bf16_f32 v17, v60, v61
    v_mfma_f32_16x16x32_bf16 v[100:103], a[76:79], a[28:31], v[36:39]
    s_mul_i32 s59, s43, 9216
    v_exp_f32 v62, v198
    v_mfma_f32_16x16x32_bf16 v[100:103], a[72:75], a[24:27], v[100:103]
    s_add_u32 s55, s55, s59
    ds_read_b64_tr_b16 a[100:101], v80 offset:24576
    v_add_f32 v49, v49, v62
    v_mfma_f32_16x16x32_bf16 v[100:103], a[68:71], a[20:23], v[100:103]
    s_mul_i32 s54, s47, 1327104
    v_exp_f32 v63, v199
    v_mfma_f32_16x16x32_bf16 v[100:103], a[64:67], a[16:19], v[100:103]
    s_add_u32 s54, s54, s55
    ds_read_b64_tr_b16 a[102:103], v80 offset:28672
    v_add_f32 v49, v49, v63
    v_mfma_f32_16x16x32_bf16 v[104:107], a[64:67], a[32:35], v[40:43]
    s_mul_i32 s59, s47, 1179648
    v_exp_f32 v56, v208
    v_mfma_f32_16x16x32_bf16 v[104:107], a[68:71], a[36:39], v[104:107]
    s_add_u32 s55, s55, s59
    ds_read_b64_tr_b16 a[104:105], v81 offset:16384
    v_cvt_pk_bf16_f32 v21, v62, v63
    v_mfma_f32_16x16x32_bf16 v[104:107], a[72:75], a[40:43], v[104:107]
    s_lshl_b32 s58, s41, 3
    v_exp_f32 v57, v209
    v_mfma_f32_16x16x32_bf16 v[104:107], a[76:79], a[44:47], v[104:107]
    s_and_b32 s59, s42, 7
    ds_read_b64_tr_b16 a[106:107], v81 offset:20480
    v_cvt_pk_bf16_f32 v18, v56, v57
    v_mfma_f32_16x16x32_bf16 v[108:111], a[76:79], a[60:63], v[44:47]
    s_add_u32 s58, s58, s59
    v_exp_f32 v58, v212
    v_mfma_f32_16x16x32_bf16 v[108:111], a[72:75], a[56:59], v[108:111]
    s_lshr_b32 s60, s58, 2
    ds_read_b64_tr_b16 a[108:109], v81 offset:24576
    v_add_f32 v49, v49, v58
    v_mfma_f32_16x16x32_bf16 v[108:111], a[68:71], a[52:55], v[108:111]
    s_lshl_b32 s57, s60, 2
    v_exp_f32 v59, v213
    v_mfma_f32_16x16x32_bf16 v[108:111], a[64:67], a[48:51], v[108:111]
    s_waitcnt lgkmcnt(7)
    ds_read_b64_tr_b16 a[110:111], v81 offset:28672
    v_add_f32 v49, v49, v59
    v_mfma_f32_16x16x32_bf16 v[124:127], a[80:83], a[48:51], v[44:47]
    s_add_u32 s57, s57, s40
    v_exp_f32 v60, v210
    v_mfma_f32_16x16x32_bf16 v[124:127], a[84:87], a[52:55], v[124:127]
    s_lshl_b32 s57, s57, 13
    ds_read_b128 a[64:67], v76 offset:8192
    v_cvt_pk_bf16_f32 v22, v58, v59
    v_mfma_f32_16x16x32_bf16 v[124:127], a[88:91], a[56:59], v[124:127]
    s_add_u32 s44, s48, -4096
    v_exp_f32 v61, v211
    v_mfma_f32_16x16x32_bf16 v[124:127], a[92:95], a[60:63], v[124:127]
    s_add_u32 m0, s49, 126976
    ds_read_b128 a[68:71], v77 offset:8192
    v_cvt_pk_bf16_f32 v19, v60, v61
    v_mfma_f32_16x16x32_bf16 v[72:75], v[10:13], v[224:227], 0
    s_mul_i32 s56, s47, 4718592
    buffer_load_dwordx4 v15, s[24:27], s44 offen lds
    v_mfma_f32_16x16x32_bf16 v[120:123], a[92:95], a[44:47], v[40:43]
    s_add_u32 s56, s56, s57
    v_exp_f32 v62, v214
    v_mfma_f32_16x16x32_bf16 v[120:123], a[88:91], a[40:43], v[120:123]
    s_lshl_b32 s59, s47, 22
    ds_read_b128 a[72:75], v78 offset:8192
    v_add_f32 v49, v49, v62
    v_mfma_f32_16x16x32_bf16 v[120:123], a[84:87], a[36:39], v[120:123]
    s_add_u32 s57, s57, s59
    v_exp_f32 v63, v215
    v_mfma_f32_16x16x32_bf16 v[120:123], a[80:83], a[32:35], v[120:123]
    s_mul_i32 s58, s58, 147456
    ds_read_b128 a[76:79], v79 offset:8192
    v_add_f32 v49, v49, v63
    v_mfma_f32_16x16x32_bf16 v[72:75], v[10:13], v[16:19], v[72:75]
    s_mul_i32 s59, s47, 9216
    ds_read_b64_tr_b16 a[112:113], v82 offset:16384
    v_mfma_f32_16x16x32_bf16 v[116:119], a[80:83], a[16:19], v[36:39]
    s_add_u32 s59, s59, s58
    v_exp_f32 v56, v200
    v_mfma_f32_16x16x32_bf16 v[116:119], a[84:87], a[20:23], v[116:119]
    s_mul_i32 s52, s47, 36864
    ds_read_b64_tr_b16 a[114:115], v82 offset:20480
    v_cvt_pk_bf16_f32 v23, v62, v63
    v_mfma_f32_16x16x32_bf16 v[116:119], a[88:91], a[24:27], v[116:119]
    s_add_u32 s58, s58, s52
    v_exp_f32 v57, v201
    v_mfma_f32_16x16x32_bf16 v[116:119], a[92:95], a[28:31], v[116:119]
    s_add_u32 s58, s58, s53
    ds_read_b64_tr_b16 a[116:117], v82 offset:24576
    v_cvt_pk_bf16_f32 v24, v56, v57
    v_mfma_f32_16x16x32_bf16 v[112:115], a[92:95], a[12:15], v[32:35]
    s_lshl_b32 s60, s60, 2
    v_exp_f32 v58, v204
    v_mfma_f32_16x16x32_bf16 v[112:115], a[88:91], a[8:11], v[112:115]
    s_add_u32 s60, s60, s47
    v_add_f32 v51, v51, v58
    v_add_f32 v48, v52, v72
    v_mfma_f32_16x16x32_bf16 v[112:115], a[84:87], a[4:7], v[112:115]
    s_mul_i32 s60, s60, 36864
    v_exp_f32 v59, v205
    v_mfma_f32_16x16x32_bf16 v[112:115], a[80:83], a[0:3], v[112:115]
    s_waitcnt lgkmcnt(3)
    v_add_f32 v51, v51, v59
    v_mfma_f32_16x16x32_bf16 v[128:131], a[64:67], a[0:3], v[32:35]
    s_mul_i32 s52, s43, 288
    v_exp_f32 v60, v202
    v_mfma_f32_16x16x32_bf16 v[128:131], a[68:71], a[4:7], v[128:131]
    s_add_u32 s60, s60, s52
    ds_read_b128 a[80:83], v76 offset:12288
    v_cvt_pk_bf16_f32 v28, v58, v59
    v_mfma_f32_16x16x32_bf16 v[128:131], a[72:75], a[8:11], v[128:131]
    s_min_u32 s63, s40, 1
    v_exp_f32 v61, v203
    v_mfma_f32_16x16x32_bf16 v[128:131], a[76:79], a[12:15], v[128:131]
    s_lshl_b32 s63, s63, 30
    ds_read_b128 a[84:87], v77 offset:12288
    v_cvt_pk_bf16_f32 v25, v60, v61
    v_mfma_f32_16x16x32_bf16 v[132:135], a[76:79], a[28:31], v[36:39]
    s_add_u32 s52, s47, 1
    v_exp_f32 v62, v206
    v_mfma_f32_16x16x32_bf16 v[132:135], a[72:75], a[24:27], v[132:135]
    s_and_b32 s52, s52, 3
    ds_read_b128 a[88:91], v78 offset:12288
    v_add_f32 v51, v51, v62
    v_mfma_f32_16x16x32_bf16 v[132:135], a[68:71], a[20:23], v[132:135]
    s_mul_i32 s64, s52, 36864
    v_exp_f32 v63, v207
    v_mfma_f32_16x16x32_bf16 v[132:135], a[64:67], a[16:19], v[132:135]
    s_add_u32 s64, s64, s59
    ds_read_b128 a[92:95], v79 offset:12288
    v_add_f32 v51, v51, v63
    v_mfma_f32_16x16x32_bf16 v[136:139], a[64:67], a[32:35], v[40:43]
    s_add_u32 s52, s47, 2
    v_exp_f32 v56, v216
    v_mfma_f32_16x16x32_bf16 v[136:139], a[68:71], a[36:39], v[136:139]
    s_and_b32 s52, s52, 3
    ds_read_b64_tr_b16 a[118:119], v82 offset:28672
    v_cvt_pk_bf16_f32 v29, v62, v63
    v_mfma_f32_16x16x32_bf16 v[136:139], a[72:75], a[40:43], v[136:139]
    s_mul_i32 s65, s52, 36864
    v_exp_f32 v57, v217
    v_mfma_f32_16x16x32_bf16 v[136:139], a[76:79], a[44:47], v[136:139]
    s_add_u32 s65, s65, s59
    ds_read_b64_tr_b16 a[120:121], v83 offset:16384
    v_cvt_pk_bf16_f32 v26, v56, v57
    v_mfma_f32_16x16x32_bf16 v[140:143], a[76:79], a[60:63], v[44:47]
    s_add_u32 s52, s47, 3
    v_exp_f32 v58, v220
    v_mfma_f32_16x16x32_bf16 v[140:143], a[72:75], a[56:59], v[140:143]
    s_and_b32 s52, s52, 3
    ds_read_b64_tr_b16 a[122:123], v83 offset:20480
    v_add_f32 v51, v51, v58
    v_mov_b32 v92, -1
    v_mfma_f32_16x16x32_bf16 v[140:143], a[68:71], a[52:55], v[140:143]
    s_mul_i32 s66, s52, 36864
    v_exp_f32 v59, v221
    v_mfma_f32_16x16x32_bf16 v[140:143], a[64:67], a[48:51], v[140:143]
    s_waitcnt lgkmcnt(3)
    ds_read_b64_tr_b16 a[124:125], v83 offset:24576
    v_add_f32 v51, v51, v59
    v_mov_b32 v93, -1
    v_mfma_f32_16x16x32_bf16 v[156:159], a[80:83], a[48:51], v[44:47]
    s_add_u32 s66, s66, s59
    v_exp_f32 v60, v218
    v_mfma_f32_16x16x32_bf16 v[156:159], a[84:87], a[52:55], v[156:159]
    s_add_u32 s52, s40, 1
    ds_read_b64_tr_b16 a[126:127], v83 offset:28672
    v_cvt_pk_bf16_f32 v30, v58, v59
    v_mov_b32 v94, -1
    v_mfma_f32_16x16x32_bf16 v[156:159], a[88:91], a[56:59], v[156:159]
    s_lshr_b32 s52, s52, 2
    v_exp_f32 v61, v219
    v_mfma_f32_16x16x32_bf16 v[156:159], a[92:95], a[60:63], v[156:159]
    s_mul_i32 s52, s52, 109568
    buffer_load_dwordx2 v[4:5], v8, s[28:31], s73 offen sc1
    v_cvt_pk_bf16_f32 v27, v60, v61
    v_mov_b32 v95, -1
    v_mfma_f32_16x16x32_bf16 v[72:75], v[10:13], v[232:235], 0
    s_add_u32 s12, s53, 131072
    v_mfma_f32_16x16x32_bf16 v[152:155], a[92:95], a[44:47], v[40:43]
    s_sub_u32 s12, s12, s52
    v_exp_f32 v62, v222
    v_mfma_f32_16x16x32_bf16 v[152:155], a[88:91], a[40:43], v[152:155]
    v_add_f32 v51, v51, v62
    v_mfma_f32_16x16x32_bf16 v[152:155], a[84:87], a[36:39], v[152:155]
    v_exp_f32 v63, v223
    v_mfma_f32_16x16x32_bf16 v[152:155], a[80:83], a[32:35], v[152:155]
    v_add_f32 v51, v51, v63
    v_mfma_f32_16x16x32_bf16 v[72:75], v[10:13], v[24:27], v[72:75]
    v_mfma_f32_16x16x32_bf16 v[148:151], a[80:83], a[16:19], v[36:39]
    v_exp_f32 v56, v96
    v_mfma_f32_16x16x32_bf16 v[148:151], a[84:87], a[20:23], v[148:151]
    v_cvt_pk_bf16_f32 v31, v62, v63
    v_max3_f32 v9, v48, v49, v51
    v_mfma_f32_16x16x32_bf16 v[148:151], a[88:91], a[24:27], v[148:151]
L_pad4:
    s_cbranch_execz L_pad7
    v_exp_f32 v57, v97
    v_mfma_f32_16x16x32_bf16 v[148:151], a[92:95], a[28:31], v[148:151]
    v_cvt_pk_bf16_f32 v240, v56, v57
    v_add_f32 v50, v54, v72
    v_mfma_f32_16x16x32_bf16 v[144:147], a[92:95], a[12:15], v[32:35]
    v_exp_f32 v58, v100
    v_mfma_f32_16x16x32_bf16 v[144:147], a[88:91], a[8:11], v[144:147]
    v_max_f32 v9, v9, v50
    v_cmp_lt_f32 vcc, s61, v9
    v_mfma_f32_16x16x32_bf16 v[144:147], a[84:87], a[4:7], v[144:147]
    s_waitcnt lgkmcnt(0)
    v_exp_f32 v59, v101
    v_mfma_f32_16x16x32_bf16 v[144:147], a[80:83], a[0:3], v[144:147]
    s_cbranch_vccnz L_rare_stubz0
L_rare_retz0:
    v_add_f32 v53, v49, v58
    v_add_f32 v53, v53, v59
    v_mfma_f32_16x16x32_bf16 a[140:143], a[96:99], v[236:239], a[140:143]
    s_waitcnt vmcnt(12)
    v_exp_f32 v60, v98
    v_mfma_f32_16x16x32_bf16 a[140:143], a[100:103], v[28:31], a[140:143]
    s_barrier
    v_cvt_pk_bf16_f32 v244, v58, v59
    v_mfma_f32_16x16x32_bf16 a[136:139], a[100:103], v[24:27], a[136:139]
    v_exp_f32 v61, v99
    v_mfma_f32_16x16x32_bf16 a[136:139], a[96:99], v[232:235], a[136:139]
    s_add_u32 s45, s48, 0
    v_cvt_pk_bf16_f32 v241, v60, v61
    v_mfma_f32_16x16x32_bf16 a[132:135], a[96:99], v[228:231], a[132:135]
    s_add_u32 m0, s49, 65536
    v_exp_f32 v62, v102
    v_mfma_f32_16x16x32_bf16 a[132:135], a[100:103], v[20:23], a[132:135]
    buffer_load_dwordx4 v15, s[24:27], s45 offen lds
    v_mfma_f32_16x16x32_bf16 a[128:131], a[100:103], v[16:19], a[128:131]
    v_exp_f32 v63, v103
    v_mfma_f32_16x16x32_bf16 a[128:131], a[96:99], v[224:227], a[128:131]
    v_add_f32 v53, v53, v62
    v_add_f32 v53, v53, v63
    v_mfma_f32_16x16x32_bf16 a[144:147], a[104:107], v[224:227], a[144:147]
    v_exp_f32 v56, v112
    v_mfma_f32_16x16x32_bf16 a[144:147], a[108:111], v[16:19], a[144:147]
    ds_read_b64_tr_b16 a[96:97], v84 offset:16384
    v_cvt_pk_bf16_f32 v245, v62, v63
    v_mfma_f32_16x16x32_bf16 a[148:151], a[108:111], v[20:23], a[148:151]
    v_exp_f32 v57, v113
    v_mfma_f32_16x16x32_bf16 a[148:151], a[104:107], v[228:231], a[148:151]
    ds_read_b64_tr_b16 a[98:99], v84 offset:20480
    v_cvt_pk_bf16_f32 v242, v56, v57
    v_mfma_f32_16x16x32_bf16 a[152:155], a[104:107], v[232:235], a[152:155]
    v_exp_f32 v58, v116
    v_mfma_f32_16x16x32_bf16 a[152:155], a[108:111], v[24:27], a[152:155]
    ds_read_b64_tr_b16 a[100:101], v84 offset:24576
    v_add_f32 v53, v53, v58
    v_mfma_f32_16x16x32_bf16 a[156:159], a[108:111], v[28:31], a[156:159]
    v_exp_f32 v59, v117
    v_mfma_f32_16x16x32_bf16 a[156:159], a[104:107], v[236:239], a[156:159]
    ds_read_b64_tr_b16 a[102:103], v84 offset:28672
    v_add_f32 v53, v53, v59
    v_mfma_f32_16x16x32_bf16 a[172:175], a[112:115], v[236:239], a[172:175]
    v_exp_f32 v60, v114
    v_mfma_f32_16x16x32_bf16 a[172:175], a[116:119], v[28:31], a[172:175]
    ds_read_b64_tr_b16 a[104:105], v85 offset:16384
    v_cvt_pk_bf16_f32 v246, v58, v59
    v_mfma_f32_16x16x32_bf16 a[168:171], a[116:119], v[24:27], a[168:171]
    v_exp_f32 v61, v115
    v_mfma_f32_16x16x32_bf16 a[168:171], a[112:115], v[232:235], a[168:171]
    s_add_u32 s78, s58, 59768832
    ds_read_b64_tr_b16 a[106:107], v85 offset:20480
    v_cvt_pk_bf16_f32 v243, v60, v61
    v_mfma_f32_16x16x32_bf16 a[164:167], a[112:115], v[228:231], a[164:167]
    buffer_store_dwordx4 v[92:95], v1, s[28:31], s78 offen sc1
    v_exp_f32 v62, v118
    v_mfma_f32_16x16x32_bf16 a[164:167], a[116:119], v[20:23], a[164:167]
    ds_read_b64_tr_b16 a[108:109], v85 offset:24576
    v_add_f32 v53, v53, v62
    v_mfma_f32_16x16x32_bf16 a[160:163], a[116:119], v[16:19], a[160:163]
    v_exp_f32 v63, v119
    v_mfma_f32_16x16x32_bf16 a[160:163], a[112:115], v[224:227], a[160:163]
    ds_read_b64_tr_b16 a[110:111], v85 offset:28672
    v_add_f32 v53, v53, v63
    v_mfma_f32_16x16x32_bf16 a[176:179], a[120:123], v[224:227], a[176:179]
    v_exp_f32 v56, v104
    v_mfma_f32_16x16x32_bf16 a[176:179], a[124:127], v[16:19], a[176:179]
    ds_read_b64_tr_b16 a[112:113], v86 offset:16384
    v_cvt_pk_bf16_f32 v247, v62, v63
    v_mfma_f32_16x16x32_bf16 a[180:183], a[124:127], v[20:23], a[180:183]
    v_exp_f32 v57, v105
    v_mfma_f32_16x16x32_bf16 a[180:183], a[120:123], v[228:231], a[180:183]
    ds_read_b64_tr_b16 a[114:115], v86 offset:20480
    v_cvt_pk_bf16_f32 v248, v56, v57
    v_mfma_f32_16x16x32_bf16 a[184:187], a[120:123], v[232:235], a[184:187]
    v_exp_f32 v58, v108
    v_mfma_f32_16x16x32_bf16 a[184:187], a[124:127], v[24:27], a[184:187]
    ds_read_b64_tr_b16 a[116:117], v86 offset:24576
    v_add_f32 v55, v51, v58
    v_mfma_f32_16x16x32_bf16 a[188:191], a[124:127], v[28:31], a[188:191]
    v_exp_f32 v59, v109
    v_mfma_f32_16x16x32_bf16 a[188:191], a[120:123], v[236:239], a[188:191]
    s_waitcnt lgkmcnt(7)
    ds_read_b64_tr_b16 a[118:119], v86 offset:28672
    v_add_f32 v55, v55, v59
    v_mfma_f32_16x16x32_bf16 a[204:207], a[96:99], v[236:239], a[204:207]
    v_exp_f32 v60, v106
    v_mfma_f32_16x16x32_bf16 a[204:207], a[100:103], v[28:31], a[204:207]
    ds_read_b64_tr_b16 a[120:121], v87 offset:16384
    v_cvt_pk_bf16_f32 v252, v58, v59
    v_mfma_f32_16x16x32_bf16 a[200:203], a[100:103], v[24:27], a[200:203]
    v_exp_f32 v61, v107
    v_mfma_f32_16x16x32_bf16 a[200:203], a[96:99], v[232:235], a[200:203]
    ds_read_b64_tr_b16 a[122:123], v87 offset:20480
    v_cvt_pk_bf16_f32 v249, v60, v61
    v_mfma_f32_16x16x32_bf16 a[196:199], a[96:99], v[228:231], a[196:199]
    v_exp_f32 v62, v110
    v_mfma_f32_16x16x32_bf16 a[196:199], a[100:103], v[20:23], a[196:199]
    ds_read_b64_tr_b16 a[124:125], v87 offset:24576
    v_add_f32 v55, v55, v62
    v_mfma_f32_16x16x32_bf16 a[192:195], a[100:103], v[16:19], a[192:195]
    v_exp_f32 v63, v111
    v_mfma_f32_16x16x32_bf16 a[192:195], a[96:99], v[224:227], a[192:195]
    s_waitcnt lgkmcnt(7)
    ds_read_b64_tr_b16 a[126:127], v87 offset:28672
    v_add_f32 v55, v55, v63
    v_mfma_f32_16x16x32_bf16 a[208:211], a[104:107], v[224:227], a[208:211]
    s_waitcnt vmcnt(2)
    v_exp_f32 v56, v120
    v_mfma_f32_16x16x32_bf16 a[208:211], a[108:111], v[16:19], a[208:211]
    s_add_u32 s79, s74, 2
    ds_read_b128 a[64:67], v76 offset:16384
    v_cvt_pk_bf16_f32 v253, v62, v63
    v_mfma_f32_16x16x32_bf16 a[212:215], a[108:111], v[20:23], a[212:215]
    v_exp_f32 v57, v121
    v_and_b32 v4, 0xffffff87, v4
    v_xor_b32 v5, s68, v5
    v_subrev_u32 v4, s79, v4
    v_min_u32 v5, 1, v5
    v_lshl_or_b32 v4, v5, 8, v4
    v_cmp_le_u32 vcc, 6, v4
    v_mfma_f32_16x16x32_bf16 a[212:215], a[104:107], v[228:231], a[212:215]
    ds_read_b128 a[68:71], v77 offset:16384
    v_cvt_pk_bf16_f32 v250, v56, v57
    v_mfma_f32_16x16x32_bf16 a[216:219], a[104:107], v[232:235], a[216:219]
    s_cbranch_vccnz L_stub_p2
L_ret_p2:
    v_exp_f32 v58, v124
    v_mfma_f32_16x16x32_bf16 a[216:219], a[108:111], v[24:27], a[216:219]
    ds_read_b128 a[72:75], v78 offset:16384
    v_add_f32 v55, v55, v58
    v_mfma_f32_16x16x32_bf16 a[220:223], a[108:111], v[28:31], a[220:223]
    v_exp_f32 v59, v125
    v_mfma_f32_16x16x32_bf16 a[220:223], a[104:107], v[236:239], a[220:223]
    s_waitcnt lgkmcnt(7)
    ds_read_b128 a[76:79], v79 offset:16384
    v_add_f32 v55, v55, v59
    v_mfma_f32_16x16x32_bf16 a[236:239], a[112:115], v[236:239], a[236:239]
    v_exp_f32 v60, v122
    v_mfma_f32_16x16x32_bf16 a[236:239], a[116:119], v[28:31], a[236:239]
    s_add_u32 s78, s58, 59769856
    ds_read_b128 a[80:83], v76 offset:20480
    v_cvt_pk_bf16_f32 v254, v58, v59
    v_mfma_f32_16x16x32_bf16 a[232:235], a[116:119], v[24:27], a[232:235]
    buffer_store_dwordx4 v[92:95], v1, s[28:31], s78 offen sc1
    v_exp_f32 v61, v123
    v_mfma_f32_16x16x32_bf16 a[232:235], a[112:115], v[232:235], a[232:235]
    ds_read_b128 a[84:87], v77 offset:20480
    v_cvt_pk_bf16_f32 v251, v60, v61
    v_mfma_f32_16x16x32_bf16 a[228:231], a[112:115], v[228:231], a[228:231]
    v_exp_f32 v62, v126
    v_mfma_f32_16x16x32_bf16 a[228:231], a[116:119], v[20:23], a[228:231]
    ds_read_b128 a[88:91], v78 offset:20480
    v_add_f32 v55, v55, v62
    v_mfma_f32_16x16x32_bf16 a[224:227], a[116:119], v[16:19], a[224:227]
    s_add_u32 s44, s48, 4096
    v_exp_f32 v63, v127
    v_mfma_f32_16x16x32_bf16 a[224:227], a[112:115], v[224:227], a[224:227]
    s_waitcnt lgkmcnt(7)
    ds_read_b128 a[92:95], v79 offset:20480
    v_add_f32 v55, v55, v63
    v_mfma_f32_16x16x32_bf16 a[240:243], a[120:123], v[224:227], a[240:243]
    s_add_u32 m0, s49, 69632
    v_exp_f32 v56, v128
    v_mfma_f32_16x16x32_bf16 a[240:243], a[124:127], v[16:19], a[240:243]
    s_waitcnt lgkmcnt(4)
    buffer_load_dwordx4 v15, s[24:27], s44 offen lds
    v_mfma_f32_16x16x32_bf16 a[244:247], a[124:127], v[20:23], a[244:247]
    v_exp_f32 v57, v129
    v_mfma_f32_16x16x32_bf16 a[244:247], a[120:123], v[228:231], a[244:247]
    s_add_u32 s45, s48, 8192
    v_cvt_pk_bf16_f32 v255, v62, v63
    v_cvt_pk_bf16_f32 v16, v56, v57
    v_mfma_f32_16x16x32_bf16 a[248:251], a[120:123], v[232:235], a[248:251]
    s_add_u32 m0, s49, 73728
    v_exp_f32 v58, v132
    v_mfma_f32_16x16x32_bf16 a[248:251], a[124:127], v[24:27], a[248:251]
    s_add_u32 s48, s48, 16384
    buffer_load_dwordx4 v15, s[24:27], s45 offen lds
    v_mfma_f32_16x16x32_bf16 a[252:255], a[124:127], v[28:31], a[252:255]
    v_exp_f32 v59, v133
    v_mfma_f32_16x16x32_bf16 a[252:255], a[120:123], v[236:239], a[252:255]
    v_add_f32 v53, v53, v58
    v_add_f32 v53, v53, v59
    v_mfma_f32_16x16x32_bf16 v[160:163], a[64:67], a[0:3], v[32:35]
    v_exp_f32 v60, v130
    v_mfma_f32_16x16x32_bf16 v[160:163], a[68:71], a[4:7], v[160:163]
    ds_read_b64_tr_b16 a[96:97], v80 offset:32768
    v_cvt_pk_bf16_f32 v20, v58, v59
    v_mfma_f32_16x16x32_bf16 v[160:163], a[72:75], a[8:11], v[160:163]
    v_exp_f32 v61, v131
    v_mfma_f32_16x16x32_bf16 v[160:163], a[76:79], a[12:15], v[160:163]
    ds_read_b64_tr_b16 a[98:99], v80 offset:36864
    v_cvt_pk_bf16_f32 v17, v60, v61
    v_mfma_f32_16x16x32_bf16 v[164:167], a[76:79], a[28:31], v[36:39]
    v_exp_f32 v62, v134
    v_mfma_f32_16x16x32_bf16 v[164:167], a[72:75], a[24:27], v[164:167]
    ds_read_b64_tr_b16 a[100:101], v80 offset:40960
    v_add_f32 v53, v53, v62
    v_mfma_f32_16x16x32_bf16 v[164:167], a[68:71], a[20:23], v[164:167]
    v_exp_f32 v63, v135
    v_mfma_f32_16x16x32_bf16 v[164:167], a[64:67], a[16:19], v[164:167]
    s_add_u32 s78, s58, 59770880
    ds_read_b64_tr_b16 a[102:103], v80 offset:45056
    v_add_f32 v53, v53, v63
    v_mfma_f32_16x16x32_bf16 v[168:171], a[64:67], a[32:35], v[40:43]
    buffer_store_dwordx4 v[92:95], v1, s[28:31], s78 offen sc1
    v_exp_f32 v56, v144
    v_mfma_f32_16x16x32_bf16 v[168:171], a[68:71], a[36:39], v[168:171]
    ds_read_b64_tr_b16 a[104:105], v81 offset:32768
    v_cvt_pk_bf16_f32 v21, v62, v63
    v_mfma_f32_16x16x32_bf16 v[168:171], a[72:75], a[40:43], v[168:171]
    v_exp_f32 v57, v145
    v_mfma_f32_16x16x32_bf16 v[168:171], a[76:79], a[44:47], v[168:171]
    ds_read_b64_tr_b16 a[106:107], v81 offset:36864
    v_cvt_pk_bf16_f32 v18, v56, v57
    v_mfma_f32_16x16x32_bf16 v[172:175], a[76:79], a[60:63], v[44:47]
    v_exp_f32 v58, v148
    v_mfma_f32_16x16x32_bf16 v[172:175], a[72:75], a[56:59], v[172:175]
    ds_read_b64_tr_b16 a[108:109], v81 offset:40960
    v_add_f32 v53, v53, v58
    v_mfma_f32_16x16x32_bf16 v[172:175], a[68:71], a[52:55], v[172:175]
    v_exp_f32 v59, v149
    v_mfma_f32_16x16x32_bf16 v[172:175], a[64:67], a[48:51], v[172:175]
    s_waitcnt lgkmcnt(7)
    ds_read_b64_tr_b16 a[110:111], v81 offset:45056
    v_add_f32 v53, v53, v59
    v_mfma_f32_16x16x32_bf16 v[188:191], a[80:83], a[48:51], v[44:47]
    v_exp_f32 v60, v146
    v_mfma_f32_16x16x32_bf16 v[188:191], a[84:87], a[52:55], v[188:191]
    ds_read_b128 a[64:67], v76 offset:24576
    v_cvt_pk_bf16_f32 v22, v58, v59
    v_mfma_f32_16x16x32_bf16 v[188:191], a[88:91], a[56:59], v[188:191]
    s_add_u32 s44, s48, -4096
    v_exp_f32 v61, v147
    v_mfma_f32_16x16x32_bf16 v[188:191], a[92:95], a[60:63], v[188:191]
    s_add_u32 m0, s49, 77824
    ds_read_b128 a[68:71], v77 offset:24576
    v_cvt_pk_bf16_f32 v19, v60, v61
    v_mfma_f32_16x16x32_bf16 v[72:75], v[10:13], v[240:243], 0
    buffer_load_dwordx4 v15, s[24:27], s44 offen lds
    v_mfma_f32_16x16x32_bf16 v[184:187], a[92:95], a[44:47], v[40:43]
    v_exp_f32 v62, v150
    v_mfma_f32_16x16x32_bf16 v[184:187], a[88:91], a[40:43], v[184:187]
    ds_read_b128 a[72:75], v78 offset:24576
    v_add_f32 v53, v53, v62
    v_mfma_f32_16x16x32_bf16 v[184:187], a[84:87], a[36:39], v[184:187]
    v_exp_f32 v63, v151
    v_mfma_f32_16x16x32_bf16 v[184:187], a[80:83], a[32:35], v[184:187]
    ds_read_b128 a[76:79], v79 offset:24576
    v_add_f32 v53, v53, v63
    v_mfma_f32_16x16x32_bf16 v[72:75], v[10:13], v[16:19], v[72:75]
    ds_read_b64_tr_b16 a[112:113], v82 offset:32768
    v_mfma_f32_16x16x32_bf16 v[180:183], a[80:83], a[16:19], v[36:39]
    v_exp_f32 v56, v136
    v_mfma_f32_16x16x32_bf16 v[180:183], a[84:87], a[20:23], v[180:183]
    ds_read_b64_tr_b16 a[114:115], v82 offset:36864
    v_cvt_pk_bf16_f32 v23, v62, v63
    v_mfma_f32_16x16x32_bf16 v[180:183], a[88:91], a[24:27], v[180:183]
    v_exp_f32 v57, v137
    v_mfma_f32_16x16x32_bf16 v[180:183], a[92:95], a[28:31], v[180:183]
    ds_read_b64_tr_b16 a[116:117], v82 offset:40960
    v_cvt_pk_bf16_f32 v24, v56, v57
    v_mfma_f32_16x16x32_bf16 v[176:179], a[92:95], a[12:15], v[32:35]
    v_exp_f32 v58, v140
    v_mfma_f32_16x16x32_bf16 v[176:179], a[88:91], a[8:11], v[176:179]
    v_add_f32 v55, v55, v58
    v_add_f32 v52, v48, v72
    v_mfma_f32_16x16x32_bf16 v[176:179], a[84:87], a[4:7], v[176:179]
    v_exp_f32 v59, v141
    v_mfma_f32_16x16x32_bf16 v[176:179], a[80:83], a[0:3], v[176:179]
    s_waitcnt lgkmcnt(3)
    v_add_f32 v55, v55, v59
    v_mfma_f32_16x16x32_bf16 v[192:195], a[64:67], a[0:3], v[32:35]
    v_exp_f32 v60, v138
    v_mfma_f32_16x16x32_bf16 v[192:195], a[68:71], a[4:7], v[192:195]
    ds_read_b128 a[80:83], v76 offset:28672
    v_cvt_pk_bf16_f32 v28, v58, v59
    v_mfma_f32_16x16x32_bf16 v[192:195], a[72:75], a[8:11], v[192:195]
    v_exp_f32 v61, v139
    v_mfma_f32_16x16x32_bf16 v[192:195], a[76:79], a[12:15], v[192:195]
    s_add_u32 s78, s58, 59771904
    ds_read_b128 a[84:87], v77 offset:28672
    v_cvt_pk_bf16_f32 v25, v60, v61
    v_mfma_f32_16x16x32_bf16 v[196:199], a[76:79], a[28:31], v[36:39]
    buffer_store_dwordx4 v[92:95], v1, s[28:31], s78 offen sc1
    v_exp_f32 v62, v142
    v_mfma_f32_16x16x32_bf16 v[196:199], a[72:75], a[24:27], v[196:199]
    ds_read_b128 a[88:91], v78 offset:28672
    v_add_f32 v55, v55, v62
    v_mfma_f32_16x16x32_bf16 v[196:199], a[68:71], a[20:23], v[196:199]
    v_exp_f32 v63, v143
    v_mfma_f32_16x16x32_bf16 v[196:199], a[64:67], a[16:19], v[196:199]
    ds_read_b128 a[92:95], v79 offset:28672
    v_add_f32 v55, v55, v63
    v_mfma_f32_16x16x32_bf16 v[200:203], a[64:67], a[32:35], v[40:43]
    v_exp_f32 v56, v152
    v_mfma_f32_16x16x32_bf16 v[200:203], a[68:71], a[36:39], v[200:203]
    ds_read_b64_tr_b16 a[118:119], v82 offset:45056
    v_cvt_pk_bf16_f32 v29, v62, v63
    v_mfma_f32_16x16x32_bf16 v[200:203], a[72:75], a[40:43], v[200:203]
    v_exp_f32 v57, v153
    v_mfma_f32_16x16x32_bf16 v[200:203], a[76:79], a[44:47], v[200:203]
    ds_read_b64_tr_b16 a[120:121], v83 offset:32768
    v_cvt_pk_bf16_f32 v26, v56, v57
    v_mfma_f32_16x16x32_bf16 v[204:207], a[76:79], a[60:63], v[44:47]
    v_exp_f32 v58, v156
    v_mfma_f32_16x16x32_bf16 v[204:207], a[72:75], a[56:59], v[204:207]
    ds_read_b64_tr_b16 a[122:123], v83 offset:36864
    v_add_f32 v55, v55, v58
    v_mfma_f32_16x16x32_bf16 v[204:207], a[68:71], a[52:55], v[204:207]
    v_exp_f32 v59, v157
    v_mfma_f32_16x16x32_bf16 v[204:207], a[64:67], a[48:51], v[204:207]
    s_waitcnt lgkmcnt(3)
    ds_read_b64_tr_b16 a[124:125], v83 offset:40960
    v_add_f32 v55, v55, v59
    v_mfma_f32_16x16x32_bf16 v[220:223], a[80:83], a[48:51], v[44:47]
    v_exp_f32 v60, v154
    v_mfma_f32_16x16x32_bf16 v[220:223], a[84:87], a[52:55], v[220:223]
    ds_read_b64_tr_b16 a[126:127], v83 offset:45056
    v_cvt_pk_bf16_f32 v30, v58, v59
    v_mfma_f32_16x16x32_bf16 v[220:223], a[88:91], a[56:59], v[220:223]
    s_add_u32 s45, s54, 80216064
    v_exp_f32 v61, v155
    v_mfma_f32_16x16x32_bf16 v[220:223], a[92:95], a[60:63], v[220:223]
    s_add_u32 m0, s12, 0
    v_cvt_pk_bf16_f32 v27, v60, v61
    v_mfma_f32_16x16x32_bf16 v[72:75], v[10:13], v[248:251], 0
    buffer_load_dwordx4 v1, s[28:31], s45 offen offset:0 sc1 lds
    v_mfma_f32_16x16x32_bf16 v[216:219], a[92:95], a[44:47], v[40:43]
    v_exp_f32 v62, v158
    v_mfma_f32_16x16x32_bf16 v[216:219], a[88:91], a[40:43], v[216:219]
    buffer_load_dwordx4 v1, s[28:31], s45 offen offset:1024 sc1 lds
    v_add_f32 v55, v55, v62
    v_mfma_f32_16x16x32_bf16 v[216:219], a[84:87], a[36:39], v[216:219]
    v_exp_f32 v63, v159
    v_mfma_f32_16x16x32_bf16 v[216:219], a[80:83], a[32:35], v[216:219]
    buffer_load_dwordx4 v1, s[28:31], s45 offen offset:2048 sc1 lds
    v_add_f32 v55, v55, v63
    v_mfma_f32_16x16x32_bf16 v[72:75], v[10:13], v[24:27], v[72:75]
    buffer_load_dwordx4 v1, s[28:31], s45 offen offset:3072 sc1 lds
    v_mfma_f32_16x16x32_bf16 v[212:215], a[80:83], a[16:19], v[36:39]
    v_exp_f32 v56, v160
    v_mfma_f32_16x16x32_bf16 v[212:215], a[84:87], a[20:23], v[212:215]
    v_cvt_pk_bf16_f32 v31, v62, v63
    v_max3_f32 v9, v52, v53, v55
    v_mfma_f32_16x16x32_bf16 v[212:215], a[88:91], a[24:27], v[212:215]
    v_exp_f32 v57, v161
    v_mfma_f32_16x16x32_bf16 v[212:215], a[92:95], a[28:31], v[212:215]
    v_cvt_pk_bf16_f32 v224, v56, v57
    v_add_f32 v54, v50, v72
    v_mfma_f32_16x16x32_bf16 v[208:211], a[92:95], a[12:15], v[32:35]
    v_exp_f32 v58, v164
    v_mfma_f32_16x16x32_bf16 v[208:211], a[88:91], a[8:11], v[208:211]
    s_add_u32 s44, s54, 80220160
    v_max_f32 v9, v9, v54
    v_cmp_lt_f32 vcc, s61, v9
    v_mfma_f32_16x16x32_bf16 v[208:211], a[84:87], a[4:7], v[208:211]
    s_waitcnt lgkmcnt(0)
    v_exp_f32 v59, v165
    v_mfma_f32_16x16x32_bf16 v[208:211], a[80:83], a[0:3], v[208:211]
    s_cbranch_vccnz L_rare_stubz1
L_rare_retz1:
    v_add_f32 v49, v53, v58
    v_add_f32 v49, v49, v59
    v_mfma_f32_16x16x32_bf16 a[140:143], a[96:99], v[252:255], a[140:143]
    s_waitcnt vmcnt(13)
    v_exp_f32 v60, v162
    v_mfma_f32_16x16x32_bf16 a[140:143], a[100:103], v[28:31], a[140:143]
    s_barrier
    v_cvt_pk_bf16_f32 v228, v58, v59
    v_mfma_f32_16x16x32_bf16 a[136:139], a[100:103], v[24:27], a[136:139]
    s_add_u32 m0, s12, 4096
    v_exp_f32 v61, v163
    v_mfma_f32_16x16x32_bf16 a[136:139], a[96:99], v[248:251], a[136:139]
    buffer_load_dwordx4 v1, s[28:31], s44 offen offset:0 sc1 lds
    v_cvt_pk_bf16_f32 v225, v60, v61
    v_mfma_f32_16x16x32_bf16 a[132:135], a[96:99], v[244:247], a[132:135]
    v_exp_f32 v62, v166
    v_mfma_f32_16x16x32_bf16 a[132:135], a[100:103], v[20:23], a[132:135]
    buffer_load_dwordx4 v1, s[28:31], s44 offen offset:1024 sc1 lds
    v_add_f32 v49, v49, v62
    v_mfma_f32_16x16x32_bf16 a[128:131], a[100:103], v[16:19], a[128:131]
    v_exp_f32 v63, v167
    v_mfma_f32_16x16x32_bf16 a[128:131], a[96:99], v[240:243], a[128:131]
    buffer_load_dwordx4 v1, s[28:31], s44 offen offset:2048 sc1 lds
    v_add_f32 v49, v49, v63
    v_mfma_f32_16x16x32_bf16 a[144:147], a[104:107], v[240:243], a[144:147]
    v_exp_f32 v56, v176
    v_mfma_f32_16x16x32_bf16 a[144:147], a[108:111], v[16:19], a[144:147]
    ds_read_b64_tr_b16 a[96:97], v84 offset:32768
    v_cvt_pk_bf16_f32 v229, v62, v63
    v_mfma_f32_16x16x32_bf16 a[148:151], a[108:111], v[20:23], a[148:151]
    v_exp_f32 v57, v177
    v_mfma_f32_16x16x32_bf16 a[148:151], a[104:107], v[244:247], a[148:151]
    ds_read_b64_tr_b16 a[98:99], v84 offset:36864
    v_cvt_pk_bf16_f32 v226, v56, v57
    v_mfma_f32_16x16x32_bf16 a[152:155], a[104:107], v[248:251], a[152:155]
    v_exp_f32 v58, v180
    v_mfma_f32_16x16x32_bf16 a[152:155], a[108:111], v[24:27], a[152:155]
    ds_read_b64_tr_b16 a[100:101], v84 offset:40960
    v_add_f32 v49, v49, v58
    v_mfma_f32_16x16x32_bf16 a[156:159], a[108:111], v[28:31], a[156:159]
    v_exp_f32 v59, v181
    v_mfma_f32_16x16x32_bf16 a[156:159], a[104:107], v[252:255], a[156:159]
    s_add_u32 s78, s58, 59772928
    ds_read_b64_tr_b16 a[102:103], v84 offset:45056
    v_add_f32 v49, v49, v59
    v_mfma_f32_16x16x32_bf16 a[172:175], a[112:115], v[252:255], a[172:175]
    buffer_store_dwordx4 v[92:95], v1, s[28:31], s78 offen sc1
    v_exp_f32 v60, v178
    v_mfma_f32_16x16x32_bf16 a[172:175], a[116:119], v[28:31], a[172:175]
    ds_read_b64_tr_b16 a[104:105], v85 offset:32768
    v_cvt_pk_bf16_f32 v230, v58, v59
    v_mfma_f32_16x16x32_bf16 a[168:171], a[116:119], v[24:27], a[168:171]
    v_exp_f32 v61, v179
    v_mfma_f32_16x16x32_bf16 a[168:171], a[112:115], v[248:251], a[168:171]
    ds_read_b64_tr_b16 a[106:107], v85 offset:36864
    v_cvt_pk_bf16_f32 v227, v60, v61
    v_mfma_f32_16x16x32_bf16 a[164:167], a[112:115], v[244:247], a[164:167]
    v_exp_f32 v62, v182
    v_mfma_f32_16x16x32_bf16 a[164:167], a[116:119], v[20:23], a[164:167]
    ds_read_b64_tr_b16 a[108:109], v85 offset:40960
    v_add_f32 v49, v49, v62
    v_mfma_f32_16x16x32_bf16 a[160:163], a[116:119], v[16:19], a[160:163]
    v_exp_f32 v63, v183
    v_mfma_f32_16x16x32_bf16 a[160:163], a[112:115], v[240:243], a[160:163]
    ds_read_b64_tr_b16 a[110:111], v85 offset:45056
    v_add_f32 v49, v49, v63
    v_mfma_f32_16x16x32_bf16 a[176:179], a[120:123], v[240:243], a[176:179]
    v_exp_f32 v56, v168
    v_mfma_f32_16x16x32_bf16 a[176:179], a[124:127], v[16:19], a[176:179]
    ds_read_b64_tr_b16 a[112:113], v86 offset:32768
    v_cvt_pk_bf16_f32 v231, v62, v63
    v_mfma_f32_16x16x32_bf16 a[180:183], a[124:127], v[20:23], a[180:183]
    v_exp_f32 v57, v169
    v_mfma_f32_16x16x32_bf16 a[180:183], a[120:123], v[244:247], a[180:183]
    ds_read_b64_tr_b16 a[114:115], v86 offset:36864
    v_cvt_pk_bf16_f32 v232, v56, v57
    v_mfma_f32_16x16x32_bf16 a[184:187], a[120:123], v[248:251], a[184:187]
    v_exp_f32 v58, v172
    v_mfma_f32_16x16x32_bf16 a[184:187], a[124:127], v[24:27], a[184:187]
    ds_read_b64_tr_b16 a[116:117], v86 offset:40960
    v_add_f32 v51, v55, v58
    v_mfma_f32_16x16x32_bf16 a[188:191], a[124:127], v[28:31], a[188:191]
    v_exp_f32 v59, v173
    v_mfma_f32_16x16x32_bf16 a[188:191], a[120:123], v[252:255], a[188:191]
    s_waitcnt lgkmcnt(7)
    ds_read_b64_tr_b16 a[118:119], v86 offset:45056
    v_add_f32 v51, v51, v59
    v_mfma_f32_16x16x32_bf16 a[204:207], a[96:99], v[252:255], a[204:207]
    v_exp_f32 v60, v170
    v_mfma_f32_16x16x32_bf16 a[204:207], a[100:103], v[28:31], a[204:207]
    ds_read_b64_tr_b16 a[120:121], v87 offset:32768
    v_cvt_pk_bf16_f32 v236, v58, v59
    v_mfma_f32_16x16x32_bf16 a[200:203], a[100:103], v[24:27], a[200:203]
    v_exp_f32 v61, v171
    v_mfma_f32_16x16x32_bf16 a[200:203], a[96:99], v[248:251], a[200:203]
    ds_read_b64_tr_b16 a[122:123], v87 offset:36864
    v_cvt_pk_bf16_f32 v233, v60, v61
    v_mfma_f32_16x16x32_bf16 a[196:199], a[96:99], v[244:247], a[196:199]
    v_exp_f32 v62, v174
    v_mfma_f32_16x16x32_bf16 a[196:199], a[100:103], v[20:23], a[196:199]
    ds_read_b64_tr_b16 a[124:125], v87 offset:40960
    v_add_f32 v51, v51, v62
    v_mfma_f32_16x16x32_bf16 a[192:195], a[100:103], v[16:19], a[192:195]
    s_add_u32 s78, s58, 59773952
    v_exp_f32 v63, v175
    v_mfma_f32_16x16x32_bf16 a[192:195], a[96:99], v[240:243], a[192:195]
    s_waitcnt lgkmcnt(7)
    ds_read_b64_tr_b16 a[126:127], v87 offset:45056
    v_add_f32 v51, v51, v63
    v_mfma_f32_16x16x32_bf16 a[208:211], a[104:107], v[240:243], a[208:211]
    buffer_store_dwordx4 v[92:95], v1, s[28:31], s78 offen sc1
    v_exp_f32 v56, v184
    v_mfma_f32_16x16x32_bf16 a[208:211], a[108:111], v[16:19], a[208:211]
    ds_read_b128 a[64:67], v76 offset:32768
    v_cvt_pk_bf16_f32 v237, v62, v63
    v_mfma_f32_16x16x32_bf16 a[212:215], a[108:111], v[20:23], a[212:215]
    v_exp_f32 v57, v185
    v_mfma_f32_16x16x32_bf16 a[212:215], a[104:107], v[244:247], a[212:215]
    ds_read_b128 a[68:71], v77 offset:32768
    v_cvt_pk_bf16_f32 v234, v56, v57
    v_mfma_f32_16x16x32_bf16 a[216:219], a[104:107], v[248:251], a[216:219]
    v_exp_f32 v58, v188
    v_mfma_f32_16x16x32_bf16 a[216:219], a[108:111], v[24:27], a[216:219]
    ds_read_b128 a[72:75], v78 offset:32768
    v_add_f32 v51, v51, v58
    v_mfma_f32_16x16x32_bf16 a[220:223], a[108:111], v[28:31], a[220:223]
    v_exp_f32 v59, v189
    v_mfma_f32_16x16x32_bf16 a[220:223], a[104:107], v[252:255], a[220:223]
    s_waitcnt lgkmcnt(7)
    ds_read_b128 a[76:79], v79 offset:32768
    v_add_f32 v51, v51, v59
    v_mfma_f32_16x16x32_bf16 a[236:239], a[112:115], v[252:255], a[236:239]
    v_exp_f32 v60, v186
    v_mfma_f32_16x16x32_bf16 a[236:239], a[116:119], v[28:31], a[236:239]
    ds_read_b128 a[80:83], v76 offset:36864
    v_cvt_pk_bf16_f32 v238, v58, v59
    v_mfma_f32_16x16x32_bf16 a[232:235], a[116:119], v[24:27], a[232:235]
    v_exp_f32 v61, v187
    v_mfma_f32_16x16x32_bf16 a[232:235], a[112:115], v[248:251], a[232:235]
    ds_read_b128 a[84:87], v77 offset:36864
    v_cvt_pk_bf16_f32 v235, v60, v61
    v_mfma_f32_16x16x32_bf16 a[228:231], a[112:115], v[244:247], a[228:231]
    v_exp_f32 v62, v190
    v_mfma_f32_16x16x32_bf16 a[228:231], a[116:119], v[20:23], a[228:231]
    ds_read_b128 a[88:91], v78 offset:36864
    v_add_f32 v51, v51, v62
    v_mfma_f32_16x16x32_bf16 a[224:227], a[116:119], v[16:19], a[224:227]
    v_exp_f32 v63, v191
    v_mfma_f32_16x16x32_bf16 a[224:227], a[112:115], v[240:243], a[224:227]
    s_waitcnt lgkmcnt(7)
    ds_read_b128 a[92:95], v79 offset:36864
    v_add_f32 v51, v51, v63
    v_mfma_f32_16x16x32_bf16 a[240:243], a[120:123], v[240:243], a[240:243]
    v_exp_f32 v56, v192
    v_mfma_f32_16x16x32_bf16 a[240:243], a[124:127], v[16:19], a[240:243]
    s_add_u32 s45, s54, 80224256
    buffer_load_dwordx4 v1, s[28:31], s44 offen offset:3072 sc1 lds
    v_cvt_pk_bf16_f32 v239, v62, v63
    v_mfma_f32_16x16x32_bf16 a[244:247], a[124:127], v[20:23], a[244:247]
    s_add_u32 m0, s12, 8192
    v_exp_f32 v57, v193
    v_mfma_f32_16x16x32_bf16 a[244:247], a[120:123], v[244:247], a[244:247]
    s_waitcnt lgkmcnt(4)
    buffer_load_dwordx4 v1, s[28:31], s45 offen offset:0 sc1 lds
    v_cvt_pk_bf16_f32 v16, v56, v57
    v_mfma_f32_16x16x32_bf16 a[248:251], a[120:123], v[248:251], a[248:251]
    s_add_u32 s48, s48, 16384
    v_exp_f32 v58, v196
    v_mfma_f32_16x16x32_bf16 a[248:251], a[124:127], v[24:27], a[248:251]
    v_add_f32 v49, v49, v58
    v_mfma_f32_16x16x32_bf16 a[252:255], a[124:127], v[28:31], a[252:255]
    v_exp_f32 v59, v197
    v_mfma_f32_16x16x32_bf16 a[252:255], a[120:123], v[252:255], a[252:255]
    v_add_f32 v49, v49, v59
    v_mfma_f32_16x16x32_bf16 v[96:99], a[64:67], a[0:3], v[32:35]
    v_exp_f32 v60, v194
    v_mfma_f32_16x16x32_bf16 v[96:99], a[68:71], a[4:7], v[96:99]
    ds_read_b64_tr_b16 a[96:97], v80 offset:49152
    v_cvt_pk_bf16_f32 v20, v58, v59
    v_mfma_f32_16x16x32_bf16 v[96:99], a[72:75], a[8:11], v[96:99]
    v_exp_f32 v61, v195
    v_mfma_f32_16x16x32_bf16 v[96:99], a[76:79], a[12:15], v[96:99]
    s_add_u32 s78, s58, 59774976
    ds_read_b64_tr_b16 a[98:99], v80 offset:53248
    v_cvt_pk_bf16_f32 v17, v60, v61
    v_mfma_f32_16x16x32_bf16 v[100:103], a[76:79], a[28:31], v[36:39]
    buffer_store_dwordx4 v[92:95], v1, s[28:31], s78 offen sc1
    v_exp_f32 v62, v198
    v_mfma_f32_16x16x32_bf16 v[100:103], a[72:75], a[24:27], v[100:103]
    ds_read_b64_tr_b16 a[100:101], v80 offset:57344
    v_add_f32 v49, v49, v62
    v_mfma_f32_16x16x32_bf16 v[100:103], a[68:71], a[20:23], v[100:103]
    v_exp_f32 v63, v199
    v_mfma_f32_16x16x32_bf16 v[100:103], a[64:67], a[16:19], v[100:103]
    ds_read_b64_tr_b16 a[102:103], v80 offset:61440
    v_add_f32 v49, v49, v63
    v_mfma_f32_16x16x32_bf16 v[104:107], a[64:67], a[32:35], v[40:43]
    v_exp_f32 v56, v208
    v_mfma_f32_16x16x32_bf16 v[104:107], a[68:71], a[36:39], v[104:107]
    ds_read_b64_tr_b16 a[104:105], v81 offset:49152
    v_cvt_pk_bf16_f32 v21, v62, v63
    v_mfma_f32_16x16x32_bf16 v[104:107], a[72:75], a[40:43], v[104:107]
    v_exp_f32 v57, v209
    v_mfma_f32_16x16x32_bf16 v[104:107], a[76:79], a[44:47], v[104:107]
    ds_read_b64_tr_b16 a[106:107], v81 offset:53248
    v_cvt_pk_bf16_f32 v18, v56, v57
    v_mfma_f32_16x16x32_bf16 v[108:111], a[76:79], a[60:63], v[44:47]
    v_exp_f32 v58, v212
    v_mfma_f32_16x16x32_bf16 v[108:111], a[72:75], a[56:59], v[108:111]
    ds_read_b64_tr_b16 a[108:109], v81 offset:57344
    v_add_f32 v49, v49, v58
    v_mfma_f32_16x16x32_bf16 v[108:111], a[68:71], a[52:55], v[108:111]
    v_exp_f32 v59, v213
    v_mfma_f32_16x16x32_bf16 v[108:111], a[64:67], a[48:51], v[108:111]
    s_waitcnt lgkmcnt(7)
    ds_read_b64_tr_b16 a[110:111], v81 offset:61440
    v_add_f32 v49, v49, v59
    v_mfma_f32_16x16x32_bf16 v[124:127], a[80:83], a[48:51], v[44:47]
    v_exp_f32 v60, v210
    v_mfma_f32_16x16x32_bf16 v[124:127], a[84:87], a[52:55], v[124:127]
    ds_read_b128 a[64:67], v76 offset:40960
    v_cvt_pk_bf16_f32 v22, v58, v59
    v_mfma_f32_16x16x32_bf16 v[124:127], a[88:91], a[56:59], v[124:127]
    v_exp_f32 v61, v211
    v_mfma_f32_16x16x32_bf16 v[124:127], a[92:95], a[60:63], v[124:127]
    ds_read_b128 a[68:71], v77 offset:40960
    v_cvt_pk_bf16_f32 v19, v60, v61
    v_mfma_f32_16x16x32_bf16 v[72:75], v[10:13], v[224:227], 0
    ds_read_b128 a[72:75], v78 offset:40960
    v_mfma_f32_16x16x32_bf16 v[120:123], a[92:95], a[44:47], v[40:43]
    v_exp_f32 v62, v214
    v_mfma_f32_16x16x32_bf16 v[120:123], a[88:91], a[40:43], v[120:123]
    ds_read_b128 a[76:79], v79 offset:40960
    v_add_f32 v49, v49, v62
    v_mfma_f32_16x16x32_bf16 v[120:123], a[84:87], a[36:39], v[120:123]
    v_exp_f32 v63, v215
    v_mfma_f32_16x16x32_bf16 v[120:123], a[80:83], a[32:35], v[120:123]
L_pad3:
    s_cbranch_execz L_pad6
    ds_read_b64_tr_b16 a[112:113], v82 offset:49152
    v_add_f32 v49, v49, v63
    v_mfma_f32_16x16x32_bf16 v[72:75], v[10:13], v[16:19], v[72:75]
    ds_read_b64_tr_b16 a[114:115], v82 offset:53248
    v_mfma_f32_16x16x32_bf16 v[116:119], a[80:83], a[16:19], v[36:39]
    v_exp_f32 v56, v200
    v_mfma_f32_16x16x32_bf16 v[116:119], a[84:87], a[20:23], v[116:119]
    ds_read_b64_tr_b16 a[116:117], v82 offset:57344
    v_cvt_pk_bf16_f32 v23, v62, v63
    v_mfma_f32_16x16x32_bf16 v[116:119], a[88:91], a[24:27], v[116:119]
    v_exp_f32 v57, v201
    v_mfma_f32_16x16x32_bf16 v[116:119], a[92:95], a[28:31], v[116:119]
    s_add_u32 s78, s58, 59776000
    v_cvt_pk_bf16_f32 v24, v56, v57
    v_mfma_f32_16x16x32_bf16 v[112:115], a[92:95], a[12:15], v[32:35]
    buffer_store_dwordx4 v[92:95], v1, s[28:31], s78 offen sc1
    v_exp_f32 v58, v204
    v_mfma_f32_16x16x32_bf16 v[112:115], a[88:91], a[8:11], v[112:115]
    v_add_f32 v51, v51, v58
    v_add_f32 v48, v52, v72
    v_mfma_f32_16x16x32_bf16 v[112:115], a[84:87], a[4:7], v[112:115]
    v_exp_f32 v59, v205
    v_mfma_f32_16x16x32_bf16 v[112:115], a[80:83], a[0:3], v[112:115]
    s_waitcnt lgkmcnt(3)
    v_add_f32 v51, v51, v59
    v_mfma_f32_16x16x32_bf16 v[128:131], a[64:67], a[0:3], v[32:35]
    v_exp_f32 v60, v202
    v_mfma_f32_16x16x32_bf16 v[128:131], a[68:71], a[4:7], v[128:131]
    ds_read_b128 a[80:83], v76 offset:45056
    v_cvt_pk_bf16_f32 v28, v58, v59
    v_mfma_f32_16x16x32_bf16 v[128:131], a[72:75], a[8:11], v[128:131]
    v_exp_f32 v61, v203
    v_mfma_f32_16x16x32_bf16 v[128:131], a[76:79], a[12:15], v[128:131]
    ds_read_b128 a[84:87], v77 offset:45056
    v_cvt_pk_bf16_f32 v25, v60, v61
    v_mfma_f32_16x16x32_bf16 v[132:135], a[76:79], a[28:31], v[36:39]
    v_exp_f32 v62, v206
    v_mfma_f32_16x16x32_bf16 v[132:135], a[72:75], a[24:27], v[132:135]
    ds_read_b128 a[88:91], v78 offset:45056
    v_add_f32 v51, v51, v62
    v_mfma_f32_16x16x32_bf16 v[132:135], a[68:71], a[20:23], v[132:135]
    v_exp_f32 v63, v207
    v_mfma_f32_16x16x32_bf16 v[132:135], a[64:67], a[16:19], v[132:135]
    ds_read_b128 a[92:95], v79 offset:45056
    v_add_f32 v51, v51, v63
    v_mfma_f32_16x16x32_bf16 v[136:139], a[64:67], a[32:35], v[40:43]
    v_exp_f32 v56, v216
    v_mfma_f32_16x16x32_bf16 v[136:139], a[68:71], a[36:39], v[136:139]
    ds_read_b64_tr_b16 a[118:119], v82 offset:61440
    v_cvt_pk_bf16_f32 v29, v62, v63
    v_mfma_f32_16x16x32_bf16 v[136:139], a[72:75], a[40:43], v[136:139]
    v_exp_f32 v57, v217
    v_mfma_f32_16x16x32_bf16 v[136:139], a[76:79], a[44:47], v[136:139]
    ds_read_b64_tr_b16 a[120:121], v83 offset:49152
    v_cvt_pk_bf16_f32 v26, v56, v57
    v_mfma_f32_16x16x32_bf16 v[140:143], a[76:79], a[60:63], v[44:47]
    v_exp_f32 v58, v220
    v_mfma_f32_16x16x32_bf16 v[140:143], a[72:75], a[56:59], v[140:143]
    ds_read_b64_tr_b16 a[122:123], v83 offset:53248
    v_add_f32 v51, v51, v58
    v_mfma_f32_16x16x32_bf16 v[140:143], a[68:71], a[52:55], v[140:143]
    v_exp_f32 v59, v221
    v_mfma_f32_16x16x32_bf16 v[140:143], a[64:67], a[48:51], v[140:143]
    s_waitcnt lgkmcnt(3)
    ds_read_b64_tr_b16 a[124:125], v83 offset:57344
    v_add_f32 v51, v51, v59
    v_mfma_f32_16x16x32_bf16 v[156:159], a[80:83], a[48:51], v[44:47]
    v_exp_f32 v60, v218
    v_mfma_f32_16x16x32_bf16 v[156:159], a[84:87], a[52:55], v[156:159]
    ds_read_b64_tr_b16 a[126:127], v83 offset:61440
    v_cvt_pk_bf16_f32 v30, v58, v59
    v_add_u32 v76, 81920, v1
    v_mfma_f32_16x16x32_bf16 v[156:159], a[88:91], a[56:59], v[156:159]
    v_exp_f32 v61, v219
    v_mfma_f32_16x16x32_bf16 v[156:159], a[92:95], a[60:63], v[156:159]
    v_cvt_pk_bf16_f32 v27, v60, v61
    v_add_u32 v77, 118784, v1
    v_mfma_f32_16x16x32_bf16 v[72:75], v[10:13], v[232:235], 0
    s_add_u32 s78, s58, 59777024
    v_mfma_f32_16x16x32_bf16 v[152:155], a[92:95], a[44:47], v[40:43]
    buffer_store_dwordx4 v[92:95], v1, s[28:31], s78 offen sc1
    v_exp_f32 v62, v222
    v_mfma_f32_16x16x32_bf16 v[152:155], a[88:91], a[40:43], v[152:155]
    v_add_f32 v51, v51, v62
    v_mfma_f32_16x16x32_bf16 v[152:155], a[84:87], a[36:39], v[152:155]
    v_exp_f32 v63, v223
    v_mfma_f32_16x16x32_bf16 v[152:155], a[80:83], a[32:35], v[152:155]
    v_add_f32 v51, v51, v63
    v_mfma_f32_16x16x32_bf16 v[72:75], v[10:13], v[24:27], v[72:75]
    v_mfma_f32_16x16x32_bf16 v[148:151], a[80:83], a[16:19], v[36:39]
    v_exp_f32 v56, v96
    v_mfma_f32_16x16x32_bf16 v[148:151], a[84:87], a[20:23], v[148:151]
    v_cvt_pk_bf16_f32 v31, v62, v63
    v_max3_f32 v9, v48, v49, v51
    v_mfma_f32_16x16x32_bf16 v[148:151], a[88:91], a[24:27], v[148:151]
    v_exp_f32 v57, v97
    v_mfma_f32_16x16x32_bf16 v[148:151], a[92:95], a[28:31], v[148:151]
    v_cvt_pk_bf16_f32 v240, v56, v57
    v_add_f32 v50, v54, v72
    v_mfma_f32_16x16x32_bf16 v[144:147], a[92:95], a[12:15], v[32:35]
    v_exp_f32 v58, v100
    v_mfma_f32_16x16x32_bf16 v[144:147], a[88:91], a[8:11], v[144:147]
    v_max_f32 v9, v9, v50
    v_cmp_lt_f32 vcc, s61, v9
    v_mfma_f32_16x16x32_bf16 v[144:147], a[84:87], a[4:7], v[144:147]
    s_waitcnt lgkmcnt(0)
    v_exp_f32 v59, v101
    v_mfma_f32_16x16x32_bf16 v[144:147], a[80:83], a[0:3], v[144:147]
    s_cbranch_vccnz L_rare_stubz2
L_rare_retz2:
    v_add_f32 v53, v49, v58
    v_add_f32 v53, v53, v59
    v_mfma_f32_16x16x32_bf16 a[140:143], a[96:99], v[236:239], a[140:143]
    s_waitcnt vmcnt(3)
    v_exp_f32 v60, v98
    v_mfma_f32_16x16x32_bf16 a[140:143], a[100:103], v[28:31], a[140:143]
    s_barrier
    v_cvt_pk_bf16_f32 v244, v58, v59
    v_mfma_f32_16x16x32_bf16 a[136:139], a[100:103], v[24:27], a[136:139]
    v_exp_f32 v61, v99
    v_mfma_f32_16x16x32_bf16 a[136:139], a[96:99], v[232:235], a[136:139]
    s_add_u32 s46, s56, 4194304
    v_cvt_pk_bf16_f32 v241, v60, v61
    v_mfma_f32_16x16x32_bf16 a[132:135], a[96:99], v[228:231], a[132:135]
    buffer_load_dwordx4 a[0:3], v1, s[28:31], s46 offen offset:0 sc1
    v_exp_f32 v62, v102
    v_mfma_f32_16x16x32_bf16 a[132:135], a[100:103], v[20:23], a[132:135]
    buffer_load_dwordx4 a[8:11], v1, s[28:31], s46 offen offset:1024 sc1
    v_add_f32 v53, v53, v62
    v_mfma_f32_16x16x32_bf16 a[128:131], a[100:103], v[16:19], a[128:131]
    v_exp_f32 v63, v103
    v_mfma_f32_16x16x32_bf16 a[128:131], a[96:99], v[224:227], a[128:131]
    v_add_f32 v53, v53, v63
    v_mfma_f32_16x16x32_bf16 a[144:147], a[104:107], v[224:227], a[144:147]
    buffer_load_dwordx4 a[16:19], v1, s[28:31], s46 offen offset:2048 sc1
    v_exp_f32 v56, v112
    v_mfma_f32_16x16x32_bf16 a[144:147], a[108:111], v[16:19], a[144:147]
    ds_read_b64_tr_b16 a[96:97], v84 offset:49152
    v_cvt_pk_bf16_f32 v245, v62, v63
    v_mfma_f32_16x16x32_bf16 a[148:151], a[108:111], v[20:23], a[148:151]
    v_exp_f32 v57, v113
    v_mfma_f32_16x16x32_bf16 a[148:151], a[104:107], v[228:231], a[148:151]
    ds_read_b64_tr_b16 a[98:99], v84 offset:53248
    v_cvt_pk_bf16_f32 v242, v56, v57
    v_mfma_f32_16x16x32_bf16 a[152:155], a[104:107], v[232:235], a[152:155]
    buffer_load_dwordx4 a[24:27], v1, s[28:31], s46 offen offset:3072 sc1
    v_exp_f32 v58, v116
    v_mfma_f32_16x16x32_bf16 a[152:155], a[108:111], v[24:27], a[152:155]
    s_add_u32 s46, s56, 4198400
    ds_read_b64_tr_b16 a[100:101], v84 offset:57344
    v_add_f32 v53, v53, v58
    v_mfma_f32_16x16x32_bf16 a[156:159], a[108:111], v[28:31], a[156:159]
    buffer_load_dwordx4 a[4:7], v1, s[28:31], s46 offen offset:0 sc1
    v_exp_f32 v59, v117
    v_mfma_f32_16x16x32_bf16 a[156:159], a[104:107], v[236:239], a[156:159]
    ds_read_b64_tr_b16 a[102:103], v84 offset:61440
    v_add_f32 v53, v53, v59
    v_mfma_f32_16x16x32_bf16 a[172:175], a[112:115], v[236:239], a[172:175]
    v_exp_f32 v60, v114
    v_mfma_f32_16x16x32_bf16 a[172:175], a[116:119], v[28:31], a[172:175]
    ds_read_b64_tr_b16 a[104:105], v85 offset:49152
    v_cvt_pk_bf16_f32 v246, v58, v59
    v_mfma_f32_16x16x32_bf16 a[168:171], a[116:119], v[24:27], a[168:171]
    buffer_load_dwordx4 a[12:15], v1, s[28:31], s46 offen offset:1024 sc1
    v_exp_f32 v61, v115
    v_mfma_f32_16x16x32_bf16 a[168:171], a[112:115], v[232:235], a[168:171]
    ds_read_b64_tr_b16 a[106:107], v85 offset:53248
    v_cvt_pk_bf16_f32 v243, v60, v61
    v_mfma_f32_16x16x32_bf16 a[164:167], a[112:115], v[228:231], a[164:167]
    buffer_load_dwordx4 a[20:23], v1, s[28:31], s46 offen offset:2048 sc1
    v_exp_f32 v62, v118
    v_mfma_f32_16x16x32_bf16 a[164:167], a[116:119], v[20:23], a[164:167]
    ds_read_b64_tr_b16 a[108:109], v85 offset:57344
    v_add_f32 v53, v53, v62
    v_mfma_f32_16x16x32_bf16 a[160:163], a[116:119], v[16:19], a[160:163]
    v_exp_f32 v63, v119
    v_mfma_f32_16x16x32_bf16 a[160:163], a[112:115], v[224:227], a[160:163]
    ds_read_b64_tr_b16 a[110:111], v85 offset:61440
    v_add_f32 v53, v53, v63
    v_mfma_f32_16x16x32_bf16 a[176:179], a[120:123], v[224:227], a[176:179]
    s_add_u32 s44, s54, 80363520
    buffer_load_dwordx4 a[28:31], v1, s[28:31], s46 offen offset:3072 sc1
    v_exp_f32 v56, v104
    v_mfma_f32_16x16x32_bf16 a[176:179], a[124:127], v[16:19], a[176:179]
    s_add_u32 m0, s53, 0
    ds_read_b64_tr_b16 a[112:113], v86 offset:49152
    v_cvt_pk_bf16_f32 v247, v62, v63
    v_mfma_f32_16x16x32_bf16 a[180:183], a[124:127], v[20:23], a[180:183]
    buffer_load_dwordx4 v1, s[28:31], s44 offen offset:0 sc1 lds
    v_exp_f32 v57, v105
    v_mfma_f32_16x16x32_bf16 a[180:183], a[120:123], v[228:231], a[180:183]
    ds_read_b64_tr_b16 a[114:115], v86 offset:53248
    v_cvt_pk_bf16_f32 v248, v56, v57
    v_mfma_f32_16x16x32_bf16 a[184:187], a[120:123], v[232:235], a[184:187]
    v_exp_f32 v58, v108
    v_mfma_f32_16x16x32_bf16 a[184:187], a[124:127], v[24:27], a[184:187]
    ds_read_b64_tr_b16 a[116:117], v86 offset:57344
    v_add_f32 v55, v51, v58
    v_mfma_f32_16x16x32_bf16 a[188:191], a[124:127], v[28:31], a[188:191]
    buffer_load_dwordx4 v1, s[28:31], s44 offen offset:1024 sc1 lds
    v_exp_f32 v59, v109
    v_mfma_f32_16x16x32_bf16 a[188:191], a[120:123], v[236:239], a[188:191]
    s_waitcnt lgkmcnt(7)
    ds_read_b64_tr_b16 a[118:119], v86 offset:61440
    v_add_f32 v55, v55, v59
    v_mfma_f32_16x16x32_bf16 a[204:207], a[96:99], v[236:239], a[204:207]
    buffer_load_dwordx4 v1, s[28:31], s44 offen offset:2048 sc1 lds
    v_exp_f32 v60, v106
    v_mfma_f32_16x16x32_bf16 a[204:207], a[100:103], v[28:31], a[204:207]
    ds_read_b64_tr_b16 a[120:121], v87 offset:49152
    v_cvt_pk_bf16_f32 v252, v58, v59
    v_mfma_f32_16x16x32_bf16 a[200:203], a[100:103], v[24:27], a[200:203]
    v_exp_f32 v61, v107
    v_mfma_f32_16x16x32_bf16 a[200:203], a[96:99], v[232:235], a[200:203]
    ds_read_b64_tr_b16 a[122:123], v87 offset:53248
    v_cvt_pk_bf16_f32 v249, v60, v61
    v_mfma_f32_16x16x32_bf16 a[196:199], a[96:99], v[228:231], a[196:199]
    s_add_u32 s45, s54, 80367616
    buffer_load_dwordx4 v1, s[28:31], s44 offen offset:3072 sc1 lds
    v_exp_f32 v62, v110
    v_mfma_f32_16x16x32_bf16 a[196:199], a[100:103], v[20:23], a[196:199]
    s_add_u32 m0, s53, 4096
    ds_read_b64_tr_b16 a[124:125], v87 offset:57344
    v_add_f32 v55, v55, v62
    v_mfma_f32_16x16x32_bf16 a[192:195], a[100:103], v[16:19], a[192:195]
    buffer_load_dwordx4 v1, s[28:31], s45 offen offset:0 sc1 lds
    v_exp_f32 v63, v111
    v_mfma_f32_16x16x32_bf16 a[192:195], a[96:99], v[224:227], a[192:195]
    s_waitcnt lgkmcnt(7)
    ds_read_b64_tr_b16 a[126:127], v87 offset:61440
    v_add_f32 v55, v55, v63
    v_mfma_f32_16x16x32_bf16 a[208:211], a[104:107], v[224:227], a[208:211]
    v_exp_f32 v56, v120
    v_mfma_f32_16x16x32_bf16 a[208:211], a[108:111], v[16:19], a[208:211]
    buffer_load_dwordx4 v1, s[28:31], s45 offen offset:1024 sc1 lds
    v_cvt_pk_bf16_f32 v253, v62, v63
    v_mfma_f32_16x16x32_bf16 a[212:215], a[108:111], v[20:23], a[212:215]
    v_exp_f32 v57, v121
    v_mfma_f32_16x16x32_bf16 a[212:215], a[104:107], v[228:231], a[212:215]
    v_cvt_pk_bf16_f32 v250, v56, v57
    v_mfma_f32_16x16x32_bf16 a[216:219], a[104:107], v[232:235], a[216:219]
    buffer_load_dwordx4 v1, s[28:31], s45 offen offset:2048 sc1 lds
    v_exp_f32 v58, v124
    v_mfma_f32_16x16x32_bf16 a[216:219], a[108:111], v[24:27], a[216:219]
    v_add_f32 v55, v55, v58
    v_mfma_f32_16x16x32_bf16 a[220:223], a[108:111], v[28:31], a[220:223]
    v_exp_f32 v59, v125
    v_mfma_f32_16x16x32_bf16 a[220:223], a[104:107], v[236:239], a[220:223]
    s_waitcnt lgkmcnt(4)
    buffer_load_dwordx4 v1, s[28:31], s45 offen offset:3072 sc1 lds
    v_add_f32 v55, v55, v59
    v_mfma_f32_16x16x32_bf16 a[236:239], a[112:115], v[236:239], a[236:239]
    s_add_u32 s44, s54, 80371712
    v_exp_f32 v60, v122
    v_mfma_f32_16x16x32_bf16 a[236:239], a[116:119], v[28:31], a[236:239]
    s_add_u32 m0, s53, 8192
    v_cvt_pk_bf16_f32 v254, v58, v59
    v_mfma_f32_16x16x32_bf16 a[232:235], a[116:119], v[24:27], a[232:235]
    buffer_load_dwordx4 v1, s[28:31], s44 offen offset:0 sc1 lds
    v_exp_f32 v61, v123
    v_mfma_f32_16x16x32_bf16 a[232:235], a[112:115], v[232:235], a[232:235]
    v_cvt_pk_bf16_f32 v251, v60, v61
    v_mfma_f32_16x16x32_bf16 a[228:231], a[112:115], v[228:231], a[228:231]
    v_exp_f32 v62, v126
    v_mfma_f32_16x16x32_bf16 a[228:231], a[116:119], v[20:23], a[228:231]
    ds_read_b128 v[32:35], v77 offset:12288
    v_add_f32 v55, v55, v62
    v_mfma_f32_16x16x32_bf16 a[224:227], a[116:119], v[16:19], a[224:227]
    v_exp_f32 v63, v127
    v_mfma_f32_16x16x32_bf16 a[224:227], a[112:115], v[224:227], a[224:227]
    s_waitcnt lgkmcnt(1)
    ds_read_b128 v[36:39], v77 offset:21504
    v_add_f32 v55, v55, v63
    v_mfma_f32_16x16x32_bf16 a[240:243], a[120:123], v[224:227], a[240:243]
    v_exp_f32 v56, v128
    v_mfma_f32_16x16x32_bf16 a[240:243], a[124:127], v[16:19], a[240:243]
    ds_read_b128 v[40:43], v77 offset:30720
    v_cvt_pk_bf16_f32 v255, v62, v63
    v_mfma_f32_16x16x32_bf16 a[244:247], a[124:127], v[20:23], a[244:247]
    v_exp_f32 v57, v129
    v_mfma_f32_16x16x32_bf16 a[244:247], a[120:123], v[228:231], a[244:247]
    ds_read_b128 v[44:47], v1 offset:49152
    v_cvt_pk_bf16_f32 v16, v56, v57
    v_mfma_f32_16x16x32_bf16 a[248:251], a[120:123], v[232:235], a[248:251]
    v_exp_f32 v58, v132
    v_mfma_f32_16x16x32_bf16 a[248:251], a[124:127], v[24:27], a[248:251]
    ds_read_b128 v[88:91], v77 offset:31744
    v_add_f32 v53, v53, v58
    v_mfma_f32_16x16x32_bf16 a[252:255], a[124:127], v[28:31], a[252:255]
    v_exp_f32 v59, v133
    v_mfma_f32_16x16x32_bf16 a[252:255], a[120:123], v[236:239], a[252:255]
    ds_read_b128 v[92:95], v1 offset:50176
    v_add_f32 v53, v53, v59
    s_waitcnt vmcnt(9) lgkmcnt(4)
    v_mfma_f32_16x16x32_bf16 v[160:163], v[32:35], a[0:3], 0
    ds_read_b64_tr_b16 a[96:97], v80 offset:0
    v_exp_f32 v60, v130
    v_mfma_f32_16x16x32_bf16 v[160:163], v[36:39], a[8:11], v[160:163]
    s_add_u32 s46, s56, 4718592
    ds_read_b128 v[232:235], v77 offset:13312
    v_cvt_pk_bf16_f32 v20, v58, v59
    v_mfma_f32_16x16x32_bf16 v[164:167], v[36:39], a[12:15], 0
    buffer_load_dwordx4 a[32:35], v1, s[28:31], s46 offen offset:0 sc1
    v_exp_f32 v61, v131
    v_mfma_f32_16x16x32_bf16 v[164:167], v[32:35], a[4:7], v[164:167]
    s_waitcnt lgkmcnt(4)
    ds_read_b128 v[236:239], v77 offset:22528
    v_cvt_pk_bf16_f32 v17, v60, v61
    v_mfma_f32_16x16x32_bf16 v[164:167], v[40:43], a[20:23], v[164:167]
    ds_read_b64_tr_b16 a[98:99], v80 offset:4096
    v_exp_f32 v62, v134
    v_mfma_f32_16x16x32_bf16 v[164:167], v[44:47], a[28:31], v[164:167]
    ds_read_b128 v[32:35], v77 offset:14336
    v_add_f32 v53, v53, v62
    v_mfma_f32_16x16x32_bf16 v[160:163], v[44:47], a[24:27], v[160:163]
    buffer_load_dwordx4 a[40:43], v1, s[28:31], s46 offen offset:1024 sc1
    v_exp_f32 v63, v135
    v_mfma_f32_16x16x32_bf16 v[160:163], v[40:43], a[16:19], v[160:163]
    s_waitcnt lgkmcnt(5)
    ds_read_b128 v[36:39], v77 offset:23552
    v_add_f32 v53, v53, v63
    v_mfma_f32_16x16x32_bf16 v[168:171], v[88:91], a[16:19], 0
    ds_read_b64_tr_b16 a[100:101], v80 offset:8192
    v_exp_f32 v56, v144
    v_mfma_f32_16x16x32_bf16 v[168:171], v[92:95], a[24:27], v[168:171]
    ds_read_b128 v[40:43], v77 offset:32768
    v_cvt_pk_bf16_f32 v21, v62, v63
    v_mfma_f32_16x16x32_bf16 v[172:175], v[92:95], a[28:31], 0
    buffer_load_dwordx4 a[48:51], v1, s[28:31], s46 offen offset:2048 sc1
    v_exp_f32 v57, v145
    v_mfma_f32_16x16x32_bf16 v[172:175], v[88:91], a[20:23], v[172:175]
    s_waitcnt lgkmcnt(5)
    ds_read_b128 v[44:47], v1 offset:51200
    v_cvt_pk_bf16_f32 v18, v56, v57
    v_mfma_f32_16x16x32_bf16 v[172:175], v[232:235], a[4:7], v[172:175]
    ds_read_b64_tr_b16 a[102:103], v80 offset:12288
    v_exp_f32 v58, v148
    v_mfma_f32_16x16x32_bf16 v[172:175], v[236:239], a[12:15], v[172:175]
    ds_read_b128 v[88:91], v77 offset:33792
    v_add_f32 v53, v53, v58
    v_mfma_f32_16x16x32_bf16 v[168:171], v[236:239], a[8:11], v[168:171]
    buffer_load_dwordx4 a[56:59], v1, s[28:31], s46 offen offset:3072 sc1
    v_exp_f32 v59, v149
    v_mfma_f32_16x16x32_bf16 v[168:171], v[232:235], a[0:3], v[168:171]
    s_waitcnt lgkmcnt(5)
    ds_read_b128 v[92:95], v1 offset:52224
    v_add_f32 v53, v53, v59
    v_mfma_f32_16x16x32_bf16 v[176:179], v[32:35], a[0:3], 0
    ds_read_b64_tr_b16 a[104:105], v81 offset:0
    v_exp_f32 v60, v146
    v_mfma_f32_16x16x32_bf16 v[176:179], v[36:39], a[8:11], v[176:179]
    s_add_u32 s46, s56, 4722688
    ds_read_b128 v[232:235], v77 offset:15360
    v_cvt_pk_bf16_f32 v22, v58, v59
    v_mfma_f32_16x16x32_bf16 v[180:183], v[36:39], a[12:15], 0
    buffer_load_dwordx4 a[36:39], v1, s[28:31], s46 offen offset:0 sc1
    v_exp_f32 v61, v147
    v_mfma_f32_16x16x32_bf16 v[180:183], v[32:35], a[4:7], v[180:183]
    s_waitcnt lgkmcnt(5)
    ds_read_b128 v[236:239], v77 offset:24576
    v_cvt_pk_bf16_f32 v19, v60, v61
    v_mfma_f32_16x16x32_bf16 v[72:75], v[10:13], v[240:243], 0
    v_mfma_f32_16x16x32_bf16 v[180:183], v[40:43], a[20:23], v[180:183]
    ds_read_b64_tr_b16 a[106:107], v81 offset:4096
    v_exp_f32 v62, v150
    v_mfma_f32_16x16x32_bf16 v[180:183], v[44:47], a[28:31], v[180:183]
    ds_read_b128 v[32:35], v77 offset:16384
    v_add_f32 v53, v53, v62
    v_mfma_f32_16x16x32_bf16 v[176:179], v[44:47], a[24:27], v[176:179]
    buffer_load_dwordx4 a[44:47], v1, s[28:31], s46 offen offset:1024 sc1
    v_exp_f32 v63, v151
    v_mfma_f32_16x16x32_bf16 v[176:179], v[40:43], a[16:19], v[176:179]
    s_waitcnt lgkmcnt(5)
    ds_read_b128 v[36:39], v77 offset:25600
    v_add_f32 v53, v53, v63
    v_mfma_f32_16x16x32_bf16 v[72:75], v[10:13], v[16:19], v[72:75]
    v_mfma_f32_16x16x32_bf16 v[184:187], v[88:91], a[16:19], 0
    ds_read_b64_tr_b16 a[108:109], v81 offset:8192
    v_exp_f32 v56, v136
    v_mfma_f32_16x16x32_bf16 v[184:187], v[92:95], a[24:27], v[184:187]
    ds_read_b128 v[40:43], v77 offset:34816
    v_cvt_pk_bf16_f32 v23, v62, v63
    v_mfma_f32_16x16x32_bf16 v[188:191], v[92:95], a[28:31], 0
    buffer_load_dwordx4 a[52:55], v1, s[28:31], s46 offen offset:2048 sc1
    v_exp_f32 v57, v137
    v_mfma_f32_16x16x32_bf16 v[188:191], v[88:91], a[20:23], v[188:191]
    s_waitcnt lgkmcnt(5)
    ds_read_b128 v[44:47], v1 offset:53248
    v_cvt_pk_bf16_f32 v24, v56, v57
    v_mfma_f32_16x16x32_bf16 v[188:191], v[232:235], a[4:7], v[188:191]
    ds_read_b64_tr_b16 a[110:111], v81 offset:12288
    v_exp_f32 v58, v140
    v_mfma_f32_16x16x32_bf16 v[188:191], v[236:239], a[12:15], v[188:191]
    ds_read_b128 v[88:91], v77 offset:35840
    v_add_f32 v55, v55, v58
    v_add_f32 v52, v48, v72
    v_mfma_f32_16x16x32_bf16 v[184:187], v[236:239], a[8:11], v[184:187]
    buffer_load_dwordx4 a[60:63], v1, s[28:31], s46 offen offset:3072 sc1
    v_exp_f32 v59, v141
    v_mfma_f32_16x16x32_bf16 v[184:187], v[232:235], a[0:3], v[184:187]
    s_waitcnt lgkmcnt(5)
    ds_read_b128 v[92:95], v1 offset:54272
    v_add_f32 v55, v55, v59
    v_mfma_f32_16x16x32_bf16 v[192:195], v[32:35], a[0:3], 0
    ds_read_b64_tr_b16 a[112:113], v82 offset:0
    v_exp_f32 v60, v138
    v_mfma_f32_16x16x32_bf16 v[192:195], v[36:39], a[8:11], v[192:195]
    s_add_u32 s46, s56, 5242880
    ds_read_b128 v[232:235], v77 offset:17408
    v_cvt_pk_bf16_f32 v28, v58, v59
    v_mfma_f32_16x16x32_bf16 v[196:199], v[36:39], a[12:15], 0
    buffer_load_dwordx4 a[64:67], v1, s[28:31], s46 offen offset:0 sc1
    v_exp_f32 v61, v139
    v_mfma_f32_16x16x32_bf16 v[196:199], v[32:35], a[4:7], v[196:199]
    s_waitcnt lgkmcnt(5)
    ds_read_b128 v[236:239], v77 offset:26624
    v_cvt_pk_bf16_f32 v25, v60, v61
    v_mfma_f32_16x16x32_bf16 v[196:199], v[40:43], a[20:23], v[196:199]
    ds_read_b64_tr_b16 a[114:115], v82 offset:4096
    v_exp_f32 v62, v142
    v_mfma_f32_16x16x32_bf16 v[196:199], v[44:47], a[28:31], v[196:199]
    ds_read_b128 v[32:35], v77 offset:18432
    v_add_f32 v55, v55, v62
    v_mfma_f32_16x16x32_bf16 v[192:195], v[44:47], a[24:27], v[192:195]
    buffer_load_dwordx4 a[72:75], v1, s[28:31], s46 offen offset:1024 sc1
    v_exp_f32 v63, v143
    v_mfma_f32_16x16x32_bf16 v[192:195], v[40:43], a[16:19], v[192:195]
    s_waitcnt lgkmcnt(5)
    ds_read_b128 v[36:39], v77 offset:27648
    v_add_f32 v55, v55, v63
    v_mfma_f32_16x16x32_bf16 v[200:203], v[88:91], a[16:19], 0
    ds_read_b64_tr_b16 a[116:117], v82 offset:8192
    v_exp_f32 v56, v152
    v_mfma_f32_16x16x32_bf16 v[200:203], v[92:95], a[24:27], v[200:203]
    ds_read_b128 v[40:43], v77 offset:36864
    v_cvt_pk_bf16_f32 v29, v62, v63
    v_mfma_f32_16x16x32_bf16 v[204:207], v[92:95], a[28:31], 0
    buffer_load_dwordx4 a[80:83], v1, s[28:31], s46 offen offset:2048 sc1
    v_exp_f32 v57, v153
    v_mfma_f32_16x16x32_bf16 v[204:207], v[88:91], a[20:23], v[204:207]
    s_waitcnt lgkmcnt(5)
    ds_read_b128 v[44:47], v1 offset:55296
    v_cvt_pk_bf16_f32 v26, v56, v57
    v_mfma_f32_16x16x32_bf16 v[204:207], v[232:235], a[4:7], v[204:207]
    ds_read_b64_tr_b16 a[118:119], v82 offset:12288
    v_exp_f32 v58, v156
    v_mfma_f32_16x16x32_bf16 v[204:207], v[236:239], a[12:15], v[204:207]
    ds_read_b128 v[88:91], v77 offset:37888
    v_add_f32 v55, v55, v58
    v_mfma_f32_16x16x32_bf16 v[200:203], v[236:239], a[8:11], v[200:203]
    buffer_load_dwordx4 a[88:91], v1, s[28:31], s46 offen offset:3072 sc1
    v_exp_f32 v59, v157
    v_mfma_f32_16x16x32_bf16 v[200:203], v[232:235], a[0:3], v[200:203]
    s_waitcnt lgkmcnt(5)
    ds_read_b128 v[92:95], v1 offset:56320
    v_add_f32 v55, v55, v59
    v_mfma_f32_16x16x32_bf16 v[208:211], v[32:35], a[0:3], 0
    ds_read_b64_tr_b16 a[120:121], v83 offset:0
    v_exp_f32 v60, v154
    v_mfma_f32_16x16x32_bf16 v[208:211], v[36:39], a[8:11], v[208:211]
    s_add_u32 s46, s56, 5246976
    ds_read_b128 v[232:235], v77 offset:19456
    v_cvt_pk_bf16_f32 v30, v58, v59
    v_mfma_f32_16x16x32_bf16 v[212:215], v[36:39], a[12:15], 0
    buffer_load_dwordx4 a[68:71], v1, s[28:31], s46 offen offset:0 sc1
    v_exp_f32 v61, v155
    v_mfma_f32_16x16x32_bf16 v[212:215], v[32:35], a[4:7], v[212:215]
    s_waitcnt lgkmcnt(5)
    ds_read_b128 v[236:239], v77 offset:28672
    v_cvt_pk_bf16_f32 v27, v60, v61
    v_mfma_f32_16x16x32_bf16 v[72:75], v[10:13], v[248:251], 0
    v_mfma_f32_16x16x32_bf16 v[212:215], v[40:43], a[20:23], v[212:215]
    ds_read_b64_tr_b16 a[122:123], v83 offset:4096
    v_exp_f32 v62, v158
    v_mfma_f32_16x16x32_bf16 v[212:215], v[44:47], a[28:31], v[212:215]
    ds_read_b128 v[32:35], v77 offset:20480
    v_add_f32 v55, v55, v62
    v_mfma_f32_16x16x32_bf16 v[208:211], v[44:47], a[24:27], v[208:211]
    buffer_load_dwordx4 a[76:79], v1, s[28:31], s46 offen offset:1024 sc1
    v_exp_f32 v63, v159
    v_mfma_f32_16x16x32_bf16 v[208:211], v[40:43], a[16:19], v[208:211]
    s_waitcnt lgkmcnt(5)
    ds_read_b128 v[36:39], v77 offset:29696
    v_add_f32 v55, v55, v63
    v_mfma_f32_16x16x32_bf16 v[72:75], v[10:13], v[24:27], v[72:75]
    v_mfma_f32_16x16x32_bf16 v[216:219], v[88:91], a[16:19], 0
    ds_read_b64_tr_b16 a[124:125], v83 offset:8192
    v_mfma_f32_16x16x32_bf16 v[216:219], v[92:95], a[24:27], v[216:219]
    ds_read_b128 v[40:43], v77 offset:38912
    v_cvt_pk_bf16_f32 v31, v62, v63
    v_max3_f32 v9, v52, v53, v55
    v_mfma_f32_16x16x32_bf16 v[220:223], v[92:95], a[28:31], 0
    buffer_load_dwordx4 a[84:87], v1, s[28:31], s46 offen offset:2048 sc1
    v_mfma_f32_16x16x32_bf16 v[220:223], v[88:91], a[20:23], v[220:223]
    s_waitcnt lgkmcnt(5)
    ds_read_b128 v[44:47], v1 offset:57344
    v_add_f32 v54, v50, v72
    v_mfma_f32_16x16x32_bf16 v[220:223], v[232:235], a[4:7], v[220:223]
    ds_read_b64_tr_b16 a[126:127], v83 offset:12288
    v_mfma_f32_16x16x32_bf16 v[220:223], v[236:239], a[12:15], v[220:223]
    v_max_f32 v9, v9, v54
    v_cmp_lt_f32 vcc, s61, v9
    v_mfma_f32_16x16x32_bf16 v[216:219], v[236:239], a[8:11], v[216:219]
    buffer_load_dwordx4 a[92:95], v1, s[28:31], s46 offen offset:3072 sc1
    v_mfma_f32_16x16x32_bf16 v[216:219], v[232:235], a[0:3], v[216:219]
    s_waitcnt lgkmcnt(4)
    v_mfma_f32_16x16x32_bf16 v[224:227], v[32:35], a[0:3], 0
    v_mfma_f32_16x16x32_bf16 v[224:227], v[36:39], a[8:11], v[224:227]
    v_mfma_f32_16x16x32_bf16 v[228:231], v[36:39], a[12:15], 0
    v_mfma_f32_16x16x32_bf16 v[228:231], v[32:35], a[4:7], v[228:231]
    s_waitcnt lgkmcnt(1)
    v_mfma_f32_16x16x32_bf16 v[228:231], v[40:43], a[20:23], v[228:231]
    v_mfma_f32_16x16x32_bf16 v[228:231], v[44:47], a[28:31], v[228:231]
    v_mfma_f32_16x16x32_bf16 v[224:227], v[44:47], a[24:27], v[224:227]
    s_waitcnt lgkmcnt(0)
    v_mfma_f32_16x16x32_bf16 v[224:227], v[40:43], a[16:19], v[224:227]
    s_cbranch_vccnz L_rare_stubz3
L_rare_retz3:
    s_setreg_imm32_b32 hwreg(HW_REG_MODE, 4, 2), 3
    v_mfma_f32_16x16x32_bf16 a[140:143], a[96:99], v[252:255], a[140:143]
    s_waitcnt vmcnt(16)
    v_mfma_f32_16x16x32_bf16 a[140:143], a[100:103], v[28:31], a[140:143]
    s_barrier
    v_mfma_f32_16x16x32_bf16 a[136:139], a[100:103], v[24:27], a[136:139]
    s_add_u32 s45, s54, 80510976
    v_rcp_f32 v52, v52
    v_mov_b32 v144, v53
    v_mfma_f32_16x16x32_bf16 a[136:139], a[96:99], v[248:251], a[136:139]
    s_add_u32 m0, s53, 81920
    v_rcp_f32 v54, v54
    v_mov_b32 v145, v55
    v_mfma_f32_16x16x32_bf16 a[132:135], a[96:99], v[244:247], a[132:135]
    buffer_load_dwordx4 v1, s[28:31], s45 offen offset:0 sc1 lds
    v_permlane32_swap_b32 v53, v144
    v_mfma_f32_16x16x32_bf16 a[132:135], a[100:103], v[20:23], a[132:135]
    buffer_load_dwordx4 v1, s[28:31], s45 offen offset:1024 sc1 lds
    v_permlane32_swap_b32 v55, v145
    v_mfma_f32_16x16x32_bf16 a[128:131], a[100:103], v[16:19], a[128:131]
    buffer_load_dwordx4 v1, s[28:31], s45 offen offset:2048 sc1 lds
    v_add_f32 v53, v53, v144
    v_mfma_f32_16x16x32_bf16 a[128:131], a[96:99], v[240:243], a[128:131]
    s_add_u32 s44, s54, 80515072
    buffer_load_dwordx4 v1, s[28:31], s45 offen offset:3072 sc1 lds
    v_add_f32 v55, v55, v145
    v_mfma_f32_16x16x32_bf16 a[144:147], a[104:107], v[240:243], a[144:147]
    s_add_u32 m0, s53, 86016
    ds_read_b64_tr_b16 a[96:97], v84 offset:0
    v_mov_b32 v144, v53
    v_mov_b32 v145, v55
    v_mfma_f32_16x16x32_bf16 a[144:147], a[108:111], v[16:19], a[144:147]
    buffer_load_dwordx4 v1, s[28:31], s44 offen offset:0 sc1 lds
    v_permlane16_swap_b32 v53, v144
    v_mfma_f32_16x16x32_bf16 a[148:151], a[108:111], v[20:23], a[148:151]
    ds_read_b64_tr_b16 a[98:99], v84 offset:4096
    v_permlane16_swap_b32 v55, v145
    v_add_f32 v53, v53, v144
    v_mfma_f32_16x16x32_bf16 a[148:151], a[104:107], v[244:247], a[148:151]
    buffer_load_dwordx4 v1, s[28:31], s44 offen offset:1024 sc1 lds
    v_add_f32 v55, v55, v145
    v_mfma_f32_16x16x32_bf16 a[152:155], a[104:107], v[248:251], a[152:155]
    ds_read_b64_tr_b16 a[100:101], v84 offset:8192
    v_rcp_f32 v53, v53
    v_mfma_f32_16x16x32_bf16 a[152:155], a[108:111], v[24:27], a[152:155]
    buffer_load_dwordx4 v1, s[28:31], s44 offen offset:2048 sc1 lds
    v_lshl_add_u32 v68, s40, 6, v2
    v_mfma_f32_16x16x32_bf16 a[156:159], a[108:111], v[28:31], a[156:159]
    ds_read_b64_tr_b16 a[102:103], v84 offset:12288
    v_rcp_f32 v55, v55
    v_mfma_f32_16x16x32_bf16 a[156:159], a[104:107], v[252:255], a[156:159]
    s_add_u32 s45, s54, 80519168
    buffer_load_dwordx4 v1, s[28:31], s44 offen offset:3072 sc1 lds
    v_mul_u32_u24 v71, 3641, v68
    v_mfma_f32_16x16x32_bf16 a[172:175], a[112:115], v[252:255], a[172:175]
    s_add_u32 m0, s53, 90112
    ds_read_b64_tr_b16 a[104:105], v85 offset:0
    v_lshrrev_b32 v71, 16, v71
    v_lshl_add_u32 v69, s40, 6, v2
    v_mfma_f32_16x16x32_bf16 a[172:175], a[116:119], v[28:31], a[172:175]
    buffer_load_dwordx4 v1, s[28:31], s45 offen offset:0 sc1 lds
    v_mul_u32_u24 v71, 864, v71
    v_mfma_f32_16x16x32_bf16 a[168:171], a[116:119], v[24:27], a[168:171]
    ds_read_b64_tr_b16 a[106:107], v85 offset:4096
    v_lshl_add_u32 v68, v68, 4, v71
    v_add_u32 v69, 256, v69
    v_mfma_f32_16x16x32_bf16 a[168:171], a[112:115], v[248:251], a[168:171]
    buffer_load_dwordx4 v[56:59], v68, s[36:39], s60 offen
    v_mul_u32_u24 v71, 3641, v69
    v_mfma_f32_16x16x32_bf16 a[164:167], a[112:115], v[244:247], a[164:167]
    ds_read_b64_tr_b16 a[108:109], v85 offset:8192
    v_lshrrev_b32 v71, 16, v71
    v_lshl_add_u32 v70, s40, 6, v2
    v_mfma_f32_16x16x32_bf16 a[164:167], a[116:119], v[20:23], a[164:167]
    v_mul_u32_u24 v71, 864, v71
    v_add_u32 v70, 512, v70
    v_accvgpr_read_b32 v96, a128
    v_mfma_f32_16x16x32_bf16 a[160:163], a[116:119], v[16:19], a[160:163]
    ds_read_b64_tr_b16 a[110:111], v85 offset:12288
    v_lshl_add_u32 v69, v69, 4, v71
    v_mul_u32_u24 v71, 3641, v70
    v_mfma_f32_16x16x32_bf16 a[160:163], a[112:115], v[240:243], a[160:163]
    buffer_load_dwordx4 v[60:63], v69, s[36:39], s60 offen
    v_lshrrev_b32 v71, 16, v71
    v_mfma_f32_16x16x32_bf16 a[176:179], a[120:123], v[240:243], a[176:179]
    ds_read_b64_tr_b16 a[112:113], v86 offset:0
    v_mul_u32_u24 v71, 864, v71
    v_accvgpr_read_b32 v97, a129
    v_mfma_f32_16x16x32_bf16 a[176:179], a[124:127], v[16:19], a[176:179]
L_pad2:
    s_cbranch_execz L_pad5
    v_lshl_add_u32 v70, v70, 4, v71
    v_accvgpr_read_b32 v98, a130
    v_accvgpr_read_b32 v99, a131
    v_mfma_f32_16x16x32_bf16 a[180:183], a[124:127], v[20:23], a[180:183]
    ds_read_b64_tr_b16 a[114:115], v86 offset:4096
    v_add_u32 v70, s63, v70
    v_accvgpr_read_b32 v100, a144
    v_mfma_f32_16x16x32_bf16 a[180:183], a[120:123], v[244:247], a[180:183]
    buffer_load_dwordx4 v[64:67], v70, s[36:39], s60 offen
    v_accvgpr_read_b32 v101, a145
    v_mfma_f32_16x16x32_bf16 a[184:187], a[120:123], v[248:251], a[184:187]
    ds_read_b64_tr_b16 a[116:117], v86 offset:8192
    v_accvgpr_read_b32 v102, a146
    v_accvgpr_read_b32 v103, a147
    v_mfma_f32_16x16x32_bf16 a[184:187], a[124:127], v[24:27], a[184:187]
    v_mul_f32 v96, v96, v52
    v_mul_f32 v97, v97, v52
    v_mul_f32 v98, v98, v52
    v_mfma_f32_16x16x32_bf16 a[188:191], a[124:127], v[28:31], a[188:191]
    ds_read_b64_tr_b16 a[118:119], v86 offset:12288
    v_mul_f32 v99, v99, v52
    v_mul_f32 v100, v100, v52
    v_mfma_f32_16x16x32_bf16 a[188:191], a[120:123], v[252:255], a[188:191]
    s_waitcnt lgkmcnt(8)
    v_mul_f32 v101, v101, v52
    v_mul_f32 v102, v102, v52
    v_mul_f32 v103, v103, v52
    v_mfma_f32_16x16x32_bf16 a[204:207], a[96:99], v[252:255], a[204:207]
    ds_read_b64_tr_b16 a[120:121], v87 offset:0
    v_cvt_pk_bf16_f32 v128, v96, v97
    v_cvt_pk_bf16_f32 v129, v98, v99
    v_mfma_f32_16x16x32_bf16 a[204:207], a[100:103], v[28:31], a[204:207]
    v_cvt_pk_bf16_f32 v130, v100, v101
    v_cvt_pk_bf16_f32 v131, v102, v103
    v_accvgpr_read_b32 v104, a132
    v_mfma_f32_16x16x32_bf16 a[200:203], a[100:103], v[24:27], a[200:203]
    ds_read_b64_tr_b16 a[122:123], v87 offset:4096
    v_accvgpr_read_b32 v105, a133
    v_accvgpr_read_b32 v106, a134
    v_mfma_f32_16x16x32_bf16 a[200:203], a[96:99], v[248:251], a[200:203]
    s_add_u32 s78, s62, 25165824
    buffer_store_dwordx4 v[128:131], v1, s[28:31], s78 offen offset:0
    v_accvgpr_read_b32 v107, a135
    v_mfma_f32_16x16x32_bf16 a[196:199], a[96:99], v[244:247], a[196:199]
    ds_read_b64_tr_b16 a[124:125], v87 offset:8192
    v_accvgpr_read_b32 v108, a148
    v_accvgpr_read_b32 v109, a149
    v_mfma_f32_16x16x32_bf16 a[196:199], a[100:103], v[20:23], a[196:199]
    v_accvgpr_read_b32 v110, a150
    v_accvgpr_read_b32 v111, a151
    v_mul_f32 v104, v104, v53
    v_mfma_f32_16x16x32_bf16 a[192:195], a[100:103], v[16:19], a[192:195]
    ds_read_b64_tr_b16 a[126:127], v87 offset:12288
    v_mul_f32 v105, v105, v53
    v_mul_f32 v106, v106, v53
    v_mfma_f32_16x16x32_bf16 a[192:195], a[96:99], v[240:243], a[192:195]
    s_waitcnt lgkmcnt(8)
    v_mul_f32 v107, v107, v53
    v_mul_f32 v108, v108, v53
    v_mul_f32 v109, v109, v53
    v_mfma_f32_16x16x32_bf16 a[208:211], a[104:107], v[240:243], a[208:211]
    v_mul_f32 v110, v110, v53
    v_mul_f32 v111, v111, v53
    v_cvt_pk_bf16_f32 v132, v104, v105
    v_mfma_f32_16x16x32_bf16 a[208:211], a[108:111], v[16:19], a[208:211]
    v_cvt_pk_bf16_f32 v133, v106, v107
    v_cvt_pk_bf16_f32 v134, v108, v109
    v_cvt_pk_bf16_f32 v135, v110, v111
    v_mfma_f32_16x16x32_bf16 a[212:215], a[108:111], v[20:23], a[212:215]
    s_add_u32 s78, s62, 25169920
    buffer_store_dwordx4 v[132:135], v1, s[28:31], s78 offen offset:0
    v_accvgpr_read_b32 v112, a136
    v_mfma_f32_16x16x32_bf16 a[212:215], a[104:107], v[244:247], a[212:215]
    v_accvgpr_read_b32 v113, a137
    v_accvgpr_read_b32 v114, a138
    v_accvgpr_read_b32 v115, a139
    v_mfma_f32_16x16x32_bf16 a[216:219], a[104:107], v[248:251], a[216:219]
    v_accvgpr_read_b32 v116, a152
    v_accvgpr_read_b32 v117, a153
    v_accvgpr_read_b32 v118, a154
    v_mfma_f32_16x16x32_bf16 a[216:219], a[108:111], v[24:27], a[216:219]
    v_accvgpr_read_b32 v119, a155
    v_mul_f32 v112, v112, v54
    v_mul_f32 v113, v113, v54
    v_mfma_f32_16x16x32_bf16 a[220:223], a[108:111], v[28:31], a[220:223]
    v_mul_f32 v114, v114, v54
    v_mul_f32 v115, v115, v54
    v_mul_f32 v116, v116, v54
    v_mfma_f32_16x16x32_bf16 a[220:223], a[104:107], v[252:255], a[220:223]
    s_waitcnt lgkmcnt(4)
    v_mul_f32 v117, v117, v54
    v_mul_f32 v118, v118, v54
    v_mul_f32 v119, v119, v54
    v_mfma_f32_16x16x32_bf16 a[236:239], a[112:115], v[252:255], a[236:239]
    v_cvt_pk_bf16_f32 v136, v112, v113
    v_cvt_pk_bf16_f32 v137, v114, v115
    v_cvt_pk_bf16_f32 v138, v116, v117
    v_mfma_f32_16x16x32_bf16 a[236:239], a[116:119], v[28:31], a[236:239]
    v_cvt_pk_bf16_f32 v139, v118, v119
    v_accvgpr_read_b32 v120, a140
    v_accvgpr_read_b32 v121, a141
    v_mfma_f32_16x16x32_bf16 a[232:235], a[116:119], v[24:27], a[232:235]
    ds_read_b128 v[88:91], v1 offset:0
    v_accvgpr_read_b32 v122, a142
    v_accvgpr_read_b32 v123, a143
    v_mfma_f32_16x16x32_bf16 a[232:235], a[112:115], v[248:251], a[232:235]
    s_add_u32 s78, s62, 25174016
    buffer_store_dwordx4 v[136:139], v1, s[28:31], s78 offen offset:0
    v_accvgpr_read_b32 v124, a156
    v_mfma_f32_16x16x32_bf16 a[228:231], a[112:115], v[244:247], a[228:231]
    ds_read_b128 v[92:95], v1 offset:9216
    v_accvgpr_read_b32 v125, a157
    v_accvgpr_read_b32 v126, a158
    v_mfma_f32_16x16x32_bf16 a[228:231], a[116:119], v[20:23], a[228:231]
    v_accvgpr_read_b32 v127, a159
    v_mul_f32 v120, v120, v55
    v_mul_f32 v121, v121, v55
    v_mfma_f32_16x16x32_bf16 a[224:227], a[116:119], v[16:19], a[224:227]
    ds_read_b128 v[232:235], v1 offset:18432
    v_mul_f32 v122, v122, v55
    v_mul_f32 v123, v123, v55
    v_mfma_f32_16x16x32_bf16 a[224:227], a[112:115], v[240:243], a[224:227]
    s_waitcnt lgkmcnt(3)
    v_mul_f32 v124, v124, v55
    v_mul_f32 v125, v125, v55
    v_mul_f32 v126, v126, v55
    v_mfma_f32_16x16x32_bf16 a[240:243], a[120:123], v[240:243], a[240:243]
    ds_read_b128 v[236:239], v1 offset:27648
    v_mul_f32 v127, v127, v55
    v_cvt_pk_bf16_f32 v140, v120, v121
    v_mfma_f32_16x16x32_bf16 a[240:243], a[124:127], v[16:19], a[240:243]
    v_cvt_pk_bf16_f32 v141, v122, v123
    v_cvt_pk_bf16_f32 v142, v124, v125
    v_cvt_pk_bf16_f32 v143, v126, v127
    v_mfma_f32_16x16x32_bf16 a[244:247], a[124:127], v[20:23], a[244:247]
    ds_read_b128 v[32:35], v1 offset:19456
    v_accvgpr_read_b32 v96, a160
    v_accvgpr_read_b32 v97, a161
    v_mfma_f32_16x16x32_bf16 a[244:247], a[120:123], v[244:247], a[244:247]
    s_add_u32 s78, s62, 25178112
    buffer_store_dwordx4 v[140:143], v1, s[28:31], s78 offen offset:0
    v_accvgpr_read_b32 v98, a162
    v_mfma_f32_16x16x32_bf16 a[248:251], a[120:123], v[248:251], a[248:251]
    ds_read_b128 v[36:39], v1 offset:28672
    v_accvgpr_read_b32 v99, a163
    v_accvgpr_read_b32 v100, a176
    v_mfma_f32_16x16x32_bf16 a[248:251], a[124:127], v[24:27], a[248:251]
    v_accvgpr_read_b32 v101, a177
    v_accvgpr_read_b32 v102, a178
    v_accvgpr_read_b32 v103, a179
    v_mfma_f32_16x16x32_bf16 a[252:255], a[124:127], v[28:31], a[252:255]
    v_mul_f32 v96, v96, v52
    v_mul_f32 v97, v97, v52
    v_mul_f32 v98, v98, v52
    v_mfma_f32_16x16x32_bf16 a[252:255], a[120:123], v[252:255], a[252:255]
    s_waitcnt vmcnt(24) lgkmcnt(4)
    v_mul_f32 v99, v99, v52
    v_mul_f32 v100, v100, v52
    v_mul_f32 v101, v101, v52
    v_mfma_f32_16x16x32_bf16 v[160:163], v[88:91], a[32:35], v[160:163]
    ds_read_b128 v[40:43], v1 offset:1024
    v_mul_f32 v102, v102, v52
    v_mul_f32 v103, v103, v52
    v_mfma_f32_16x16x32_bf16 v[160:163], v[92:95], a[40:43], v[160:163]
    s_add_u32 s44, s54, 80658432
    v_cvt_pk_bf16_f32 v128, v96, v97
    v_cvt_pk_bf16_f32 v129, v98, v99
    v_cvt_pk_bf16_f32 v130, v100, v101
    v_mfma_f32_16x16x32_bf16 v[164:167], v[92:95], a[44:47], v[164:167]
    s_add_u32 m0, s53, 118784
    ds_read_b128 v[44:47], v1 offset:10240
    v_cvt_pk_bf16_f32 v131, v102, v103
    v_accvgpr_read_b32 v104, a164
    v_mfma_f32_16x16x32_bf16 v[164:167], v[88:91], a[36:39], v[164:167]
    s_waitcnt lgkmcnt(4)
    buffer_load_dwordx4 v1, s[28:31], s44 offen offset:0 sc1 lds
    v_accvgpr_read_b32 v105, a165
    v_mfma_f32_16x16x32_bf16 v[164:167], v[232:235], a[52:55], v[164:167]
    ds_read_b128 v[88:91], v1 offset:2048
    v_accvgpr_read_b32 v106, a166
    v_accvgpr_read_b32 v107, a167
    v_mfma_f32_16x16x32_bf16 v[164:167], v[236:239], a[60:63], v[164:167]
    buffer_load_dwordx4 v1, s[28:31], s44 offen offset:1024 sc1 lds
    v_accvgpr_read_b32 v108, a180
    v_mfma_f32_16x16x32_bf16 v[160:163], v[236:239], a[56:59], v[160:163]
    ds_read_b128 v[92:95], v1 offset:11264
    v_accvgpr_read_b32 v109, a181
    v_accvgpr_read_b32 v110, a182
    v_mfma_f32_16x16x32_bf16 v[160:163], v[232:235], a[48:51], v[160:163]
    s_waitcnt lgkmcnt(4)
    v_accvgpr_read_b32 v111, a183
    v_mul_f32 v104, v104, v53
    v_mul_f32 v105, v105, v53
    v_mfma_f32_16x16x32_bf16 v[168:171], v[32:35], a[48:51], v[168:171]
    ds_read_b128 v[232:235], v1 offset:20480
    v_mul_f32 v106, v106, v53
    v_mul_f32 v107, v107, v53
    v_mfma_f32_16x16x32_bf16 v[168:171], v[36:39], a[56:59], v[168:171]
    buffer_load_dwordx4 v1, s[28:31], s44 offen offset:2048 sc1 lds
    v_mul_f32 v108, v108, v53
    v_mfma_f32_16x16x32_bf16 v[172:175], v[36:39], a[60:63], v[172:175]
    ds_read_b128 v[236:239], v1 offset:29696
    v_mul_f32 v109, v109, v53
    v_mul_f32 v110, v110, v53
    v_mfma_f32_16x16x32_bf16 v[172:175], v[32:35], a[52:55], v[172:175]
    s_waitcnt lgkmcnt(4)
    buffer_load_dwordx4 v1, s[28:31], s44 offen offset:3072 sc1 lds
    v_mul_f32 v111, v111, v53
    v_mfma_f32_16x16x32_bf16 v[172:175], v[40:43], a[36:39], v[172:175]
    ds_read_b128 v[32:35], v1 offset:21504
    v_cvt_pk_bf16_f32 v132, v104, v105
    v_cvt_pk_bf16_f32 v133, v106, v107
    v_mfma_f32_16x16x32_bf16 v[172:175], v[44:47], a[44:47], v[172:175]
    s_add_u32 s78, s62, 25165824
    buffer_store_dwordx4 v[128:131], v1, s[28:31], s78 offen offset:1024
    v_cvt_pk_bf16_f32 v134, v108, v109
    v_mfma_f32_16x16x32_bf16 v[168:171], v[44:47], a[40:43], v[168:171]
    s_add_u32 s46, s56, 5767168
    ds_read_b128 v[36:39], v1 offset:30720
    v_cvt_pk_bf16_f32 v135, v110, v111
    v_accvgpr_read_b32 v112, a168
    v_mfma_f32_16x16x32_bf16 v[168:171], v[40:43], a[32:35], v[168:171]
    s_waitcnt lgkmcnt(4)
    buffer_load_dwordx4 a[0:3], v1, s[28:31], s46 offen offset:0 sc1
    v_accvgpr_read_b32 v113, a169
    v_mfma_f32_16x16x32_bf16 v[176:179], v[88:91], a[32:35], v[176:179]
    ds_read_b128 v[40:43], v1 offset:3072
    v_accvgpr_read_b32 v114, a170
    v_accvgpr_read_b32 v115, a171
    v_mfma_f32_16x16x32_bf16 v[176:179], v[92:95], a[40:43], v[176:179]
    s_add_u32 s78, s62, 25169920
    buffer_store_dwordx4 v[132:135], v1, s[28:31], s78 offen offset:1024
    v_accvgpr_read_b32 v116, a184
    v_mfma_f32_16x16x32_bf16 v[180:183], v[92:95], a[44:47], v[180:183]
    ds_read_b128 v[44:47], v1 offset:12288
    v_accvgpr_read_b32 v117, a185
    v_accvgpr_read_b32 v118, a186
    v_mfma_f32_16x16x32_bf16 v[180:183], v[88:91], a[36:39], v[180:183]
    s_waitcnt lgkmcnt(4)
    buffer_load_dwordx4 a[8:11], v1, s[28:31], s46 offen offset:1024 sc1
    v_accvgpr_read_b32 v119, a187
    v_mfma_f32_16x16x32_bf16 v[180:183], v[232:235], a[52:55], v[180:183]
    ds_read_b128 v[88:91], v1 offset:4096
    v_mul_f32 v112, v112, v54
    v_mul_f32 v113, v113, v54
    v_mfma_f32_16x16x32_bf16 v[180:183], v[236:239], a[60:63], v[180:183]
    buffer_load_dwordx4 a[16:19], v1, s[28:31], s46 offen offset:2048 sc1
    v_mul_f32 v114, v114, v54
    v_mfma_f32_16x16x32_bf16 v[176:179], v[236:239], a[56:59], v[176:179]
    ds_read_b128 v[92:95], v1 offset:13312
    v_mul_f32 v115, v115, v54
    v_mul_f32 v116, v116, v54
    v_mfma_f32_16x16x32_bf16 v[176:179], v[232:235], a[48:51], v[176:179]
    s_waitcnt lgkmcnt(4)
    v_mul_f32 v117, v117, v54
    v_mul_f32 v118, v118, v54
    v_mul_f32 v119, v119, v54
    v_mfma_f32_16x16x32_bf16 v[184:187], v[32:35], a[48:51], v[184:187]
    ds_read_b128 v[232:235], v1 offset:22528
    v_cvt_pk_bf16_f32 v136, v112, v113
    v_cvt_pk_bf16_f32 v137, v114, v115
    v_mfma_f32_16x16x32_bf16 v[184:187], v[36:39], a[56:59], v[184:187]
    buffer_load_dwordx4 a[24:27], v1, s[28:31], s46 offen offset:3072 sc1
    v_cvt_pk_bf16_f32 v138, v116, v117
    v_mfma_f32_16x16x32_bf16 v[188:191], v[36:39], a[60:63], v[188:191]
    ds_read_b128 v[236:239], v1 offset:31744
    v_cvt_pk_bf16_f32 v139, v118, v119
    v_accvgpr_read_b32 v120, a172
    v_mfma_f32_16x16x32_bf16 v[188:191], v[32:35], a[52:55], v[188:191]
    s_waitcnt lgkmcnt(4)
    v_accvgpr_read_b32 v121, a173
    v_accvgpr_read_b32 v122, a174
    v_accvgpr_read_b32 v123, a175
    v_mfma_f32_16x16x32_bf16 v[188:191], v[40:43], a[36:39], v[188:191]
    ds_read_b128 v[32:35], v1 offset:23552
    v_accvgpr_read_b32 v124, a188
    v_accvgpr_read_b32 v125, a189
    v_mfma_f32_16x16x32_bf16 v[188:191], v[44:47], a[44:47], v[188:191]
    s_add_u32 s45, s54, 80662528
    v_accvgpr_read_b32 v126, a190
    v_accvgpr_read_b32 v127, a191
    v_mul_f32 v120, v120, v55
    v_mfma_f32_16x16x32_bf16 v[184:187], v[44:47], a[40:43], v[184:187]
    s_add_u32 m0, s53, 122880
    ds_read_b128 v[36:39], v1 offset:32768
    v_mul_f32 v121, v121, v55
    v_mul_f32 v122, v122, v55
    v_mfma_f32_16x16x32_bf16 v[184:187], v[40:43], a[32:35], v[184:187]
    s_waitcnt lgkmcnt(4)
    buffer_load_dwordx4 v1, s[28:31], s45 offen offset:0 sc1 lds
    v_mul_f32 v123, v123, v55
    v_mfma_f32_16x16x32_bf16 v[192:195], v[88:91], a[32:35], v[192:195]
    ds_read_b128 v[40:43], v1 offset:5120
    v_mul_f32 v124, v124, v55
    v_mul_f32 v125, v125, v55
    v_mfma_f32_16x16x32_bf16 v[192:195], v[92:95], a[40:43], v[192:195]
    buffer_load_dwordx4 v1, s[28:31], s45 offen offset:1024 sc1 lds
    v_mul_f32 v126, v126, v55
    v_mfma_f32_16x16x32_bf16 v[196:199], v[92:95], a[44:47], v[196:199]
    ds_read_b128 v[44:47], v1 offset:14336
    v_mul_f32 v127, v127, v55
    v_cvt_pk_bf16_f32 v140, v120, v121
    v_mfma_f32_16x16x32_bf16 v[196:199], v[88:91], a[36:39], v[196:199]
    s_waitcnt lgkmcnt(4)
    buffer_load_dwordx4 v1, s[28:31], s45 offen offset:2048 sc1 lds
    v_cvt_pk_bf16_f32 v141, v122, v123
    v_mfma_f32_16x16x32_bf16 v[196:199], v[232:235], a[52:55], v[196:199]
    ds_read_b128 v[88:91], v1 offset:6144
    v_cvt_pk_bf16_f32 v142, v124, v125
    v_cvt_pk_bf16_f32 v143, v126, v127
    v_mfma_f32_16x16x32_bf16 v[196:199], v[236:239], a[60:63], v[196:199]
    buffer_load_dwordx4 v1, s[28:31], s45 offen offset:3072 sc1 lds
    v_accvgpr_read_b32 v96, a192
    v_mfma_f32_16x16x32_bf16 v[192:195], v[236:239], a[56:59], v[192:195]
    ds_read_b128 v[92:95], v1 offset:15360
    v_accvgpr_read_b32 v97, a193
    v_accvgpr_read_b32 v98, a194
    v_mfma_f32_16x16x32_bf16 v[192:195], v[232:235], a[48:51], v[192:195]
    s_waitcnt lgkmcnt(4)
    v_accvgpr_read_b32 v99, a195
    v_accvgpr_read_b32 v100, a208
    v_accvgpr_read_b32 v101, a209
    v_mfma_f32_16x16x32_bf16 v[200:203], v[32:35], a[48:51], v[200:203]
    s_add_u32 s46, s56, 5771264
    ds_read_b128 v[232:235], v1 offset:24576
    v_accvgpr_read_b32 v102, a210
    v_accvgpr_read_b32 v103, a211
    v_mfma_f32_16x16x32_bf16 v[200:203], v[36:39], a[56:59], v[200:203]
    buffer_load_dwordx4 a[4:7], v1, s[28:31], s46 offen offset:0 sc1
    v_mul_f32 v96, v96, v52
    v_mfma_f32_16x16x32_bf16 v[204:207], v[36:39], a[60:63], v[204:207]
    ds_read_b128 v[236:239], v1 offset:33792
    v_mul_f32 v97, v97, v52
    v_mul_f32 v98, v98, v52
    v_mfma_f32_16x16x32_bf16 v[204:207], v[32:35], a[52:55], v[204:207]
    s_waitcnt lgkmcnt(4)
    v_mul_f32 v99, v99, v52
    v_mul_f32 v100, v100, v52
    v_mul_f32 v101, v101, v52
    v_mfma_f32_16x16x32_bf16 v[204:207], v[40:43], a[36:39], v[204:207]
    ds_read_b128 v[32:35], v1 offset:25600
    v_mul_f32 v102, v102, v52
    v_mul_f32 v103, v103, v52
    v_mfma_f32_16x16x32_bf16 v[204:207], v[44:47], a[44:47], v[204:207]
    buffer_load_dwordx4 a[12:15], v1, s[28:31], s46 offen offset:1024 sc1
    v_cvt_pk_bf16_f32 v128, v96, v97
    v_mfma_f32_16x16x32_bf16 v[200:203], v[44:47], a[40:43], v[200:203]
    ds_read_b128 v[36:39], v1 offset:34816
    v_cvt_pk_bf16_f32 v129, v98, v99
    v_cvt_pk_bf16_f32 v130, v100, v101
    v_mfma_f32_16x16x32_bf16 v[200:203], v[40:43], a[32:35], v[200:203]
    s_waitcnt lgkmcnt(4)
    buffer_load_dwordx4 a[20:23], v1, s[28:31], s46 offen offset:2048 sc1
    v_cvt_pk_bf16_f32 v131, v102, v103
    v_mfma_f32_16x16x32_bf16 v[208:211], v[88:91], a[32:35], v[208:211]
    ds_read_b128 v[40:43], v1 offset:7168
    v_accvgpr_read_b32 v104, a196
    v_accvgpr_read_b32 v105, a197
    v_mfma_f32_16x16x32_bf16 v[208:211], v[92:95], a[40:43], v[208:211]
    s_add_u32 s78, s62, 25174016
    buffer_store_dwordx4 v[136:139], v1, s[28:31], s78 offen offset:1024
    v_accvgpr_read_b32 v106, a198
    v_mfma_f32_16x16x32_bf16 v[212:215], v[92:95], a[44:47], v[212:215]
    ds_read_b128 v[44:47], v1 offset:16384
    v_accvgpr_read_b32 v107, a199
    v_accvgpr_read_b32 v108, a212
    v_mfma_f32_16x16x32_bf16 v[212:215], v[88:91], a[36:39], v[212:215]
    s_waitcnt lgkmcnt(4)
    buffer_load_dwordx4 a[28:31], v1, s[28:31], s46 offen offset:3072 sc1
    v_accvgpr_read_b32 v109, a213
    v_mfma_f32_16x16x32_bf16 v[212:215], v[232:235], a[52:55], v[212:215]
    ds_read_b128 v[88:91], v1 offset:8192
    v_accvgpr_read_b32 v110, a214
    v_accvgpr_read_b32 v111, a215
    v_mfma_f32_16x16x32_bf16 v[212:215], v[236:239], a[60:63], v[212:215]
    s_add_u32 s44, s54, 80666624
    v_mul_f32 v104, v104, v53
    v_mul_f32 v105, v105, v53
    v_mul_f32 v106, v106, v53
    v_mfma_f32_16x16x32_bf16 v[208:211], v[236:239], a[56:59], v[208:211]
    s_add_u32 m0, s53, 126976
    ds_read_b128 v[92:95], v1 offset:17408
    v_mul_f32 v107, v107, v53
    v_mul_f32 v108, v108, v53
    v_mfma_f32_16x16x32_bf16 v[208:211], v[232:235], a[48:51], v[208:211]
    s_waitcnt lgkmcnt(4)
    buffer_load_dwordx4 v1, s[28:31], s44 offen offset:0 sc1 lds
    v_mul_f32 v109, v109, v53
    v_mfma_f32_16x16x32_bf16 v[216:219], v[32:35], a[48:51], v[216:219]
    ds_read_b128 v[232:235], v1 offset:26624
    v_mul_f32 v110, v110, v53
    v_mul_f32 v111, v111, v53
    v_mfma_f32_16x16x32_bf16 v[216:219], v[36:39], a[56:59], v[216:219]
    s_add_u32 s78, s62, 25178112
    buffer_store_dwordx4 v[140:143], v1, s[28:31], s78 offen offset:1024
    v_cvt_pk_bf16_f32 v132, v104, v105
    v_mfma_f32_16x16x32_bf16 v[220:223], v[36:39], a[60:63], v[220:223]
    ds_read_b128 v[236:239], v1 offset:35840
    v_cvt_pk_bf16_f32 v133, v106, v107
    v_cvt_pk_bf16_f32 v134, v108, v109
    v_mfma_f32_16x16x32_bf16 v[220:223], v[32:35], a[52:55], v[220:223]
    s_waitcnt lgkmcnt(4)
    v_cvt_pk_bf16_f32 v135, v110, v111
    v_accvgpr_read_b32 v112, a200
    v_accvgpr_read_b32 v113, a201
    v_mfma_f32_16x16x32_bf16 v[220:223], v[40:43], a[36:39], v[220:223]
    s_add_u32 s78, s62, 25165824
    buffer_store_dwordx4 v[128:131], v1, s[28:31], s78 offen offset:2048
    v_accvgpr_read_b32 v114, a202
    v_mfma_f32_16x16x32_bf16 v[220:223], v[44:47], a[44:47], v[220:223]
    s_add_u32 s78, s62, 25169920
    buffer_store_dwordx4 v[132:135], v1, s[28:31], s78 offen offset:2048
    v_accvgpr_read_b32 v115, a203
    v_mfma_f32_16x16x32_bf16 v[216:219], v[44:47], a[40:43], v[216:219]
    s_waitcnt vmcnt(30) lgkmcnt(0)
    v_accvgpr_read_b32 v116, a216
    v_accvgpr_read_b32 v117, a217
    v_accvgpr_read_b32 v118, a218
    v_mfma_f32_16x16x32_bf16 v[216:219], v[40:43], a[32:35], v[216:219]
    s_barrier
    v_accvgpr_read_b32 v119, a219
    v_mul_f32 v112, v112, v54
    v_mul_f32 v113, v113, v54
    v_mfma_f32_16x16x32_bf16 v[224:227], v[88:91], a[32:35], v[224:227]
    ds_read_b128 v[32:35], v76 offset:0
    v_mul_f32 v114, v114, v54
    v_mul_f32 v115, v115, v54
    v_mfma_f32_16x16x32_bf16 v[224:227], v[92:95], a[40:43], v[224:227]
    ds_read_b128 v[36:39], v76 offset:9216
    v_mul_f32 v116, v116, v54
    v_mul_f32 v117, v117, v54
    v_mfma_f32_16x16x32_bf16 v[228:231], v[92:95], a[44:47], v[228:231]
    ds_read_b128 v[40:43], v76 offset:18432
    v_mul_f32 v118, v118, v54
    v_mul_f32 v119, v119, v54
    v_mfma_f32_16x16x32_bf16 v[228:231], v[88:91], a[36:39], v[228:231]
    s_waitcnt lgkmcnt(3)
    ds_read_b128 v[44:47], v76 offset:27648
    v_cvt_pk_bf16_f32 v136, v112, v113
    v_cvt_pk_bf16_f32 v137, v114, v115
    v_mfma_f32_16x16x32_bf16 v[228:231], v[232:235], a[52:55], v[228:231]
    ds_read_b128 v[88:91], v76 offset:19456
    v_cvt_pk_bf16_f32 v138, v116, v117
    v_cvt_pk_bf16_f32 v139, v118, v119
    v_mfma_f32_16x16x32_bf16 v[228:231], v[236:239], a[60:63], v[228:231]
    s_add_u32 s78, s62, 25174016
    buffer_store_dwordx4 v[136:139], v1, s[28:31], s78 offen offset:2048
    v_accvgpr_read_b32 v120, a204
    v_mfma_f32_16x16x32_bf16 v[224:227], v[236:239], a[56:59], v[224:227]
    ds_read_b128 v[92:95], v76 offset:28672
    v_accvgpr_read_b32 v121, a205
    v_accvgpr_read_b32 v122, a206
    v_mfma_f32_16x16x32_bf16 v[224:227], v[232:235], a[48:51], v[224:227]
    s_waitcnt lgkmcnt(4)
    v_accvgpr_read_b32 v123, a207
    v_accvgpr_read_b32 v124, a220
    v_accvgpr_read_b32 v125, a221
    v_mfma_f32_16x16x32_bf16 v[160:163], v[32:35], a[64:67], v[160:163]
    ds_read_b128 v[232:235], v76 offset:1024
    v_accvgpr_read_b32 v126, a222
    v_accvgpr_read_b32 v127, a223
    v_mfma_f32_16x16x32_bf16 v[160:163], v[36:39], a[72:75], v[160:163]
    s_add_u32 s45, s54, 80805888
    v_mul_f32 v120, v120, v55
    v_mul_f32 v121, v121, v55
    v_mul_f32 v122, v122, v55
    v_mfma_f32_16x16x32_bf16 v[164:167], v[36:39], a[76:79], v[164:167]
    s_add_u32 m0, s53, 0
    ds_read_b128 v[236:239], v76 offset:10240
    v_mul_f32 v123, v123, v55
    v_mul_f32 v124, v124, v55
    v_mfma_f32_16x16x32_bf16 v[164:167], v[32:35], a[68:71], v[164:167]
    s_waitcnt lgkmcnt(4)
    buffer_load_dwordx4 v1, s[28:31], s45 offen offset:0 sc1 lds
    v_mul_f32 v125, v125, v55
    v_mfma_f32_16x16x32_bf16 v[164:167], v[40:43], a[84:87], v[164:167]
    ds_read_b128 v[32:35], v76 offset:2048
    v_mul_f32 v126, v126, v55
    v_mul_f32 v127, v127, v55
    v_mfma_f32_16x16x32_bf16 v[164:167], v[44:47], a[92:95], v[164:167]
    buffer_load_dwordx4 v1, s[28:31], s45 offen offset:1024 sc1 lds
    v_cvt_pk_bf16_f32 v140, v120, v121
    v_mfma_f32_16x16x32_bf16 v[160:163], v[44:47], a[88:91], v[160:163]
    ds_read_b128 v[36:39], v76 offset:11264
    v_cvt_pk_bf16_f32 v141, v122, v123
    v_cvt_pk_bf16_f32 v142, v124, v125
    v_mfma_f32_16x16x32_bf16 v[160:163], v[40:43], a[80:83], v[160:163]
    s_waitcnt lgkmcnt(4)
    v_cvt_pk_bf16_f32 v143, v126, v127
    v_accvgpr_read_b32 v96, a224
    v_accvgpr_read_b32 v97, a225
    v_mfma_f32_16x16x32_bf16 v[168:171], v[88:91], a[80:83], v[168:171]
    ds_read_b128 v[40:43], v76 offset:20480
    v_accvgpr_read_b32 v98, a226
    v_accvgpr_read_b32 v99, a227
    v_mfma_f32_16x16x32_bf16 v[168:171], v[92:95], a[88:91], v[168:171]
    buffer_load_dwordx4 v1, s[28:31], s45 offen offset:2048 sc1 lds
    v_accvgpr_read_b32 v100, a240
    v_mfma_f32_16x16x32_bf16 v[172:175], v[92:95], a[92:95], v[172:175]
    ds_read_b128 v[44:47], v76 offset:29696
    v_accvgpr_read_b32 v101, a241
    v_accvgpr_read_b32 v102, a242
    v_mfma_f32_16x16x32_bf16 v[172:175], v[88:91], a[84:87], v[172:175]
    s_waitcnt lgkmcnt(4)
    buffer_load_dwordx4 v1, s[28:31], s45 offen offset:3072 sc1 lds
    v_accvgpr_read_b32 v103, a243
    v_mfma_f32_16x16x32_bf16 v[172:175], v[232:235], a[68:71], v[172:175]
    ds_read_b128 v[88:91], v76 offset:21504
    v_mul_f32 v96, v96, v52
    v_mul_f32 v97, v97, v52
    v_mfma_f32_16x16x32_bf16 v[172:175], v[236:239], a[76:79], v[172:175]
    s_add_u32 s78, s62, 25178112
    buffer_store_dwordx4 v[140:143], v1, s[28:31], s78 offen offset:2048
    v_mul_f32 v98, v98, v52
    v_mfma_f32_16x16x32_bf16 v[168:171], v[236:239], a[72:75], v[168:171]
    s_add_u32 s46, s56, 6291456
    ds_read_b128 v[92:95], v76 offset:30720
    v_mul_f32 v99, v99, v52
    v_mul_f32 v100, v100, v52
    v_mfma_f32_16x16x32_bf16 v[168:171], v[232:235], a[64:67], v[168:171]
    s_waitcnt lgkmcnt(4)
    buffer_load_dwordx4 a[32:35], v1, s[28:31], s46 offen offset:0 sc1
    v_mul_f32 v101, v101, v52
    v_mfma_f32_16x16x32_bf16 v[176:179], v[32:35], a[64:67], v[176:179]
    ds_read_b128 v[232:235], v76 offset:3072
    v_mul_f32 v102, v102, v52
    v_mul_f32 v103, v103, v52
    v_mfma_f32_16x16x32_bf16 v[176:179], v[36:39], a[72:75], v[176:179]
    v_cvt_pk_bf16_f32 v128, v96, v97
    v_cvt_pk_bf16_f32 v129, v98, v99
    v_cvt_pk_bf16_f32 v130, v100, v101
    v_mfma_f32_16x16x32_bf16 v[180:183], v[36:39], a[76:79], v[180:183]
    ds_read_b128 v[236:239], v76 offset:12288
    v_cvt_pk_bf16_f32 v131, v102, v103
    v_accvgpr_read_b32 v104, a228
    v_mfma_f32_16x16x32_bf16 v[180:183], v[32:35], a[68:71], v[180:183]
    s_waitcnt lgkmcnt(4)
    buffer_load_dwordx4 a[40:43], v1, s[28:31], s46 offen offset:1024 sc1
    v_accvgpr_read_b32 v105, a229
    v_mfma_f32_16x16x32_bf16 v[180:183], v[40:43], a[84:87], v[180:183]
    ds_read_b128 v[32:35], v76 offset:4096
    v_accvgpr_read_b32 v106, a230
    v_accvgpr_read_b32 v107, a231
    v_mfma_f32_16x16x32_bf16 v[180:183], v[44:47], a[92:95], v[180:183]
    buffer_load_dwordx4 a[48:51], v1, s[28:31], s46 offen offset:2048 sc1
    v_accvgpr_read_b32 v108, a244
    v_mfma_f32_16x16x32_bf16 v[176:179], v[44:47], a[88:91], v[176:179]
    ds_read_b128 v[36:39], v76 offset:13312
    v_accvgpr_read_b32 v109, a245
    v_accvgpr_read_b32 v110, a246
    v_mfma_f32_16x16x32_bf16 v[176:179], v[40:43], a[80:83], v[176:179]
    s_waitcnt lgkmcnt(4)
    v_accvgpr_read_b32 v111, a247
    v_mul_f32 v104, v104, v53
    v_mul_f32 v105, v105, v53
    v_mfma_f32_16x16x32_bf16 v[184:187], v[88:91], a[80:83], v[184:187]
    ds_read_b128 v[40:43], v76 offset:22528
    v_mul_f32 v106, v106, v53
    v_mul_f32 v107, v107, v53
    v_mfma_f32_16x16x32_bf16 v[184:187], v[92:95], a[88:91], v[184:187]
    buffer_load_dwordx4 a[56:59], v1, s[28:31], s46 offen offset:3072 sc1
    v_mul_f32 v108, v108, v53
    v_mfma_f32_16x16x32_bf16 v[188:191], v[92:95], a[92:95], v[188:191]
    ds_read_b128 v[44:47], v76 offset:31744
    v_mul_f32 v109, v109, v53
    v_mul_f32 v110, v110, v53
    v_mfma_f32_16x16x32_bf16 v[188:191], v[88:91], a[84:87], v[188:191]
    s_waitcnt lgkmcnt(4)
    v_mul_f32 v111, v111, v53
    v_cvt_pk_bf16_f32 v132, v104, v105
    v_cvt_pk_bf16_f32 v133, v106, v107
    v_mfma_f32_16x16x32_bf16 v[188:191], v[232:235], a[68:71], v[188:191]
    ds_read_b128 v[88:91], v76 offset:23552
    v_cvt_pk_bf16_f32 v134, v108, v109
    v_cvt_pk_bf16_f32 v135, v110, v111
    v_mfma_f32_16x16x32_bf16 v[188:191], v[236:239], a[76:79], v[188:191]
    s_add_u32 s44, s54, 80809984
    v_accvgpr_read_b32 v112, a232
    v_accvgpr_read_b32 v113, a233
    v_accvgpr_read_b32 v114, a234
    v_mfma_f32_16x16x32_bf16 v[184:187], v[236:239], a[72:75], v[184:187]
L_pad1:
    s_cbranch_execz L_pad4
    s_add_u32 m0, s53, 4096
    ds_read_b128 v[92:95], v76 offset:32768
    v_accvgpr_read_b32 v115, a235
    v_accvgpr_read_b32 v116, a248
    v_mfma_f32_16x16x32_bf16 v[184:187], v[232:235], a[64:67], v[184:187]
    s_waitcnt lgkmcnt(4)
    buffer_load_dwordx4 v1, s[28:31], s44 offen offset:0 sc1 lds
    v_accvgpr_read_b32 v117, a249
    v_mfma_f32_16x16x32_bf16 v[192:195], v[32:35], a[64:67], v[192:195]
    ds_read_b128 v[232:235], v76 offset:5120
    v_accvgpr_read_b32 v118, a250
    v_accvgpr_read_b32 v119, a251
    v_mfma_f32_16x16x32_bf16 v[192:195], v[36:39], a[72:75], v[192:195]
    buffer_load_dwordx4 v1, s[28:31], s44 offen offset:1024 sc1 lds
    v_mul_f32 v112, v112, v54
    v_mfma_f32_16x16x32_bf16 v[196:199], v[36:39], a[76:79], v[196:199]
    ds_read_b128 v[236:239], v76 offset:14336
    v_mul_f32 v113, v113, v54
    v_mul_f32 v114, v114, v54
    v_mfma_f32_16x16x32_bf16 v[196:199], v[32:35], a[68:71], v[196:199]
    s_waitcnt lgkmcnt(4)
    buffer_load_dwordx4 v1, s[28:31], s44 offen offset:2048 sc1 lds
    v_mul_f32 v115, v115, v54
    v_mfma_f32_16x16x32_bf16 v[196:199], v[40:43], a[84:87], v[196:199]
    ds_read_b128 v[32:35], v76 offset:6144
    v_mul_f32 v116, v116, v54
    v_mul_f32 v117, v117, v54
    v_mfma_f32_16x16x32_bf16 v[196:199], v[44:47], a[92:95], v[196:199]
    buffer_load_dwordx4 v1, s[28:31], s44 offen offset:3072 sc1 lds
    v_mul_f32 v118, v118, v54
    v_mfma_f32_16x16x32_bf16 v[192:195], v[44:47], a[88:91], v[192:195]
    ds_read_b128 v[36:39], v76 offset:15360
    v_mul_f32 v119, v119, v54
    v_cvt_pk_bf16_f32 v136, v112, v113
    v_mfma_f32_16x16x32_bf16 v[192:195], v[40:43], a[80:83], v[192:195]
    s_waitcnt lgkmcnt(4)
    v_cvt_pk_bf16_f32 v137, v114, v115
    v_cvt_pk_bf16_f32 v138, v116, v117
    v_cvt_pk_bf16_f32 v139, v118, v119
    v_mfma_f32_16x16x32_bf16 v[200:203], v[88:91], a[80:83], v[200:203]
    s_add_u32 s46, s56, 6295552
    ds_read_b128 v[40:43], v76 offset:24576
    v_accvgpr_read_b32 v120, a236
    v_accvgpr_read_b32 v121, a237
    v_mfma_f32_16x16x32_bf16 v[200:203], v[92:95], a[88:91], v[200:203]
    buffer_load_dwordx4 a[36:39], v1, s[28:31], s46 offen offset:0 sc1
    v_accvgpr_read_b32 v122, a238
    v_mfma_f32_16x16x32_bf16 v[204:207], v[92:95], a[92:95], v[204:207]
    ds_read_b128 v[44:47], v76 offset:33792
    v_accvgpr_read_b32 v123, a239
    v_accvgpr_read_b32 v124, a252
    v_mfma_f32_16x16x32_bf16 v[204:207], v[88:91], a[84:87], v[204:207]
    s_waitcnt lgkmcnt(4)
    v_accvgpr_read_b32 v125, a253
    v_accvgpr_read_b32 v126, a254
    v_accvgpr_read_b32 v127, a255
    v_mfma_f32_16x16x32_bf16 v[204:207], v[232:235], a[68:71], v[204:207]
    ds_read_b128 v[88:91], v76 offset:25600
    v_mul_f32 v120, v120, v55
    v_mul_f32 v121, v121, v55
    v_mfma_f32_16x16x32_bf16 v[204:207], v[236:239], a[76:79], v[204:207]
    buffer_load_dwordx4 a[44:47], v1, s[28:31], s46 offen offset:1024 sc1
    v_mul_f32 v122, v122, v55
    v_mfma_f32_16x16x32_bf16 v[200:203], v[236:239], a[72:75], v[200:203]
    ds_read_b128 v[92:95], v76 offset:34816
    v_mul_f32 v123, v123, v55
    v_mul_f32 v124, v124, v55
    v_mfma_f32_16x16x32_bf16 v[200:203], v[232:235], a[64:67], v[200:203]
    s_waitcnt lgkmcnt(4)
    buffer_load_dwordx4 a[52:55], v1, s[28:31], s46 offen offset:2048 sc1
    v_mul_f32 v125, v125, v55
    v_mfma_f32_16x16x32_bf16 v[208:211], v[32:35], a[64:67], v[208:211]
    ds_read_b128 v[232:235], v76 offset:7168
    v_mul_f32 v126, v126, v55
    v_mul_f32 v127, v127, v55
    v_mfma_f32_16x16x32_bf16 v[208:211], v[36:39], a[72:75], v[208:211]
    s_add_u32 s78, s62, 25165824
    buffer_store_dwordx4 v[128:131], v1, s[28:31], s78 offen offset:3072
    v_cvt_pk_bf16_f32 v140, v120, v121
    v_mfma_f32_16x16x32_bf16 v[212:215], v[36:39], a[76:79], v[212:215]
    ds_read_b128 v[236:239], v76 offset:16384
    v_cvt_pk_bf16_f32 v141, v122, v123
    v_cvt_pk_bf16_f32 v142, v124, v125
    v_mfma_f32_16x16x32_bf16 v[212:215], v[32:35], a[68:71], v[212:215]
    s_waitcnt lgkmcnt(4)
    buffer_load_dwordx4 a[60:63], v1, s[28:31], s46 offen offset:3072 sc1
    v_cvt_pk_bf16_f32 v143, v126, v127
    v_mfma_f32_16x16x32_bf16 v[212:215], v[40:43], a[84:87], v[212:215]
    ds_read_b128 v[32:35], v76 offset:8192
    v_mfma_f32_16x16x32_bf16 v[212:215], v[44:47], a[92:95], v[212:215]
    s_add_u32 s45, s54, 80814080
    v_mfma_f32_16x16x32_bf16 v[208:211], v[44:47], a[88:91], v[208:211]
    s_add_u32 m0, s53, 8192
    ds_read_b128 v[36:39], v76 offset:17408
    v_mfma_f32_16x16x32_bf16 v[208:211], v[40:43], a[80:83], v[208:211]
    s_waitcnt lgkmcnt(4)
    buffer_load_dwordx4 v1, s[28:31], s45 offen offset:0 sc1 lds
    v_mfma_f32_16x16x32_bf16 v[216:219], v[88:91], a[80:83], v[216:219]
    ds_read_b128 v[40:43], v76 offset:26624
    v_mfma_f32_16x16x32_bf16 v[216:219], v[92:95], a[88:91], v[216:219]
    s_add_u32 s78, s62, 25169920
    buffer_store_dwordx4 v[132:135], v1, s[28:31], s78 offen offset:3072
    v_mfma_f32_16x16x32_bf16 v[220:223], v[92:95], a[92:95], v[220:223]
    ds_read_b128 v[44:47], v76 offset:35840
    v_mfma_f32_16x16x32_bf16 v[220:223], v[88:91], a[84:87], v[220:223]
    s_waitcnt lgkmcnt(4)
    v_mfma_f32_16x16x32_bf16 v[220:223], v[232:235], a[68:71], v[220:223]
    s_add_u32 s78, s62, 25174016
    buffer_store_dwordx4 v[136:139], v1, s[28:31], s78 offen offset:3072
    v_mfma_f32_16x16x32_bf16 v[220:223], v[236:239], a[76:79], v[220:223]
    s_add_u32 s78, s62, 25178112
    buffer_store_dwordx4 v[140:143], v1, s[28:31], s78 offen offset:3072
    v_mfma_f32_16x16x32_bf16 v[216:219], v[236:239], a[72:75], v[216:219]
    s_waitcnt vmcnt(26) lgkmcnt(0)
    v_mfma_f32_16x16x32_bf16 v[216:219], v[232:235], a[64:67], v[216:219]
    s_barrier
    v_mfma_f32_16x16x32_bf16 v[224:227], v[32:35], a[64:67], v[224:227]
    ds_read_b128 v[88:91], v77 offset:0
    v_mfma_f32_16x16x32_bf16 v[224:227], v[36:39], a[72:75], v[224:227]
    ds_read_b128 v[92:95], v77 offset:9216
    v_mfma_f32_16x16x32_bf16 v[228:231], v[36:39], a[76:79], v[228:231]
    ds_read_b128 v[232:235], v77 offset:18432
    v_mfma_f32_16x16x32_bf16 v[228:231], v[32:35], a[68:71], v[228:231]
    s_waitcnt lgkmcnt(3)
    ds_read_b128 v[236:239], v77 offset:27648
    v_mfma_f32_16x16x32_bf16 v[228:231], v[40:43], a[84:87], v[228:231]
    ds_read_b128 v[32:35], v77 offset:19456
    v_mfma_f32_16x16x32_bf16 v[228:231], v[44:47], a[92:95], v[228:231]
    v_mfma_f32_16x16x32_bf16 v[224:227], v[44:47], a[88:91], v[224:227]
    ds_read_b128 v[36:39], v77 offset:28672
    v_mfma_f32_16x16x32_bf16 v[224:227], v[40:43], a[80:83], v[224:227]
    s_waitcnt lgkmcnt(4)
    v_mfma_f32_16x16x32_bf16 v[160:163], v[88:91], a[0:3], v[160:163]
    ds_read_b128 v[40:43], v77 offset:1024
    v_mfma_f32_16x16x32_bf16 v[160:163], v[92:95], a[8:11], v[160:163]
    s_add_u32 s44, s54, 80953344
    v_mfma_f32_16x16x32_bf16 v[164:167], v[92:95], a[12:15], v[164:167]
    s_add_u32 m0, s53, 81920
    ds_read_b128 v[44:47], v77 offset:10240
    v_mfma_f32_16x16x32_bf16 v[164:167], v[88:91], a[4:7], v[164:167]
    s_waitcnt lgkmcnt(4)
    buffer_load_dwordx4 v1, s[28:31], s44 offen offset:0 sc1 lds
    v_mfma_f32_16x16x32_bf16 v[164:167], v[232:235], a[20:23], v[164:167]
    ds_read_b128 v[88:91], v77 offset:2048
    v_mfma_f32_16x16x32_bf16 v[164:167], v[236:239], a[28:31], v[164:167]
    buffer_load_dwordx4 v1, s[28:31], s44 offen offset:1024 sc1 lds
    v_mfma_f32_16x16x32_bf16 v[160:163], v[236:239], a[24:27], v[160:163]
    ds_read_b128 v[92:95], v77 offset:11264
    v_mfma_f32_16x16x32_bf16 v[160:163], v[232:235], a[16:19], v[160:163]
    s_waitcnt lgkmcnt(4)
    v_mfma_f32_16x16x32_bf16 v[168:171], v[32:35], a[16:19], v[168:171]
    ds_read_b128 v[232:235], v77 offset:20480
    v_mfma_f32_16x16x32_bf16 v[168:171], v[36:39], a[24:27], v[168:171]
    buffer_load_dwordx4 v1, s[28:31], s44 offen offset:2048 sc1 lds
    v_mfma_f32_16x16x32_bf16 v[172:175], v[36:39], a[28:31], v[172:175]
    ds_read_b128 v[236:239], v77 offset:29696
    v_mfma_f32_16x16x32_bf16 v[172:175], v[32:35], a[20:23], v[172:175]
    s_waitcnt lgkmcnt(4)
    buffer_load_dwordx4 v1, s[28:31], s44 offen offset:3072 sc1 lds
    v_mfma_f32_16x16x32_bf16 v[172:175], v[40:43], a[4:7], v[172:175]
    ds_read_b128 v[32:35], v77 offset:21504
    v_mfma_f32_16x16x32_bf16 v[172:175], v[44:47], a[12:15], v[172:175]
    v_mfma_f32_16x16x32_bf16 v[168:171], v[44:47], a[8:11], v[168:171]
    s_add_u32 s46, s56, 6815744
    ds_read_b128 v[36:39], v77 offset:30720
    v_mfma_f32_16x16x32_bf16 v[168:171], v[40:43], a[0:3], v[168:171]
    s_waitcnt lgkmcnt(4)
    buffer_load_dwordx4 a[64:67], v1, s[28:31], s46 offen offset:0 sc1
    v_mfma_f32_16x16x32_bf16 v[176:179], v[88:91], a[0:3], v[176:179]
    ds_read_b128 v[40:43], v77 offset:3072
    v_mfma_f32_16x16x32_bf16 v[176:179], v[92:95], a[8:11], v[176:179]
    v_mfma_f32_16x16x32_bf16 v[180:183], v[92:95], a[12:15], v[180:183]
    ds_read_b128 v[44:47], v77 offset:12288
    v_mfma_f32_16x16x32_bf16 v[180:183], v[88:91], a[4:7], v[180:183]
    s_waitcnt lgkmcnt(4)
    buffer_load_dwordx4 a[72:75], v1, s[28:31], s46 offen offset:1024 sc1
    v_mfma_f32_16x16x32_bf16 v[180:183], v[232:235], a[20:23], v[180:183]
    ds_read_b128 v[88:91], v77 offset:4096
    v_mfma_f32_16x16x32_bf16 v[180:183], v[236:239], a[28:31], v[180:183]
    buffer_load_dwordx4 a[80:83], v1, s[28:31], s46 offen offset:2048 sc1
    v_mfma_f32_16x16x32_bf16 v[176:179], v[236:239], a[24:27], v[176:179]
    ds_read_b128 v[92:95], v77 offset:13312
    v_mfma_f32_16x16x32_bf16 v[176:179], v[232:235], a[16:19], v[176:179]
    s_waitcnt lgkmcnt(4)
    v_mfma_f32_16x16x32_bf16 v[184:187], v[32:35], a[16:19], v[184:187]
    ds_read_b128 v[232:235], v77 offset:22528
    v_mfma_f32_16x16x32_bf16 v[184:187], v[36:39], a[24:27], v[184:187]
    buffer_load_dwordx4 a[88:91], v1, s[28:31], s46 offen offset:3072 sc1
    v_mfma_f32_16x16x32_bf16 v[188:191], v[36:39], a[28:31], v[188:191]
    ds_read_b128 v[236:239], v77 offset:31744
    v_mfma_f32_16x16x32_bf16 v[188:191], v[32:35], a[20:23], v[188:191]
    s_waitcnt lgkmcnt(4)
    v_mfma_f32_16x16x32_bf16 v[188:191], v[40:43], a[4:7], v[188:191]
    ds_read_b128 v[32:35], v77 offset:23552
    v_mfma_f32_16x16x32_bf16 v[188:191], v[44:47], a[12:15], v[188:191]
    s_add_u32 s45, s54, 80957440
    v_mfma_f32_16x16x32_bf16 v[184:187], v[44:47], a[8:11], v[184:187]
    s_add_u32 m0, s53, 86016
    ds_read_b128 v[36:39], v77 offset:32768
    v_mfma_f32_16x16x32_bf16 v[184:187], v[40:43], a[0:3], v[184:187]
    s_waitcnt lgkmcnt(4)
    buffer_load_dwordx4 v1, s[28:31], s45 offen offset:0 sc1 lds
    v_mfma_f32_16x16x32_bf16 v[192:195], v[88:91], a[0:3], v[192:195]
    ds_read_b128 v[40:43], v77 offset:5120
    v_mfma_f32_16x16x32_bf16 v[192:195], v[92:95], a[8:11], v[192:195]
    buffer_load_dwordx4 v1, s[28:31], s45 offen offset:1024 sc1 lds
    v_mfma_f32_16x16x32_bf16 v[196:199], v[92:95], a[12:15], v[196:199]
    ds_read_b128 v[44:47], v77 offset:14336
    v_mfma_f32_16x16x32_bf16 v[196:199], v[88:91], a[4:7], v[196:199]
    s_waitcnt lgkmcnt(4)
    buffer_load_dwordx4 v1, s[28:31], s45 offen offset:2048 sc1 lds
    v_mfma_f32_16x16x32_bf16 v[196:199], v[232:235], a[20:23], v[196:199]
    ds_read_b128 v[88:91], v77 offset:6144
    v_mfma_f32_16x16x32_bf16 v[196:199], v[236:239], a[28:31], v[196:199]
    buffer_load_dwordx4 v1, s[28:31], s45 offen offset:3072 sc1 lds
    v_mfma_f32_16x16x32_bf16 v[192:195], v[236:239], a[24:27], v[192:195]
    ds_read_b128 v[92:95], v77 offset:15360
    v_mfma_f32_16x16x32_bf16 v[192:195], v[232:235], a[16:19], v[192:195]
    s_waitcnt lgkmcnt(4)
    v_mfma_f32_16x16x32_bf16 v[200:203], v[32:35], a[16:19], v[200:203]
    s_add_u32 s46, s56, 6819840
    ds_read_b128 v[232:235], v77 offset:24576
    v_mfma_f32_16x16x32_bf16 v[200:203], v[36:39], a[24:27], v[200:203]
    buffer_load_dwordx4 a[68:71], v1, s[28:31], s46 offen offset:0 sc1
    v_mfma_f32_16x16x32_bf16 v[204:207], v[36:39], a[28:31], v[204:207]
    ds_read_b128 v[236:239], v77 offset:33792
    v_mfma_f32_16x16x32_bf16 v[204:207], v[32:35], a[20:23], v[204:207]
    s_waitcnt lgkmcnt(4)
    v_mfma_f32_16x16x32_bf16 v[204:207], v[40:43], a[4:7], v[204:207]
    ds_read_b128 v[32:35], v77 offset:25600
    v_mfma_f32_16x16x32_bf16 v[204:207], v[44:47], a[12:15], v[204:207]
    buffer_load_dwordx4 a[76:79], v1, s[28:31], s46 offen offset:1024 sc1
    v_mfma_f32_16x16x32_bf16 v[200:203], v[44:47], a[8:11], v[200:203]
    ds_read_b128 v[36:39], v77 offset:34816
    v_mfma_f32_16x16x32_bf16 v[200:203], v[40:43], a[0:3], v[200:203]
    s_waitcnt lgkmcnt(4)
    buffer_load_dwordx4 a[84:87], v1, s[28:31], s46 offen offset:2048 sc1
    v_mfma_f32_16x16x32_bf16 v[208:211], v[88:91], a[0:3], v[208:211]
    ds_read_b128 v[40:43], v77 offset:7168
    v_mfma_f32_16x16x32_bf16 v[208:211], v[92:95], a[8:11], v[208:211]
    v_mfma_f32_16x16x32_bf16 v[212:215], v[92:95], a[12:15], v[212:215]
    ds_read_b128 v[44:47], v77 offset:16384
    v_mfma_f32_16x16x32_bf16 v[212:215], v[88:91], a[4:7], v[212:215]
    s_waitcnt lgkmcnt(4)
    buffer_load_dwordx4 a[92:95], v1, s[28:31], s46 offen offset:3072 sc1
    v_mfma_f32_16x16x32_bf16 v[212:215], v[232:235], a[20:23], v[212:215]
    ds_read_b128 v[88:91], v77 offset:8192
    v_mfma_f32_16x16x32_bf16 v[212:215], v[236:239], a[28:31], v[212:215]
    s_add_u32 s44, s54, 80961536
    v_mfma_f32_16x16x32_bf16 v[208:211], v[236:239], a[24:27], v[208:211]
    s_add_u32 m0, s53, 90112
    ds_read_b128 v[92:95], v77 offset:17408
    v_mfma_f32_16x16x32_bf16 v[208:211], v[232:235], a[16:19], v[208:211]
    s_waitcnt lgkmcnt(4)
    buffer_load_dwordx4 v1, s[28:31], s44 offen offset:0 sc1 lds
    v_mfma_f32_16x16x32_bf16 v[216:219], v[32:35], a[16:19], v[216:219]
    ds_read_b128 v[232:235], v77 offset:26624
    v_mfma_f32_16x16x32_bf16 v[216:219], v[36:39], a[24:27], v[216:219]
    v_mfma_f32_16x16x32_bf16 v[220:223], v[36:39], a[28:31], v[220:223]
    ds_read_b128 v[236:239], v77 offset:35840
    v_mfma_f32_16x16x32_bf16 v[220:223], v[32:35], a[20:23], v[220:223]
    s_waitcnt lgkmcnt(4)
    v_mfma_f32_16x16x32_bf16 v[220:223], v[40:43], a[4:7], v[220:223]
    v_mfma_f32_16x16x32_bf16 v[220:223], v[44:47], a[12:15], v[220:223]
    v_mfma_f32_16x16x32_bf16 v[216:219], v[44:47], a[8:11], v[216:219]
    s_waitcnt vmcnt(20) lgkmcnt(0)
    v_mfma_f32_16x16x32_bf16 v[216:219], v[40:43], a[0:3], v[216:219]
    s_barrier
    v_mfma_f32_16x16x32_bf16 v[224:227], v[88:91], a[0:3], v[224:227]
    ds_read_b128 v[32:35], v1 offset:0
    v_mfma_f32_16x16x32_bf16 v[224:227], v[92:95], a[8:11], v[224:227]
    ds_read_b128 v[36:39], v1 offset:9216
    v_mfma_f32_16x16x32_bf16 v[228:231], v[92:95], a[12:15], v[228:231]
    ds_read_b128 v[40:43], v1 offset:18432
    v_mfma_f32_16x16x32_bf16 v[228:231], v[88:91], a[4:7], v[228:231]
    s_waitcnt lgkmcnt(3)
    ds_read_b128 v[44:47], v1 offset:27648
    v_mfma_f32_16x16x32_bf16 v[228:231], v[232:235], a[20:23], v[228:231]
    ds_read_b128 v[88:91], v1 offset:19456
    v_mfma_f32_16x16x32_bf16 v[228:231], v[236:239], a[28:31], v[228:231]
    v_mfma_f32_16x16x32_bf16 v[224:227], v[236:239], a[24:27], v[224:227]
    ds_read_b128 v[92:95], v1 offset:28672
    v_mfma_f32_16x16x32_bf16 v[224:227], v[232:235], a[16:19], v[224:227]
    s_waitcnt lgkmcnt(4)
    v_mfma_f32_16x16x32_bf16 v[160:163], v[32:35], a[32:35], v[160:163]
    ds_read_b128 v[232:235], v1 offset:1024
    v_mfma_f32_16x16x32_bf16 v[160:163], v[36:39], a[40:43], v[160:163]
    s_add_u32 s45, s54, 81100800
    v_mfma_f32_16x16x32_bf16 v[164:167], v[36:39], a[44:47], v[164:167]
    s_add_u32 m0, s53, 118784
    ds_read_b128 v[236:239], v1 offset:10240
    v_mfma_f32_16x16x32_bf16 v[164:167], v[32:35], a[36:39], v[164:167]
    s_waitcnt lgkmcnt(4)
    buffer_load_dwordx4 v1, s[28:31], s45 offen offset:0 sc1 lds
    v_mfma_f32_16x16x32_bf16 v[164:167], v[40:43], a[52:55], v[164:167]
    ds_read_b128 v[32:35], v1 offset:2048
    v_mfma_f32_16x16x32_bf16 v[164:167], v[44:47], a[60:63], v[164:167]
    buffer_load_dwordx4 v1, s[28:31], s45 offen offset:1024 sc1 lds
    v_mfma_f32_16x16x32_bf16 v[160:163], v[44:47], a[56:59], v[160:163]
    ds_read_b128 v[36:39], v1 offset:11264
    v_mfma_f32_16x16x32_bf16 v[160:163], v[40:43], a[48:51], v[160:163]
    s_waitcnt lgkmcnt(4)
    v_mfma_f32_16x16x32_bf16 v[168:171], v[88:91], a[48:51], v[168:171]
    ds_read_b128 v[40:43], v1 offset:20480
    v_mfma_f32_16x16x32_bf16 v[168:171], v[92:95], a[56:59], v[168:171]
    buffer_load_dwordx4 v1, s[28:31], s45 offen offset:2048 sc1 lds
    v_mfma_f32_16x16x32_bf16 v[172:175], v[92:95], a[60:63], v[172:175]
    ds_read_b128 v[44:47], v1 offset:29696
    v_mfma_f32_16x16x32_bf16 v[172:175], v[88:91], a[52:55], v[172:175]
    s_waitcnt lgkmcnt(4)
    buffer_load_dwordx4 v1, s[28:31], s45 offen offset:3072 sc1 lds
    v_mfma_f32_16x16x32_bf16 v[172:175], v[232:235], a[36:39], v[172:175]
    ds_read_b128 v[88:91], v1 offset:21504
    v_mfma_f32_16x16x32_bf16 v[172:175], v[236:239], a[44:47], v[172:175]
    v_mfma_f32_16x16x32_bf16 v[168:171], v[236:239], a[40:43], v[168:171]
    s_add_u32 s46, s56, 7340032
    ds_read_b128 v[92:95], v1 offset:30720
    v_mfma_f32_16x16x32_bf16 v[168:171], v[232:235], a[32:35], v[168:171]
    s_waitcnt lgkmcnt(4)
    buffer_load_dwordx4 a[0:3], v1, s[28:31], s46 offen offset:0 sc1
    v_mfma_f32_16x16x32_bf16 v[176:179], v[32:35], a[32:35], v[176:179]
    ds_read_b128 v[232:235], v1 offset:3072
    v_mfma_f32_16x16x32_bf16 v[176:179], v[36:39], a[40:43], v[176:179]
    v_mfma_f32_16x16x32_bf16 v[180:183], v[36:39], a[44:47], v[180:183]
    ds_read_b128 v[236:239], v1 offset:12288
    v_mfma_f32_16x16x32_bf16 v[180:183], v[32:35], a[36:39], v[180:183]
    s_waitcnt lgkmcnt(4)
    buffer_load_dwordx4 a[8:11], v1, s[28:31], s46 offen offset:1024 sc1
    v_mfma_f32_16x16x32_bf16 v[180:183], v[40:43], a[52:55], v[180:183]
    ds_read_b128 v[32:35], v1 offset:4096
    v_mfma_f32_16x16x32_bf16 v[180:183], v[44:47], a[60:63], v[180:183]
    buffer_load_dwordx4 a[16:19], v1, s[28:31], s46 offen offset:2048 sc1
    v_mfma_f32_16x16x32_bf16 v[176:179], v[44:47], a[56:59], v[176:179]
    ds_read_b128 v[36:39], v1 offset:13312
    v_mfma_f32_16x16x32_bf16 v[176:179], v[40:43], a[48:51], v[176:179]
    s_waitcnt lgkmcnt(4)
    v_mfma_f32_16x16x32_bf16 v[184:187], v[88:91], a[48:51], v[184:187]
    ds_read_b128 v[40:43], v1 offset:22528
    v_mfma_f32_16x16x32_bf16 v[184:187], v[92:95], a[56:59], v[184:187]
    buffer_load_dwordx4 a[24:27], v1, s[28:31], s46 offen offset:3072 sc1
    v_mfma_f32_16x16x32_bf16 v[188:191], v[92:95], a[60:63], v[188:191]
    ds_read_b128 v[44:47], v1 offset:31744
    v_mfma_f32_16x16x32_bf16 v[188:191], v[88:91], a[52:55], v[188:191]
    s_waitcnt lgkmcnt(4)
    v_mfma_f32_16x16x32_bf16 v[188:191], v[232:235], a[36:39], v[188:191]
    ds_read_b128 v[88:91], v1 offset:23552
    v_mfma_f32_16x16x32_bf16 v[188:191], v[236:239], a[44:47], v[188:191]
    s_add_u32 s44, s54, 81104896
    v_mfma_f32_16x16x32_bf16 v[184:187], v[236:239], a[40:43], v[184:187]
    s_add_u32 m0, s53, 122880
    ds_read_b128 v[92:95], v1 offset:32768
    v_mfma_f32_16x16x32_bf16 v[184:187], v[232:235], a[32:35], v[184:187]
    s_waitcnt lgkmcnt(4)
    buffer_load_dwordx4 v1, s[28:31], s44 offen offset:0 sc1 lds
    v_mfma_f32_16x16x32_bf16 v[192:195], v[32:35], a[32:35], v[192:195]
    ds_read_b128 v[232:235], v1 offset:5120
    v_mfma_f32_16x16x32_bf16 v[192:195], v[36:39], a[40:43], v[192:195]
    buffer_load_dwordx4 v1, s[28:31], s44 offen offset:1024 sc1 lds
    v_mfma_f32_16x16x32_bf16 v[196:199], v[36:39], a[44:47], v[196:199]
    ds_read_b128 v[236:239], v1 offset:14336
    v_mfma_f32_16x16x32_bf16 v[196:199], v[32:35], a[36:39], v[196:199]
    s_waitcnt lgkmcnt(4)
    buffer_load_dwordx4 v1, s[28:31], s44 offen offset:2048 sc1 lds
    v_mfma_f32_16x16x32_bf16 v[196:199], v[40:43], a[52:55], v[196:199]
    ds_read_b128 v[32:35], v1 offset:6144
    v_mfma_f32_16x16x32_bf16 v[196:199], v[44:47], a[60:63], v[196:199]
    buffer_load_dwordx4 v1, s[28:31], s44 offen offset:3072 sc1 lds
    v_mfma_f32_16x16x32_bf16 v[192:195], v[44:47], a[56:59], v[192:195]
    ds_read_b128 v[36:39], v1 offset:15360
    v_mfma_f32_16x16x32_bf16 v[192:195], v[40:43], a[48:51], v[192:195]
    s_waitcnt lgkmcnt(4)
    v_mfma_f32_16x16x32_bf16 v[200:203], v[88:91], a[48:51], v[200:203]
    s_add_u32 s46, s56, 7344128
    ds_read_b128 v[40:43], v1 offset:24576
    v_mfma_f32_16x16x32_bf16 v[200:203], v[92:95], a[56:59], v[200:203]
    buffer_load_dwordx4 a[4:7], v1, s[28:31], s46 offen offset:0 sc1
    v_mfma_f32_16x16x32_bf16 v[204:207], v[92:95], a[60:63], v[204:207]
    ds_read_b128 v[44:47], v1 offset:33792
    v_mfma_f32_16x16x32_bf16 v[204:207], v[88:91], a[52:55], v[204:207]
    s_waitcnt lgkmcnt(4)
    v_mfma_f32_16x16x32_bf16 v[204:207], v[232:235], a[36:39], v[204:207]
    ds_read_b128 v[88:91], v1 offset:25600
    v_mfma_f32_16x16x32_bf16 v[204:207], v[236:239], a[44:47], v[204:207]
    buffer_load_dwordx4 a[12:15], v1, s[28:31], s46 offen offset:1024 sc1
    v_mfma_f32_16x16x32_bf16 v[200:203], v[236:239], a[40:43], v[200:203]
    ds_read_b128 v[92:95], v1 offset:34816
    v_mfma_f32_16x16x32_bf16 v[200:203], v[232:235], a[32:35], v[200:203]
    s_waitcnt lgkmcnt(4)
    buffer_load_dwordx4 a[20:23], v1, s[28:31], s46 offen offset:2048 sc1
    v_mfma_f32_16x16x32_bf16 v[208:211], v[32:35], a[32:35], v[208:211]
    ds_read_b128 v[232:235], v1 offset:7168
    v_mfma_f32_16x16x32_bf16 v[208:211], v[36:39], a[40:43], v[208:211]
    v_mfma_f32_16x16x32_bf16 v[212:215], v[36:39], a[44:47], v[212:215]
    ds_read_b128 v[236:239], v1 offset:16384
    v_mfma_f32_16x16x32_bf16 v[212:215], v[32:35], a[36:39], v[212:215]
    s_waitcnt lgkmcnt(4)
    buffer_load_dwordx4 a[28:31], v1, s[28:31], s46 offen offset:3072 sc1
    v_mfma_f32_16x16x32_bf16 v[212:215], v[40:43], a[52:55], v[212:215]
    ds_read_b128 v[32:35], v1 offset:8192
    v_mfma_f32_16x16x32_bf16 v[212:215], v[44:47], a[60:63], v[212:215]
    s_add_u32 s45, s54, 81108992
    v_mfma_f32_16x16x32_bf16 v[208:211], v[44:47], a[56:59], v[208:211]
    s_add_u32 m0, s53, 126976
    ds_read_b128 v[36:39], v1 offset:17408
    v_mfma_f32_16x16x32_bf16 v[208:211], v[40:43], a[48:51], v[208:211]
    s_waitcnt lgkmcnt(4)
    buffer_load_dwordx4 v1, s[28:31], s45 offen offset:0 sc1 lds
    v_mfma_f32_16x16x32_bf16 v[216:219], v[88:91], a[48:51], v[216:219]
    ds_read_b128 v[40:43], v1 offset:26624
    v_mfma_f32_16x16x32_bf16 v[216:219], v[92:95], a[56:59], v[216:219]
    v_mfma_f32_16x16x32_bf16 v[220:223], v[92:95], a[60:63], v[220:223]
    ds_read_b128 v[44:47], v1 offset:35840
    v_add_u32_e64 v6, s69, 3
    v_mfma_f32_16x16x32_bf16 v[220:223], v[88:91], a[52:55], v[220:223]
    s_waitcnt lgkmcnt(4)
    v_mfma_f32_16x16x32_bf16 v[220:223], v[232:235], a[36:39], v[220:223]
    v_mfma_f32_16x16x32_bf16 v[220:223], v[236:239], a[44:47], v[220:223]
    v_mfma_f32_16x16x32_bf16 v[216:219], v[236:239], a[40:43], v[216:219]
    s_waitcnt vmcnt(17) lgkmcnt(0)
    v_mfma_f32_16x16x32_bf16 v[216:219], v[232:235], a[32:35], v[216:219]
    s_barrier
    v_mfma_f32_16x16x32_bf16 v[224:227], v[32:35], a[32:35], v[224:227]
    ds_read_b128 v[88:91], v76 offset:0
    v_mfma_f32_16x16x32_bf16 v[224:227], v[36:39], a[40:43], v[224:227]
    s_cmp_lg_u32 s72, 0
    ds_read_b128 v[92:95], v76 offset:9216
    v_mfma_f32_16x16x32_bf16 v[228:231], v[36:39], a[44:47], v[228:231]
    s_cbranch_scc1 L_stub_w3
L_ret_w3:
    ds_read_b128 v[232:235], v76 offset:18432
    v_mfma_f32_16x16x32_bf16 v[228:231], v[32:35], a[36:39], v[228:231]
    s_waitcnt lgkmcnt(3)
    ds_read_b128 v[236:239], v76 offset:27648
    v_mfma_f32_16x16x32_bf16 v[228:231], v[40:43], a[52:55], v[228:231]
    ds_read_b128 v[32:35], v76 offset:19456
    v_mfma_f32_16x16x32_bf16 v[228:231], v[44:47], a[60:63], v[228:231]
    buffer_store_dwordx2 v[6:7], v0, s[28:31], s73 offen sc1
    v_mfma_f32_16x16x32_bf16 v[224:227], v[44:47], a[56:59], v[224:227]
    ds_read_b128 v[36:39], v76 offset:28672
    v_mfma_f32_16x16x32_bf16 v[224:227], v[40:43], a[48:51], v[224:227]
    s_waitcnt lgkmcnt(4)
    v_mfma_f32_16x16x32_bf16 v[160:163], v[88:91], a[64:67], v[160:163]
    ds_read_b128 v[40:43], v76 offset:1024
    v_mfma_f32_16x16x32_bf16 v[160:163], v[92:95], a[72:75], v[160:163]
    s_lshl_b32 s52, s41, 11
    v_mfma_f32_16x16x32_bf16 v[164:167], v[92:95], a[76:79], v[164:167]
    s_lshl_b32 s43, s47, 9
    ds_read_b128 v[44:47], v76 offset:10240
    v_mfma_f32_16x16x32_bf16 v[164:167], v[88:91], a[68:71], v[164:167]
    s_waitcnt lgkmcnt(4)
    v_mfma_f32_16x16x32_bf16 v[164:167], v[232:235], a[84:87], v[164:167]
    s_add_u32 s43, s43, s52
    ds_read_b128 v[88:91], v76 offset:2048
    v_mfma_f32_16x16x32_bf16 v[164:167], v[236:239], a[92:95], v[164:167]
    s_add_u32 s44, s54, 81248256
    v_and_b32 v8, 7, v2
    v_lshl_add_u32 v8, v8, 3, s43
    v_mfma_f32_16x16x32_bf16 v[160:163], v[236:239], a[88:91], v[160:163]
    s_add_u32 m0, s53, 0
    ds_read_b128 v[92:95], v76 offset:11264
    v_mfma_f32_16x16x32_bf16 v[160:163], v[232:235], a[80:83], v[160:163]
    s_waitcnt lgkmcnt(4)
    buffer_load_dwordx4 v1, s[28:31], s44 offen offset:0 sc1 lds
    v_mfma_f32_16x16x32_bf16 v[168:171], v[32:35], a[80:83], v[168:171]
    ds_read_b128 v[232:235], v76 offset:20480
    v_mfma_f32_16x16x32_bf16 v[168:171], v[36:39], a[88:91], v[168:171]
    buffer_load_dwordx4 v1, s[28:31], s44 offen offset:1024 sc1 lds
    v_mfma_f32_16x16x32_bf16 v[172:175], v[36:39], a[92:95], v[172:175]
    ds_read_b128 v[236:239], v76 offset:29696
    v_mfma_f32_16x16x32_bf16 v[172:175], v[32:35], a[84:87], v[172:175]
    s_waitcnt lgkmcnt(4)
    buffer_load_dwordx4 v1, s[28:31], s44 offen offset:2048 sc1 lds
    v_mfma_f32_16x16x32_bf16 v[172:175], v[40:43], a[68:71], v[172:175]
    ds_read_b128 v[32:35], v76 offset:21504
    v_mfma_f32_16x16x32_bf16 v[172:175], v[44:47], a[76:79], v[172:175]
    buffer_load_dwordx4 v1, s[28:31], s44 offen offset:3072 sc1 lds
    v_mfma_f32_16x16x32_bf16 v[168:171], v[44:47], a[72:75], v[168:171]
    s_add_u32 s46, s56, 7864320
    ds_read_b128 v[36:39], v76 offset:30720
    v_mfma_f32_16x16x32_bf16 v[168:171], v[40:43], a[64:67], v[168:171]
    s_waitcnt lgkmcnt(4)
    buffer_load_dwordx4 a[32:35], v1, s[28:31], s46 offen offset:0 sc1
    v_mfma_f32_16x16x32_bf16 v[176:179], v[88:91], a[64:67], v[176:179]
    ds_read_b128 v[40:43], v76 offset:3072
    v_mfma_f32_16x16x32_bf16 v[176:179], v[92:95], a[72:75], v[176:179]
    v_mfma_f32_16x16x32_bf16 v[180:183], v[92:95], a[76:79], v[180:183]
    ds_read_b128 v[44:47], v76 offset:12288
    v_mfma_f32_16x16x32_bf16 v[180:183], v[88:91], a[68:71], v[180:183]
    s_waitcnt lgkmcnt(4)
    buffer_load_dwordx4 a[40:43], v1, s[28:31], s46 offen offset:1024 sc1
    v_mfma_f32_16x16x32_bf16 v[180:183], v[232:235], a[84:87], v[180:183]
    ds_read_b128 v[88:91], v76 offset:4096
    v_mfma_f32_16x16x32_bf16 v[180:183], v[236:239], a[92:95], v[180:183]
    buffer_load_dwordx4 a[48:51], v1, s[28:31], s46 offen offset:2048 sc1
    v_mfma_f32_16x16x32_bf16 v[176:179], v[236:239], a[88:91], v[176:179]
    ds_read_b128 v[92:95], v76 offset:13312
    v_mfma_f32_16x16x32_bf16 v[176:179], v[232:235], a[80:83], v[176:179]
    s_waitcnt lgkmcnt(4)
    v_mfma_f32_16x16x32_bf16 v[184:187], v[32:35], a[80:83], v[184:187]
    ds_read_b128 v[232:235], v76 offset:22528
    v_mfma_f32_16x16x32_bf16 v[184:187], v[36:39], a[88:91], v[184:187]
    buffer_load_dwordx4 a[56:59], v1, s[28:31], s46 offen offset:3072 sc1
    v_mfma_f32_16x16x32_bf16 v[188:191], v[36:39], a[92:95], v[188:191]
    ds_read_b128 v[236:239], v76 offset:31744
    v_mfma_f32_16x16x32_bf16 v[188:191], v[32:35], a[84:87], v[188:191]
    s_waitcnt lgkmcnt(4)
    v_mfma_f32_16x16x32_bf16 v[188:191], v[40:43], a[68:71], v[188:191]
    ds_read_b128 v[32:35], v76 offset:23552
    v_mfma_f32_16x16x32_bf16 v[188:191], v[44:47], a[76:79], v[188:191]
    s_add_u32 s45, s54, 81252352
    v_mfma_f32_16x16x32_bf16 v[184:187], v[44:47], a[72:75], v[184:187]
    s_add_u32 m0, s53, 4096
    ds_read_b128 v[36:39], v76 offset:32768
    v_mfma_f32_16x16x32_bf16 v[184:187], v[40:43], a[64:67], v[184:187]
    s_waitcnt lgkmcnt(4)
    buffer_load_dwordx4 v1, s[28:31], s45 offen offset:0 sc1 lds
    v_mfma_f32_16x16x32_bf16 v[192:195], v[88:91], a[64:67], v[192:195]
    ds_read_b128 v[40:43], v76 offset:5120
    v_mfma_f32_16x16x32_bf16 v[192:195], v[92:95], a[72:75], v[192:195]
    buffer_load_dwordx4 v1, s[28:31], s45 offen offset:1024 sc1 lds
    v_mfma_f32_16x16x32_bf16 v[196:199], v[92:95], a[76:79], v[196:199]
    ds_read_b128 v[44:47], v76 offset:14336
    v_mfma_f32_16x16x32_bf16 v[196:199], v[88:91], a[68:71], v[196:199]
    s_waitcnt lgkmcnt(4)
    buffer_load_dwordx4 v1, s[28:31], s45 offen offset:2048 sc1 lds
    v_mfma_f32_16x16x32_bf16 v[196:199], v[232:235], a[84:87], v[196:199]
    ds_read_b128 v[88:91], v76 offset:6144
    v_mfma_f32_16x16x32_bf16 v[196:199], v[236:239], a[92:95], v[196:199]
    buffer_load_dwordx4 v1, s[28:31], s45 offen offset:3072 sc1 lds
    v_mfma_f32_16x16x32_bf16 v[192:195], v[236:239], a[88:91], v[192:195]
    ds_read_b128 v[92:95], v76 offset:15360
    v_mfma_f32_16x16x32_bf16 v[192:195], v[232:235], a[80:83], v[192:195]
    s_waitcnt lgkmcnt(4)
    v_mfma_f32_16x16x32_bf16 v[200:203], v[32:35], a[80:83], v[200:203]
    s_add_u32 s46, s56, 7868416
    ds_read_b128 v[232:235], v76 offset:24576
    v_mfma_f32_16x16x32_bf16 v[200:203], v[36:39], a[88:91], v[200:203]
    buffer_load_dwordx4 a[36:39], v1, s[28:31], s46 offen offset:0 sc1
    v_mfma_f32_16x16x32_bf16 v[204:207], v[36:39], a[92:95], v[204:207]
    ds_read_b128 v[236:239], v76 offset:33792
    v_mfma_f32_16x16x32_bf16 v[204:207], v[32:35], a[84:87], v[204:207]
    s_waitcnt lgkmcnt(4)
    v_mfma_f32_16x16x32_bf16 v[204:207], v[40:43], a[68:71], v[204:207]
    ds_read_b128 v[32:35], v76 offset:25600
    v_mfma_f32_16x16x32_bf16 v[204:207], v[44:47], a[76:79], v[204:207]
    buffer_load_dwordx4 a[44:47], v1, s[28:31], s46 offen offset:1024 sc1
    v_mfma_f32_16x16x32_bf16 v[200:203], v[44:47], a[72:75], v[200:203]
    ds_read_b128 v[36:39], v76 offset:34816
    v_mfma_f32_16x16x32_bf16 v[200:203], v[40:43], a[64:67], v[200:203]
    s_waitcnt lgkmcnt(4)
    buffer_load_dwordx4 a[52:55], v1, s[28:31], s46 offen offset:2048 sc1
    v_mfma_f32_16x16x32_bf16 v[208:211], v[88:91], a[64:67], v[208:211]
    ds_read_b128 v[40:43], v76 offset:7168
    v_mfma_f32_16x16x32_bf16 v[208:211], v[92:95], a[72:75], v[208:211]
    v_mfma_f32_16x16x32_bf16 v[212:215], v[92:95], a[76:79], v[212:215]
L_pad0:
    s_cbranch_execz L_pad3
    ds_read_b128 v[44:47], v76 offset:16384
    v_mfma_f32_16x16x32_bf16 v[212:215], v[88:91], a[68:71], v[212:215]
    s_waitcnt lgkmcnt(4)
    buffer_load_dwordx4 a[60:63], v1, s[28:31], s46 offen offset:3072 sc1
    v_mfma_f32_16x16x32_bf16 v[212:215], v[232:235], a[84:87], v[212:215]
    ds_read_b128 v[88:91], v76 offset:8192
    v_mfma_f32_16x16x32_bf16 v[212:215], v[236:239], a[92:95], v[212:215]
    s_add_u32 s44, s54, 81256448
    v_mfma_f32_16x16x32_bf16 v[208:211], v[236:239], a[88:91], v[208:211]
    s_add_u32 m0, s53, 8192
    ds_read_b128 v[92:95], v76 offset:17408
    v_mfma_f32_16x16x32_bf16 v[208:211], v[232:235], a[80:83], v[208:211]
    s_waitcnt lgkmcnt(4)
    buffer_load_dwordx4 v1, s[28:31], s44 offen offset:0 sc1 lds
    v_mfma_f32_16x16x32_bf16 v[216:219], v[32:35], a[80:83], v[216:219]
    ds_read_b128 v[232:235], v76 offset:26624
    v_mfma_f32_16x16x32_bf16 v[216:219], v[36:39], a[88:91], v[216:219]
    v_mfma_f32_16x16x32_bf16 v[220:223], v[36:39], a[92:95], v[220:223]
    ds_read_b128 v[236:239], v76 offset:35840
    v_mfma_f32_16x16x32_bf16 v[220:223], v[32:35], a[84:87], v[220:223]
    s_waitcnt lgkmcnt(4)
    v_mfma_f32_16x16x32_bf16 v[220:223], v[40:43], a[68:71], v[220:223]
    v_mfma_f32_16x16x32_bf16 v[220:223], v[44:47], a[76:79], v[220:223]
    v_mfma_f32_16x16x32_bf16 v[216:219], v[44:47], a[72:75], v[216:219]
    s_waitcnt vmcnt(18) lgkmcnt(0)
    v_mfma_f32_16x16x32_bf16 v[216:219], v[40:43], a[64:67], v[216:219]
    s_barrier
    v_mfma_f32_16x16x32_bf16 v[224:227], v[88:91], a[64:67], v[224:227]
    ds_read_b128 v[32:35], v77 offset:0
    v_mfma_f32_16x16x32_bf16 v[224:227], v[92:95], a[72:75], v[224:227]
    ds_read_b128 v[36:39], v77 offset:9216
    v_mfma_f32_16x16x32_bf16 v[228:231], v[92:95], a[76:79], v[228:231]
    ds_read_b128 v[40:43], v77 offset:18432
    v_mfma_f32_16x16x32_bf16 v[228:231], v[88:91], a[68:71], v[228:231]
    s_waitcnt lgkmcnt(3)
    ds_read_b128 v[44:47], v77 offset:27648
    v_mfma_f32_16x16x32_bf16 v[228:231], v[232:235], a[84:87], v[228:231]
    ds_read_b128 v[88:91], v77 offset:19456
    v_mfma_f32_16x16x32_bf16 v[228:231], v[236:239], a[92:95], v[228:231]
    v_mfma_f32_16x16x32_bf16 v[224:227], v[236:239], a[88:91], v[224:227]
    ds_read_b128 v[92:95], v77 offset:28672
    v_mfma_f32_16x16x32_bf16 v[224:227], v[232:235], a[80:83], v[224:227]
    s_waitcnt lgkmcnt(4)
    v_mfma_f32_16x16x32_bf16 v[160:163], v[32:35], a[0:3], v[160:163]
    s_lshl_b32 s59, s41, 3
    ds_read_b128 v[232:235], v77 offset:1024
    v_mfma_f32_16x16x32_bf16 v[160:163], v[36:39], a[8:11], v[160:163]
    s_add_u32 s45, s54, 81395712
    v_mfma_f32_16x16x32_bf16 v[164:167], v[36:39], a[12:15], v[164:167]
    s_add_u32 m0, s53, 81920
    ds_read_b128 v[236:239], v77 offset:10240
    v_mfma_f32_16x16x32_bf16 v[164:167], v[32:35], a[4:7], v[164:167]
    s_waitcnt lgkmcnt(4)
    buffer_load_dwordx4 v1, s[28:31], s45 offen offset:0 sc1 lds
    v_mfma_f32_16x16x32_bf16 v[164:167], v[40:43], a[20:23], v[164:167]
    s_and_b32 s78, s42, 7
    ds_read_b128 v[32:35], v77 offset:2048
    v_mfma_f32_16x16x32_bf16 v[164:167], v[44:47], a[28:31], v[164:167]
    s_add_u32 s59, s59, s78
    buffer_load_dwordx4 v1, s[28:31], s45 offen offset:1024 sc1 lds
    v_mfma_f32_16x16x32_bf16 v[160:163], v[44:47], a[24:27], v[160:163]
    s_lshl_b32 s59, s59, 9
    ds_read_b128 v[36:39], v77 offset:11264
    v_mfma_f32_16x16x32_bf16 v[160:163], v[40:43], a[16:19], v[160:163]
    s_waitcnt lgkmcnt(4)
    v_mfma_f32_16x16x32_bf16 v[168:171], v[88:91], a[16:19], v[168:171]
    s_add_u32 s59, s59, 32768
    ds_read_b128 v[40:43], v77 offset:20480
    v_mfma_f32_16x16x32_bf16 v[168:171], v[92:95], a[24:27], v[168:171]
    s_lshl_b32 s12, s40, 7
    buffer_load_dwordx4 v1, s[28:31], s45 offen offset:2048 sc1 lds
    v_mfma_f32_16x16x32_bf16 v[172:175], v[92:95], a[28:31], v[172:175]
    s_add_u32 s12, s12, s59
    ds_read_b128 v[44:47], v77 offset:29696
    v_mfma_f32_16x16x32_bf16 v[172:175], v[88:91], a[20:23], v[172:175]
    s_waitcnt lgkmcnt(4)
    buffer_load_dwordx4 v1, s[28:31], s45 offen offset:3072 sc1 lds
    v_mfma_f32_16x16x32_bf16 v[172:175], v[232:235], a[4:7], v[172:175]
    s_lshl_b32 s13, s47, 3
    ds_read_b128 v[88:91], v77 offset:21504
    v_mfma_f32_16x16x32_bf16 v[172:175], v[236:239], a[12:15], v[172:175]
    s_add_u32 s12, s12, s13
    v_mfma_f32_16x16x32_bf16 v[168:171], v[236:239], a[8:11], v[168:171]
    s_add_u32 s46, s56, 8388608
    ds_read_b128 v[92:95], v77 offset:30720
    v_mfma_f32_16x16x32_bf16 v[168:171], v[232:235], a[0:3], v[168:171]
    s_waitcnt lgkmcnt(4)
    buffer_load_dwordx4 a[64:67], v1, s[28:31], s46 offen offset:0 sc1
    v_mfma_f32_16x16x32_bf16 v[176:179], v[32:35], a[0:3], v[176:179]
    s_lshl_b32 s13, s47, 7
    ds_read_b128 v[232:235], v77 offset:3072
    v_mfma_f32_16x16x32_bf16 v[176:179], v[36:39], a[8:11], v[176:179]
    s_add_u32 s59, s59, s13
    v_mfma_f32_16x16x32_bf16 v[180:183], v[36:39], a[12:15], v[180:183]
    s_add_u32 s13, s47, 1
    ds_read_b128 v[236:239], v77 offset:12288
    v_mfma_f32_16x16x32_bf16 v[180:183], v[32:35], a[4:7], v[180:183]
    s_waitcnt lgkmcnt(4)
    buffer_load_dwordx4 a[72:75], v1, s[28:31], s46 offen offset:1024 sc1
    v_mfma_f32_16x16x32_bf16 v[180:183], v[40:43], a[20:23], v[180:183]
    s_cmp_eq_u32 s40, s47
    s_cselect_b32 s14, 1073741824, 0
    s_cselect_b32 s15, 0, 18432
    ds_read_b128 v[32:35], v77 offset:4096
    v_mfma_f32_16x16x32_bf16 v[180:183], v[44:47], a[28:31], v[180:183]
    s_add_u32 s58, s58, s14
    buffer_load_dwordx4 a[80:83], v1, s[28:31], s46 offen offset:2048 sc1
    v_mfma_f32_16x16x32_bf16 v[176:179], v[44:47], a[24:27], v[176:179]
    s_add_u32 s15, s15, 40960
    ds_read_b128 v[36:39], v77 offset:13312
    v_mfma_f32_16x16x32_bf16 v[176:179], v[40:43], a[16:19], v[176:179]
    s_waitcnt lgkmcnt(4)
    v_mfma_f32_16x16x32_bf16 v[184:187], v[88:91], a[16:19], v[184:187]
    s_cmp_eq_u32 s40, 0
    s_cselect_b32 s48, 8192, 1073741824
    ds_read_b128 v[40:43], v77 offset:22528
    v_mfma_f32_16x16x32_bf16 v[184:187], v[92:95], a[24:27], v[184:187]
    buffer_load_dwordx4 a[88:91], v1, s[28:31], s46 offen offset:3072 sc1
    v_mfma_f32_16x16x32_bf16 v[188:191], v[92:95], a[28:31], v[188:191]
    ds_read_b128 v[44:47], v77 offset:31744
    v_mfma_f32_16x16x32_bf16 v[188:191], v[88:91], a[20:23], v[188:191]
    s_waitcnt lgkmcnt(4)
    v_mfma_f32_16x16x32_bf16 v[188:191], v[232:235], a[4:7], v[188:191]
    ds_read_b128 v[88:91], v77 offset:23552
    v_mfma_f32_16x16x32_bf16 v[188:191], v[236:239], a[12:15], v[188:191]
    s_add_u32 s44, s54, 81399808
    v_mfma_f32_16x16x32_bf16 v[184:187], v[236:239], a[8:11], v[184:187]
    s_add_u32 m0, s53, 86016
    ds_read_b128 v[92:95], v77 offset:32768
    v_mfma_f32_16x16x32_bf16 v[184:187], v[232:235], a[0:3], v[184:187]
    s_waitcnt lgkmcnt(4)
    buffer_load_dwordx4 v1, s[28:31], s44 offen offset:0 sc1 lds
    v_mfma_f32_16x16x32_bf16 v[192:195], v[32:35], a[0:3], v[192:195]
    ds_read_b128 v[232:235], v77 offset:5120
    v_mfma_f32_16x16x32_bf16 v[192:195], v[36:39], a[8:11], v[192:195]
    buffer_load_dwordx4 v1, s[28:31], s44 offen offset:1024 sc1 lds
    v_mfma_f32_16x16x32_bf16 v[196:199], v[36:39], a[12:15], v[196:199]
    ds_read_b128 v[236:239], v77 offset:14336
    v_mfma_f32_16x16x32_bf16 v[196:199], v[32:35], a[4:7], v[196:199]
    s_waitcnt lgkmcnt(4)
    buffer_load_dwordx4 v1, s[28:31], s44 offen offset:2048 sc1 lds
    v_mfma_f32_16x16x32_bf16 v[196:199], v[40:43], a[20:23], v[196:199]
    ds_read_b128 v[32:35], v77 offset:6144
    v_mfma_f32_16x16x32_bf16 v[196:199], v[44:47], a[28:31], v[196:199]
    buffer_load_dwordx4 v1, s[28:31], s44 offen offset:3072 sc1 lds
    v_mfma_f32_16x16x32_bf16 v[192:195], v[44:47], a[24:27], v[192:195]
    ds_read_b128 v[36:39], v77 offset:15360
    v_mfma_f32_16x16x32_bf16 v[192:195], v[40:43], a[16:19], v[192:195]
    s_waitcnt lgkmcnt(4)
    v_mfma_f32_16x16x32_bf16 v[200:203], v[88:91], a[16:19], v[200:203]
    s_add_u32 s46, s56, 8392704
    ds_read_b128 v[40:43], v77 offset:24576
    v_mfma_f32_16x16x32_bf16 v[200:203], v[92:95], a[24:27], v[200:203]
    buffer_load_dwordx4 a[68:71], v1, s[28:31], s46 offen offset:0 sc1
    v_mfma_f32_16x16x32_bf16 v[204:207], v[92:95], a[28:31], v[204:207]
    ds_read_b128 v[44:47], v77 offset:33792
    v_mfma_f32_16x16x32_bf16 v[204:207], v[88:91], a[20:23], v[204:207]
    s_waitcnt lgkmcnt(4)
    v_mfma_f32_16x16x32_bf16 v[204:207], v[232:235], a[4:7], v[204:207]
    ds_read_b128 v[88:91], v77 offset:25600
    v_mfma_f32_16x16x32_bf16 v[204:207], v[236:239], a[12:15], v[204:207]
    buffer_load_dwordx4 a[76:79], v1, s[28:31], s46 offen offset:1024 sc1
    v_mfma_f32_16x16x32_bf16 v[200:203], v[236:239], a[8:11], v[200:203]
    ds_read_b128 v[92:95], v77 offset:34816
    v_mfma_f32_16x16x32_bf16 v[200:203], v[232:235], a[0:3], v[200:203]
    s_waitcnt lgkmcnt(4)
    buffer_load_dwordx4 a[84:87], v1, s[28:31], s46 offen offset:2048 sc1
    v_mfma_f32_16x16x32_bf16 v[208:211], v[32:35], a[0:3], v[208:211]
    ds_read_b128 v[232:235], v77 offset:7168
    v_mfma_f32_16x16x32_bf16 v[208:211], v[36:39], a[8:11], v[208:211]
    v_mfma_f32_16x16x32_bf16 v[212:215], v[36:39], a[12:15], v[212:215]
    ds_read_b128 v[236:239], v77 offset:16384
    v_mfma_f32_16x16x32_bf16 v[212:215], v[32:35], a[4:7], v[212:215]
    s_waitcnt lgkmcnt(4)
    buffer_load_dwordx4 a[92:95], v1, s[28:31], s46 offen offset:3072 sc1
    v_mfma_f32_16x16x32_bf16 v[212:215], v[40:43], a[20:23], v[212:215]
    ds_read_b128 v[32:35], v77 offset:8192
    v_mfma_f32_16x16x32_bf16 v[212:215], v[44:47], a[28:31], v[212:215]
    s_add_u32 s45, s54, 81403904
    v_mfma_f32_16x16x32_bf16 v[208:211], v[44:47], a[24:27], v[208:211]
    s_add_u32 m0, s53, 90112
    ds_read_b128 v[36:39], v77 offset:17408
    v_mfma_f32_16x16x32_bf16 v[208:211], v[40:43], a[16:19], v[208:211]
    s_waitcnt lgkmcnt(4)
    buffer_load_dwordx4 v1, s[28:31], s45 offen offset:0 sc1 lds
    v_mfma_f32_16x16x32_bf16 v[216:219], v[88:91], a[16:19], v[216:219]
    ds_read_b128 v[40:43], v77 offset:26624
    v_mfma_f32_16x16x32_bf16 v[216:219], v[92:95], a[24:27], v[216:219]
    v_mfma_f32_16x16x32_bf16 v[220:223], v[92:95], a[28:31], v[220:223]
    ds_read_b128 v[44:47], v77 offset:35840
    v_mfma_f32_16x16x32_bf16 v[220:223], v[88:91], a[20:23], v[220:223]
    s_waitcnt lgkmcnt(4)
    v_mfma_f32_16x16x32_bf16 v[220:223], v[232:235], a[4:7], v[220:223]
    v_add_u32 v80, s49, v1
    v_and_b32 v78, 15, v2
    v_mfma_f32_16x16x32_bf16 v[220:223], v[236:239], a[12:15], v[220:223]
    v_add_u32 v81, 4096, v80
    v_add_u32 v82, s48, v80
    v_mfma_f32_16x16x32_bf16 v[216:219], v[236:239], a[8:11], v[216:219]
    s_waitcnt vmcnt(17) lgkmcnt(0)
    v_mul_u32_u24 v78, 288, v78
    v_lshrrev_b32 v79, 4, v2
    v_mfma_f32_16x16x32_bf16 v[216:219], v[232:235], a[0:3], v[216:219]
    s_barrier
    v_lshl_add_u32 v78, v79, 3, v78
    v_lshrrev_b32 v79, 16, s63
    v_mfma_f32_16x16x32_bf16 v[224:227], v[32:35], a[0:3], v[224:227]
    ds_read_b128 v[88:91], v1 offset:0
    v_lshl_add_u32 v78, s40, 5, v78
    v_mfma_f32_16x16x32_bf16 v[224:227], v[36:39], a[8:11], v[224:227]
    ds_read_b128 v[92:95], v1 offset:9216
    v_add_u32 v79, v79, v78
    v_mfma_f32_16x16x32_bf16 v[228:231], v[36:39], a[12:15], v[228:231]
    ds_read_b128 v[232:235], v1 offset:18432
    v_add_u32 v84, s15, v1
    v_mfma_f32_16x16x32_bf16 v[228:231], v[32:35], a[4:7], v[228:231]
    s_waitcnt lgkmcnt(3)
    ds_read_b128 v[236:239], v1 offset:27648
    v_add_u32 v85, 40960, v80
    v_mfma_f32_16x16x32_bf16 v[228:231], v[40:43], a[20:23], v[228:231]
    ds_read_b128 v[32:35], v1 offset:19456
    v_mfma_f32_16x16x32_bf16 v[228:231], v[44:47], a[28:31], v[228:231]
    buffer_load_dwordx2 v[4:5], v8, s[28:31], s73 offen sc1
    v_mfma_f32_16x16x32_bf16 v[224:227], v[44:47], a[24:27], v[224:227]
    ds_read_b128 v[36:39], v1 offset:28672
    v_mfma_f32_16x16x32_bf16 v[224:227], v[40:43], a[16:19], v[224:227]
    s_waitcnt lgkmcnt(4)
    v_mfma_f32_16x16x32_bf16 v[160:163], v[88:91], a[32:35], v[160:163]
    ds_read_b128 v[40:43], v1 offset:1024
    v_mfma_f32_16x16x32_bf16 v[160:163], v[92:95], a[40:43], v[160:163]
    s_add_u32 s44, s55, 75497472
    v_mfma_f32_16x16x32_bf16 v[164:167], v[92:95], a[44:47], v[164:167]
    s_add_u32 m0, s53, 118784
    ds_read_b128 v[44:47], v1 offset:10240
    v_mfma_f32_16x16x32_bf16 v[164:167], v[88:91], a[36:39], v[164:167]
    s_waitcnt lgkmcnt(4)
    buffer_load_dwordx4 v1, s[28:31], s44 offen offset:0 sc1 lds
    v_mfma_f32_16x16x32_bf16 v[164:167], v[232:235], a[52:55], v[164:167]
    ds_read_b128 v[88:91], v1 offset:2048
    v_mfma_f32_16x16x32_bf16 v[164:167], v[236:239], a[60:63], v[164:167]
    buffer_load_dwordx4 v1, s[28:31], s44 offen offset:1024 sc1 lds
    v_mfma_f32_16x16x32_bf16 v[160:163], v[236:239], a[56:59], v[160:163]
    ds_read_b128 v[92:95], v1 offset:11264
    v_mfma_f32_16x16x32_bf16 v[160:163], v[232:235], a[48:51], v[160:163]
    s_waitcnt lgkmcnt(4)
    buffer_load_dwordx4 v1, s[28:31], s44 offen offset:2048 sc1 lds
    v_mfma_f32_16x16x32_bf16 v[168:171], v[32:35], a[48:51], v[168:171]
    ds_read_b128 v[232:235], v1 offset:20480
    v_mfma_f32_16x16x32_bf16 v[168:171], v[36:39], a[56:59], v[168:171]
    buffer_load_dwordx4 v1, s[28:31], s44 offen offset:3072 sc1 lds
    v_mfma_f32_16x16x32_bf16 v[172:175], v[36:39], a[60:63], v[172:175]
    ds_read_b128 v[236:239], v1 offset:29696
    v_mfma_f32_16x16x32_bf16 v[172:175], v[32:35], a[52:55], v[172:175]
    s_waitcnt lgkmcnt(4)
    v_mfma_f32_16x16x32_bf16 v[172:175], v[40:43], a[36:39], v[172:175]
    ds_read_b128 v[32:35], v1 offset:21504
    v_mfma_f32_16x16x32_bf16 v[172:175], v[44:47], a[44:47], v[172:175]
    s_add_u32 s45, s55, 75501568
    v_mfma_f32_16x16x32_bf16 v[168:171], v[44:47], a[40:43], v[168:171]
    s_add_u32 m0, s53, 122880
    ds_read_b128 v[36:39], v1 offset:30720
    v_mfma_f32_16x16x32_bf16 v[168:171], v[40:43], a[32:35], v[168:171]
    s_waitcnt lgkmcnt(4)
    buffer_load_dwordx4 v1, s[28:31], s45 offen offset:0 sc1 lds
    v_mfma_f32_16x16x32_bf16 v[176:179], v[88:91], a[32:35], v[176:179]
    ds_read_b128 v[40:43], v1 offset:3072
    v_mfma_f32_16x16x32_bf16 v[176:179], v[92:95], a[40:43], v[176:179]
    buffer_load_dwordx4 v1, s[28:31], s45 offen offset:1024 sc1 lds
    v_mfma_f32_16x16x32_bf16 v[180:183], v[92:95], a[44:47], v[180:183]
    ds_read_b128 v[44:47], v1 offset:12288
    v_mfma_f32_16x16x32_bf16 v[180:183], v[88:91], a[36:39], v[180:183]
    s_waitcnt lgkmcnt(4)
    buffer_load_dwordx4 v1, s[28:31], s45 offen offset:2048 sc1 lds
    v_mfma_f32_16x16x32_bf16 v[180:183], v[232:235], a[52:55], v[180:183]
    ds_read_b128 v[88:91], v1 offset:4096
    v_mfma_f32_16x16x32_bf16 v[180:183], v[236:239], a[60:63], v[180:183]
    buffer_load_dwordx4 v1, s[28:31], s45 offen offset:3072 sc1 lds
    v_mfma_f32_16x16x32_bf16 v[176:179], v[236:239], a[56:59], v[176:179]
    ds_read_b128 v[92:95], v1 offset:13312
    v_mfma_f32_16x16x32_bf16 v[176:179], v[232:235], a[48:51], v[176:179]
    s_waitcnt lgkmcnt(4)
    v_mfma_f32_16x16x32_bf16 v[184:187], v[32:35], a[48:51], v[184:187]
    ds_read_b128 v[232:235], v1 offset:22528
    v_mfma_f32_16x16x32_bf16 v[184:187], v[36:39], a[56:59], v[184:187]
    s_add_u32 s44, s55, 75505664
    v_mfma_f32_16x16x32_bf16 v[188:191], v[36:39], a[60:63], v[188:191]
    s_add_u32 m0, s53, 126976
    ds_read_b128 v[236:239], v1 offset:31744
    v_mfma_f32_16x16x32_bf16 v[188:191], v[32:35], a[52:55], v[188:191]
    s_waitcnt lgkmcnt(4)
    buffer_load_dwordx4 v1, s[28:31], s44 offen offset:0 sc1 lds
    v_mfma_f32_16x16x32_bf16 v[188:191], v[40:43], a[36:39], v[188:191]
    s_waitcnt vmcnt(9)
    ds_read_b128 v[32:35], v1 offset:23552
    v_mfma_f32_16x16x32_bf16 v[188:191], v[44:47], a[44:47], v[188:191]
    s_add_u32 s79, s74, 3
    v_and_b32 v4, 0xffffff87, v4
    v_xor_b32 v5, s68, v5
    v_subrev_u32 v4, s79, v4
    v_min_u32 v5, 1, v5
    v_lshl_or_b32 v4, v5, 8, v4
    v_cmp_le_u32 vcc, 5, v4
    v_mfma_f32_16x16x32_bf16 v[184:187], v[44:47], a[40:43], v[184:187]
    ds_read_b128 v[36:39], v1 offset:32768
    s_cbranch_vccnz L_stub_p3
L_ret_p3:
    v_mfma_f32_16x16x32_bf16 v[184:187], v[40:43], a[32:35], v[184:187]
    s_waitcnt lgkmcnt(4)
    v_mfma_f32_16x16x32_bf16 v[192:195], v[88:91], a[32:35], v[192:195]
    s_add_u32 s46, s57, 25165824
    ds_read_b128 v[40:43], v1 offset:5120
    v_mfma_f32_16x16x32_bf16 v[192:195], v[92:95], a[40:43], v[192:195]
    buffer_load_dwordx4 a[0:3], v1, s[28:31], s46 offen offset:0 sc1
    v_mfma_f32_16x16x32_bf16 v[196:199], v[92:95], a[44:47], v[196:199]
    ds_read_b128 v[44:47], v1 offset:14336
    v_mfma_f32_16x16x32_bf16 v[196:199], v[88:91], a[36:39], v[196:199]
    s_waitcnt lgkmcnt(4)
    buffer_load_dwordx4 a[8:11], v1, s[28:31], s46 offen offset:1024 sc1
    v_mfma_f32_16x16x32_bf16 v[196:199], v[232:235], a[52:55], v[196:199]
    ds_read_b128 v[88:91], v1 offset:6144
    v_mfma_f32_16x16x32_bf16 v[196:199], v[236:239], a[60:63], v[196:199]
    v_mfma_f32_16x16x32_bf16 v[192:195], v[236:239], a[56:59], v[192:195]
    ds_read_b128 v[92:95], v1 offset:15360
    v_mfma_f32_16x16x32_bf16 v[192:195], v[232:235], a[48:51], v[192:195]
    s_waitcnt lgkmcnt(4)
    buffer_load_dwordx4 a[16:19], v1, s[28:31], s46 offen offset:2048 sc1
    v_mfma_f32_16x16x32_bf16 v[200:203], v[32:35], a[48:51], v[200:203]
    ds_read_b128 v[232:235], v1 offset:24576
    v_mfma_f32_16x16x32_bf16 v[200:203], v[36:39], a[56:59], v[200:203]
    buffer_load_dwordx4 a[24:27], v1, s[28:31], s46 offen offset:3072 sc1
    v_mfma_f32_16x16x32_bf16 v[204:207], v[36:39], a[60:63], v[204:207]
    ds_read_b128 v[236:239], v1 offset:33792
    v_mfma_f32_16x16x32_bf16 v[204:207], v[32:35], a[52:55], v[204:207]
    s_waitcnt lgkmcnt(4)
    v_mfma_f32_16x16x32_bf16 v[204:207], v[40:43], a[36:39], v[204:207]
    s_add_u32 s46, s57, 25169920
    ds_read_b128 v[32:35], v1 offset:25600
    v_mfma_f32_16x16x32_bf16 v[204:207], v[44:47], a[44:47], v[204:207]
    buffer_load_dwordx4 a[4:7], v1, s[28:31], s46 offen offset:0 sc1
    v_mfma_f32_16x16x32_bf16 v[200:203], v[44:47], a[40:43], v[200:203]
    ds_read_b128 v[36:39], v1 offset:34816
    v_mfma_f32_16x16x32_bf16 v[200:203], v[40:43], a[32:35], v[200:203]
    s_waitcnt lgkmcnt(4)
    buffer_load_dwordx4 a[12:15], v1, s[28:31], s46 offen offset:1024 sc1
    v_mfma_f32_16x16x32_bf16 v[208:211], v[88:91], a[32:35], v[208:211]
    ds_read_b128 v[40:43], v1 offset:7168
    v_mfma_f32_16x16x32_bf16 v[208:211], v[92:95], a[40:43], v[208:211]
    v_mfma_f32_16x16x32_bf16 v[212:215], v[92:95], a[44:47], v[212:215]
    ds_read_b128 v[44:47], v1 offset:16384
    v_mfma_f32_16x16x32_bf16 v[212:215], v[88:91], a[36:39], v[212:215]
    s_waitcnt lgkmcnt(4)
    buffer_load_dwordx4 a[20:23], v1, s[28:31], s46 offen offset:2048 sc1
    v_mfma_f32_16x16x32_bf16 v[212:215], v[232:235], a[52:55], v[212:215]
    ds_read_b128 v[88:91], v1 offset:8192
    v_mfma_f32_16x16x32_bf16 v[212:215], v[236:239], a[60:63], v[212:215]
    buffer_load_dwordx4 a[28:31], v1, s[28:31], s46 offen offset:3072 sc1
    v_mfma_f32_16x16x32_bf16 v[208:211], v[236:239], a[56:59], v[208:211]
    ds_read_b128 v[92:95], v1 offset:17408
    v_mfma_f32_16x16x32_bf16 v[208:211], v[232:235], a[48:51], v[208:211]
    s_waitcnt lgkmcnt(4)
    v_mfma_f32_16x16x32_bf16 v[216:219], v[32:35], a[48:51], v[216:219]
    ds_read_b128 v[232:235], v1 offset:26624
    v_mfma_f32_16x16x32_bf16 v[216:219], v[36:39], a[56:59], v[216:219]
    v_mfma_f32_16x16x32_bf16 v[220:223], v[36:39], a[60:63], v[220:223]
    ds_read_b128 v[236:239], v1 offset:35840
    v_mfma_f32_16x16x32_bf16 v[220:223], v[32:35], a[52:55], v[220:223]
    s_waitcnt lgkmcnt(4)
    v_mfma_f32_16x16x32_bf16 v[220:223], v[40:43], a[36:39], v[220:223]
    v_mfma_f32_16x16x32_bf16 v[220:223], v[44:47], a[44:47], v[220:223]
    v_mfma_f32_16x16x32_bf16 v[216:219], v[44:47], a[40:43], v[216:219]
    s_waitcnt vmcnt(18) lgkmcnt(0)
    v_mfma_f32_16x16x32_bf16 v[216:219], v[40:43], a[32:35], v[216:219]
    s_barrier
    v_mfma_f32_16x16x32_bf16 v[224:227], v[88:91], a[32:35], v[224:227]
    ds_read_b128 v[32:35], v76 offset:0
    v_mfma_f32_16x16x32_bf16 v[224:227], v[92:95], a[40:43], v[224:227]
    ds_read_b128 v[36:39], v76 offset:9216
    v_mfma_f32_16x16x32_bf16 v[228:231], v[92:95], a[44:47], v[228:231]
    ds_read_b128 v[40:43], v76 offset:18432
    v_mfma_f32_16x16x32_bf16 v[228:231], v[88:91], a[36:39], v[228:231]
    s_waitcnt lgkmcnt(3)
    ds_read_b128 v[44:47], v76 offset:27648
    v_mfma_f32_16x16x32_bf16 v[228:231], v[232:235], a[52:55], v[228:231]
    ds_read_b128 v[88:91], v76 offset:19456
    v_mfma_f32_16x16x32_bf16 v[228:231], v[236:239], a[60:63], v[228:231]
    v_mfma_f32_16x16x32_bf16 v[224:227], v[236:239], a[56:59], v[224:227]
    ds_read_b128 v[92:95], v76 offset:28672
    v_mfma_f32_16x16x32_bf16 v[224:227], v[232:235], a[48:51], v[224:227]
    s_waitcnt lgkmcnt(4)
    v_mfma_f32_16x16x32_bf16 v[160:163], v[32:35], a[64:67], v[160:163]
    ds_read_b128 v[232:235], v76 offset:1024
    v_mov_b32 v0, s12
    v_mfma_f32_16x16x32_bf16 v[160:163], v[36:39], a[72:75], v[160:163]
    s_add_u32 s45, s55, 75644928
    v_min_u32 v8, 2, v2
    v_mfma_f32_16x16x32_bf16 v[164:167], v[36:39], a[76:79], v[164:167]
    s_add_u32 m0, s53, 0
    ds_read_b128 v[236:239], v76 offset:10240
    v_add_u32 v8, s13, v8
    v_mfma_f32_16x16x32_bf16 v[164:167], v[32:35], a[68:71], v[164:167]
    s_waitcnt lgkmcnt(4)
    buffer_load_dwordx4 v1, s[28:31], s45 offen offset:0 sc1 lds
    v_mfma_f32_16x16x32_bf16 v[164:167], v[40:43], a[84:87], v[164:167]
    ds_read_b128 v[32:35], v76 offset:2048
    v_and_b32 v8, 3, v8
    v_mfma_f32_16x16x32_bf16 v[164:167], v[44:47], a[92:95], v[164:167]
    buffer_load_dwordx4 v1, s[28:31], s45 offen offset:1024 sc1 lds
    v_mfma_f32_16x16x32_bf16 v[160:163], v[44:47], a[88:91], v[160:163]
    ds_read_b128 v[36:39], v76 offset:11264
    v_lshl_add_u32 v8, v8, 3, s59
    v_mfma_f32_16x16x32_bf16 v[160:163], v[40:43], a[80:83], v[160:163]
    s_waitcnt lgkmcnt(4)
    v_mfma_f32_16x16x32_bf16 v[168:171], v[88:91], a[80:83], v[168:171]
    ds_read_b128 v[40:43], v76 offset:20480
    v_mfma_f32_16x16x32_bf16 v[168:171], v[92:95], a[88:91], v[168:171]
    buffer_load_dwordx4 v1, s[28:31], s45 offen offset:2048 sc1 lds
    v_mfma_f32_16x16x32_bf16 v[172:175], v[92:95], a[92:95], v[172:175]
    ds_read_b128 v[44:47], v76 offset:29696
    v_mfma_f32_16x16x32_bf16 v[172:175], v[88:91], a[84:87], v[172:175]
    s_waitcnt lgkmcnt(4)
    buffer_load_dwordx4 v1, s[28:31], s45 offen offset:3072 sc1 lds
    v_mfma_f32_16x16x32_bf16 v[172:175], v[232:235], a[68:71], v[172:175]
    ds_read_b128 v[88:91], v76 offset:21504
    v_cvt_pk_bf16_f32 v160, v160, v161
    v_mfma_f32_16x16x32_bf16 v[172:175], v[236:239], a[76:79], v[172:175]
    v_cvt_pk_bf16_f32 v161, v162, v163
    v_cvt_pk_bf16_f32 v162, v164, v165
    v_mfma_f32_16x16x32_bf16 v[168:171], v[236:239], a[72:75], v[168:171]
    s_add_u32 s46, s57, 25690112
    ds_read_b128 v[92:95], v76 offset:30720
    v_cvt_pk_bf16_f32 v163, v166, v167
    v_mfma_f32_16x16x32_bf16 v[168:171], v[232:235], a[64:67], v[168:171]
    s_waitcnt lgkmcnt(4)
    buffer_load_dwordx4 a[32:35], v1, s[28:31], s46 offen offset:0 sc1
    v_mfma_f32_16x16x32_bf16 v[176:179], v[32:35], a[64:67], v[176:179]
    ds_read_b128 v[232:235], v76 offset:3072
    v_mfma_f32_16x16x32_bf16 v[176:179], v[36:39], a[72:75], v[176:179]
    s_add_u32 s78, s58, 50331648
    buffer_store_dwordx4 v[160:163], v1, s[28:31], s78 offen sc1
    v_mfma_f32_16x16x32_bf16 v[180:183], v[36:39], a[76:79], v[180:183]
    ds_read_b128 v[236:239], v76 offset:12288
    v_mfma_f32_16x16x32_bf16 v[180:183], v[32:35], a[68:71], v[180:183]
    s_waitcnt lgkmcnt(4)
    buffer_load_dwordx4 a[40:43], v1, s[28:31], s46 offen offset:1024 sc1
    v_mfma_f32_16x16x32_bf16 v[180:183], v[40:43], a[84:87], v[180:183]
    ds_read_b128 v[32:35], v76 offset:4096
    v_mfma_f32_16x16x32_bf16 v[180:183], v[44:47], a[92:95], v[180:183]
    buffer_load_dwordx4 a[48:51], v1, s[28:31], s46 offen offset:2048 sc1
    v_mfma_f32_16x16x32_bf16 v[176:179], v[44:47], a[88:91], v[176:179]
    ds_read_b128 v[36:39], v76 offset:13312
    v_mfma_f32_16x16x32_bf16 v[176:179], v[40:43], a[80:83], v[176:179]
    s_waitcnt lgkmcnt(4)
    v_mfma_f32_16x16x32_bf16 v[184:187], v[88:91], a[80:83], v[184:187]
    ds_read_b128 v[40:43], v76 offset:22528
    v_mfma_f32_16x16x32_bf16 v[184:187], v[92:95], a[88:91], v[184:187]
    buffer_load_dwordx4 a[56:59], v1, s[28:31], s46 offen offset:3072 sc1
    v_mfma_f32_16x16x32_bf16 v[188:191], v[92:95], a[92:95], v[188:191]
    ds_read_b128 v[44:47], v76 offset:31744
    v_mfma_f32_16x16x32_bf16 v[188:191], v[88:91], a[84:87], v[188:191]
    s_waitcnt lgkmcnt(4)
    v_mfma_f32_16x16x32_bf16 v[188:191], v[232:235], a[68:71], v[188:191]
    ds_read_b128 v[88:91], v76 offset:23552
    v_mfma_f32_16x16x32_bf16 v[188:191], v[236:239], a[76:79], v[188:191]
    s_add_u32 s44, s55, 75649024
    v_mfma_f32_16x16x32_bf16 v[184:187], v[236:239], a[72:75], v[184:187]
    s_add_u32 m0, s53, 4096
    ds_read_b128 v[92:95], v76 offset:32768
    v_mfma_f32_16x16x32_bf16 v[184:187], v[232:235], a[64:67], v[184:187]
    s_waitcnt lgkmcnt(4)
    buffer_load_dwordx4 v1, s[28:31], s44 offen offset:0 sc1 lds
    v_mfma_f32_16x16x32_bf16 v[192:195], v[32:35], a[64:67], v[192:195]
    ds_read_b128 v[232:235], v76 offset:5120
    v_mfma_f32_16x16x32_bf16 v[192:195], v[36:39], a[72:75], v[192:195]
    buffer_load_dwordx4 v1, s[28:31], s44 offen offset:1024 sc1 lds
    v_mfma_f32_16x16x32_bf16 v[196:199], v[36:39], a[76:79], v[196:199]
    ds_read_b128 v[236:239], v76 offset:14336
    v_mfma_f32_16x16x32_bf16 v[196:199], v[32:35], a[68:71], v[196:199]
    s_waitcnt lgkmcnt(4)
    buffer_load_dwordx4 v1, s[28:31], s44 offen offset:2048 sc1 lds
    v_mfma_f32_16x16x32_bf16 v[196:199], v[40:43], a[84:87], v[196:199]
    ds_read_b128 v[32:35], v76 offset:6144
    v_mfma_f32_16x16x32_bf16 v[196:199], v[44:47], a[92:95], v[196:199]
    buffer_load_dwordx4 v1, s[28:31], s44 offen offset:3072 sc1 lds
    v_mfma_f32_16x16x32_bf16 v[192:195], v[44:47], a[88:91], v[192:195]
    ds_read_b128 v[36:39], v76 offset:15360
    v_mfma_f32_16x16x32_bf16 v[192:195], v[40:43], a[80:83], v[192:195]
    s_waitcnt lgkmcnt(4)
    v_mfma_f32_16x16x32_bf16 v[200:203], v[88:91], a[80:83], v[200:203]
    s_add_u32 s46, s57, 25694208
    ds_read_b128 v[40:43], v76 offset:24576
    v_mfma_f32_16x16x32_bf16 v[200:203], v[92:95], a[88:91], v[200:203]
    buffer_load_dwordx4 a[36:39], v1, s[28:31], s46 offen offset:0 sc1
    v_mfma_f32_16x16x32_bf16 v[204:207], v[92:95], a[92:95], v[204:207]
    ds_read_b128 v[44:47], v76 offset:33792
    v_mfma_f32_16x16x32_bf16 v[204:207], v[88:91], a[84:87], v[204:207]
    s_waitcnt lgkmcnt(4)
    v_mfma_f32_16x16x32_bf16 v[204:207], v[232:235], a[68:71], v[204:207]
    ds_read_b128 v[88:91], v76 offset:25600
    v_mfma_f32_16x16x32_bf16 v[204:207], v[236:239], a[76:79], v[204:207]
    buffer_load_dwordx4 a[44:47], v1, s[28:31], s46 offen offset:1024 sc1
    v_mfma_f32_16x16x32_bf16 v[200:203], v[236:239], a[72:75], v[200:203]
    ds_read_b128 v[92:95], v76 offset:34816
    v_mfma_f32_16x16x32_bf16 v[200:203], v[232:235], a[64:67], v[200:203]
    s_waitcnt lgkmcnt(4)
    buffer_load_dwordx4 a[52:55], v1, s[28:31], s46 offen offset:2048 sc1
    v_mfma_f32_16x16x32_bf16 v[208:211], v[32:35], a[64:67], v[208:211]
    ds_read_b128 v[232:235], v76 offset:7168
    v_mfma_f32_16x16x32_bf16 v[208:211], v[36:39], a[72:75], v[208:211]
    ds_write_b128 v84, v[160:163] offset:0
    v_mfma_f32_16x16x32_bf16 v[212:215], v[36:39], a[76:79], v[212:215]
    ds_read_b128 v[236:239], v76 offset:16384
    v_mfma_f32_16x16x32_bf16 v[212:215], v[32:35], a[68:71], v[212:215]
    s_waitcnt lgkmcnt(5)
    buffer_load_dwordx4 a[60:63], v1, s[28:31], s46 offen offset:3072 sc1
    v_mfma_f32_16x16x32_bf16 v[212:215], v[40:43], a[84:87], v[212:215]
    ds_read_b128 v[32:35], v76 offset:8192
    v_mfma_f32_16x16x32_bf16 v[212:215], v[44:47], a[92:95], v[212:215]
    s_add_u32 s45, s55, 75653120
    v_cvt_pk_bf16_f32 v168, v168, v169
    v_cvt_pk_bf16_f32 v169, v170, v171
    v_mfma_f32_16x16x32_bf16 v[208:211], v[44:47], a[88:91], v[208:211]
    s_add_u32 m0, s53, 8192
    ds_read_b128 v[36:39], v76 offset:17408
    v_cvt_pk_bf16_f32 v170, v172, v173
    v_mfma_f32_16x16x32_bf16 v[208:211], v[40:43], a[80:83], v[208:211]
    s_waitcnt lgkmcnt(5)
    buffer_load_dwordx4 v1, s[28:31], s45 offen offset:0 sc1 lds
    v_mfma_f32_16x16x32_bf16 v[216:219], v[88:91], a[80:83], v[216:219]
    ds_read_b128 v[40:43], v76 offset:26624
    v_cvt_pk_bf16_f32 v171, v174, v175
    v_mfma_f32_16x16x32_bf16 v[216:219], v[92:95], a[88:91], v[216:219]
    s_add_u32 s78, s58, 50332672
    buffer_store_dwordx4 v[168:171], v1, s[28:31], s78 offen sc1
    v_mfma_f32_16x16x32_bf16 v[220:223], v[92:95], a[92:95], v[220:223]
    ds_read_b128 v[44:47], v76 offset:35840
    v_mfma_f32_16x16x32_bf16 v[220:223], v[88:91], a[84:87], v[220:223]
    s_waitcnt lgkmcnt(4)
    v_mfma_f32_16x16x32_bf16 v[220:223], v[232:235], a[68:71], v[220:223]
    ds_write_b128 v84, v[168:171] offset:1024
    v_mfma_f32_16x16x32_bf16 v[220:223], v[236:239], a[76:79], v[220:223]
    v_mfma_f32_16x16x32_bf16 v[216:219], v[236:239], a[72:75], v[216:219]
    s_waitcnt vmcnt(19) lgkmcnt(0)
    v_mfma_f32_16x16x32_bf16 v[216:219], v[232:235], a[64:67], v[216:219]
    s_barrier
    v_mfma_f32_16x16x32_bf16 v[224:227], v[32:35], a[64:67], v[224:227]
    ds_read_b128 v[88:91], v77 offset:0
    v_mfma_f32_16x16x32_bf16 v[224:227], v[36:39], a[72:75], v[224:227]
    ds_read_b128 v[92:95], v77 offset:9216
    v_mfma_f32_16x16x32_bf16 v[228:231], v[36:39], a[76:79], v[228:231]
    ds_read_b128 v[232:235], v77 offset:18432
    v_mfma_f32_16x16x32_bf16 v[228:231], v[32:35], a[68:71], v[228:231]
    s_waitcnt lgkmcnt(4)
    ds_read_b128 v[236:239], v77 offset:27648
    v_mfma_f32_16x16x32_bf16 v[228:231], v[40:43], a[84:87], v[228:231]
    ds_read_b128 v[32:35], v77 offset:19456
    v_mfma_f32_16x16x32_bf16 v[228:231], v[44:47], a[92:95], v[228:231]
    v_mfma_f32_16x16x32_bf16 v[224:227], v[44:47], a[88:91], v[224:227]
    ds_read_b128 v[36:39], v77 offset:28672
    v_mfma_f32_16x16x32_bf16 v[224:227], v[40:43], a[80:83], v[224:227]
    s_waitcnt lgkmcnt(4)
    v_mfma_f32_16x16x32_bf16 v[96:99], v[88:91], a[0:3], 0
    ds_read_b128 v[40:43], v77 offset:1024
    v_mfma_f32_16x16x32_bf16 v[96:99], v[92:95], a[8:11], v[96:99]
    s_add_u32 s44, s55, 75792384
    v_mfma_f32_16x16x32_bf16 v[100:103], v[92:95], a[12:15], 0
    s_add_u32 m0, s53, 81920
    ds_read_b128 v[44:47], v77 offset:10240
    v_mfma_f32_16x16x32_bf16 v[100:103], v[88:91], a[4:7], v[100:103]
    s_waitcnt lgkmcnt(4)
    buffer_load_dwordx4 v1, s[28:31], s44 offen offset:0 sc1 lds
    v_mfma_f32_16x16x32_bf16 v[100:103], v[232:235], a[20:23], v[100:103]
    ds_read_b128 v[88:91], v77 offset:2048
    v_mfma_f32_16x16x32_bf16 v[100:103], v[236:239], a[28:31], v[100:103]
    buffer_load_dwordx4 v1, s[28:31], s44 offen offset:1024 sc1 lds
    v_mfma_f32_16x16x32_bf16 v[96:99], v[236:239], a[24:27], v[96:99]
    ds_read_b128 v[92:95], v77 offset:11264
    v_mfma_f32_16x16x32_bf16 v[96:99], v[232:235], a[16:19], v[96:99]
    s_waitcnt lgkmcnt(4)
    v_mfma_f32_16x16x32_bf16 v[104:107], v[32:35], a[16:19], 0
    ds_read_b128 v[232:235], v77 offset:20480
    v_mfma_f32_16x16x32_bf16 v[104:107], v[36:39], a[24:27], v[104:107]
    buffer_load_dwordx4 v1, s[28:31], s44 offen offset:2048 sc1 lds
    v_mfma_f32_16x16x32_bf16 v[108:111], v[36:39], a[28:31], 0
    ds_read_b128 v[236:239], v77 offset:29696
    v_mfma_f32_16x16x32_bf16 v[108:111], v[32:35], a[20:23], v[108:111]
    s_waitcnt lgkmcnt(4)
    buffer_load_dwordx4 v1, s[28:31], s44 offen offset:3072 sc1 lds
    v_mfma_f32_16x16x32_bf16 v[108:111], v[40:43], a[4:7], v[108:111]
    ds_read_b128 v[32:35], v77 offset:21504
    v_mfma_f32_16x16x32_bf16 v[108:111], v[44:47], a[12:15], v[108:111]
    v_mfma_f32_16x16x32_bf16 v[104:107], v[44:47], a[8:11], v[104:107]
    s_add_u32 s46, s57, 26214400
    ds_read_b128 v[36:39], v77 offset:30720
    v_mfma_f32_16x16x32_bf16 v[104:107], v[40:43], a[0:3], v[104:107]
    s_waitcnt lgkmcnt(4)
    buffer_load_dwordx4 a[64:67], v1, s[28:31], s46 offen offset:0 sc1
    v_mfma_f32_16x16x32_bf16 v[112:115], v[88:91], a[0:3], 0
    ds_read_b128 v[40:43], v77 offset:3072
    v_mfma_f32_16x16x32_bf16 v[112:115], v[92:95], a[8:11], v[112:115]
    v_mfma_f32_16x16x32_bf16 v[116:119], v[92:95], a[12:15], 0
    ds_read_b128 v[44:47], v77 offset:12288
    v_mfma_f32_16x16x32_bf16 v[116:119], v[88:91], a[4:7], v[116:119]
    s_waitcnt lgkmcnt(4)
    buffer_load_dwordx4 a[72:75], v1, s[28:31], s46 offen offset:1024 sc1
    v_mfma_f32_16x16x32_bf16 v[116:119], v[232:235], a[20:23], v[116:119]
    ds_read_b128 v[88:91], v77 offset:4096
    v_mfma_f32_16x16x32_bf16 v[116:119], v[236:239], a[28:31], v[116:119]
    buffer_load_dwordx4 a[80:83], v1, s[28:31], s46 offen offset:2048 sc1
    v_mfma_f32_16x16x32_bf16 v[112:115], v[236:239], a[24:27], v[112:115]
    ds_read_b128 v[92:95], v77 offset:13312
    v_cvt_pk_bf16_f32 v176, v176, v177
    v_mfma_f32_16x16x32_bf16 v[112:115], v[232:235], a[16:19], v[112:115]
    s_waitcnt lgkmcnt(4)
    v_cvt_pk_bf16_f32 v177, v178, v179
    v_cvt_pk_bf16_f32 v178, v180, v181
    v_mfma_f32_16x16x32_bf16 v[120:123], v[32:35], a[16:19], 0
    ds_read_b128 v[232:235], v77 offset:22528
    v_cvt_pk_bf16_f32 v179, v182, v183
    v_mfma_f32_16x16x32_bf16 v[120:123], v[36:39], a[24:27], v[120:123]
    buffer_load_dwordx4 a[88:91], v1, s[28:31], s46 offen offset:3072 sc1
    v_mfma_f32_16x16x32_bf16 v[124:127], v[36:39], a[28:31], 0
    ds_read_b128 v[236:239], v77 offset:31744
    v_mfma_f32_16x16x32_bf16 v[124:127], v[32:35], a[20:23], v[124:127]
    s_waitcnt lgkmcnt(4)
    v_mfma_f32_16x16x32_bf16 v[124:127], v[40:43], a[4:7], v[124:127]
    ds_read_b128 v[32:35], v77 offset:23552
    v_mfma_f32_16x16x32_bf16 v[124:127], v[44:47], a[12:15], v[124:127]
    s_add_u32 s45, s55, 75796480
    v_mfma_f32_16x16x32_bf16 v[120:123], v[44:47], a[8:11], v[120:123]
    s_add_u32 m0, s53, 86016
    ds_read_b128 v[36:39], v77 offset:32768
    v_mfma_f32_16x16x32_bf16 v[120:123], v[40:43], a[0:3], v[120:123]
    s_waitcnt lgkmcnt(4)
    buffer_load_dwordx4 v1, s[28:31], s45 offen offset:0 sc1 lds
    v_mfma_f32_16x16x32_bf16 v[128:131], v[88:91], a[0:3], 0
    ds_read_b128 v[40:43], v77 offset:5120
    v_mfma_f32_16x16x32_bf16 v[128:131], v[92:95], a[8:11], v[128:131]
    buffer_load_dwordx4 v1, s[28:31], s45 offen offset:1024 sc1 lds
    v_mfma_f32_16x16x32_bf16 v[132:135], v[92:95], a[12:15], 0
    ds_read_b128 v[44:47], v77 offset:14336
    v_mfma_f32_16x16x32_bf16 v[132:135], v[88:91], a[4:7], v[132:135]
    s_waitcnt lgkmcnt(4)
    buffer_load_dwordx4 v1, s[28:31], s45 offen offset:2048 sc1 lds
    v_mfma_f32_16x16x32_bf16 v[132:135], v[232:235], a[20:23], v[132:135]
    ds_read_b128 v[88:91], v77 offset:6144
    v_mfma_f32_16x16x32_bf16 v[132:135], v[236:239], a[28:31], v[132:135]
    buffer_load_dwordx4 v1, s[28:31], s45 offen offset:3072 sc1 lds
    v_mfma_f32_16x16x32_bf16 v[128:131], v[236:239], a[24:27], v[128:131]
    ds_read_b128 v[92:95], v77 offset:15360
    v_mfma_f32_16x16x32_bf16 v[128:131], v[232:235], a[16:19], v[128:131]
    s_waitcnt lgkmcnt(4)
    v_mfma_f32_16x16x32_bf16 v[136:139], v[32:35], a[16:19], 0
    s_add_u32 s46, s57, 26218496
    ds_read_b128 v[232:235], v77 offset:24576
    v_mfma_f32_16x16x32_bf16 v[136:139], v[36:39], a[24:27], v[136:139]
    buffer_load_dwordx4 a[68:71], v1, s[28:31], s46 offen offset:0 sc1
    v_mfma_f32_16x16x32_bf16 v[140:143], v[36:39], a[28:31], 0
    ds_read_b128 v[236:239], v77 offset:33792
    v_mfma_f32_16x16x32_bf16 v[140:143], v[32:35], a[20:23], v[140:143]
    s_waitcnt lgkmcnt(4)
    v_mfma_f32_16x16x32_bf16 v[140:143], v[40:43], a[4:7], v[140:143]
    ds_read_b128 v[32:35], v77 offset:25600
    v_mfma_f32_16x16x32_bf16 v[140:143], v[44:47], a[12:15], v[140:143]
    buffer_load_dwordx4 a[76:79], v1, s[28:31], s46 offen offset:1024 sc1
    v_mfma_f32_16x16x32_bf16 v[136:139], v[44:47], a[8:11], v[136:139]
    ds_read_b128 v[36:39], v77 offset:34816
    v_mfma_f32_16x16x32_bf16 v[136:139], v[40:43], a[0:3], v[136:139]
    s_waitcnt lgkmcnt(4)
    buffer_load_dwordx4 a[84:87], v1, s[28:31], s46 offen offset:2048 sc1
    v_mfma_f32_16x16x32_bf16 v[144:147], v[88:91], a[0:3], 0
    ds_read_b128 v[40:43], v77 offset:7168
    v_mfma_f32_16x16x32_bf16 v[144:147], v[92:95], a[8:11], v[144:147]
    s_add_u32 s78, s58, 50333696
    buffer_store_dwordx4 v[176:179], v1, s[28:31], s78 offen sc1
    v_mfma_f32_16x16x32_bf16 v[148:151], v[92:95], a[12:15], 0
    ds_read_b128 v[44:47], v77 offset:16384
    v_mfma_f32_16x16x32_bf16 v[148:151], v[88:91], a[4:7], v[148:151]
    s_waitcnt lgkmcnt(4)
    buffer_load_dwordx4 a[92:95], v1, s[28:31], s46 offen offset:3072 sc1
    v_mfma_f32_16x16x32_bf16 v[148:151], v[232:235], a[20:23], v[148:151]
    ds_read_b128 v[88:91], v77 offset:8192
    v_mfma_f32_16x16x32_bf16 v[148:151], v[236:239], a[28:31], v[148:151]
    s_add_u32 s44, s55, 75800576
    v_mfma_f32_16x16x32_bf16 v[144:147], v[236:239], a[24:27], v[144:147]
    s_add_u32 m0, s53, 90112
    ds_read_b128 v[92:95], v77 offset:17408
    v_mfma_f32_16x16x32_bf16 v[144:147], v[232:235], a[16:19], v[144:147]
    s_waitcnt lgkmcnt(4)
    buffer_load_dwordx4 v1, s[28:31], s44 offen offset:0 sc1 lds
    v_mfma_f32_16x16x32_bf16 v[152:155], v[32:35], a[16:19], 0
    ds_read_b128 v[232:235], v77 offset:26624
    v_mfma_f32_16x16x32_bf16 v[152:155], v[36:39], a[24:27], v[152:155]
    ds_write_b128 v84, v[176:179] offset:2048
    v_mfma_f32_16x16x32_bf16 v[156:159], v[36:39], a[28:31], 0
    ds_read_b128 v[236:239], v77 offset:35840
    v_mfma_f32_16x16x32_bf16 v[156:159], v[32:35], a[20:23], v[156:159]
    s_waitcnt lgkmcnt(5)
    v_mfma_f32_16x16x32_bf16 v[156:159], v[40:43], a[4:7], v[156:159]
    v_mfma_f32_16x16x32_bf16 v[156:159], v[44:47], a[12:15], v[156:159]
    v_mfma_f32_16x16x32_bf16 v[152:155], v[44:47], a[8:11], v[152:155]
    s_waitcnt vmcnt(19) lgkmcnt(0)
    v_mfma_f32_16x16x32_bf16 v[152:155], v[40:43], a[0:3], v[152:155]
    s_barrier
    v_cvt_pk_bf16_f32 v184, v184, v185
    v_cvt_pk_bf16_f32 v185, v186, v187
    v_mfma_f32_16x16x32_bf16 v[240:243], v[88:91], a[0:3], 0
    ds_read_b128 v[32:35], v1 offset:0
    v_cvt_pk_bf16_f32 v186, v188, v189
    v_mfma_f32_16x16x32_bf16 v[240:243], v[92:95], a[8:11], v[240:243]
    ds_read_b128 v[36:39], v1 offset:9216
    v_cvt_pk_bf16_f32 v187, v190, v191
    v_mfma_f32_16x16x32_bf16 v[244:247], v[92:95], a[12:15], 0
    ds_read_b128 v[40:43], v1 offset:18432
    v_mfma_f32_16x16x32_bf16 v[244:247], v[88:91], a[4:7], v[244:247]
    s_waitcnt lgkmcnt(3)
    ds_read_b128 v[44:47], v1 offset:27648
    v_mfma_f32_16x16x32_bf16 v[244:247], v[232:235], a[20:23], v[244:247]
    ds_read_b128 v[88:91], v1 offset:19456
    v_mfma_f32_16x16x32_bf16 v[244:247], v[236:239], a[28:31], v[244:247]
    s_add_u32 s78, s58, 50334720
    buffer_store_dwordx4 v[184:187], v1, s[28:31], s78 offen sc1
    v_mfma_f32_16x16x32_bf16 v[240:243], v[236:239], a[24:27], v[240:243]
    ds_read_b128 v[92:95], v1 offset:28672
    v_mfma_f32_16x16x32_bf16 v[240:243], v[232:235], a[16:19], v[240:243]
    s_waitcnt lgkmcnt(4)
    v_mfma_f32_16x16x32_bf16 v[96:99], v[32:35], a[32:35], v[96:99]
    ds_read_b128 v[232:235], v1 offset:1024
    v_mfma_f32_16x16x32_bf16 v[96:99], v[36:39], a[40:43], v[96:99]
    s_add_u32 s45, s55, 75939840
    v_mfma_f32_16x16x32_bf16 v[100:103], v[36:39], a[44:47], v[100:103]
    s_add_u32 m0, s53, 118784
    ds_read_b128 v[236:239], v1 offset:10240
    v_mfma_f32_16x16x32_bf16 v[100:103], v[32:35], a[36:39], v[100:103]
    s_waitcnt lgkmcnt(4)
    buffer_load_dwordx4 v1, s[28:31], s45 offen offset:0 sc1 lds
    v_mfma_f32_16x16x32_bf16 v[100:103], v[40:43], a[52:55], v[100:103]
    ds_read_b128 v[32:35], v1 offset:2048
    v_mfma_f32_16x16x32_bf16 v[100:103], v[44:47], a[60:63], v[100:103]
    buffer_load_dwordx4 v1, s[28:31], s45 offen offset:1024 sc1 lds
    v_mfma_f32_16x16x32_bf16 v[96:99], v[44:47], a[56:59], v[96:99]
    ds_read_b128 v[36:39], v1 offset:11264
    v_mfma_f32_16x16x32_bf16 v[96:99], v[40:43], a[48:51], v[96:99]
    s_waitcnt lgkmcnt(4)
    v_mfma_f32_16x16x32_bf16 v[104:107], v[88:91], a[48:51], v[104:107]
    ds_read_b128 v[40:43], v1 offset:20480
    v_mfma_f32_16x16x32_bf16 v[104:107], v[92:95], a[56:59], v[104:107]
    buffer_load_dwordx4 v1, s[28:31], s45 offen offset:2048 sc1 lds
    v_mfma_f32_16x16x32_bf16 v[108:111], v[92:95], a[60:63], v[108:111]
    ds_read_b128 v[44:47], v1 offset:29696
    v_mfma_f32_16x16x32_bf16 v[108:111], v[88:91], a[52:55], v[108:111]
    s_waitcnt lgkmcnt(4)
    buffer_load_dwordx4 v1, s[28:31], s45 offen offset:3072 sc1 lds
    v_mfma_f32_16x16x32_bf16 v[108:111], v[232:235], a[36:39], v[108:111]
    ds_read_b128 v[88:91], v1 offset:21504
    v_mfma_f32_16x16x32_bf16 v[108:111], v[236:239], a[44:47], v[108:111]
    ds_write_b128 v84, v[184:187] offset:3072
    v_mfma_f32_16x16x32_bf16 v[104:107], v[236:239], a[40:43], v[104:107]
    s_add_u32 s46, s57, 26738688
    ds_read_b128 v[92:95], v1 offset:30720
    v_mfma_f32_16x16x32_bf16 v[104:107], v[232:235], a[32:35], v[104:107]
    s_waitcnt lgkmcnt(5)
    buffer_load_dwordx4 a[0:3], v1, s[28:31], s46 offen offset:0 sc1
    v_mfma_f32_16x16x32_bf16 v[112:115], v[32:35], a[32:35], v[112:115]
    ds_read_b128 v[232:235], v1 offset:3072
    v_mfma_f32_16x16x32_bf16 v[112:115], v[36:39], a[40:43], v[112:115]
    v_mfma_f32_16x16x32_bf16 v[116:119], v[36:39], a[44:47], v[116:119]
    ds_read_b128 v[236:239], v1 offset:12288
    v_mfma_f32_16x16x32_bf16 v[116:119], v[32:35], a[36:39], v[116:119]
    s_waitcnt lgkmcnt(5)
    buffer_load_dwordx4 a[8:11], v1, s[28:31], s46 offen offset:1024 sc1
    v_mfma_f32_16x16x32_bf16 v[116:119], v[40:43], a[52:55], v[116:119]
    ds_read_b128 v[32:35], v1 offset:4096
    v_mfma_f32_16x16x32_bf16 v[116:119], v[44:47], a[60:63], v[116:119]
    buffer_load_dwordx4 a[16:19], v1, s[28:31], s46 offen offset:2048 sc1
    v_mfma_f32_16x16x32_bf16 v[112:115], v[44:47], a[56:59], v[112:115]
    ds_read_b128 v[36:39], v1 offset:13312
    v_mfma_f32_16x16x32_bf16 v[112:115], v[40:43], a[48:51], v[112:115]
    s_waitcnt lgkmcnt(4)
    v_mfma_f32_16x16x32_bf16 v[120:123], v[88:91], a[48:51], v[120:123]
    ds_read_b128 v[40:43], v1 offset:22528
    v_mfma_f32_16x16x32_bf16 v[120:123], v[92:95], a[56:59], v[120:123]
    buffer_load_dwordx4 a[24:27], v1, s[28:31], s46 offen offset:3072 sc1
    v_mfma_f32_16x16x32_bf16 v[124:127], v[92:95], a[60:63], v[124:127]
    ds_read_b128 v[44:47], v1 offset:31744
    v_mfma_f32_16x16x32_bf16 v[124:127], v[88:91], a[52:55], v[124:127]
    s_waitcnt lgkmcnt(4)
    v_mfma_f32_16x16x32_bf16 v[124:127], v[232:235], a[36:39], v[124:127]
    ds_read_b128 v[88:91], v1 offset:23552
    v_mfma_f32_16x16x32_bf16 v[124:127], v[236:239], a[44:47], v[124:127]
    s_add_u32 s44, s55, 75943936
    v_mfma_f32_16x16x32_bf16 v[120:123], v[236:239], a[40:43], v[120:123]
    s_add_u32 m0, s53, 122880
    ds_read_b128 v[92:95], v1 offset:32768
    v_mfma_f32_16x16x32_bf16 v[120:123], v[232:235], a[32:35], v[120:123]
    s_waitcnt lgkmcnt(4)
    buffer_load_dwordx4 v1, s[28:31], s44 offen offset:0 sc1 lds
    v_mfma_f32_16x16x32_bf16 v[128:131], v[32:35], a[32:35], v[128:131]
    ds_read_b128 v[232:235], v1 offset:5120
    v_mfma_f32_16x16x32_bf16 v[128:131], v[36:39], a[40:43], v[128:131]
    buffer_load_dwordx4 v1, s[28:31], s44 offen offset:1024 sc1 lds
    v_mfma_f32_16x16x32_bf16 v[132:135], v[36:39], a[44:47], v[132:135]
    ds_read_b128 v[236:239], v1 offset:14336
    v_cvt_pk_bf16_f32 v192, v192, v193
    v_mfma_f32_16x16x32_bf16 v[132:135], v[32:35], a[36:39], v[132:135]
    s_waitcnt lgkmcnt(4)
    buffer_load_dwordx4 v1, s[28:31], s44 offen offset:2048 sc1 lds
    v_mfma_f32_16x16x32_bf16 v[132:135], v[40:43], a[52:55], v[132:135]
    ds_read_b128 v[32:35], v1 offset:6144
    v_cvt_pk_bf16_f32 v193, v194, v195
    v_mfma_f32_16x16x32_bf16 v[132:135], v[44:47], a[60:63], v[132:135]
    buffer_load_dwordx4 v1, s[28:31], s44 offen offset:3072 sc1 lds
    v_mfma_f32_16x16x32_bf16 v[128:131], v[44:47], a[56:59], v[128:131]
    ds_read_b128 v[36:39], v1 offset:15360
    v_cvt_pk_bf16_f32 v194, v196, v197
    v_mfma_f32_16x16x32_bf16 v[128:131], v[40:43], a[48:51], v[128:131]
    s_waitcnt lgkmcnt(4)
    v_cvt_pk_bf16_f32 v195, v198, v199
    v_mfma_f32_16x16x32_bf16 v[136:139], v[88:91], a[48:51], v[136:139]
    s_add_u32 s46, s57, 26742784
    ds_read_b128 v[40:43], v1 offset:24576
    v_mfma_f32_16x16x32_bf16 v[136:139], v[92:95], a[56:59], v[136:139]
    buffer_load_dwordx4 a[4:7], v1, s[28:31], s46 offen offset:0 sc1
    v_mfma_f32_16x16x32_bf16 v[140:143], v[92:95], a[60:63], v[140:143]
    ds_read_b128 v[44:47], v1 offset:33792
    v_mfma_f32_16x16x32_bf16 v[140:143], v[88:91], a[52:55], v[140:143]
    s_waitcnt lgkmcnt(4)
    v_mfma_f32_16x16x32_bf16 v[140:143], v[232:235], a[36:39], v[140:143]
    ds_read_b128 v[88:91], v1 offset:25600
    v_mfma_f32_16x16x32_bf16 v[140:143], v[236:239], a[44:47], v[140:143]
    buffer_load_dwordx4 a[12:15], v1, s[28:31], s46 offen offset:1024 sc1
    v_mfma_f32_16x16x32_bf16 v[136:139], v[236:239], a[40:43], v[136:139]
    ds_read_b128 v[92:95], v1 offset:34816
    v_mfma_f32_16x16x32_bf16 v[136:139], v[232:235], a[32:35], v[136:139]
    s_waitcnt lgkmcnt(4)
    buffer_load_dwordx4 a[20:23], v1, s[28:31], s46 offen offset:2048 sc1
    v_mfma_f32_16x16x32_bf16 v[144:147], v[32:35], a[32:35], v[144:147]
    ds_read_b128 v[232:235], v1 offset:7168
    v_mfma_f32_16x16x32_bf16 v[144:147], v[36:39], a[40:43], v[144:147]
    s_add_u32 s78, s58, 50335744
    buffer_store_dwordx4 v[192:195], v1, s[28:31], s78 offen sc1
    v_mfma_f32_16x16x32_bf16 v[148:151], v[36:39], a[44:47], v[148:151]
    ds_read_b128 v[236:239], v1 offset:16384
    v_mfma_f32_16x16x32_bf16 v[148:151], v[32:35], a[36:39], v[148:151]
    s_waitcnt lgkmcnt(4)
    buffer_load_dwordx4 a[28:31], v1, s[28:31], s46 offen offset:3072 sc1
    v_mfma_f32_16x16x32_bf16 v[148:151], v[40:43], a[52:55], v[148:151]
    ds_read_b128 v[32:35], v1 offset:8192
    v_mfma_f32_16x16x32_bf16 v[148:151], v[44:47], a[60:63], v[148:151]
    s_add_u32 s45, s55, 75948032
    v_mfma_f32_16x16x32_bf16 v[144:147], v[44:47], a[56:59], v[144:147]
    s_add_u32 m0, s53, 126976
    ds_read_b128 v[36:39], v1 offset:17408
    v_mfma_f32_16x16x32_bf16 v[144:147], v[40:43], a[48:51], v[144:147]
    s_waitcnt lgkmcnt(4)
    buffer_load_dwordx4 v1, s[28:31], s45 offen offset:0 sc1 lds
    v_mfma_f32_16x16x32_bf16 v[152:155], v[88:91], a[48:51], v[152:155]
    ds_read_b128 v[40:43], v1 offset:26624
    v_mfma_f32_16x16x32_bf16 v[152:155], v[92:95], a[56:59], v[152:155]
    ds_write_b128 v84, v[192:195] offset:4096
    v_mfma_f32_16x16x32_bf16 v[156:159], v[92:95], a[60:63], v[156:159]
    ds_read_b128 v[44:47], v1 offset:35840
    v_mfma_f32_16x16x32_bf16 v[156:159], v[88:91], a[52:55], v[156:159]
    s_waitcnt lgkmcnt(5)
    v_mfma_f32_16x16x32_bf16 v[156:159], v[232:235], a[36:39], v[156:159]
    v_mfma_f32_16x16x32_bf16 v[156:159], v[236:239], a[44:47], v[156:159]
    v_mfma_f32_16x16x32_bf16 v[152:155], v[236:239], a[40:43], v[152:155]
    s_waitcnt vmcnt(19) lgkmcnt(0)
    v_mfma_f32_16x16x32_bf16 v[152:155], v[232:235], a[32:35], v[152:155]
    s_barrier
    v_mfma_f32_16x16x32_bf16 v[240:243], v[32:35], a[32:35], v[240:243]
    ds_read_b128 v[88:91], v76 offset:0
    v_mfma_f32_16x16x32_bf16 v[240:243], v[36:39], a[40:43], v[240:243]
    ds_read_b128 v[92:95], v76 offset:9216
    v_mfma_f32_16x16x32_bf16 v[244:247], v[36:39], a[44:47], v[244:247]
    ds_read_b128 v[232:235], v76 offset:18432
    v_mfma_f32_16x16x32_bf16 v[244:247], v[32:35], a[36:39], v[244:247]
    s_waitcnt lgkmcnt(3)
    ds_read_b128 v[236:239], v76 offset:27648
    v_mfma_f32_16x16x32_bf16 v[244:247], v[40:43], a[52:55], v[244:247]
    ds_read_b128 v[32:35], v76 offset:19456
    v_mfma_f32_16x16x32_bf16 v[244:247], v[44:47], a[60:63], v[244:247]
    v_mfma_f32_16x16x32_bf16 v[240:243], v[44:47], a[56:59], v[240:243]
    ds_read_b128 v[36:39], v76 offset:28672
    v_mfma_f32_16x16x32_bf16 v[240:243], v[40:43], a[48:51], v[240:243]
    s_waitcnt lgkmcnt(4)
    v_mfma_f32_16x16x32_bf16 v[96:99], v[88:91], a[64:67], v[96:99]
    ds_read_b128 v[40:43], v76 offset:1024
    v_mfma_f32_16x16x32_bf16 v[96:99], v[92:95], a[72:75], v[96:99]
    s_add_u32 s44, s55, 76087296
    v_mfma_f32_16x16x32_bf16 v[100:103], v[92:95], a[76:79], v[100:103]
    s_add_u32 m0, s53, 0
    ds_read_b128 v[44:47], v76 offset:10240
    v_cvt_pk_bf16_f32 v200, v200, v201
    v_mfma_f32_16x16x32_bf16 v[100:103], v[88:91], a[68:71], v[100:103]
    s_waitcnt lgkmcnt(4)
    buffer_load_dwordx4 v1, s[28:31], s44 offen offset:0 sc1 lds
    v_mfma_f32_16x16x32_bf16 v[100:103], v[232:235], a[84:87], v[100:103]
    ds_read_b128 v[88:91], v76 offset:2048
    v_cvt_pk_bf16_f32 v201, v202, v203
    v_mfma_f32_16x16x32_bf16 v[100:103], v[236:239], a[92:95], v[100:103]
    buffer_load_dwordx4 v1, s[28:31], s44 offen offset:1024 sc1 lds
    v_mfma_f32_16x16x32_bf16 v[96:99], v[236:239], a[88:91], v[96:99]
    ds_read_b128 v[92:95], v76 offset:11264
    v_cvt_pk_bf16_f32 v202, v204, v205
    v_mfma_f32_16x16x32_bf16 v[96:99], v[232:235], a[80:83], v[96:99]
    s_waitcnt lgkmcnt(4)
    v_cvt_pk_bf16_f32 v203, v206, v207
    v_mfma_f32_16x16x32_bf16 v[104:107], v[32:35], a[80:83], v[104:107]
    ds_read_b128 v[232:235], v76 offset:20480
    v_mfma_f32_16x16x32_bf16 v[104:107], v[36:39], a[88:91], v[104:107]
    buffer_load_dwordx4 v1, s[28:31], s44 offen offset:2048 sc1 lds
    v_mfma_f32_16x16x32_bf16 v[108:111], v[36:39], a[92:95], v[108:111]
    ds_read_b128 v[236:239], v76 offset:29696
    v_mfma_f32_16x16x32_bf16 v[108:111], v[32:35], a[84:87], v[108:111]
    s_waitcnt lgkmcnt(4)
    buffer_load_dwordx4 v1, s[28:31], s44 offen offset:3072 sc1 lds
    v_mfma_f32_16x16x32_bf16 v[108:111], v[40:43], a[68:71], v[108:111]
    ds_read_b128 v[32:35], v76 offset:21504
    v_mfma_f32_16x16x32_bf16 v[108:111], v[44:47], a[76:79], v[108:111]
    s_add_u32 s78, s58, 50336768
    buffer_store_dwordx4 v[200:203], v1, s[28:31], s78 offen sc1
    v_mfma_f32_16x16x32_bf16 v[104:107], v[44:47], a[72:75], v[104:107]
    s_add_u32 s46, s57, 27262976
    ds_read_b128 v[36:39], v76 offset:30720
    v_mfma_f32_16x16x32_bf16 v[104:107], v[40:43], a[64:67], v[104:107]
    s_waitcnt lgkmcnt(4)
    buffer_load_dwordx4 a[32:35], v1, s[28:31], s46 offen offset:0 sc1
    v_mfma_f32_16x16x32_bf16 v[112:115], v[88:91], a[64:67], v[112:115]
    ds_read_b128 v[40:43], v76 offset:3072
    v_mfma_f32_16x16x32_bf16 v[112:115], v[92:95], a[72:75], v[112:115]
    ds_write_b128 v84, v[200:203] offset:5120
    v_mfma_f32_16x16x32_bf16 v[116:119], v[92:95], a[76:79], v[116:119]
    ds_read_b128 v[44:47], v76 offset:12288
    v_mfma_f32_16x16x32_bf16 v[116:119], v[88:91], a[68:71], v[116:119]
    s_waitcnt lgkmcnt(5)
    buffer_load_dwordx4 a[40:43], v1, s[28:31], s46 offen offset:1024 sc1
    v_mfma_f32_16x16x32_bf16 v[116:119], v[232:235], a[84:87], v[116:119]
    ds_read_b128 v[88:91], v76 offset:4096
    v_mfma_f32_16x16x32_bf16 v[116:119], v[236:239], a[92:95], v[116:119]
    buffer_load_dwordx4 a[48:51], v1, s[28:31], s46 offen offset:2048 sc1
    v_mfma_f32_16x16x32_bf16 v[112:115], v[236:239], a[88:91], v[112:115]
    ds_read_b128 v[92:95], v76 offset:13312
    v_mfma_f32_16x16x32_bf16 v[112:115], v[232:235], a[80:83], v[112:115]
    s_waitcnt lgkmcnt(5)
    v_mfma_f32_16x16x32_bf16 v[120:123], v[32:35], a[80:83], v[120:123]
    ds_read_b128 v[232:235], v76 offset:22528
    v_mfma_f32_16x16x32_bf16 v[120:123], v[36:39], a[88:91], v[120:123]
    buffer_load_dwordx4 a[56:59], v1, s[28:31], s46 offen offset:3072 sc1
    v_mfma_f32_16x16x32_bf16 v[124:127], v[36:39], a[92:95], v[124:127]
    ds_read_b128 v[236:239], v76 offset:31744
    v_mfma_f32_16x16x32_bf16 v[124:127], v[32:35], a[84:87], v[124:127]
    s_waitcnt lgkmcnt(4)
    v_mfma_f32_16x16x32_bf16 v[124:127], v[40:43], a[68:71], v[124:127]
    ds_read_b128 v[32:35], v76 offset:23552
    v_mfma_f32_16x16x32_bf16 v[124:127], v[44:47], a[76:79], v[124:127]
    s_add_u32 s45, s55, 76091392
    v_mfma_f32_16x16x32_bf16 v[120:123], v[44:47], a[72:75], v[120:123]
    s_add_u32 m0, s53, 4096
    ds_read_b128 v[36:39], v76 offset:32768
    v_mfma_f32_16x16x32_bf16 v[120:123], v[40:43], a[64:67], v[120:123]
    s_waitcnt lgkmcnt(4)
    buffer_load_dwordx4 v1, s[28:31], s45 offen offset:0 sc1 lds
    v_mfma_f32_16x16x32_bf16 v[128:131], v[88:91], a[64:67], v[128:131]
    ds_read_b128 v[40:43], v76 offset:5120
    v_mfma_f32_16x16x32_bf16 v[128:131], v[92:95], a[72:75], v[128:131]
    buffer_load_dwordx4 v1, s[28:31], s45 offen offset:1024 sc1 lds
    v_mfma_f32_16x16x32_bf16 v[132:135], v[92:95], a[76:79], v[132:135]
    ds_read_b128 v[44:47], v76 offset:14336
    v_mfma_f32_16x16x32_bf16 v[132:135], v[88:91], a[68:71], v[132:135]
    s_waitcnt lgkmcnt(4)
    buffer_load_dwordx4 v1, s[28:31], s45 offen offset:2048 sc1 lds
    v_mfma_f32_16x16x32_bf16 v[132:135], v[232:235], a[84:87], v[132:135]
    ds_read_b128 v[88:91], v76 offset:6144
    v_mfma_f32_16x16x32_bf16 v[132:135], v[236:239], a[92:95], v[132:135]
    buffer_load_dwordx4 v1, s[28:31], s45 offen offset:3072 sc1 lds
    v_mfma_f32_16x16x32_bf16 v[128:131], v[236:239], a[88:91], v[128:131]
    ds_read_b128 v[92:95], v76 offset:15360
    v_mfma_f32_16x16x32_bf16 v[128:131], v[232:235], a[80:83], v[128:131]
    s_waitcnt lgkmcnt(4)
    v_mfma_f32_16x16x32_bf16 v[136:139], v[32:35], a[80:83], v[136:139]
    s_add_u32 s46, s57, 27267072
    ds_read_b128 v[232:235], v76 offset:24576
    v_mfma_f32_16x16x32_bf16 v[136:139], v[36:39], a[88:91], v[136:139]
    buffer_load_dwordx4 a[36:39], v1, s[28:31], s46 offen offset:0 sc1
    v_mfma_f32_16x16x32_bf16 v[140:143], v[36:39], a[92:95], v[140:143]
    ds_read_b128 v[236:239], v76 offset:33792
    v_mfma_f32_16x16x32_bf16 v[140:143], v[32:35], a[84:87], v[140:143]
    s_waitcnt lgkmcnt(4)
    v_cvt_pk_bf16_f32 v208, v208, v209
    v_cvt_pk_bf16_f32 v209, v210, v211
    v_mfma_f32_16x16x32_bf16 v[140:143], v[40:43], a[68:71], v[140:143]
    ds_read_b128 v[32:35], v76 offset:25600
    v_cvt_pk_bf16_f32 v210, v212, v213
    v_mfma_f32_16x16x32_bf16 v[140:143], v[44:47], a[76:79], v[140:143]
    buffer_load_dwordx4 a[44:47], v1, s[28:31], s46 offen offset:1024 sc1
    v_mfma_f32_16x16x32_bf16 v[136:139], v[44:47], a[72:75], v[136:139]
    ds_read_b128 v[36:39], v76 offset:34816
    v_cvt_pk_bf16_f32 v211, v214, v215
    v_mfma_f32_16x16x32_bf16 v[136:139], v[40:43], a[64:67], v[136:139]
    s_waitcnt lgkmcnt(4)
    buffer_load_dwordx4 a[52:55], v1, s[28:31], s46 offen offset:2048 sc1
    v_mfma_f32_16x16x32_bf16 v[144:147], v[88:91], a[64:67], v[144:147]
    ds_read_b128 v[40:43], v76 offset:7168
    v_mfma_f32_16x16x32_bf16 v[144:147], v[92:95], a[72:75], v[144:147]
    s_add_u32 s78, s58, 50337792
    buffer_store_dwordx4 v[208:211], v1, s[28:31], s78 offen sc1
    v_mfma_f32_16x16x32_bf16 v[148:151], v[92:95], a[76:79], v[148:151]
    ds_read_b128 v[44:47], v76 offset:16384
    v_mfma_f32_16x16x32_bf16 v[148:151], v[88:91], a[68:71], v[148:151]
    s_waitcnt lgkmcnt(4)
    buffer_load_dwordx4 a[60:63], v1, s[28:31], s46 offen offset:3072 sc1
    v_mfma_f32_16x16x32_bf16 v[148:151], v[232:235], a[84:87], v[148:151]
    ds_read_b128 v[88:91], v76 offset:8192
    v_mfma_f32_16x16x32_bf16 v[148:151], v[236:239], a[92:95], v[148:151]
    s_add_u32 s44, s55, 76095488
    v_mfma_f32_16x16x32_bf16 v[144:147], v[236:239], a[88:91], v[144:147]
    s_add_u32 m0, s53, 8192
    ds_read_b128 v[92:95], v76 offset:17408
    v_mfma_f32_16x16x32_bf16 v[144:147], v[232:235], a[80:83], v[144:147]
    s_waitcnt lgkmcnt(4)
    buffer_load_dwordx4 v1, s[28:31], s44 offen offset:0 sc1 lds
    v_mfma_f32_16x16x32_bf16 v[152:155], v[32:35], a[80:83], v[152:155]
    ds_read_b128 v[232:235], v76 offset:26624
    v_mfma_f32_16x16x32_bf16 v[152:155], v[36:39], a[88:91], v[152:155]
    ds_write_b128 v84, v[208:211] offset:6144
    v_mfma_f32_16x16x32_bf16 v[156:159], v[36:39], a[92:95], v[156:159]
    ds_read_b128 v[236:239], v76 offset:35840
    v_mfma_f32_16x16x32_bf16 v[156:159], v[32:35], a[84:87], v[156:159]
    s_waitcnt lgkmcnt(5)
    v_mfma_f32_16x16x32_bf16 v[156:159], v[40:43], a[68:71], v[156:159]
    v_mfma_f32_16x16x32_bf16 v[156:159], v[44:47], a[76:79], v[156:159]
    v_mfma_f32_16x16x32_bf16 v[152:155], v[44:47], a[72:75], v[152:155]
    s_waitcnt vmcnt(19) lgkmcnt(0)
    v_mfma_f32_16x16x32_bf16 v[152:155], v[40:43], a[64:67], v[152:155]
    s_barrier
    v_mfma_f32_16x16x32_bf16 v[240:243], v[88:91], a[64:67], v[240:243]
    ds_read_b128 v[32:35], v77 offset:0
    v_mfma_f32_16x16x32_bf16 v[240:243], v[92:95], a[72:75], v[240:243]
    ds_read_b128 v[36:39], v77 offset:9216
    v_mfma_f32_16x16x32_bf16 v[244:247], v[92:95], a[76:79], v[244:247]
    ds_read_b128 v[40:43], v77 offset:18432
    v_mfma_f32_16x16x32_bf16 v[244:247], v[88:91], a[68:71], v[244:247]
    s_waitcnt lgkmcnt(3)
    ds_read_b128 v[44:47], v77 offset:27648
    v_mfma_f32_16x16x32_bf16 v[244:247], v[232:235], a[84:87], v[244:247]
    ds_read_b128 v[88:91], v77 offset:19456
    v_mfma_f32_16x16x32_bf16 v[244:247], v[236:239], a[92:95], v[244:247]
    v_mfma_f32_16x16x32_bf16 v[240:243], v[236:239], a[88:91], v[240:243]
    ds_read_b128 v[92:95], v77 offset:28672
    v_mfma_f32_16x16x32_bf16 v[240:243], v[232:235], a[80:83], v[240:243]
    s_waitcnt lgkmcnt(4)
    v_mfma_f32_16x16x32_bf16 v[96:99], v[32:35], a[0:3], v[96:99]
    ds_read_b128 v[232:235], v77 offset:1024
    v_mfma_f32_16x16x32_bf16 v[96:99], v[36:39], a[8:11], v[96:99]
    s_add_u32 s45, s55, 76234752
    v_mfma_f32_16x16x32_bf16 v[100:103], v[36:39], a[12:15], v[100:103]
    s_add_u32 m0, s53, 81920
    ds_read_b128 v[236:239], v77 offset:10240
    v_mfma_f32_16x16x32_bf16 v[100:103], v[32:35], a[4:7], v[100:103]
    s_waitcnt lgkmcnt(4)
    buffer_load_dwordx4 v1, s[28:31], s45 offen offset:0 sc1 lds
    v_mfma_f32_16x16x32_bf16 v[100:103], v[40:43], a[20:23], v[100:103]
    ds_read_b128 v[32:35], v77 offset:2048
    v_mfma_f32_16x16x32_bf16 v[100:103], v[44:47], a[28:31], v[100:103]
    buffer_load_dwordx4 v1, s[28:31], s45 offen offset:1024 sc1 lds
    v_mfma_f32_16x16x32_bf16 v[96:99], v[44:47], a[24:27], v[96:99]
    ds_read_b128 v[36:39], v77 offset:11264
    v_mfma_f32_16x16x32_bf16 v[96:99], v[40:43], a[16:19], v[96:99]
    s_waitcnt lgkmcnt(4)
    v_mfma_f32_16x16x32_bf16 v[104:107], v[88:91], a[16:19], v[104:107]
    ds_read_b128 v[40:43], v77 offset:20480
    v_mfma_f32_16x16x32_bf16 v[104:107], v[92:95], a[24:27], v[104:107]
    buffer_load_dwordx4 v1, s[28:31], s45 offen offset:2048 sc1 lds
    v_mfma_f32_16x16x32_bf16 v[108:111], v[92:95], a[28:31], v[108:111]
    ds_read_b128 v[44:47], v77 offset:29696
    v_mfma_f32_16x16x32_bf16 v[108:111], v[88:91], a[20:23], v[108:111]
    s_waitcnt lgkmcnt(4)
    buffer_load_dwordx4 v1, s[28:31], s45 offen offset:3072 sc1 lds
    v_mfma_f32_16x16x32_bf16 v[108:111], v[232:235], a[4:7], v[108:111]
    ds_read_b128 v[88:91], v77 offset:21504
    v_cvt_pk_bf16_f32 v216, v216, v217
    v_mfma_f32_16x16x32_bf16 v[108:111], v[236:239], a[12:15], v[108:111]
    v_cvt_pk_bf16_f32 v217, v218, v219
    v_cvt_pk_bf16_f32 v218, v220, v221
    v_mfma_f32_16x16x32_bf16 v[104:107], v[236:239], a[8:11], v[104:107]
    s_add_u32 s46, s57, 27787264
    ds_read_b128 v[92:95], v77 offset:30720
    v_cvt_pk_bf16_f32 v219, v222, v223
    v_mfma_f32_16x16x32_bf16 v[104:107], v[232:235], a[0:3], v[104:107]
    s_waitcnt lgkmcnt(4)
    buffer_load_dwordx4 a[64:67], v1, s[28:31], s46 offen offset:0 sc1
    v_mfma_f32_16x16x32_bf16 v[112:115], v[32:35], a[0:3], v[112:115]
    ds_read_b128 v[232:235], v77 offset:3072
    v_mfma_f32_16x16x32_bf16 v[112:115], v[36:39], a[8:11], v[112:115]
    s_add_u32 s78, s58, 50338816
    buffer_store_dwordx4 v[216:219], v1, s[28:31], s78 offen sc1
    v_mfma_f32_16x16x32_bf16 v[116:119], v[36:39], a[12:15], v[116:119]
    ds_read_b128 v[236:239], v77 offset:12288
    v_mfma_f32_16x16x32_bf16 v[116:119], v[32:35], a[4:7], v[116:119]
    s_waitcnt lgkmcnt(4)
    buffer_load_dwordx4 a[72:75], v1, s[28:31], s46 offen offset:1024 sc1
    v_mfma_f32_16x16x32_bf16 v[116:119], v[40:43], a[20:23], v[116:119]
    ds_read_b128 v[32:35], v77 offset:4096
    v_mfma_f32_16x16x32_bf16 v[116:119], v[44:47], a[28:31], v[116:119]
    buffer_load_dwordx4 a[80:83], v1, s[28:31], s46 offen offset:2048 sc1
    v_mfma_f32_16x16x32_bf16 v[112:115], v[44:47], a[24:27], v[112:115]
    ds_read_b128 v[36:39], v77 offset:13312
    v_mfma_f32_16x16x32_bf16 v[112:115], v[40:43], a[16:19], v[112:115]
    s_waitcnt lgkmcnt(4)
    v_mfma_f32_16x16x32_bf16 v[120:123], v[88:91], a[16:19], v[120:123]
    ds_read_b128 v[40:43], v77 offset:22528
    v_mfma_f32_16x16x32_bf16 v[120:123], v[92:95], a[24:27], v[120:123]
    buffer_load_dwordx4 a[88:91], v1, s[28:31], s46 offen offset:3072 sc1
    v_mfma_f32_16x16x32_bf16 v[124:127], v[92:95], a[28:31], v[124:127]
    ds_read_b128 v[44:47], v77 offset:31744
    v_mfma_f32_16x16x32_bf16 v[124:127], v[88:91], a[20:23], v[124:127]
    s_waitcnt lgkmcnt(4)
    v_mfma_f32_16x16x32_bf16 v[124:127], v[232:235], a[4:7], v[124:127]
    ds_read_b128 v[88:91], v77 offset:23552
    v_mfma_f32_16x16x32_bf16 v[124:127], v[236:239], a[12:15], v[124:127]
    s_add_u32 s44, s55, 76238848
    v_mfma_f32_16x16x32_bf16 v[120:123], v[236:239], a[8:11], v[120:123]
    s_add_u32 m0, s53, 86016
    ds_read_b128 v[92:95], v77 offset:32768
    v_mfma_f32_16x16x32_bf16 v[120:123], v[232:235], a[0:3], v[120:123]
    s_waitcnt lgkmcnt(4)
    buffer_load_dwordx4 v1, s[28:31], s44 offen offset:0 sc1 lds
    v_mfma_f32_16x16x32_bf16 v[128:131], v[32:35], a[0:3], v[128:131]
    ds_read_b128 v[232:235], v77 offset:5120
    v_mfma_f32_16x16x32_bf16 v[128:131], v[36:39], a[8:11], v[128:131]
    buffer_load_dwordx4 v1, s[28:31], s44 offen offset:1024 sc1 lds
    v_mfma_f32_16x16x32_bf16 v[132:135], v[36:39], a[12:15], v[132:135]
    ds_read_b128 v[236:239], v77 offset:14336
    v_mfma_f32_16x16x32_bf16 v[132:135], v[32:35], a[4:7], v[132:135]
    s_waitcnt lgkmcnt(4)
    buffer_load_dwordx4 v1, s[28:31], s44 offen offset:2048 sc1 lds
    v_mfma_f32_16x16x32_bf16 v[132:135], v[40:43], a[20:23], v[132:135]
    ds_read_b128 v[32:35], v77 offset:6144
    v_mfma_f32_16x16x32_bf16 v[132:135], v[44:47], a[28:31], v[132:135]
    buffer_load_dwordx4 v1, s[28:31], s44 offen offset:3072 sc1 lds
    v_mfma_f32_16x16x32_bf16 v[128:131], v[44:47], a[24:27], v[128:131]
    ds_read_b128 v[36:39], v77 offset:15360
    v_mfma_f32_16x16x32_bf16 v[128:131], v[40:43], a[16:19], v[128:131]
    s_waitcnt lgkmcnt(4)
    v_mfma_f32_16x16x32_bf16 v[136:139], v[88:91], a[16:19], v[136:139]
    s_add_u32 s46, s57, 27791360
    ds_read_b128 v[40:43], v77 offset:24576
    v_mfma_f32_16x16x32_bf16 v[136:139], v[92:95], a[24:27], v[136:139]
    buffer_load_dwordx4 a[68:71], v1, s[28:31], s46 offen offset:0 sc1
    v_mfma_f32_16x16x32_bf16 v[140:143], v[92:95], a[28:31], v[140:143]
    ds_read_b128 v[44:47], v77 offset:33792
    v_mfma_f32_16x16x32_bf16 v[140:143], v[88:91], a[20:23], v[140:143]
    s_waitcnt lgkmcnt(4)
    v_mfma_f32_16x16x32_bf16 v[140:143], v[232:235], a[4:7], v[140:143]
    ds_read_b128 v[88:91], v77 offset:25600
    v_mfma_f32_16x16x32_bf16 v[140:143], v[236:239], a[12:15], v[140:143]
    buffer_load_dwordx4 a[76:79], v1, s[28:31], s46 offen offset:1024 sc1
    v_mfma_f32_16x16x32_bf16 v[136:139], v[236:239], a[8:11], v[136:139]
    ds_read_b128 v[92:95], v77 offset:34816
    v_mfma_f32_16x16x32_bf16 v[136:139], v[232:235], a[0:3], v[136:139]
    s_waitcnt lgkmcnt(4)
    buffer_load_dwordx4 a[84:87], v1, s[28:31], s46 offen offset:2048 sc1
    v_mfma_f32_16x16x32_bf16 v[144:147], v[32:35], a[0:3], v[144:147]
    ds_read_b128 v[232:235], v77 offset:7168
    v_mfma_f32_16x16x32_bf16 v[144:147], v[36:39], a[8:11], v[144:147]
    ds_write_b128 v84, v[216:219] offset:7168
    v_mfma_f32_16x16x32_bf16 v[148:151], v[36:39], a[12:15], v[148:151]
    ds_read_b128 v[236:239], v77 offset:16384
    v_mfma_f32_16x16x32_bf16 v[148:151], v[32:35], a[4:7], v[148:151]
    s_waitcnt lgkmcnt(5)
    buffer_load_dwordx4 a[92:95], v1, s[28:31], s46 offen offset:3072 sc1
    v_mfma_f32_16x16x32_bf16 v[148:151], v[40:43], a[20:23], v[148:151]
    ds_read_b128 v[32:35], v77 offset:8192
    v_mfma_f32_16x16x32_bf16 v[148:151], v[44:47], a[28:31], v[148:151]
    s_add_u32 s45, s55, 76242944
    v_mfma_f32_16x16x32_bf16 v[144:147], v[44:47], a[24:27], v[144:147]
    s_add_u32 m0, s53, 90112
    ds_read_b128 v[36:39], v77 offset:17408
    v_cvt_pk_bf16_f32 v224, v224, v225
    v_mfma_f32_16x16x32_bf16 v[144:147], v[40:43], a[16:19], v[144:147]
    s_waitcnt lgkmcnt(5)
    buffer_load_dwordx4 v1, s[28:31], s45 offen offset:0 sc1 lds
    v_mfma_f32_16x16x32_bf16 v[152:155], v[88:91], a[16:19], v[152:155]
    ds_read_b128 v[40:43], v77 offset:26624
    v_cvt_pk_bf16_f32 v225, v226, v227
    v_mfma_f32_16x16x32_bf16 v[152:155], v[92:95], a[24:27], v[152:155]
    v_cvt_pk_bf16_f32 v226, v228, v229
    v_cvt_pk_bf16_f32 v227, v230, v231
    v_mfma_f32_16x16x32_bf16 v[156:159], v[92:95], a[28:31], v[156:159]
    ds_read_b128 v[44:47], v77 offset:35840
    v_mfma_f32_16x16x32_bf16 v[156:159], v[88:91], a[20:23], v[156:159]
    s_waitcnt lgkmcnt(4)
    v_mfma_f32_16x16x32_bf16 v[156:159], v[232:235], a[4:7], v[156:159]
    s_add_u32 s78, s58, 50339840
    buffer_store_dwordx4 v[224:227], v1, s[28:31], s78 offen sc1
    v_mfma_f32_16x16x32_bf16 v[156:159], v[236:239], a[12:15], v[156:159]
    ds_write_b128 v84, v[224:227] offset:8192
    v_mfma_f32_16x16x32_bf16 v[152:155], v[236:239], a[8:11], v[152:155]
    s_waitcnt vmcnt(19) lgkmcnt(0)
    v_mfma_f32_16x16x32_bf16 v[152:155], v[232:235], a[0:3], v[152:155]
    s_barrier
    v_mfma_f32_16x16x32_bf16 v[240:243], v[32:35], a[0:3], v[240:243]
    ds_read_b128 v[88:91], v1 offset:0
    v_mfma_f32_16x16x32_bf16 v[240:243], v[36:39], a[8:11], v[240:243]
    ds_read_b128 v[92:95], v1 offset:9216
    v_mfma_f32_16x16x32_bf16 v[244:247], v[36:39], a[12:15], v[244:247]
    ds_read_b128 v[232:235], v1 offset:18432
    v_mfma_f32_16x16x32_bf16 v[244:247], v[32:35], a[4:7], v[244:247]
    s_waitcnt lgkmcnt(4)
    ds_read_b128 v[236:239], v1 offset:27648
    v_mfma_f32_16x16x32_bf16 v[244:247], v[40:43], a[20:23], v[244:247]
    ds_read_b128 v[32:35], v1 offset:19456
    v_mfma_f32_16x16x32_bf16 v[244:247], v[44:47], a[28:31], v[244:247]
    v_mfma_f32_16x16x32_bf16 v[240:243], v[44:47], a[24:27], v[240:243]
    ds_read_b128 v[36:39], v1 offset:28672
    v_mfma_f32_16x16x32_bf16 v[240:243], v[40:43], a[16:19], v[240:243]
    s_waitcnt lgkmcnt(4)
    v_mfma_f32_16x16x32_bf16 v[96:99], v[88:91], a[32:35], v[96:99]
    ds_read_b128 v[40:43], v1 offset:1024
    v_mfma_f32_16x16x32_bf16 v[96:99], v[92:95], a[40:43], v[96:99]
    s_add_u32 s44, s55, 76382208
    s_mov_b32 s61, 0xffff0000
    v_mfma_f32_16x16x32_bf16 v[100:103], v[92:95], a[44:47], v[100:103]
    s_add_u32 m0, s53, 118784
    ds_read_b128 v[44:47], v1 offset:10240
    v_mfma_f32_16x16x32_bf16 v[100:103], v[88:91], a[36:39], v[100:103]
    s_waitcnt lgkmcnt(4)
    buffer_load_dwordx4 v1, s[28:31], s44 offen offset:0 sc1 lds
    v_mfma_f32_16x16x32_bf16 v[100:103], v[232:235], a[52:55], v[100:103]
    ds_read_b128 v[88:91], v1 offset:2048
    v_mfma_f32_16x16x32_bf16 v[100:103], v[236:239], a[60:63], v[100:103]
    buffer_load_dwordx4 v1, s[28:31], s44 offen offset:1024 sc1 lds
    v_mfma_f32_16x16x32_bf16 v[96:99], v[236:239], a[56:59], v[96:99]
    ds_read_b128 v[92:95], v1 offset:11264
    v_mfma_f32_16x16x32_bf16 v[96:99], v[232:235], a[48:51], v[96:99]
    s_waitcnt lgkmcnt(4)
    v_mfma_f32_16x16x32_bf16 v[104:107], v[32:35], a[48:51], v[104:107]
    ds_read_b128 v[232:235], v1 offset:20480
    v_mfma_f32_16x16x32_bf16 v[104:107], v[36:39], a[56:59], v[104:107]
    buffer_load_dwordx4 v1, s[28:31], s44 offen offset:2048 sc1 lds
    v_mfma_f32_16x16x32_bf16 v[108:111], v[36:39], a[60:63], v[108:111]
    ds_read_b128 v[236:239], v1 offset:29696
    v_mfma_f32_16x16x32_bf16 v[108:111], v[32:35], a[52:55], v[108:111]
    s_waitcnt lgkmcnt(4)
    buffer_load_dwordx4 v1, s[28:31], s44 offen offset:3072 sc1 lds
    v_mfma_f32_16x16x32_bf16 v[108:111], v[40:43], a[36:39], v[108:111]
    ds_read_b128 v[32:35], v1 offset:21504
    v_mfma_f32_16x16x32_bf16 v[108:111], v[44:47], a[44:47], v[108:111]
    v_mfma_f32_16x16x32_bf16 v[104:107], v[44:47], a[40:43], v[104:107]
    s_add_u32 s46, s57, 28311552
    ds_read_b128 v[36:39], v1 offset:30720
    v_mfma_f32_16x16x32_bf16 v[104:107], v[40:43], a[32:35], v[104:107]
    s_waitcnt lgkmcnt(4)
    buffer_load_dwordx4 a[0:3], v1, s[28:31], s46 offen offset:0 sc1
    v_mfma_f32_16x16x32_bf16 v[112:115], v[88:91], a[32:35], v[112:115]
    ds_read_b128 v[40:43], v1 offset:3072
    v_mfma_f32_16x16x32_bf16 v[112:115], v[92:95], a[40:43], v[112:115]
    v_mfma_f32_16x16x32_bf16 v[116:119], v[92:95], a[44:47], v[116:119]
    ds_read_b128 v[44:47], v1 offset:12288
    v_mfma_f32_16x16x32_bf16 v[116:119], v[88:91], a[36:39], v[116:119]
    s_waitcnt lgkmcnt(4)
    buffer_load_dwordx4 a[8:11], v1, s[28:31], s46 offen offset:1024 sc1
    v_mfma_f32_16x16x32_bf16 v[116:119], v[232:235], a[52:55], v[116:119]
    ds_read_b128 v[88:91], v1 offset:4096
    v_mfma_f32_16x16x32_bf16 v[116:119], v[236:239], a[60:63], v[116:119]
    buffer_load_dwordx4 a[16:19], v1, s[28:31], s46 offen offset:2048 sc1
    v_mfma_f32_16x16x32_bf16 v[112:115], v[236:239], a[56:59], v[112:115]
    ds_read_b128 v[92:95], v1 offset:13312
    v_mfma_f32_16x16x32_bf16 v[112:115], v[232:235], a[48:51], v[112:115]
    s_waitcnt lgkmcnt(4)
    v_mfma_f32_16x16x32_bf16 v[120:123], v[32:35], a[48:51], v[120:123]
    ds_read_b128 v[232:235], v1 offset:22528
    v_mfma_f32_16x16x32_bf16 v[120:123], v[36:39], a[56:59], v[120:123]
    buffer_load_dwordx4 a[24:27], v1, s[28:31], s46 offen offset:3072 sc1
    v_mfma_f32_16x16x32_bf16 v[124:127], v[36:39], a[60:63], v[124:127]
    ds_read_b128 v[236:239], v1 offset:31744
    v_mfma_f32_16x16x32_bf16 v[124:127], v[32:35], a[52:55], v[124:127]
    s_waitcnt lgkmcnt(4)
    v_mfma_f32_16x16x32_bf16 v[124:127], v[40:43], a[36:39], v[124:127]
    ds_read_b128 v[32:35], v1 offset:23552
    v_mfma_f32_16x16x32_bf16 v[124:127], v[44:47], a[44:47], v[124:127]
    s_add_u32 s45, s55, 76386304
    v_mfma_f32_16x16x32_bf16 v[120:123], v[44:47], a[40:43], v[120:123]
    s_add_u32 m0, s53, 122880
    ds_read_b128 v[36:39], v1 offset:32768
    v_mfma_f32_16x16x32_bf16 v[120:123], v[40:43], a[32:35], v[120:123]
    s_waitcnt lgkmcnt(4)
    buffer_load_dwordx4 v1, s[28:31], s45 offen offset:0 sc1 lds
    v_mfma_f32_16x16x32_bf16 v[128:131], v[88:91], a[32:35], v[128:131]
    ds_read_b128 v[40:43], v1 offset:5120
    v_mfma_f32_16x16x32_bf16 v[128:131], v[92:95], a[40:43], v[128:131]
    buffer_load_dwordx4 v1, s[28:31], s45 offen offset:1024 sc1 lds
    v_mfma_f32_16x16x32_bf16 v[132:135], v[92:95], a[44:47], v[132:135]
    ds_read_b128 v[44:47], v1 offset:14336
    v_mfma_f32_16x16x32_bf16 v[132:135], v[88:91], a[36:39], v[132:135]
    s_waitcnt lgkmcnt(4)
    buffer_load_dwordx4 v1, s[28:31], s45 offen offset:2048 sc1 lds
    v_mfma_f32_16x16x32_bf16 v[132:135], v[232:235], a[52:55], v[132:135]
    ds_read_b128 v[88:91], v1 offset:6144
    v_mfma_f32_16x16x32_bf16 v[132:135], v[236:239], a[60:63], v[132:135]
    buffer_load_dwordx4 v1, s[28:31], s45 offen offset:3072 sc1 lds
    v_mfma_f32_16x16x32_bf16 v[128:131], v[236:239], a[56:59], v[128:131]
    ds_read_b128 v[92:95], v1 offset:15360
    v_mfma_f32_16x16x32_bf16 v[128:131], v[232:235], a[48:51], v[128:131]
    s_waitcnt lgkmcnt(4)
    v_mfma_f32_16x16x32_bf16 v[136:139], v[32:35], a[48:51], v[136:139]
    s_add_u32 s46, s57, 28315648
    ds_read_b128 v[232:235], v1 offset:24576
    v_mfma_f32_16x16x32_bf16 v[136:139], v[36:39], a[56:59], v[136:139]
    buffer_load_dwordx4 a[4:7], v1, s[28:31], s46 offen offset:0 sc1
    v_mfma_f32_16x16x32_bf16 v[140:143], v[36:39], a[60:63], v[140:143]
    ds_read_b128 v[236:239], v1 offset:33792
    v_mfma_f32_16x16x32_bf16 v[140:143], v[32:35], a[52:55], v[140:143]
    s_waitcnt lgkmcnt(4)
    v_mfma_f32_16x16x32_bf16 v[140:143], v[40:43], a[36:39], v[140:143]
    ds_read_b128 v[32:35], v1 offset:25600
    v_mfma_f32_16x16x32_bf16 v[140:143], v[44:47], a[44:47], v[140:143]
    buffer_load_dwordx4 a[12:15], v1, s[28:31], s46 offen offset:1024 sc1
    v_mfma_f32_16x16x32_bf16 v[136:139], v[44:47], a[40:43], v[136:139]
    ds_read_b128 v[36:39], v1 offset:34816
    v_mfma_f32_16x16x32_bf16 v[136:139], v[40:43], a[32:35], v[136:139]
    s_waitcnt lgkmcnt(4)
    buffer_load_dwordx4 a[20:23], v1, s[28:31], s46 offen offset:2048 sc1
    v_mfma_f32_16x16x32_bf16 v[144:147], v[88:91], a[32:35], v[144:147]
    ds_read_b128 v[40:43], v1 offset:7168
    v_mfma_f32_16x16x32_bf16 v[144:147], v[92:95], a[40:43], v[144:147]
    v_mfma_f32_16x16x32_bf16 v[148:151], v[92:95], a[44:47], v[148:151]
    ds_read_b128 v[44:47], v1 offset:16384
    v_mfma_f32_16x16x32_bf16 v[148:151], v[88:91], a[36:39], v[148:151]
    s_waitcnt lgkmcnt(4)
    buffer_load_dwordx4 a[28:31], v1, s[28:31], s46 offen offset:3072 sc1
    v_mfma_f32_16x16x32_bf16 v[148:151], v[232:235], a[52:55], v[148:151]
    ds_read_b128 v[88:91], v1 offset:8192
    v_mfma_f32_16x16x32_bf16 v[148:151], v[236:239], a[60:63], v[148:151]
    s_add_u32 s44, s55, 76390400
    v_mfma_f32_16x16x32_bf16 v[144:147], v[236:239], a[56:59], v[144:147]
    s_add_u32 m0, s53, 126976
    ds_read_b128 v[92:95], v1 offset:17408
    v_mfma_f32_16x16x32_bf16 v[144:147], v[232:235], a[48:51], v[144:147]
    s_waitcnt lgkmcnt(4)
    buffer_load_dwordx4 v1, s[28:31], s44 offen offset:0 sc1 lds
    v_mfma_f32_16x16x32_bf16 v[152:155], v[32:35], a[48:51], v[152:155]
    ds_read_b128 v[232:235], v1 offset:26624
    v_mfma_f32_16x16x32_bf16 v[152:155], v[36:39], a[56:59], v[152:155]
    v_mfma_f32_16x16x32_bf16 v[156:159], v[36:39], a[60:63], v[156:159]
    ds_read_b128 v[236:239], v1 offset:35840
    v_add_u32_e64 v6, s69, 4
    v_mfma_f32_16x16x32_bf16 v[156:159], v[32:35], a[52:55], v[156:159]
    s_waitcnt lgkmcnt(4)
    v_mfma_f32_16x16x32_bf16 v[156:159], v[40:43], a[36:39], v[156:159]
    v_mfma_f32_16x16x32_bf16 v[156:159], v[44:47], a[44:47], v[156:159]
    v_mfma_f32_16x16x32_bf16 v[152:155], v[44:47], a[40:43], v[152:155]
    s_waitcnt vmcnt(17) lgkmcnt(0)
    v_mfma_f32_16x16x32_bf16 v[152:155], v[40:43], a[32:35], v[152:155]
    s_barrier
    v_mfma_f32_16x16x32_bf16 v[240:243], v[88:91], a[32:35], v[240:243]
    ds_read_b128 v[32:35], v76 offset:0
    v_mfma_f32_16x16x32_bf16 v[240:243], v[92:95], a[40:43], v[240:243]
    ds_read_b128 v[36:39], v76 offset:9216
    v_mfma_f32_16x16x32_bf16 v[244:247], v[92:95], a[44:47], v[244:247]
    ds_read_b128 v[40:43], v76 offset:18432
    v_mfma_f32_16x16x32_bf16 v[244:247], v[88:91], a[36:39], v[244:247]
    s_waitcnt lgkmcnt(3)
    ds_read_b128 v[44:47], v76 offset:27648
    v_mfma_f32_16x16x32_bf16 v[244:247], v[232:235], a[52:55], v[244:247]
    ds_read_b128 v[88:91], v76 offset:19456
    v_mfma_f32_16x16x32_bf16 v[244:247], v[236:239], a[60:63], v[244:247]
    buffer_store_dwordx2 v[6:7], v0, s[28:31], s73 offen sc1
    v_mfma_f32_16x16x32_bf16 v[240:243], v[236:239], a[56:59], v[240:243]
    ds_read_b128 v[92:95], v76 offset:28672
    v_mfma_f32_16x16x32_bf16 v[240:243], v[232:235], a[48:51], v[240:243]
    s_waitcnt lgkmcnt(4)
    v_mfma_f32_16x16x32_bf16 v[96:99], v[32:35], a[64:67], v[96:99]
    ds_read_b128 v[232:235], v76 offset:1024
    v_mfma_f32_16x16x32_bf16 v[96:99], v[36:39], a[72:75], v[96:99]
    s_add_u32 s45, s55, 76529664
    v_mfma_f32_16x16x32_bf16 v[100:103], v[36:39], a[76:79], v[100:103]
    s_add_u32 m0, s53, 0
    ds_read_b128 v[236:239], v76 offset:10240
    v_mfma_f32_16x16x32_bf16 v[100:103], v[32:35], a[68:71], v[100:103]
    s_waitcnt lgkmcnt(4)
    buffer_load_dwordx4 v1, s[28:31], s45 offen offset:0 sc1 lds
    v_mfma_f32_16x16x32_bf16 v[100:103], v[40:43], a[84:87], v[100:103]
    ds_read_b128 v[32:35], v76 offset:2048
    v_mfma_f32_16x16x32_bf16 v[100:103], v[44:47], a[92:95], v[100:103]
    buffer_load_dwordx4 v1, s[28:31], s45 offen offset:1024 sc1 lds
    v_mfma_f32_16x16x32_bf16 v[96:99], v[44:47], a[88:91], v[96:99]
    ds_read_b128 v[36:39], v76 offset:11264
    v_mfma_f32_16x16x32_bf16 v[96:99], v[40:43], a[80:83], v[96:99]
    s_waitcnt lgkmcnt(4)
    v_mfma_f32_16x16x32_bf16 v[104:107], v[88:91], a[80:83], v[104:107]
    ds_read_b128 v[40:43], v76 offset:20480
    v_mfma_f32_16x16x32_bf16 v[104:107], v[92:95], a[88:91], v[104:107]
    buffer_load_dwordx4 v1, s[28:31], s45 offen offset:2048 sc1 lds
    v_mfma_f32_16x16x32_bf16 v[108:111], v[92:95], a[92:95], v[108:111]
    ds_read_b128 v[44:47], v76 offset:29696
    v_mfma_f32_16x16x32_bf16 v[108:111], v[88:91], a[84:87], v[108:111]
    s_waitcnt lgkmcnt(4)
    buffer_load_dwordx4 v1, s[28:31], s45 offen offset:3072 sc1 lds
    v_mfma_f32_16x16x32_bf16 v[108:111], v[232:235], a[68:71], v[108:111]
    ds_read_b128 v[88:91], v76 offset:21504
    v_mfma_f32_16x16x32_bf16 v[108:111], v[236:239], a[76:79], v[108:111]
    v_mfma_f32_16x16x32_bf16 v[104:107], v[236:239], a[72:75], v[104:107]
    s_add_u32 s46, s57, 28835840
    ds_read_b128 v[92:95], v76 offset:30720
    v_mfma_f32_16x16x32_bf16 v[104:107], v[232:235], a[64:67], v[104:107]
    s_waitcnt lgkmcnt(4)
    buffer_load_dwordx4 a[32:35], v1, s[28:31], s46 offen offset:0 sc1
    v_mfma_f32_16x16x32_bf16 v[112:115], v[32:35], a[64:67], v[112:115]
    ds_read_b128 v[232:235], v76 offset:3072
    v_mfma_f32_16x16x32_bf16 v[112:115], v[36:39], a[72:75], v[112:115]
    v_mfma_f32_16x16x32_bf16 v[116:119], v[36:39], a[76:79], v[116:119]
    ds_read_b128 v[236:239], v76 offset:12288
    v_mfma_f32_16x16x32_bf16 v[116:119], v[32:35], a[68:71], v[116:119]
    s_waitcnt lgkmcnt(4)
    buffer_load_dwordx4 a[40:43], v1, s[28:31], s46 offen offset:1024 sc1
    v_mfma_f32_16x16x32_bf16 v[116:119], v[40:43], a[84:87], v[116:119]
    ds_read_b128 v[32:35], v76 offset:4096
    v_mfma_f32_16x16x32_bf16 v[116:119], v[44:47], a[92:95], v[116:119]
    buffer_load_dwordx4 a[48:51], v1, s[28:31], s46 offen offset:2048 sc1
    v_mfma_f32_16x16x32_bf16 v[112:115], v[44:47], a[88:91], v[112:115]
    ds_read_b128 v[36:39], v76 offset:13312
    v_mfma_f32_16x16x32_bf16 v[112:115], v[40:43], a[80:83], v[112:115]
    s_waitcnt lgkmcnt(4)
    v_mfma_f32_16x16x32_bf16 v[120:123], v[88:91], a[80:83], v[120:123]
    ds_read_b128 v[40:43], v76 offset:22528
    v_mfma_f32_16x16x32_bf16 v[120:123], v[92:95], a[88:91], v[120:123]
    buffer_load_dwordx4 a[56:59], v1, s[28:31], s46 offen offset:3072 sc1
    v_mfma_f32_16x16x32_bf16 v[124:127], v[92:95], a[92:95], v[124:127]
    ds_read_b128 v[44:47], v76 offset:31744
    v_mfma_f32_16x16x32_bf16 v[124:127], v[88:91], a[84:87], v[124:127]
    s_waitcnt lgkmcnt(4)
    v_mfma_f32_16x16x32_bf16 v[124:127], v[232:235], a[68:71], v[124:127]
    ds_read_b128 v[88:91], v76 offset:23552
    v_mfma_f32_16x16x32_bf16 v[124:127], v[236:239], a[76:79], v[124:127]
    s_add_u32 s44, s55, 76533760
    v_mfma_f32_16x16x32_bf16 v[120:123], v[236:239], a[72:75], v[120:123]
    s_add_u32 m0, s53, 4096
    ds_read_b128 v[92:95], v76 offset:32768
    v_mfma_f32_16x16x32_bf16 v[120:123], v[232:235], a[64:67], v[120:123]
    s_waitcnt lgkmcnt(4)
    buffer_load_dwordx4 v1, s[28:31], s44 offen offset:0 sc1 lds
    v_mfma_f32_16x16x32_bf16 v[128:131], v[32:35], a[64:67], v[128:131]
    ds_read_b128 v[232:235], v76 offset:5120
    v_mfma_f32_16x16x32_bf16 v[128:131], v[36:39], a[72:75], v[128:131]
    buffer_load_dwordx4 v1, s[28:31], s44 offen offset:1024 sc1 lds
    v_mfma_f32_16x16x32_bf16 v[132:135], v[36:39], a[76:79], v[132:135]
    ds_read_b128 v[236:239], v76 offset:14336
    v_mfma_f32_16x16x32_bf16 v[132:135], v[32:35], a[68:71], v[132:135]
    s_waitcnt lgkmcnt(4)
    buffer_load_dwordx4 v1, s[28:31], s44 offen offset:2048 sc1 lds
    v_mfma_f32_16x16x32_bf16 v[132:135], v[40:43], a[84:87], v[132:135]
    ds_read_b128 v[32:35], v76 offset:6144
    v_mfma_f32_16x16x32_bf16 v[132:135], v[44:47], a[92:95], v[132:135]
    buffer_load_dwordx4 v1, s[28:31], s44 offen offset:3072 sc1 lds
    v_mfma_f32_16x16x32_bf16 v[128:131], v[44:47], a[88:91], v[128:131]
    ds_read_b128 v[36:39], v76 offset:15360
    v_mfma_f32_16x16x32_bf16 v[128:131], v[40:43], a[80:83], v[128:131]
    s_waitcnt lgkmcnt(4)
    v_mfma_f32_16x16x32_bf16 v[136:139], v[88:91], a[80:83], v[136:139]
    s_add_u32 s46, s57, 28839936
    ds_read_b128 v[40:43], v76 offset:24576
    v_mfma_f32_16x16x32_bf16 v[136:139], v[92:95], a[88:91], v[136:139]
    buffer_load_dwordx4 a[36:39], v1, s[28:31], s46 offen offset:0 sc1
    v_mfma_f32_16x16x32_bf16 v[140:143], v[92:95], a[92:95], v[140:143]
    ds_read_b128 v[44:47], v76 offset:33792
    v_mfma_f32_16x16x32_bf16 v[140:143], v[88:91], a[84:87], v[140:143]
    s_waitcnt lgkmcnt(4)
    v_mfma_f32_16x16x32_bf16 v[140:143], v[232:235], a[68:71], v[140:143]
    ds_read_b128 v[88:91], v76 offset:25600
    v_mfma_f32_16x16x32_bf16 v[140:143], v[236:239], a[76:79], v[140:143]
    buffer_load_dwordx4 a[44:47], v1, s[28:31], s46 offen offset:1024 sc1
    v_mfma_f32_16x16x32_bf16 v[136:139], v[236:239], a[72:75], v[136:139]
    ds_read_b128 v[92:95], v76 offset:34816
    v_mfma_f32_16x16x32_bf16 v[136:139], v[232:235], a[64:67], v[136:139]
    s_waitcnt lgkmcnt(4)
    buffer_load_dwordx4 a[52:55], v1, s[28:31], s46 offen offset:2048 sc1
    v_mfma_f32_16x16x32_bf16 v[144:147], v[32:35], a[64:67], v[144:147]
    ds_read_b128 v[232:235], v76 offset:7168
    v_mfma_f32_16x16x32_bf16 v[144:147], v[36:39], a[72:75], v[144:147]
    buffer_load_dwordx2 v[4:5], v8, s[28:31], s73 offen sc1
    v_mfma_f32_16x16x32_bf16 v[148:151], v[36:39], a[76:79], v[148:151]
    ds_read_b128 v[236:239], v76 offset:16384
    v_mfma_f32_16x16x32_bf16 v[148:151], v[32:35], a[68:71], v[148:151]
    s_waitcnt lgkmcnt(4)
    buffer_load_dwordx4 a[60:63], v1, s[28:31], s46 offen offset:3072 sc1
    v_mfma_f32_16x16x32_bf16 v[148:151], v[40:43], a[84:87], v[148:151]
    ds_read_b128 v[32:35], v76 offset:8192
    v_mfma_f32_16x16x32_bf16 v[148:151], v[44:47], a[92:95], v[148:151]
    s_add_u32 s45, s55, 76537856
    v_mfma_f32_16x16x32_bf16 v[144:147], v[44:47], a[88:91], v[144:147]
    s_add_u32 m0, s53, 8192
    ds_read_b128 v[36:39], v76 offset:17408
    v_mfma_f32_16x16x32_bf16 v[144:147], v[40:43], a[80:83], v[144:147]
    s_waitcnt lgkmcnt(4)
    buffer_load_dwordx4 v1, s[28:31], s45 offen offset:0 sc1 lds
    v_mfma_f32_16x16x32_bf16 v[152:155], v[88:91], a[80:83], v[152:155]
    ds_read_b128 v[40:43], v76 offset:26624
    v_mfma_f32_16x16x32_bf16 v[152:155], v[92:95], a[88:91], v[152:155]
    v_mfma_f32_16x16x32_bf16 v[156:159], v[92:95], a[92:95], v[156:159]
    ds_read_b128 v[44:47], v76 offset:35840
    v_mfma_f32_16x16x32_bf16 v[156:159], v[88:91], a[84:87], v[156:159]
    s_waitcnt lgkmcnt(4)
    v_mfma_f32_16x16x32_bf16 v[156:159], v[232:235], a[68:71], v[156:159]
    v_mfma_f32_16x16x32_bf16 v[156:159], v[236:239], a[76:79], v[156:159]
    v_mfma_f32_16x16x32_bf16 v[152:155], v[236:239], a[72:75], v[152:155]
    s_waitcnt vmcnt(19) lgkmcnt(0)
    v_mfma_f32_16x16x32_bf16 v[152:155], v[232:235], a[64:67], v[152:155]
    s_barrier
    v_mfma_f32_16x16x32_bf16 v[240:243], v[32:35], a[64:67], v[240:243]
    ds_read_b128 v[88:91], v77 offset:0
    v_mfma_f32_16x16x32_bf16 v[240:243], v[36:39], a[72:75], v[240:243]
    ds_read_b128 v[92:95], v77 offset:9216
    v_mfma_f32_16x16x32_bf16 v[244:247], v[36:39], a[76:79], v[244:247]
    ds_read_b128 v[232:235], v77 offset:18432
    v_mfma_f32_16x16x32_bf16 v[244:247], v[32:35], a[68:71], v[244:247]
    s_waitcnt lgkmcnt(3)
    ds_read_b128 v[236:239], v77 offset:27648
    v_mfma_f32_16x16x32_bf16 v[244:247], v[40:43], a[84:87], v[244:247]
    ds_read_b128 v[32:35], v77 offset:19456
    v_mfma_f32_16x16x32_bf16 v[244:247], v[44:47], a[92:95], v[244:247]
    v_mfma_f32_16x16x32_bf16 v[240:243], v[44:47], a[88:91], v[240:243]
    ds_read_b128 v[36:39], v77 offset:28672
    v_mfma_f32_16x16x32_bf16 v[240:243], v[40:43], a[80:83], v[240:243]
    s_waitcnt lgkmcnt(4)
    v_mfma_f32_16x16x32_bf16 v[96:99], v[88:91], a[0:3], v[96:99]
    ds_read_b128 v[40:43], v77 offset:1024
    v_mfma_f32_16x16x32_bf16 v[96:99], v[92:95], a[8:11], v[96:99]
    v_mfma_f32_16x16x32_bf16 v[100:103], v[92:95], a[12:15], v[100:103]
    ds_read_b128 v[44:47], v77 offset:10240
    v_mfma_f32_16x16x32_bf16 v[100:103], v[88:91], a[4:7], v[100:103]
    s_waitcnt lgkmcnt(4)
    v_mfma_f32_16x16x32_bf16 v[100:103], v[232:235], a[20:23], v[100:103]
    ds_read_b128 v[88:91], v77 offset:2048
    v_mfma_f32_16x16x32_bf16 v[100:103], v[236:239], a[28:31], v[100:103]
    v_mfma_f32_16x16x32_bf16 v[96:99], v[236:239], a[24:27], v[96:99]
    ds_read_b128 v[92:95], v77 offset:11264
    v_mfma_f32_16x16x32_bf16 v[96:99], v[232:235], a[16:19], v[96:99]
    s_waitcnt lgkmcnt(4)
    v_mfma_f32_16x16x32_bf16 v[104:107], v[32:35], a[16:19], v[104:107]
    ds_read_b128 v[232:235], v77 offset:20480
    v_mfma_f32_16x16x32_bf16 v[104:107], v[36:39], a[24:27], v[104:107]
    v_mfma_f32_16x16x32_bf16 v[108:111], v[36:39], a[28:31], v[108:111]
    ds_read_b128 v[236:239], v77 offset:29696
    v_mfma_f32_16x16x32_bf16 v[108:111], v[32:35], a[20:23], v[108:111]
    s_waitcnt lgkmcnt(4)
    v_mfma_f32_16x16x32_bf16 v[108:111], v[40:43], a[4:7], v[108:111]
    s_waitcnt vmcnt(2)
    ds_read_b128 v[32:35], v77 offset:21504
    v_mfma_f32_16x16x32_bf16 v[108:111], v[44:47], a[12:15], v[108:111]
    s_add_u32 s79, s74, 4
    v_and_b32 v4, 0xffffff87, v4
    v_xor_b32 v5, s68, v5
    v_subrev_u32 v4, s79, v4
    v_min_u32 v5, 1, v5
    v_lshl_or_b32 v4, v5, 8, v4
    v_cmp_le_u32 vcc, 4, v4
    s_cbranch_vccnz L_stub_p4
L_ret_p4:
    v_mfma_f32_16x16x32_bf16 v[104:107], v[44:47], a[8:11], v[104:107]
    ds_read_b128 v[36:39], v77 offset:30720
    v_mfma_f32_16x16x32_bf16 v[104:107], v[40:43], a[0:3], v[104:107]
    s_waitcnt lgkmcnt(4)
    v_mfma_f32_16x16x32_bf16 v[112:115], v[88:91], a[0:3], v[112:115]
    s_add_u32 s44, s64, 50331648
    ds_read_b128 v[40:43], v77 offset:3072
    v_mfma_f32_16x16x32_bf16 v[112:115], v[92:95], a[8:11], v[112:115]
    buffer_load_dwordx4 v[160:163], v80, s[28:31], s44 offen sc1
    v_mfma_f32_16x16x32_bf16 v[116:119], v[92:95], a[12:15], v[116:119]
    s_add_u32 s45, s65, 50331648
    ds_read_b128 v[44:47], v77 offset:12288
    v_mfma_f32_16x16x32_bf16 v[116:119], v[88:91], a[4:7], v[116:119]
    s_waitcnt lgkmcnt(4)
    buffer_load_dwordx4 v[164:167], v80, s[28:31], s45 offen sc1
    v_mfma_f32_16x16x32_bf16 v[116:119], v[232:235], a[20:23], v[116:119]
    ds_read_b128 v[88:91], v77 offset:4096
    v_mfma_f32_16x16x32_bf16 v[116:119], v[236:239], a[28:31], v[116:119]
    v_mfma_f32_16x16x32_bf16 v[112:115], v[236:239], a[24:27], v[112:115]
    s_add_u32 s44, s66, 50331648
    ds_read_b128 v[92:95], v77 offset:13312
    v_mfma_f32_16x16x32_bf16 v[112:115], v[232:235], a[16:19], v[112:115]
    s_waitcnt lgkmcnt(4)
    buffer_load_dwordx4 v[168:171], v80, s[28:31], s44 offen sc1
    v_mfma_f32_16x16x32_bf16 v[120:123], v[32:35], a[16:19], v[120:123]
    ds_read_b128 v[232:235], v77 offset:22528
    v_mfma_f32_16x16x32_bf16 v[120:123], v[36:39], a[24:27], v[120:123]
    v_mfma_f32_16x16x32_bf16 v[124:127], v[36:39], a[28:31], v[124:127]
    s_add_u32 s45, s64, 50331648
    ds_read_b128 v[236:239], v77 offset:31744
    v_mfma_f32_16x16x32_bf16 v[124:127], v[32:35], a[20:23], v[124:127]
    s_waitcnt lgkmcnt(4)
    buffer_load_dwordx4 v[176:179], v81, s[28:31], s45 offen sc1
    v_mfma_f32_16x16x32_bf16 v[124:127], v[40:43], a[4:7], v[124:127]
    s_add_u32 s44, s65, 50331648
    ds_read_b128 v[32:35], v77 offset:23552
    v_mfma_f32_16x16x32_bf16 v[124:127], v[44:47], a[12:15], v[124:127]
    buffer_load_dwordx4 v[180:183], v81, s[28:31], s44 offen sc1
    v_mfma_f32_16x16x32_bf16 v[120:123], v[44:47], a[8:11], v[120:123]
    ds_read_b128 v[36:39], v77 offset:32768
    v_mfma_f32_16x16x32_bf16 v[120:123], v[40:43], a[0:3], v[120:123]
    s_waitcnt lgkmcnt(4)
    v_mfma_f32_16x16x32_bf16 v[128:131], v[88:91], a[0:3], v[128:131]
    s_add_u32 s45, s66, 50331648
    ds_read_b128 v[40:43], v77 offset:5120
    v_mfma_f32_16x16x32_bf16 v[128:131], v[92:95], a[8:11], v[128:131]
    buffer_load_dwordx4 v[184:187], v81, s[28:31], s45 offen sc1
    v_mfma_f32_16x16x32_bf16 v[132:135], v[92:95], a[12:15], v[132:135]
    ds_read_b128 v[44:47], v77 offset:14336
    v_mfma_f32_16x16x32_bf16 v[132:135], v[88:91], a[4:7], v[132:135]
    s_waitcnt lgkmcnt(4)
    v_mfma_f32_16x16x32_bf16 v[132:135], v[232:235], a[20:23], v[132:135]
    s_add_u32 s44, s64, 50331648
    ds_read_b128 v[88:91], v77 offset:6144
    v_mfma_f32_16x16x32_bf16 v[132:135], v[236:239], a[28:31], v[132:135]
    buffer_load_dwordx4 v[192:195], v82, s[28:31], s44 offen sc1
    v_mfma_f32_16x16x32_bf16 v[128:131], v[236:239], a[24:27], v[128:131]
    s_add_u32 s45, s65, 50331648
    ds_read_b128 v[92:95], v77 offset:15360
    v_mfma_f32_16x16x32_bf16 v[128:131], v[232:235], a[16:19], v[128:131]
    s_waitcnt lgkmcnt(4)
    buffer_load_dwordx4 v[196:199], v82, s[28:31], s45 offen sc1
    v_mfma_f32_16x16x32_bf16 v[136:139], v[32:35], a[16:19], v[136:139]
    ds_read_b128 v[232:235], v77 offset:24576
    v_mfma_f32_16x16x32_bf16 v[136:139], v[36:39], a[24:27], v[136:139]
    v_mfma_f32_16x16x32_bf16 v[140:143], v[36:39], a[28:31], v[140:143]
    s_add_u32 s44, s66, 50331648
    ds_read_b128 v[236:239], v77 offset:33792
    v_mfma_f32_16x16x32_bf16 v[140:143], v[32:35], a[20:23], v[140:143]
    s_waitcnt lgkmcnt(4)
    buffer_load_dwordx4 v[200:203], v82, s[28:31], s44 offen sc1
    v_mfma_f32_16x16x32_bf16 v[140:143], v[40:43], a[4:7], v[140:143]
    ds_read_b128 v[32:35], v77 offset:25600
    v_mfma_f32_16x16x32_bf16 v[140:143], v[44:47], a[12:15], v[140:143]
    v_mfma_f32_16x16x32_bf16 v[136:139], v[44:47], a[8:11], v[136:139]
    ds_read_b128 v[36:39], v77 offset:34816
    v_mfma_f32_16x16x32_bf16 v[136:139], v[40:43], a[0:3], v[136:139]
    s_waitcnt lgkmcnt(4)
    ds_read_b128 v[172:175], v85 offset:0
    v_mfma_f32_16x16x32_bf16 v[144:147], v[88:91], a[0:3], v[144:147]
    ds_read_b128 v[40:43], v77 offset:7168
    v_mfma_f32_16x16x32_bf16 v[144:147], v[92:95], a[8:11], v[144:147]
    v_mfma_f32_16x16x32_bf16 v[148:151], v[92:95], a[12:15], v[148:151]
    ds_read_b128 v[44:47], v77 offset:16384
    v_mfma_f32_16x16x32_bf16 v[148:151], v[88:91], a[4:7], v[148:151]
    s_waitcnt lgkmcnt(5)
    ds_read_b128 v[188:191], v85 offset:4096
    v_mfma_f32_16x16x32_bf16 v[148:151], v[232:235], a[20:23], v[148:151]
    ds_read_b128 v[88:91], v77 offset:8192
    v_mfma_f32_16x16x32_bf16 v[148:151], v[236:239], a[28:31], v[148:151]
    ds_read_b128 v[204:207], v85 offset:8192
    v_mfma_f32_16x16x32_bf16 v[144:147], v[236:239], a[24:27], v[144:147]
    ds_read_b128 v[92:95], v77 offset:17408
    v_mfma_f32_16x16x32_bf16 v[144:147], v[232:235], a[16:19], v[144:147]
    s_waitcnt lgkmcnt(7)
    v_mfma_f32_16x16x32_bf16 v[152:155], v[32:35], a[16:19], v[152:155]
    ds_read_b128 v[232:235], v77 offset:26624
    v_mfma_f32_16x16x32_bf16 v[152:155], v[36:39], a[24:27], v[152:155]
    v_mfma_f32_16x16x32_bf16 v[156:159], v[36:39], a[28:31], v[156:159]
    ds_read_b128 v[236:239], v77 offset:35840
    v_mfma_f32_16x16x32_bf16 v[156:159], v[32:35], a[20:23], v[156:159]
    s_waitcnt lgkmcnt(6)
    v_mfma_f32_16x16x32_bf16 v[156:159], v[40:43], a[4:7], v[156:159]
    v_mfma_f32_16x16x32_bf16 v[156:159], v[44:47], a[12:15], v[156:159]
    v_mfma_f32_16x16x32_bf16 v[152:155], v[44:47], a[8:11], v[152:155]
    s_waitcnt vmcnt(9) lgkmcnt(0)
    v_mfma_f32_16x16x32_bf16 v[152:155], v[40:43], a[0:3], v[152:155]
    s_barrier
    v_mfma_f32_16x16x32_bf16 v[240:243], v[88:91], a[0:3], v[240:243]
    ds_read_b128 v[32:35], v1 offset:0
    v_mfma_f32_16x16x32_bf16 v[240:243], v[92:95], a[8:11], v[240:243]
    ds_read_b128 v[36:39], v1 offset:9216
    v_mfma_f32_16x16x32_bf16 v[244:247], v[92:95], a[12:15], v[244:247]
    ds_read_b128 v[40:43], v1 offset:18432
    v_mfma_f32_16x16x32_bf16 v[244:247], v[88:91], a[4:7], v[244:247]
    s_waitcnt lgkmcnt(3)
    ds_read_b128 v[44:47], v1 offset:27648
    v_mfma_f32_16x16x32_bf16 v[244:247], v[232:235], a[20:23], v[244:247]
    ds_read_b128 v[88:91], v1 offset:19456
    v_mfma_f32_16x16x32_bf16 v[244:247], v[236:239], a[28:31], v[244:247]
    v_add_u32_e64 v6, s69, 5
    v_mfma_f32_16x16x32_bf16 v[240:243], v[236:239], a[24:27], v[240:243]
    ds_read_b128 v[92:95], v1 offset:28672
    v_mfma_f32_16x16x32_bf16 v[240:243], v[232:235], a[16:19], v[240:243]
    s_waitcnt lgkmcnt(4)
    v_mfma_f32_16x16x32_bf16 v[96:99], v[32:35], a[32:35], v[96:99]
    ds_read_b128 v[232:235], v1 offset:1024
    v_mfma_f32_16x16x32_bf16 v[96:99], v[36:39], a[40:43], v[96:99]
    buffer_store_dwordx2 v[6:7], v0, s[28:31], s73 offen sc1
    v_mfma_f32_16x16x32_bf16 v[100:103], v[36:39], a[44:47], v[100:103]
    ds_read_b128 v[236:239], v1 offset:10240
    v_mfma_f32_16x16x32_bf16 v[100:103], v[32:35], a[36:39], v[100:103]
    s_waitcnt lgkmcnt(4)
    v_mfma_f32_16x16x32_bf16 v[100:103], v[40:43], a[52:55], v[100:103]
    ds_read_b128 v[32:35], v1 offset:2048
    v_mfma_f32_16x16x32_bf16 v[100:103], v[44:47], a[60:63], v[100:103]
    v_mfma_f32_16x16x32_bf16 v[96:99], v[44:47], a[56:59], v[96:99]
    ds_read_b128 v[36:39], v1 offset:11264
    v_mfma_f32_16x16x32_bf16 v[96:99], v[40:43], a[48:51], v[96:99]
    s_waitcnt lgkmcnt(4)
    v_mfma_f32_16x16x32_bf16 v[104:107], v[88:91], a[48:51], v[104:107]
    ds_read_b128 v[40:43], v1 offset:20480
    v_mfma_f32_16x16x32_bf16 v[104:107], v[92:95], a[56:59], v[104:107]
    v_mfma_f32_16x16x32_bf16 v[108:111], v[92:95], a[60:63], v[108:111]
    ds_read_b128 v[44:47], v1 offset:29696
    v_mfma_f32_16x16x32_bf16 v[108:111], v[88:91], a[52:55], v[108:111]
    s_waitcnt lgkmcnt(4)
    v_mfma_f32_16x16x32_bf16 v[108:111], v[232:235], a[36:39], v[108:111]
    ds_read_b128 v[88:91], v1 offset:21504
    v_cvt_pk_bf16_f32 v96, v96, v97
    v_mfma_f32_16x16x32_bf16 v[108:111], v[236:239], a[44:47], v[108:111]
    v_cvt_pk_bf16_f32 v97, v98, v99
    v_cvt_pk_bf16_f32 v98, v100, v101
    v_mfma_f32_16x16x32_bf16 v[104:107], v[236:239], a[40:43], v[104:107]
    ds_read_b128 v[92:95], v1 offset:30720
    v_cvt_pk_bf16_f32 v99, v102, v103
    v_mfma_f32_16x16x32_bf16 v[104:107], v[232:235], a[32:35], v[104:107]
    s_waitcnt lgkmcnt(4)
    v_mfma_f32_16x16x32_bf16 v[112:115], v[32:35], a[32:35], v[112:115]
    ds_read_b128 v[232:235], v1 offset:3072
    v_mfma_f32_16x16x32_bf16 v[112:115], v[36:39], a[40:43], v[112:115]
    s_add_u32 s78, s58, 59768832
    buffer_store_dwordx4 v[96:99], v1, s[28:31], s78 offen sc1
    v_mfma_f32_16x16x32_bf16 v[116:119], v[36:39], a[44:47], v[116:119]
    ds_read_b128 v[236:239], v1 offset:12288
    v_mfma_f32_16x16x32_bf16 v[116:119], v[32:35], a[36:39], v[116:119]
    s_waitcnt lgkmcnt(4)
    v_mfma_f32_16x16x32_bf16 v[116:119], v[40:43], a[52:55], v[116:119]
    ds_read_b128 v[32:35], v1 offset:4096
    v_cvt_pk_bf16_f32 v104, v104, v105
    v_mfma_f32_16x16x32_bf16 v[116:119], v[44:47], a[60:63], v[116:119]
    ds_write_b128 v84, v[96:99] offset:9216
    v_cvt_pk_bf16_f32 v105, v106, v107
    v_mfma_f32_16x16x32_bf16 v[112:115], v[44:47], a[56:59], v[112:115]
    ds_read_b128 v[36:39], v1 offset:13312
    v_cvt_pk_bf16_f32 v106, v108, v109
    v_mfma_f32_16x16x32_bf16 v[112:115], v[40:43], a[48:51], v[112:115]
    s_waitcnt lgkmcnt(5)
    v_cvt_pk_bf16_f32 v107, v110, v111
    v_mfma_f32_16x16x32_bf16 v[120:123], v[88:91], a[48:51], v[120:123]
    ds_read_b128 v[40:43], v1 offset:22528
    v_mfma_f32_16x16x32_bf16 v[120:123], v[92:95], a[56:59], v[120:123]
    s_add_u32 s78, s58, 59769856
    buffer_store_dwordx4 v[104:107], v1, s[28:31], s78 offen sc1
    v_mfma_f32_16x16x32_bf16 v[124:127], v[92:95], a[60:63], v[124:127]
    ds_read_b128 v[44:47], v1 offset:31744
    v_mfma_f32_16x16x32_bf16 v[124:127], v[88:91], a[52:55], v[124:127]
    s_waitcnt lgkmcnt(5)
    v_mfma_f32_16x16x32_bf16 v[124:127], v[232:235], a[36:39], v[124:127]
    ds_read_b128 v[88:91], v1 offset:23552
    v_cvt_pk_bf16_f32 v112, v112, v113
    v_mfma_f32_16x16x32_bf16 v[124:127], v[236:239], a[44:47], v[124:127]
    ds_write_b128 v84, v[104:107] offset:10240
    v_cvt_pk_bf16_f32 v113, v114, v115
    v_mfma_f32_16x16x32_bf16 v[120:123], v[236:239], a[40:43], v[120:123]
    ds_read_b128 v[92:95], v1 offset:32768
    v_cvt_pk_bf16_f32 v114, v116, v117
    v_mfma_f32_16x16x32_bf16 v[120:123], v[232:235], a[32:35], v[120:123]
    s_waitcnt lgkmcnt(5)
    v_cvt_pk_bf16_f32 v115, v118, v119
    v_mfma_f32_16x16x32_bf16 v[128:131], v[32:35], a[32:35], v[128:131]
    ds_read_b128 v[232:235], v1 offset:5120
    v_mfma_f32_16x16x32_bf16 v[128:131], v[36:39], a[40:43], v[128:131]
    s_add_u32 s78, s58, 59770880
    buffer_store_dwordx4 v[112:115], v1, s[28:31], s78 offen sc1
    v_mfma_f32_16x16x32_bf16 v[132:135], v[36:39], a[44:47], v[132:135]
    ds_read_b128 v[236:239], v1 offset:14336
    v_mfma_f32_16x16x32_bf16 v[132:135], v[32:35], a[36:39], v[132:135]
    s_waitcnt lgkmcnt(5)
    v_mfma_f32_16x16x32_bf16 v[132:135], v[40:43], a[52:55], v[132:135]
    ds_read_b128 v[32:35], v1 offset:6144
    v_cvt_pk_bf16_f32 v120, v120, v121
    v_mfma_f32_16x16x32_bf16 v[132:135], v[44:47], a[60:63], v[132:135]
    ds_write_b128 v84, v[112:115] offset:11264
    v_cvt_pk_bf16_f32 v121, v122, v123
    v_mfma_f32_16x16x32_bf16 v[128:131], v[44:47], a[56:59], v[128:131]
    ds_read_b128 v[36:39], v1 offset:15360
    v_cvt_pk_bf16_f32 v122, v124, v125
    v_mfma_f32_16x16x32_bf16 v[128:131], v[40:43], a[48:51], v[128:131]
    s_waitcnt lgkmcnt(5)
    v_cvt_pk_bf16_f32 v123, v126, v127
    v_mfma_f32_16x16x32_bf16 v[136:139], v[88:91], a[48:51], v[136:139]
    ds_read_b128 v[40:43], v1 offset:24576
    v_mfma_f32_16x16x32_bf16 v[136:139], v[92:95], a[56:59], v[136:139]
    s_add_u32 s78, s58, 59771904
    buffer_store_dwordx4 v[120:123], v1, s[28:31], s78 offen sc1
    v_mfma_f32_16x16x32_bf16 v[140:143], v[92:95], a[60:63], v[140:143]
    ds_read_b128 v[44:47], v1 offset:33792
    v_mfma_f32_16x16x32_bf16 v[140:143], v[88:91], a[52:55], v[140:143]
    s_waitcnt lgkmcnt(5)
    v_mfma_f32_16x16x32_bf16 v[140:143], v[232:235], a[36:39], v[140:143]
    ds_read_b128 v[88:91], v1 offset:25600
    v_cvt_pk_bf16_f32 v128, v128, v129
    v_mfma_f32_16x16x32_bf16 v[140:143], v[236:239], a[44:47], v[140:143]
    ds_write_b128 v84, v[120:123] offset:12288
    v_cvt_pk_bf16_f32 v129, v130, v131
    v_mfma_f32_16x16x32_bf16 v[136:139], v[236:239], a[40:43], v[136:139]
    ds_read_b128 v[92:95], v1 offset:34816
    v_cvt_pk_bf16_f32 v130, v132, v133
    v_mfma_f32_16x16x32_bf16 v[136:139], v[232:235], a[32:35], v[136:139]
    s_waitcnt lgkmcnt(5)
    v_cvt_pk_bf16_f32 v131, v134, v135
    v_mfma_f32_16x16x32_bf16 v[144:147], v[32:35], a[32:35], v[144:147]
    ds_read_b128 v[232:235], v1 offset:7168
    v_mfma_f32_16x16x32_bf16 v[144:147], v[36:39], a[40:43], v[144:147]
    s_add_u32 s78, s58, 59772928
    buffer_store_dwordx4 v[128:131], v1, s[28:31], s78 offen sc1
    v_mfma_f32_16x16x32_bf16 v[148:151], v[36:39], a[44:47], v[148:151]
    ds_read_b128 v[236:239], v1 offset:16384
    v_mfma_f32_16x16x32_bf16 v[148:151], v[32:35], a[36:39], v[148:151]
    s_waitcnt lgkmcnt(5)
    v_mfma_f32_16x16x32_bf16 v[148:151], v[40:43], a[52:55], v[148:151]
    ds_read_b128 v[32:35], v1 offset:8192
    v_cvt_pk_bf16_f32 v136, v136, v137
    v_mfma_f32_16x16x32_bf16 v[148:151], v[44:47], a[60:63], v[148:151]
    ds_write_b128 v84, v[128:131] offset:13312
    v_cvt_pk_bf16_f32 v137, v138, v139
    v_mfma_f32_16x16x32_bf16 v[144:147], v[44:47], a[56:59], v[144:147]
    ds_read_b128 v[36:39], v1 offset:17408
    v_cvt_pk_bf16_f32 v138, v140, v141
    v_mfma_f32_16x16x32_bf16 v[144:147], v[40:43], a[48:51], v[144:147]
    s_waitcnt lgkmcnt(5)
    v_cvt_pk_bf16_f32 v139, v142, v143
    v_mfma_f32_16x16x32_bf16 v[152:155], v[88:91], a[48:51], v[152:155]
    ds_read_b128 v[40:43], v1 offset:26624
    v_mfma_f32_16x16x32_bf16 v[152:155], v[92:95], a[56:59], v[152:155]
    s_add_u32 s78, s58, 59773952
    buffer_store_dwordx4 v[136:139], v1, s[28:31], s78 offen sc1
    v_mfma_f32_16x16x32_bf16 v[156:159], v[92:95], a[60:63], v[156:159]
    ds_read_b128 v[44:47], v1 offset:35840
    v_mfma_f32_16x16x32_bf16 v[156:159], v[88:91], a[52:55], v[156:159]
    s_waitcnt lgkmcnt(5)
    v_mfma_f32_16x16x32_bf16 v[156:159], v[232:235], a[36:39], v[156:159]
    ds_write_b128 v84, v[136:139] offset:14336
    v_cvt_pk_bf16_f32 v144, v144, v145
    v_mfma_f32_16x16x32_bf16 v[156:159], v[236:239], a[44:47], v[156:159]
    v_cvt_pk_bf16_f32 v145, v146, v147
    v_cvt_pk_bf16_f32 v146, v148, v149
    v_mfma_f32_16x16x32_bf16 v[152:155], v[236:239], a[40:43], v[152:155]
    v_cvt_pk_bf16_f32 v147, v150, v151
    v_mfma_f32_16x16x32_bf16 v[152:155], v[232:235], a[32:35], v[152:155]
    s_waitcnt lgkmcnt(3)
    v_mfma_f32_16x16x32_bf16 v[240:243], v[32:35], a[32:35], v[240:243]
    s_add_u32 s78, s58, 59774976
    buffer_store_dwordx4 v[144:147], v1, s[28:31], s78 offen sc1
    v_mfma_f32_16x16x32_bf16 v[240:243], v[36:39], a[40:43], v[240:243]
    ds_write_b128 v84, v[144:147] offset:15360
    v_mfma_f32_16x16x32_bf16 v[244:247], v[36:39], a[44:47], v[244:247]
    v_mfma_f32_16x16x32_bf16 v[244:247], v[32:35], a[36:39], v[244:247]
    s_waitcnt lgkmcnt(2)
    v_mfma_f32_16x16x32_bf16 v[244:247], v[40:43], a[52:55], v[244:247]
    v_cvt_pk_bf16_f32 v152, v152, v153
    v_cvt_pk_bf16_f32 v153, v154, v155
    v_mfma_f32_16x16x32_bf16 v[244:247], v[44:47], a[60:63], v[244:247]
    v_cvt_pk_bf16_f32 v154, v156, v157
    v_cvt_pk_bf16_f32 v155, v158, v159
    v_mfma_f32_16x16x32_bf16 v[240:243], v[44:47], a[56:59], v[240:243]
    s_add_u32 s78, s58, 59776000
    buffer_store_dwordx4 v[152:155], v1, s[28:31], s78 offen sc1
    v_mfma_f32_16x16x32_bf16 v[240:243], v[40:43], a[48:51], v[240:243]
    ds_write_b128 v84, v[152:155] offset:16384
    s_nop 6
    v_cvt_pk_bf16_f32 v240, v240, v241
    v_cvt_pk_bf16_f32 v241, v242, v243
    v_cvt_pk_bf16_f32 v242, v244, v245
    v_cvt_pk_bf16_f32 v243, v246, v247
    s_add_u32 s78, s58, 59777024
    buffer_store_dwordx4 v[240:243], v1, s[28:31], s78 offen sc1
    ds_write_b128 v84, v[240:243] offset:17408
    s_waitcnt lgkmcnt(0)
    s_add_u32 s45, s64, 59768832
    buffer_load_dwordx4 v[96:99], v80, s[28:31], s45 offen sc1
    s_add_u32 s44, s65, 59768832
    buffer_load_dwordx4 v[100:103], v80, s[28:31], s44 offen sc1
    s_add_u32 s45, s66, 59768832
    buffer_load_dwordx4 v[104:107], v80, s[28:31], s45 offen sc1
    s_add_u32 s44, s64, 59768832
    buffer_load_dwordx4 v[112:115], v81, s[28:31], s44 offen sc1
    s_add_u32 s45, s65, 59768832
    buffer_load_dwordx4 v[116:119], v81, s[28:31], s45 offen sc1
    s_add_u32 s44, s66, 59768832
    buffer_load_dwordx4 v[120:123], v81, s[28:31], s44 offen sc1
    s_add_u32 s45, s64, 59768832
    buffer_load_dwordx4 v[128:131], v82, s[28:31], s45 offen sc1
    s_add_u32 s44, s65, 59768832
    buffer_load_dwordx4 v[132:135], v82, s[28:31], s44 offen sc1
    s_add_u32 s45, s66, 59768832
    buffer_load_dwordx4 v[136:139], v82, s[28:31], s45 offen sc1
    s_waitcnt vmcnt(19)
    s_barrier
    ds_read_b128 v[108:111], v85 offset:9216
    ds_read_b128 v[124:127], v85 offset:13312
    ds_read_b128 v[140:143], v85 offset:17408
    v_lshlrev_b32 v208, 16, v160
    v_and_b32 v209, s61, v160
    v_lshlrev_b32 v210, 16, v161
    v_and_b32 v211, s61, v161
    v_lshlrev_b32 v212, 16, v162
    v_and_b32 v213, s61, v162
    v_lshlrev_b32 v214, 16, v163
    v_and_b32 v215, s61, v163
    v_lshlrev_b32 v24, 16, v164
    v_and_b32 v25, s61, v164
    v_lshlrev_b32 v26, 16, v165
    v_and_b32 v27, s61, v165
    v_lshlrev_b32 v28, 16, v166
    v_and_b32 v29, s61, v166
    v_lshlrev_b32 v30, 16, v167
    v_and_b32 v31, s61, v167
    v_pk_add_f32 v[208:209], v[208:209], v[24:25]
    v_pk_add_f32 v[210:211], v[210:211], v[26:27]
    v_pk_add_f32 v[212:213], v[212:213], v[28:29]
    v_pk_add_f32 v[214:215], v[214:215], v[30:31]
    v_lshlrev_b32 v16, 16, v168
    v_and_b32 v17, s61, v168
    v_lshlrev_b32 v18, 16, v169
    v_and_b32 v19, s61, v169
    v_lshlrev_b32 v20, 16, v170
    v_and_b32 v21, s61, v170
    v_lshlrev_b32 v22, 16, v171
    v_and_b32 v23, s61, v171
    v_pk_add_f32 v[208:209], v[208:209], v[16:17]
    v_pk_add_f32 v[210:211], v[210:211], v[18:19]
    v_pk_add_f32 v[212:213], v[212:213], v[20:21]
    v_pk_add_f32 v[214:215], v[214:215], v[22:23]
    v_lshlrev_b32 v24, 16, v172
    v_and_b32 v25, s61, v172
    v_lshlrev_b32 v26, 16, v173
    v_and_b32 v27, s61, v173
    v_lshlrev_b32 v28, 16, v174
    v_and_b32 v29, s61, v174
    v_lshlrev_b32 v30, 16, v175
    v_and_b32 v31, s61, v175
    v_pk_add_f32 v[208:209], v[208:209], v[24:25]
    v_pk_add_f32 v[210:211], v[210:211], v[26:27]
    v_pk_add_f32 v[212:213], v[212:213], v[28:29]
    v_pk_add_f32 v[214:215], v[214:215], v[30:31]
    v_mul_f32 v160, 0xbfb8aa3b, v208
    v_mul_f32 v161, 0xbfb8aa3b, v209
    v_mul_f32 v162, 0xbfb8aa3b, v210
    v_mul_f32 v163, 0xbfb8aa3b, v211
    v_mul_f32 v164, 0xbfb8aa3b, v212
    v_mul_f32 v165, 0xbfb8aa3b, v213
    v_mul_f32 v166, 0xbfb8aa3b, v214
    v_mul_f32 v167, 0xbfb8aa3b, v215
    v_exp_f32 v160, v160
    v_exp_f32 v161, v161
    v_exp_f32 v162, v162
    v_exp_f32 v163, v163
    v_exp_f32 v164, v164
    v_exp_f32 v165, v165
    v_exp_f32 v166, v166
    v_exp_f32 v167, v167
    v_add_f32 v160, 1.0, v160
    v_add_f32 v161, 1.0, v161
    v_add_f32 v162, 1.0, v162
    v_add_f32 v163, 1.0, v163
    v_add_f32 v164, 1.0, v164
    v_add_f32 v165, 1.0, v165
    v_add_f32 v166, 1.0, v166
    v_add_f32 v167, 1.0, v167
    v_rcp_f32 v160, v160
    v_rcp_f32 v161, v161
    v_rcp_f32 v162, v162
    v_rcp_f32 v163, v163
    v_rcp_f32 v164, v164
    v_rcp_f32 v165, v165
    v_rcp_f32 v166, v166
    v_rcp_f32 v167, v167
    v_pk_mul_f32 v[208:209], v[208:209], v[160:161]
    v_pk_mul_f32 v[210:211], v[210:211], v[162:163]
    v_pk_mul_f32 v[212:213], v[212:213], v[164:165]
    v_pk_mul_f32 v[214:215], v[214:215], v[166:167]
    v_lshlrev_b32 v216, 16, v176
    v_and_b32 v217, s61, v176
    v_lshlrev_b32 v218, 16, v177
    v_and_b32 v219, s61, v177
    v_lshlrev_b32 v220, 16, v178
    v_and_b32 v221, s61, v178
    v_lshlrev_b32 v222, 16, v179
    v_and_b32 v223, s61, v179
    v_lshlrev_b32 v24, 16, v180
    v_and_b32 v25, s61, v180
    v_lshlrev_b32 v26, 16, v181
    v_and_b32 v27, s61, v181
    v_lshlrev_b32 v28, 16, v182
    v_and_b32 v29, s61, v182
    v_lshlrev_b32 v30, 16, v183
    v_and_b32 v31, s61, v183
    v_pk_add_f32 v[216:217], v[216:217], v[24:25]
    v_pk_add_f32 v[218:219], v[218:219], v[26:27]
    v_pk_add_f32 v[220:221], v[220:221], v[28:29]
    v_pk_add_f32 v[222:223], v[222:223], v[30:31]
    v_lshlrev_b32 v16, 16, v184
    v_and_b32 v17, s61, v184
    v_lshlrev_b32 v18, 16, v185
    v_and_b32 v19, s61, v185
    v_lshlrev_b32 v20, 16, v186
    v_and_b32 v21, s61, v186
    v_lshlrev_b32 v22, 16, v187
    v_and_b32 v23, s61, v187
    v_pk_add_f32 v[216:217], v[216:217], v[16:17]
    v_pk_add_f32 v[218:219], v[218:219], v[18:19]
    v_pk_add_f32 v[220:221], v[220:221], v[20:21]
    v_pk_add_f32 v[222:223], v[222:223], v[22:23]
    v_lshlrev_b32 v24, 16, v188
    v_and_b32 v25, s61, v188
    v_lshlrev_b32 v26, 16, v189
    v_and_b32 v27, s61, v189
    v_lshlrev_b32 v28, 16, v190
    v_and_b32 v29, s61, v190
    v_lshlrev_b32 v30, 16, v191
    v_and_b32 v31, s61, v191
    v_pk_add_f32 v[216:217], v[216:217], v[24:25]
    v_pk_add_f32 v[218:219], v[218:219], v[26:27]
    v_pk_add_f32 v[220:221], v[220:221], v[28:29]
    v_pk_add_f32 v[222:223], v[222:223], v[30:31]
    v_mul_f32 v176, 0xbfb8aa3b, v216
    v_mul_f32 v177, 0xbfb8aa3b, v217
    v_mul_f32 v178, 0xbfb8aa3b, v218
    v_mul_f32 v179, 0xbfb8aa3b, v219
    v_mul_f32 v180, 0xbfb8aa3b, v220
    v_mul_f32 v181, 0xbfb8aa3b, v221
    v_mul_f32 v182, 0xbfb8aa3b, v222
    v_mul_f32 v183, 0xbfb8aa3b, v223
    v_exp_f32 v176, v176
    v_exp_f32 v177, v177
    v_exp_f32 v178, v178
    v_exp_f32 v179, v179
    v_exp_f32 v180, v180
    v_exp_f32 v181, v181
    v_exp_f32 v182, v182
    v_exp_f32 v183, v183
    v_add_f32 v176, 1.0, v176
    v_add_f32 v177, 1.0, v177
    v_add_f32 v178, 1.0, v178
    v_add_f32 v179, 1.0, v179
    v_add_f32 v180, 1.0, v180
    v_add_f32 v181, 1.0, v181
    v_add_f32 v182, 1.0, v182
    v_add_f32 v183, 1.0, v183
    v_rcp_f32 v176, v176
    v_rcp_f32 v177, v177
    v_rcp_f32 v178, v178
    v_rcp_f32 v179, v179
    v_rcp_f32 v180, v180
    v_rcp_f32 v181, v181
    v_rcp_f32 v182, v182
    v_rcp_f32 v183, v183
    v_pk_mul_f32 v[216:217], v[216:217], v[176:177]
    v_pk_mul_f32 v[218:219], v[218:219], v[178:179]
    v_pk_mul_f32 v[220:221], v[220:221], v[180:181]
    v_pk_mul_f32 v[222:223], v[222:223], v[182:183]
    v_lshlrev_b32 v224, 16, v192
    v_and_b32 v225, s61, v192
    v_lshlrev_b32 v226, 16, v193
    v_and_b32 v227, s61, v193
    v_lshlrev_b32 v228, 16, v194
    v_and_b32 v229, s61, v194
    v_lshlrev_b32 v230, 16, v195
    v_and_b32 v231, s61, v195
    v_lshlrev_b32 v24, 16, v196
    v_and_b32 v25, s61, v196
    v_lshlrev_b32 v26, 16, v197
    v_and_b32 v27, s61, v197
    v_lshlrev_b32 v28, 16, v198
    v_and_b32 v29, s61, v198
    v_lshlrev_b32 v30, 16, v199
    v_and_b32 v31, s61, v199
    v_pk_add_f32 v[224:225], v[224:225], v[24:25]
    v_pk_add_f32 v[226:227], v[226:227], v[26:27]
    v_pk_add_f32 v[228:229], v[228:229], v[28:29]
    v_pk_add_f32 v[230:231], v[230:231], v[30:31]
    v_lshlrev_b32 v16, 16, v200
    v_and_b32 v17, s61, v200
    v_lshlrev_b32 v18, 16, v201
    v_and_b32 v19, s61, v201
    v_lshlrev_b32 v20, 16, v202
    v_and_b32 v21, s61, v202
    v_lshlrev_b32 v22, 16, v203
    v_and_b32 v23, s61, v203
    v_pk_add_f32 v[224:225], v[224:225], v[16:17]
    v_pk_add_f32 v[226:227], v[226:227], v[18:19]
    v_pk_add_f32 v[228:229], v[228:229], v[20:21]
    v_pk_add_f32 v[230:231], v[230:231], v[22:23]
    v_lshlrev_b32 v24, 16, v204
    v_and_b32 v25, s61, v204
    v_lshlrev_b32 v26, 16, v205
    v_and_b32 v27, s61, v205
    v_lshlrev_b32 v28, 16, v206
    v_and_b32 v29, s61, v206
    v_lshlrev_b32 v30, 16, v207
    v_and_b32 v31, s61, v207
    v_pk_add_f32 v[224:225], v[224:225], v[24:25]
    v_pk_add_f32 v[226:227], v[226:227], v[26:27]
    v_pk_add_f32 v[228:229], v[228:229], v[28:29]
    v_pk_add_f32 v[230:231], v[230:231], v[30:31]
    v_mul_f32 v192, 0xbfb8aa3b, v224
    v_mul_f32 v193, 0xbfb8aa3b, v225
    v_mul_f32 v194, 0xbfb8aa3b, v226
    v_mul_f32 v195, 0xbfb8aa3b, v227
    v_mul_f32 v196, 0xbfb8aa3b, v228
    v_mul_f32 v197, 0xbfb8aa3b, v229
    v_mul_f32 v198, 0xbfb8aa3b, v230
    v_mul_f32 v199, 0xbfb8aa3b, v231
    v_exp_f32 v192, v192
    v_exp_f32 v193, v193
    v_exp_f32 v194, v194
    v_exp_f32 v195, v195
    v_exp_f32 v196, v196
    v_exp_f32 v197, v197
    v_exp_f32 v198, v198
    v_exp_f32 v199, v199
    v_add_f32 v192, 1.0, v192
    v_add_f32 v193, 1.0, v193
    v_add_f32 v194, 1.0, v194
    v_add_f32 v195, 1.0, v195
    v_add_f32 v196, 1.0, v196
    v_add_f32 v197, 1.0, v197
    v_add_f32 v198, 1.0, v198
    v_add_f32 v199, 1.0, v199
    v_rcp_f32 v192, v192
    v_rcp_f32 v193, v193
    v_rcp_f32 v194, v194
    v_rcp_f32 v195, v195
    v_rcp_f32 v196, v196
    v_rcp_f32 v197, v197
    v_rcp_f32 v198, v198
    v_rcp_f32 v199, v199
    v_pk_mul_f32 v[224:225], v[224:225], v[192:193]
    v_pk_mul_f32 v[226:227], v[226:227], v[194:195]
    v_pk_mul_f32 v[228:229], v[228:229], v[196:197]
    v_pk_mul_f32 v[230:231], v[230:231], v[198:199]
    v_lshlrev_b32 v32, 16, v56
    v_and_b32 v33, s61, v56
    v_lshlrev_b32 v34, 16, v57
    v_and_b32 v35, s61, v57
    v_lshlrev_b32 v36, 16, v58
    v_and_b32 v37, s61, v58
    v_lshlrev_b32 v38, 16, v59
    v_and_b32 v39, s61, v59
    v_lshlrev_b32 v40, 16, v60
    v_and_b32 v41, s61, v60
    v_lshlrev_b32 v42, 16, v61
    v_and_b32 v43, s61, v61
    v_lshlrev_b32 v44, 16, v62
    v_and_b32 v45, s61, v62
    v_lshlrev_b32 v46, 16, v63
    v_and_b32 v47, s61, v63
    v_lshlrev_b32 v48, 16, v64
    v_and_b32 v49, s61, v64
    v_lshlrev_b32 v50, 16, v65
    v_and_b32 v51, s61, v65
    v_lshlrev_b32 v52, 16, v66
    v_and_b32 v53, s61, v66
    v_lshlrev_b32 v54, 16, v67
    v_and_b32 v55, s61, v67
    s_mov_b32 s52, 0x40000
    s_add_u32 s79, s74, 5
L_dcheck:
    s_waitcnt vmcnt(0)
    v_max_u32 v4, v96, v97
    v_max_u32 v5, v98, v99
    v_max3_u32 v4, v4, v100, v101
    v_max3_u32 v5, v5, v102, v103
    v_max3_u32 v4, v4, v104, v105
    v_max3_u32 v5, v5, v106, v107
    v_max3_u32 v4, v4, v112, v113
    v_max3_u32 v5, v5, v114, v115
    v_max3_u32 v4, v4, v116, v117
    v_max3_u32 v5, v5, v118, v119
    v_max3_u32 v4, v4, v120, v121
    v_max3_u32 v5, v5, v122, v123
    v_max3_u32 v4, v4, v128, v129
    v_max3_u32 v5, v5, v130, v131
    v_max3_u32 v4, v4, v132, v133
    v_max3_u32 v5, v5, v134, v135
    v_max3_u32 v4, v4, v136, v137
    v_max3_u32 v5, v5, v138, v139
    v_max_u32 v4, v4, v5
    v_cmp_eq_u32 vcc, -1, v4
    s_cbranch_vccz L_dready
    s_cmp_eq_u32 s52, 0x40000
    s_cbranch_scc0 L_dagain
    s_call_b64 s[50:51], L_spin0
L_dagain:
    s_add_u32 s44, s64, 59768832
    buffer_load_dwordx4 v[96:99], v80, s[28:31], s44 offen sc1
    s_add_u32 s45, s65, 59768832
    buffer_load_dwordx4 v[100:103], v80, s[28:31], s45 offen sc1
    s_add_u32 s44, s66, 59768832
    buffer_load_dwordx4 v[104:107], v80, s[28:31], s44 offen sc1
    s_add_u32 s45, s64, 59768832
    buffer_load_dwordx4 v[112:115], v81, s[28:31], s45 offen sc1
    s_add_u32 s44, s65, 59768832
    buffer_load_dwordx4 v[116:119], v81, s[28:31], s44 offen sc1
    s_add_u32 s45, s66, 59768832
    buffer_load_dwordx4 v[120:123], v81, s[28:31], s45 offen sc1
    s_add_u32 s44, s64, 59768832
    buffer_load_dwordx4 v[128:131], v82, s[28:31], s44 offen sc1
    s_add_u32 s45, s65, 59768832
    buffer_load_dwordx4 v[132:135], v82, s[28:31], s45 offen sc1
    s_add_u32 s44, s66, 59768832
    buffer_load_dwordx4 v[136:139], v82, s[28:31], s44 offen sc1
    s_sub_u32 s52, s52, 1
    s_cmp_lg_u32 s52, 0
    s_cbranch_scc1 L_dcheck
    s_waitcnt vmcnt(0)
L_dready:
    s_waitcnt lgkmcnt(0)
    v_lshlrev_b32 v160, 16, v96
    v_and_b32 v161, s61, v96
    v_lshlrev_b32 v162, 16, v97
    v_and_b32 v163, s61, v97
    v_lshlrev_b32 v164, 16, v98
    v_and_b32 v165, s61, v98
    v_lshlrev_b32 v166, 16, v99
    v_and_b32 v167, s61, v99
    v_lshlrev_b32 v24, 16, v100
    v_and_b32 v25, s61, v100
    v_lshlrev_b32 v26, 16, v101
    v_and_b32 v27, s61, v101
    v_lshlrev_b32 v28, 16, v102
    v_and_b32 v29, s61, v102
    v_lshlrev_b32 v30, 16, v103
    v_and_b32 v31, s61, v103
    v_pk_add_f32 v[160:161], v[160:161], v[24:25]
    v_pk_add_f32 v[162:163], v[162:163], v[26:27]
    v_pk_add_f32 v[164:165], v[164:165], v[28:29]
    v_pk_add_f32 v[166:167], v[166:167], v[30:31]
    v_lshlrev_b32 v16, 16, v104
    v_and_b32 v17, s61, v104
    v_lshlrev_b32 v18, 16, v105
    v_and_b32 v19, s61, v105
    v_lshlrev_b32 v20, 16, v106
    v_and_b32 v21, s61, v106
    v_lshlrev_b32 v22, 16, v107
    v_and_b32 v23, s61, v107
    v_pk_add_f32 v[160:161], v[160:161], v[16:17]
    v_pk_add_f32 v[162:163], v[162:163], v[18:19]
    v_pk_add_f32 v[164:165], v[164:165], v[20:21]
    v_pk_add_f32 v[166:167], v[166:167], v[22:23]
    v_lshlrev_b32 v24, 16, v108
    v_and_b32 v25, s61, v108
    v_lshlrev_b32 v26, 16, v109
    v_and_b32 v27, s61, v109
    v_lshlrev_b32 v28, 16, v110
    v_and_b32 v29, s61, v110
    v_lshlrev_b32 v30, 16, v111
    v_and_b32 v31, s61, v111
    v_pk_add_f32 v[160:161], v[160:161], v[24:25]
    v_pk_add_f32 v[162:163], v[162:163], v[26:27]
    v_pk_add_f32 v[164:165], v[164:165], v[28:29]
    v_pk_add_f32 v[166:167], v[166:167], v[30:31]
    v_pk_mul_f32 v[160:161], v[160:161], v[208:209]
    v_pk_mul_f32 v[162:163], v[162:163], v[210:211]
    v_pk_mul_f32 v[164:165], v[164:165], v[212:213]
    v_pk_mul_f32 v[166:167], v[166:167], v[214:215]
    v_cvt_pk_bf16_f32 v160, v160, v161
    v_cvt_pk_bf16_f32 v161, v162, v163
    v_cvt_pk_bf16_f32 v162, v164, v165
    v_cvt_pk_bf16_f32 v163, v166, v167
    ds_write_b64 v78, v[160:161] offset:0
    ds_write_b64 v78, v[162:163] offset:4608
    v_lshlrev_b32 v168, 16, v112
    v_and_b32 v169, s61, v112
    v_lshlrev_b32 v170, 16, v113
    v_and_b32 v171, s61, v113
    v_lshlrev_b32 v172, 16, v114
    v_and_b32 v173, s61, v114
    v_lshlrev_b32 v174, 16, v115
    v_and_b32 v175, s61, v115
    v_lshlrev_b32 v24, 16, v116
    v_and_b32 v25, s61, v116
    v_lshlrev_b32 v26, 16, v117
    v_and_b32 v27, s61, v117
    v_lshlrev_b32 v28, 16, v118
    v_and_b32 v29, s61, v118
    v_lshlrev_b32 v30, 16, v119
    v_and_b32 v31, s61, v119
    v_pk_add_f32 v[168:169], v[168:169], v[24:25]
    v_pk_add_f32 v[170:171], v[170:171], v[26:27]
    v_pk_add_f32 v[172:173], v[172:173], v[28:29]
    v_pk_add_f32 v[174:175], v[174:175], v[30:31]
    v_lshlrev_b32 v16, 16, v120
    v_and_b32 v17, s61, v120
    v_lshlrev_b32 v18, 16, v121
    v_and_b32 v19, s61, v121
    v_lshlrev_b32 v20, 16, v122
    v_and_b32 v21, s61, v122
    v_lshlrev_b32 v22, 16, v123
    v_and_b32 v23, s61, v123
    v_pk_add_f32 v[168:169], v[168:169], v[16:17]
    v_pk_add_f32 v[170:171], v[170:171], v[18:19]
    v_pk_add_f32 v[172:173], v[172:173], v[20:21]
    v_pk_add_f32 v[174:175], v[174:175], v[22:23]
    v_lshlrev_b32 v24, 16, v124
    v_and_b32 v25, s61, v124
    v_lshlrev_b32 v26, 16, v125
    v_and_b32 v27, s61, v125
    v_lshlrev_b32 v28, 16, v126
    v_and_b32 v29, s61, v126
    v_lshlrev_b32 v30, 16, v127
    v_and_b32 v31, s61, v127
    v_pk_add_f32 v[168:169], v[168:169], v[24:25]
    v_pk_add_f32 v[170:171], v[170:171], v[26:27]
    v_pk_add_f32 v[172:173], v[172:173], v[28:29]
    v_pk_add_f32 v[174:175], v[174:175], v[30:31]
    v_pk_mul_f32 v[168:169], v[168:169], v[216:217]
    v_pk_mul_f32 v[170:171], v[170:171], v[218:219]
    v_pk_mul_f32 v[172:173], v[172:173], v[220:221]
    v_pk_mul_f32 v[174:175], v[174:175], v[222:223]
    v_cvt_pk_bf16_f32 v168, v168, v169
    v_cvt_pk_bf16_f32 v169, v170, v171
    v_cvt_pk_bf16_f32 v170, v172, v173
    v_cvt_pk_bf16_f32 v171, v174, v175
    ds_write_b64 v78, v[168:169] offset:128
    ds_write_b64 v78, v[170:171] offset:4736
    v_lshlrev_b32 v176, 16, v128
    v_and_b32 v177, s61, v128
    v_lshlrev_b32 v178, 16, v129
    v_and_b32 v179, s61, v129
    v_lshlrev_b32 v180, 16, v130
    v_and_b32 v181, s61, v130
    v_lshlrev_b32 v182, 16, v131
    v_and_b32 v183, s61, v131
    v_lshlrev_b32 v24, 16, v132
    v_and_b32 v25, s61, v132
    v_lshlrev_b32 v26, 16, v133
    v_and_b32 v27, s61, v133
    v_lshlrev_b32 v28, 16, v134
    v_and_b32 v29, s61, v134
    v_lshlrev_b32 v30, 16, v135
    v_and_b32 v31, s61, v135
    v_pk_add_f32 v[176:177], v[176:177], v[24:25]
    v_pk_add_f32 v[178:179], v[178:179], v[26:27]
    v_pk_add_f32 v[180:181], v[180:181], v[28:29]
    v_pk_add_f32 v[182:183], v[182:183], v[30:31]
    v_lshlrev_b32 v16, 16, v136
    v_and_b32 v17, s61, v136
    v_lshlrev_b32 v18, 16, v137
    v_and_b32 v19, s61, v137
    v_lshlrev_b32 v20, 16, v138
    v_and_b32 v21, s61, v138
    v_lshlrev_b32 v22, 16, v139
    v_and_b32 v23, s61, v139
    v_pk_add_f32 v[176:177], v[176:177], v[16:17]
    v_pk_add_f32 v[178:179], v[178:179], v[18:19]
    v_pk_add_f32 v[180:181], v[180:181], v[20:21]
    v_pk_add_f32 v[182:183], v[182:183], v[22:23]
    v_lshlrev_b32 v24, 16, v140
    v_and_b32 v25, s61, v140
    v_lshlrev_b32 v26, 16, v141
    v_and_b32 v27, s61, v141
    v_lshlrev_b32 v28, 16, v142
    v_and_b32 v29, s61, v142
    v_lshlrev_b32 v30, 16, v143
    v_and_b32 v31, s61, v143
    v_pk_add_f32 v[176:177], v[176:177], v[24:25]
    v_pk_add_f32 v[178:179], v[178:179], v[26:27]
    v_pk_add_f32 v[180:181], v[180:181], v[28:29]
    v_pk_add_f32 v[182:183], v[182:183], v[30:31]
    v_pk_mul_f32 v[176:177], v[176:177], v[224:225]
    v_pk_mul_f32 v[178:179], v[178:179], v[226:227]
    v_pk_mul_f32 v[180:181], v[180:181], v[228:229]
    v_pk_mul_f32 v[182:183], v[182:183], v[230:231]
    v_cvt_pk_bf16_f32 v176, v176, v177
    v_cvt_pk_bf16_f32 v177, v178, v179
    v_cvt_pk_bf16_f32 v178, v180, v181
    v_cvt_pk_bf16_f32 v179, v182, v183
    ds_write_b64 v79, v[176:177] offset:256
    ds_write_b64 v79, v[178:179] offset:4864
    s_waitcnt lgkmcnt(0)
    s_barrier
    ds_read_b128 v[128:131], v80 offset:0
    ds_read_b128 v[132:135], v80 offset:4096
    ds_read_b128 v[136:139], v80 offset:8192
    s_waitcnt lgkmcnt(2)
    v_lshlrev_b32 v96, 16, v128
    v_and_b32 v97, s61, v128
    v_lshlrev_b32 v98, 16, v129
    v_and_b32 v99, s61, v129
    v_lshlrev_b32 v100, 16, v130
    v_and_b32 v101, s61, v130
    v_lshlrev_b32 v102, 16, v131
    v_and_b32 v103, s61, v131
    v_pk_add_f32 v[96:97], v[96:97], v[32:33]
    v_pk_add_f32 v[98:99], v[98:99], v[34:35]
    v_pk_add_f32 v[100:101], v[100:101], v[36:37]
    v_pk_add_f32 v[102:103], v[102:103], v[38:39]
    v_cvt_pk_bf16_f32 v96, v96, v97
    v_cvt_pk_bf16_f32 v97, v98, v99
    v_cvt_pk_bf16_f32 v98, v100, v101
    v_cvt_pk_bf16_f32 v99, v102, v103
    buffer_store_dwordx4 v[96:99], v68, s[16:19], s60 offen
    s_waitcnt lgkmcnt(1)
    v_lshlrev_b32 v104, 16, v132
    v_and_b32 v105, s61, v132
    v_lshlrev_b32 v106, 16, v133
    v_and_b32 v107, s61, v133
    v_lshlrev_b32 v108, 16, v134
    v_and_b32 v109, s61, v134
    v_lshlrev_b32 v110, 16, v135
    v_and_b32 v111, s61, v135
    v_pk_add_f32 v[104:105], v[104:105], v[40:41]
    v_pk_add_f32 v[106:107], v[106:107], v[42:43]
    v_pk_add_f32 v[108:109], v[108:109], v[44:45]
    v_pk_add_f32 v[110:111], v[110:111], v[46:47]
    v_cvt_pk_bf16_f32 v104, v104, v105
    v_cvt_pk_bf16_f32 v105, v106, v107
    v_cvt_pk_bf16_f32 v106, v108, v109
    v_cvt_pk_bf16_f32 v107, v110, v111
    buffer_store_dwordx4 v[104:107], v69, s[16:19], s60 offen
    s_waitcnt lgkmcnt(0)
    v_lshlrev_b32 v112, 16, v136
    v_and_b32 v113, s61, v136
    v_lshlrev_b32 v114, 16, v137
    v_and_b32 v115, s61, v137
    v_lshlrev_b32 v116, 16, v138
    v_and_b32 v117, s61, v138
    v_lshlrev_b32 v118, 16, v139
    v_and_b32 v119, s61, v139
    v_pk_add_f32 v[112:113], v[112:113], v[48:49]
    v_pk_add_f32 v[114:115], v[114:115], v[50:51]
    v_pk_add_f32 v[116:117], v[116:117], v[52:53]
    v_pk_add_f32 v[118:119], v[118:119], v[54:55]
    v_cvt_pk_bf16_f32 v112, v112, v113
    v_cvt_pk_bf16_f32 v113, v114, v115
    v_cvt_pk_bf16_f32 v114, v116, v117
    v_cvt_pk_bf16_f32 v115, v118, v119
    buffer_store_dwordx4 v[112:115], v70, s[16:19], s60 offen
    s_lshl_b32 s44, s2, 12
    v_mov_b32 v4, 0
    v_mov_b32 v5, 0
    buffer_store_dwordx2 v[4:5], v4, s[32:35], s44 offen sc1
L_done:
    s_endpgm
L_rare_stubl0:
    s_call_b64 s[50:51], L_rare0
    s_branch L_rare_retl0
L_rare_stubl1:
    s_call_b64 s[50:51], L_rare1
    s_branch L_rare_retl1
L_rare_stubl2:
    s_call_b64 s[50:51], L_rare0
    s_branch L_rare_retl2
L_rare_stubl3:
    s_call_b64 s[50:51], L_rare1
    s_branch L_rare_retl3
L_rare_stubz0:
    s_call_b64 s[50:51], L_rare0
    s_branch L_rare_retz0
L_rare_stubz1:
    s_call_b64 s[50:51], L_rare1
    s_branch L_rare_retz1
L_rare_stubz2:
    s_call_b64 s[50:51], L_rare0
    s_branch L_rare_retz2
L_rare_stubz3:
    s_call_b64 s[50:51], L_rareZ
    s_branch L_rare_retz3
L_stub_p2:
    s_call_b64 s[50:51], L_spin0
    s_branch L_ret_p2
L_stub_p3:
    s_call_b64 s[50:51], L_spin0
    s_branch L_ret_p3
L_stub_p4:
    s_call_b64 s[50:51], L_spin0
    s_branch L_ret_p4
L_stub_w2:
    buffer_wbl2 sc1
    s_waitcnt vmcnt(0)
    s_branch L_ret_w2
L_stub_w3:
    buffer_wbl2 sc1
    s_waitcnt vmcnt(0)
    s_branch L_ret_w3
L_spin0:
    s_mov_b32 s75, 0x40000
L_spin1:
    buffer_load_dwordx2 v[4:5], v8, s[28:31], s73 offen sc1
    s_sub_u32 s76, s74, s79
    s_add_u32 s76, s76, 8
    s_waitcnt vmcnt(0)
    v_and_b32 v4, 0xffffff87, v4
    v_xor_b32 v5, s68, v5
    v_subrev_u32 v4, s79, v4
    v_min_u32 v5, 1, v5
    v_lshl_or_b32 v4, v5, 8, v4
    v_cmp_le_u32 vcc, s76, v4
    s_cbranch_vccz L_spin2
    s_sub_u32 s75, s75, 1
    s_sleep 1
    s_cmp_lg_u32 s75, 0
    s_cbranch_scc1 L_spin1
L_spin2:
    s_setpc_b64 s[50:51]
L_rare0:
    s_nop 15
    v_max3_f32 v64, v160, v161, v162
    v_max3_f32 v64, v64, v163, v176
    v_max3_f32 v64, v64, v177, v178
    v_max3_f32 v64, v64, v179, v192
    v_max3_f32 v64, v64, v193, v194
    v_max3_f32 v64, v64, v195, v208
    v_max3_f32 v64, v64, v209, v210
    v_max_f32 v64, v64, v211
    v_log_f32 v68, v52
    s_nop 0
    v_max_f32 v64, v64, v68
    v_add_f32 v64, 0x42cc0000, v64
    v_max_f32 v64, 0, v64
    v_max3_f32 v65, v164, v165, v166
    v_max3_f32 v65, v65, v167, v180
    v_max3_f32 v65, v65, v181, v182
    v_max3_f32 v65, v65, v183, v196
    v_max3_f32 v65, v65, v197, v198
    v_max3_f32 v65, v65, v199, v212
    v_max3_f32 v65, v65, v213, v214
    v_max_f32 v65, v65, v215
    v_log_f32 v68, v53
    s_nop 0
    v_max_f32 v65, v65, v68
    v_add_f32 v65, 0x42cc0000, v65
    v_max_f32 v65, 0, v65
    v_max3_f32 v66, v168, v169, v170
    v_max3_f32 v66, v66, v171, v184
    v_max3_f32 v66, v66, v185, v186
    v_max3_f32 v66, v66, v187, v200
    v_max3_f32 v66, v66, v201, v202
    v_max3_f32 v66, v66, v203, v216
    v_max3_f32 v66, v66, v217, v218
    v_max_f32 v66, v66, v219
    v_log_f32 v68, v54
    s_nop 0
    v_max_f32 v66, v66, v68
    v_add_f32 v66, 0x42cc0000, v66
    v_max_f32 v66, 0, v66
    v_max3_f32 v67, v172, v173, v174
    v_max3_f32 v67, v67, v175, v188
    v_max3_f32 v67, v67, v189, v190
    v_max3_f32 v67, v67, v191, v204
    v_max3_f32 v67, v67, v205, v206
    v_max3_f32 v67, v67, v207, v220
    v_max3_f32 v67, v67, v221, v222
    v_max_f32 v67, v67, v223
    v_log_f32 v68, v55
    s_nop 0
    v_max_f32 v67, v67, v68
    v_add_f32 v67, 0x42cc0000, v67
    v_max_f32 v67, 0, v67
    v_mov_b32 v68, v64
    v_mov_b32 v69, v65
    v_mov_b32 v70, v66
    v_mov_b32 v71, v67
    v_permlane32_swap_b32 v64, v68
    v_permlane32_swap_b32 v65, v69
    v_permlane32_swap_b32 v66, v70
    v_permlane32_swap_b32 v67, v71
    v_max_f32 v64, v64, v68
    v_max_f32 v65, v65, v69
    v_max_f32 v66, v66, v70
    v_max_f32 v67, v67, v71
    v_mov_b32 v68, v64
    v_mov_b32 v69, v65
    v_mov_b32 v70, v66
    v_mov_b32 v71, v67
    v_permlane16_swap_b32 v64, v68
    v_permlane16_swap_b32 v65, v69
    v_permlane16_swap_b32 v66, v70
    v_permlane16_swap_b32 v67, v71
    v_max_f32 v64, v64, v68
    v_max_f32 v65, v65, v69
    v_max_f32 v66, v66, v70
    v_max_f32 v67, v67, v71
    v_sub_f32 v68, 0, v64
    v_exp_f32 v68, v68
    v_sub_f32 v69, 0, v65
    v_exp_f32 v69, v69
    v_sub_f32 v70, 0, v66
    v_exp_f32 v70, v70
    v_sub_f32 v71, 0, v67
    v_exp_f32 v71, v71
    s_setreg_imm32_b32 hwreg(HW_REG_MODE, 4, 2), 3
    s_nop 1
    v_mul_f32 v52, v52, v68
    v_sub_f32 v32, v32, v64
    v_sub_f32 v33, v33, v64
    v_sub_f32 v34, v34, v64
    v_sub_f32 v35, v35, v64
    v_sub_f32 v160, v160, v64
    v_sub_f32 v161, v161, v64
    v_sub_f32 v162, v162, v64
    v_sub_f32 v163, v163, v64
    v_sub_f32 v176, v176, v64
    v_sub_f32 v177, v177, v64
    v_sub_f32 v178, v178, v64
    v_sub_f32 v179, v179, v64
    v_sub_f32 v192, v192, v64
    v_sub_f32 v193, v193, v64
    v_sub_f32 v194, v194, v64
    v_sub_f32 v195, v195, v64
    v_sub_f32 v208, v208, v64
    v_sub_f32 v209, v209, v64
    v_sub_f32 v210, v210, v64
    v_sub_f32 v211, v211, v64
    v_sub_f32 v96, v96, v64
    v_sub_f32 v97, v97, v64
    v_sub_f32 v98, v98, v64
    v_sub_f32 v99, v99, v64
    v_sub_f32 v112, v112, v64
    v_sub_f32 v113, v113, v64
    v_sub_f32 v114, v114, v64
    v_sub_f32 v115, v115, v64
    v_sub_f32 v128, v128, v64
    v_sub_f32 v129, v129, v64
    v_sub_f32 v130, v130, v64
    v_sub_f32 v131, v131, v64
    v_sub_f32 v144, v144, v64
    v_sub_f32 v145, v145, v64
    v_sub_f32 v146, v146, v64
    v_sub_f32 v147, v147, v64
    v_accvgpr_read_b32 v56, a128
    v_accvgpr_read_b32 v57, a129
    v_accvgpr_read_b32 v58, a130
    v_accvgpr_read_b32 v59, a131
    v_mul_f32 v56, v56, v68
    v_mul_f32 v57, v57, v68
    v_mul_f32 v58, v58, v68
    v_mul_f32 v59, v59, v68
    v_accvgpr_write_b32 a128, v56
    v_accvgpr_write_b32 a129, v57
    v_accvgpr_write_b32 a130, v58
    v_accvgpr_write_b32 a131, v59
    v_accvgpr_read_b32 v56, a144
    v_accvgpr_read_b32 v57, a145
    v_accvgpr_read_b32 v58, a146
    v_accvgpr_read_b32 v59, a147
    v_mul_f32 v56, v56, v68
    v_mul_f32 v57, v57, v68
    v_mul_f32 v58, v58, v68
    v_mul_f32 v59, v59, v68
    v_accvgpr_write_b32 a144, v56
    v_accvgpr_write_b32 a145, v57
    v_accvgpr_write_b32 a146, v58
    v_accvgpr_write_b32 a147, v59
    v_accvgpr_read_b32 v56, a160
    v_accvgpr_read_b32 v57, a161
    v_accvgpr_read_b32 v58, a162
    v_accvgpr_read_b32 v59, a163
    v_mul_f32 v56, v56, v68
    v_mul_f32 v57, v57, v68
    v_mul_f32 v58, v58, v68
    v_mul_f32 v59, v59, v68
    v_accvgpr_write_b32 a160, v56
    v_accvgpr_write_b32 a161, v57
    v_accvgpr_write_b32 a162, v58
    v_accvgpr_write_b32 a163, v59
    v_accvgpr_read_b32 v56, a176
    v_accvgpr_read_b32 v57, a177
    v_accvgpr_read_b32 v58, a178
    v_accvgpr_read_b32 v59, a179
    v_mul_f32 v56, v56, v68
    v_mul_f32 v57, v57, v68
    v_mul_f32 v58, v58, v68
    v_mul_f32 v59, v59, v68
    v_accvgpr_write_b32 a176, v56
    v_accvgpr_write_b32 a177, v57
    v_accvgpr_write_b32 a178, v58
    v_accvgpr_write_b32 a179, v59
    v_accvgpr_read_b32 v56, a192
    v_accvgpr_read_b32 v57, a193
    v_accvgpr_read_b32 v58, a194
    v_accvgpr_read_b32 v59, a195
    v_mul_f32 v56, v56, v68
    v_mul_f32 v57, v57, v68
    v_mul_f32 v58, v58, v68
    v_mul_f32 v59, v59, v68
    v_accvgpr_write_b32 a192, v56
    v_accvgpr_write_b32 a193, v57
    v_accvgpr_write_b32 a194, v58
    v_accvgpr_write_b32 a195, v59
    v_accvgpr_read_b32 v56, a208
    v_accvgpr_read_b32 v57, a209
    v_accvgpr_read_b32 v58, a210
    v_accvgpr_read_b32 v59, a211
    v_mul_f32 v56, v56, v68
    v_mul_f32 v57, v57, v68
    v_mul_f32 v58, v58, v68
    v_mul_f32 v59, v59, v68
    v_accvgpr_write_b32 a208, v56
    v_accvgpr_write_b32 a209, v57
    v_accvgpr_write_b32 a210, v58
    v_accvgpr_write_b32 a211, v59
    v_accvgpr_read_b32 v56, a224
    v_accvgpr_read_b32 v57, a225
    v_accvgpr_read_b32 v58, a226
    v_accvgpr_read_b32 v59, a227
    v_mul_f32 v56, v56, v68
    v_mul_f32 v57, v57, v68
    v_mul_f32 v58, v58, v68
    v_mul_f32 v59, v59, v68
    v_accvgpr_write_b32 a224, v56
    v_accvgpr_write_b32 a225, v57
    v_accvgpr_write_b32 a226, v58
    v_accvgpr_write_b32 a227, v59
    v_accvgpr_read_b32 v56, a240
    v_accvgpr_read_b32 v57, a241
    v_accvgpr_read_b32 v58, a242
    v_accvgpr_read_b32 v59, a243
    v_mul_f32 v56, v56, v68
    v_mul_f32 v57, v57, v68
    v_mul_f32 v58, v58, v68
    v_mul_f32 v59, v59, v68
    v_accvgpr_write_b32 a240, v56
    v_accvgpr_write_b32 a241, v57
    v_accvgpr_write_b32 a242, v58
    v_accvgpr_write_b32 a243, v59
    v_mul_f32 v53, v53, v69
    v_sub_f32 v36, v36, v65
    v_sub_f32 v37, v37, v65
    v_sub_f32 v38, v38, v65
    v_sub_f32 v39, v39, v65
    v_sub_f32 v164, v164, v65
    v_sub_f32 v165, v165, v65
    v_sub_f32 v166, v166, v65
    v_sub_f32 v167, v167, v65
    v_sub_f32 v180, v180, v65
    v_sub_f32 v181, v181, v65
    v_sub_f32 v182, v182, v65
    v_sub_f32 v183, v183, v65
    v_sub_f32 v196, v196, v65
    v_sub_f32 v197, v197, v65
    v_sub_f32 v198, v198, v65
    v_sub_f32 v199, v199, v65
    v_sub_f32 v212, v212, v65
    v_sub_f32 v213, v213, v65
    v_sub_f32 v214, v214, v65
    v_sub_f32 v215, v215, v65
    v_sub_f32 v100, v100, v65
    v_sub_f32 v101, v101, v65
    v_sub_f32 v102, v102, v65
    v_sub_f32 v103, v103, v65
    v_sub_f32 v116, v116, v65
    v_sub_f32 v117, v117, v65
    v_sub_f32 v118, v118, v65
    v_sub_f32 v119, v119, v65
    v_sub_f32 v132, v132, v65
    v_sub_f32 v133, v133, v65
    v_sub_f32 v134, v134, v65
    v_sub_f32 v135, v135, v65
    v_sub_f32 v148, v148, v65
    v_sub_f32 v149, v149, v65
    v_sub_f32 v150, v150, v65
    v_sub_f32 v151, v151, v65
    v_accvgpr_read_b32 v56, a132
    v_accvgpr_read_b32 v57, a133
    v_accvgpr_read_b32 v58, a134
    v_accvgpr_read_b32 v59, a135
    v_mul_f32 v56, v56, v69
    v_mul_f32 v57, v57, v69
    v_mul_f32 v58, v58, v69
    v_mul_f32 v59, v59, v69
    v_accvgpr_write_b32 a132, v56
    v_accvgpr_write_b32 a133, v57
    v_accvgpr_write_b32 a134, v58
    v_accvgpr_write_b32 a135, v59
    v_accvgpr_read_b32 v56, a148
    v_accvgpr_read_b32 v57, a149
    v_accvgpr_read_b32 v58, a150
    v_accvgpr_read_b32 v59, a151
    v_mul_f32 v56, v56, v69
    v_mul_f32 v57, v57, v69
    v_mul_f32 v58, v58, v69
    v_mul_f32 v59, v59, v69
    v_accvgpr_write_b32 a148, v56
    v_accvgpr_write_b32 a149, v57
    v_accvgpr_write_b32 a150, v58
    v_accvgpr_write_b32 a151, v59
    v_accvgpr_read_b32 v56, a164
    v_accvgpr_read_b32 v57, a165
    v_accvgpr_read_b32 v58, a166
    v_accvgpr_read_b32 v59, a167
    v_mul_f32 v56, v56, v69
    v_mul_f32 v57, v57, v69
    v_mul_f32 v58, v58, v69
    v_mul_f32 v59, v59, v69
    v_accvgpr_write_b32 a164, v56
    v_accvgpr_write_b32 a165, v57
    v_accvgpr_write_b32 a166, v58
    v_accvgpr_write_b32 a167, v59
    v_accvgpr_read_b32 v56, a180
    v_accvgpr_read_b32 v57, a181
    v_accvgpr_read_b32 v58, a182
    v_accvgpr_read_b32 v59, a183
    v_mul_f32 v56, v56, v69
    v_mul_f32 v57, v57, v69
    v_mul_f32 v58, v58, v69
    v_mul_f32 v59, v59, v69
    v_accvgpr_write_b32 a180, v56
    v_accvgpr_write_b32 a181, v57
    v_accvgpr_write_b32 a182, v58
    v_accvgpr_write_b32 a183, v59
    v_accvgpr_read_b32 v56, a196
    v_accvgpr_read_b32 v57, a197
    v_accvgpr_read_b32 v58, a198
    v_accvgpr_read_b32 v59, a199
    v_mul_f32 v56, v56, v69
    v_mul_f32 v57, v57, v69
    v_mul_f32 v58, v58, v69
    v_mul_f32 v59, v59, v69
    v_accvgpr_write_b32 a196, v56
    v_accvgpr_write_b32 a197, v57
    v_accvgpr_write_b32 a198, v58
    v_accvgpr_write_b32 a199, v59
    v_accvgpr_read_b32 v56, a212
    v_accvgpr_read_b32 v57, a213
    v_accvgpr_read_b32 v58, a214
    v_accvgpr_read_b32 v59, a215
    v_mul_f32 v56, v56, v69
    v_mul_f32 v57, v57, v69
    v_mul_f32 v58, v58, v69
    v_mul_f32 v59, v59, v69
    v_accvgpr_write_b32 a212, v56
    v_accvgpr_write_b32 a213, v57
    v_accvgpr_write_b32 a214, v58
    v_accvgpr_write_b32 a215, v59
    v_accvgpr_read_b32 v56, a228
    v_accvgpr_read_b32 v57, a229
    v_accvgpr_read_b32 v58, a230
    v_accvgpr_read_b32 v59, a231
    v_mul_f32 v56, v56, v69
    v_mul_f32 v57, v57, v69
    v_mul_f32 v58, v58, v69
    v_mul_f32 v59, v59, v69
    v_accvgpr_write_b32 a228, v56
    v_accvgpr_write_b32 a229, v57
    v_accvgpr_write_b32 a230, v58
    v_accvgpr_write_b32 a231, v59
    v_accvgpr_read_b32 v56, a244
    v_accvgpr_read_b32 v57, a245
    v_accvgpr_read_b32 v58, a246
    v_accvgpr_read_b32 v59, a247
    v_mul_f32 v56, v56, v69
    v_mul_f32 v57, v57, v69
    v_mul_f32 v58, v58, v69
    v_mul_f32 v59, v59, v69
    v_accvgpr_write_b32 a244, v56
    v_accvgpr_write_b32 a245, v57
    v_accvgpr_write_b32 a246, v58
    v_accvgpr_write_b32 a247, v59
    v_mul_f32 v54, v54, v70
    v_sub_f32 v40, v40, v66
    v_sub_f32 v41, v41, v66
    v_sub_f32 v42, v42, v66
    v_sub_f32 v43, v43, v66
    v_sub_f32 v168, v168, v66
    v_sub_f32 v169, v169, v66
    v_sub_f32 v170, v170, v66
    v_sub_f32 v171, v171, v66
    v_sub_f32 v184, v184, v66
    v_sub_f32 v185, v185, v66
    v_sub_f32 v186, v186, v66
    v_sub_f32 v187, v187, v66
    v_sub_f32 v200, v200, v66
    v_sub_f32 v201, v201, v66
    v_sub_f32 v202, v202, v66
    v_sub_f32 v203, v203, v66
    v_sub_f32 v216, v216, v66
    v_sub_f32 v217, v217, v66
    v_sub_f32 v218, v218, v66
    v_sub_f32 v219, v219, v66
    v_sub_f32 v104, v104, v66
    v_sub_f32 v105, v105, v66
    v_sub_f32 v106, v106, v66
    v_sub_f32 v107, v107, v66
    v_sub_f32 v120, v120, v66
    v_sub_f32 v121, v121, v66
    v_sub_f32 v122, v122, v66
    v_sub_f32 v123, v123, v66
    v_sub_f32 v136, v136, v66
    v_sub_f32 v137, v137, v66
    v_sub_f32 v138, v138, v66
    v_sub_f32 v139, v139, v66
    v_sub_f32 v152, v152, v66
    v_sub_f32 v153, v153, v66
    v_sub_f32 v154, v154, v66
    v_sub_f32 v155, v155, v66
    v_accvgpr_read_b32 v56, a136
    v_accvgpr_read_b32 v57, a137
    v_accvgpr_read_b32 v58, a138
    v_accvgpr_read_b32 v59, a139
    v_mul_f32 v56, v56, v70
    v_mul_f32 v57, v57, v70
    v_mul_f32 v58, v58, v70
    v_mul_f32 v59, v59, v70
    v_accvgpr_write_b32 a136, v56
    v_accvgpr_write_b32 a137, v57
    v_accvgpr_write_b32 a138, v58
    v_accvgpr_write_b32 a139, v59
    v_accvgpr_read_b32 v56, a152
    v_accvgpr_read_b32 v57, a153
    v_accvgpr_read_b32 v58, a154
    v_accvgpr_read_b32 v59, a155
    v_mul_f32 v56, v56, v70
    v_mul_f32 v57, v57, v70
    v_mul_f32 v58, v58, v70
    v_mul_f32 v59, v59, v70
    v_accvgpr_write_b32 a152, v56
    v_accvgpr_write_b32 a153, v57
    v_accvgpr_write_b32 a154, v58
    v_accvgpr_write_b32 a155, v59
    v_accvgpr_read_b32 v56, a168
    v_accvgpr_read_b32 v57, a169
    v_accvgpr_read_b32 v58, a170
    v_accvgpr_read_b32 v59, a171
    v_mul_f32 v56, v56, v70
    v_mul_f32 v57, v57, v70
    v_mul_f32 v58, v58, v70
    v_mul_f32 v59, v59, v70
    v_accvgpr_write_b32 a168, v56
    v_accvgpr_write_b32 a169, v57
    v_accvgpr_write_b32 a170, v58
    v_accvgpr_write_b32 a171, v59
    v_accvgpr_read_b32 v56, a184
    v_accvgpr_read_b32 v57, a185
    v_accvgpr_read_b32 v58, a186
    v_accvgpr_read_b32 v59, a187
    v_mul_f32 v56, v56, v70
    v_mul_f32 v57, v57, v70
    v_mul_f32 v58, v58, v70
    v_mul_f32 v59, v59, v70
    v_accvgpr_write_b32 a184, v56
    v_accvgpr_write_b32 a185, v57
    v_accvgpr_write_b32 a186, v58
    v_accvgpr_write_b32 a187, v59
    v_accvgpr_read_b32 v56, a200
    v_accvgpr_read_b32 v57, a201
    v_accvgpr_read_b32 v58, a202
    v_accvgpr_read_b32 v59, a203
    v_mul_f32 v56, v56, v70
    v_mul_f32 v57, v57, v70
    v_mul_f32 v58, v58, v70
    v_mul_f32 v59, v59, v70
    v_accvgpr_write_b32 a200, v56
    v_accvgpr_write_b32 a201, v57
    v_accvgpr_write_b32 a202, v58
    v_accvgpr_write_b32 a203, v59
    v_accvgpr_read_b32 v56, a216
    v_accvgpr_read_b32 v57, a217
    v_accvgpr_read_b32 v58, a218
    v_accvgpr_read_b32 v59, a219
    v_mul_f32 v56, v56, v70
    v_mul_f32 v57, v57, v70
    v_mul_f32 v58, v58, v70
    v_mul_f32 v59, v59, v70
    v_accvgpr_write_b32 a216, v56
    v_accvgpr_write_b32 a217, v57
    v_accvgpr_write_b32 a218, v58
    v_accvgpr_write_b32 a219, v59
    v_accvgpr_read_b32 v56, a232
    v_accvgpr_read_b32 v57, a233
    v_accvgpr_read_b32 v58, a234
    v_accvgpr_read_b32 v59, a235
    v_mul_f32 v56, v56, v70
    v_mul_f32 v57, v57, v70
    v_mul_f32 v58, v58, v70
    v_mul_f32 v59, v59, v70
    v_accvgpr_write_b32 a232, v56
    v_accvgpr_write_b32 a233, v57
    v_accvgpr_write_b32 a234, v58
    v_accvgpr_write_b32 a235, v59
    v_accvgpr_read_b32 v56, a248
    v_accvgpr_read_b32 v57, a249
    v_accvgpr_read_b32 v58, a250
    v_accvgpr_read_b32 v59, a251
    v_mul_f32 v56, v56, v70
    v_mul_f32 v57, v57, v70
    v_mul_f32 v58, v58, v70
    v_mul_f32 v59, v59, v70
    v_accvgpr_write_b32 a248, v56
    v_accvgpr_write_b32 a249, v57
    v_accvgpr_write_b32 a250, v58
    v_accvgpr_write_b32 a251, v59
    v_mul_f32 v55, v55, v71
    v_sub_f32 v44, v44, v67
    v_sub_f32 v45, v45, v67
    v_sub_f32 v46, v46, v67
    v_sub_f32 v47, v47, v67
    v_sub_f32 v172, v172, v67
    v_sub_f32 v173, v173, v67
    v_sub_f32 v174, v174, v67
    v_sub_f32 v175, v175, v67
    v_sub_f32 v188, v188, v67
    v_sub_f32 v189, v189, v67
    v_sub_f32 v190, v190, v67
    v_sub_f32 v191, v191, v67
    v_sub_f32 v204, v204, v67
    v_sub_f32 v205, v205, v67
    v_sub_f32 v206, v206, v67
    v_sub_f32 v207, v207, v67
    v_sub_f32 v220, v220, v67
    v_sub_f32 v221, v221, v67
    v_sub_f32 v222, v222, v67
    v_sub_f32 v223, v223, v67
    v_sub_f32 v108, v108, v67
    v_sub_f32 v109, v109, v67
    v_sub_f32 v110, v110, v67
    v_sub_f32 v111, v111, v67
    v_sub_f32 v124, v124, v67
    v_sub_f32 v125, v125, v67
    v_sub_f32 v126, v126, v67
    v_sub_f32 v127, v127, v67
    v_sub_f32 v140, v140, v67
    v_sub_f32 v141, v141, v67
    v_sub_f32 v142, v142, v67
    v_sub_f32 v143, v143, v67
    v_sub_f32 v156, v156, v67
    v_sub_f32 v157, v157, v67
    v_sub_f32 v158, v158, v67
    v_sub_f32 v159, v159, v67
    v_accvgpr_read_b32 v56, a140
    v_accvgpr_read_b32 v57, a141
    v_accvgpr_read_b32 v58, a142
    v_accvgpr_read_b32 v59, a143
    v_mul_f32 v56, v56, v71
    v_mul_f32 v57, v57, v71
    v_mul_f32 v58, v58, v71
    v_mul_f32 v59, v59, v71
    v_accvgpr_write_b32 a140, v56
    v_accvgpr_write_b32 a141, v57
    v_accvgpr_write_b32 a142, v58
    v_accvgpr_write_b32 a143, v59
    v_accvgpr_read_b32 v56, a156
    v_accvgpr_read_b32 v57, a157
    v_accvgpr_read_b32 v58, a158
    v_accvgpr_read_b32 v59, a159
    v_mul_f32 v56, v56, v71
    v_mul_f32 v57, v57, v71
    v_mul_f32 v58, v58, v71
    v_mul_f32 v59, v59, v71
    v_accvgpr_write_b32 a156, v56
    v_accvgpr_write_b32 a157, v57
    v_accvgpr_write_b32 a158, v58
    v_accvgpr_write_b32 a159, v59
    v_accvgpr_read_b32 v56, a172
    v_accvgpr_read_b32 v57, a173
    v_accvgpr_read_b32 v58, a174
    v_accvgpr_read_b32 v59, a175
    v_mul_f32 v56, v56, v71
    v_mul_f32 v57, v57, v71
    v_mul_f32 v58, v58, v71
    v_mul_f32 v59, v59, v71
    v_accvgpr_write_b32 a172, v56
    v_accvgpr_write_b32 a173, v57
    v_accvgpr_write_b32 a174, v58
    v_accvgpr_write_b32 a175, v59
    v_accvgpr_read_b32 v56, a188
    v_accvgpr_read_b32 v57, a189
    v_accvgpr_read_b32 v58, a190
    v_accvgpr_read_b32 v59, a191
    v_mul_f32 v56, v56, v71
    v_mul_f32 v57, v57, v71
    v_mul_f32 v58, v58, v71
    v_mul_f32 v59, v59, v71
    v_accvgpr_write_b32 a188, v56
    v_accvgpr_write_b32 a189, v57
    v_accvgpr_write_b32 a190, v58
    v_accvgpr_write_b32 a191, v59
    v_accvgpr_read_b32 v56, a204
    v_accvgpr_read_b32 v57, a205
    v_accvgpr_read_b32 v58, a206
    v_accvgpr_read_b32 v59, a207
    v_mul_f32 v56, v56, v71
    v_mul_f32 v57, v57, v71
    v_mul_f32 v58, v58, v71
    v_mul_f32 v59, v59, v71
    v_accvgpr_write_b32 a204, v56
    v_accvgpr_write_b32 a205, v57
    v_accvgpr_write_b32 a206, v58
    v_accvgpr_write_b32 a207, v59
    v_accvgpr_read_b32 v56, a220
    v_accvgpr_read_b32 v57, a221
    v_accvgpr_read_b32 v58, a222
    v_accvgpr_read_b32 v59, a223
    v_mul_f32 v56, v56, v71
    v_mul_f32 v57, v57, v71
    v_mul_f32 v58, v58, v71
    v_mul_f32 v59, v59, v71
    v_accvgpr_write_b32 a220, v56
    v_accvgpr_write_b32 a221, v57
    v_accvgpr_write_b32 a222, v58
    v_accvgpr_write_b32 a223, v59
    v_accvgpr_read_b32 v56, a236
    v_accvgpr_read_b32 v57, a237
    v_accvgpr_read_b32 v58, a238
    v_accvgpr_read_b32 v59, a239
    v_mul_f32 v56, v56, v71
    v_mul_f32 v57, v57, v71
    v_mul_f32 v58, v58, v71
    v_mul_f32 v59, v59, v71
    v_accvgpr_write_b32 a236, v56
    v_accvgpr_write_b32 a237, v57
    v_accvgpr_write_b32 a238, v58
    v_accvgpr_write_b32 a239, v59
    v_accvgpr_read_b32 v56, a252
    v_accvgpr_read_b32 v57, a253
    v_accvgpr_read_b32 v58, a254
    v_accvgpr_read_b32 v59, a255
    v_mul_f32 v56, v56, v71
    v_mul_f32 v57, v57, v71
    v_mul_f32 v58, v58, v71
    v_mul_f32 v59, v59, v71
    v_accvgpr_write_b32 a252, v56
    v_accvgpr_write_b32 a253, v57
    v_accvgpr_write_b32 a254, v58
    v_accvgpr_write_b32 a255, v59
    s_setreg_imm32_b32 hwreg(HW_REG_MODE, 4, 2), 0
    s_nop 1
    v_exp_f32 v56, v160
    v_exp_f32 v57, v161
    s_nop 0
    v_cvt_pk_bf16_f32 v224, v56, v57
    v_exp_f32 v58, v164
    s_nop 0
    v_add_f32 v49, v53, v58
    v_exp_f32 v59, v165
    s_nop 0
    v_add_f32 v49, v49, v59
    v_cvt_pk_bf16_f32 v228, v58, v59
    v_exp_f32 v60, v162
    v_exp_f32 v61, v163
    s_nop 0
    v_cvt_pk_bf16_f32 v225, v60, v61
    v_exp_f32 v62, v166
    s_nop 0
    v_add_f32 v49, v49, v62
    v_exp_f32 v63, v167
    s_nop 0
    v_add_f32 v49, v49, v63
    v_cvt_pk_bf16_f32 v229, v62, v63
    v_exp_f32 v56, v176
    v_exp_f32 v57, v177
    s_nop 0
    v_cvt_pk_bf16_f32 v226, v56, v57
    v_exp_f32 v58, v180
    s_nop 0
    v_add_f32 v49, v49, v58
    v_exp_f32 v59, v181
    s_nop 0
    v_add_f32 v49, v49, v59
    v_cvt_pk_bf16_f32 v230, v58, v59
    v_exp_f32 v60, v178
    v_exp_f32 v61, v179
    s_nop 0
    v_cvt_pk_bf16_f32 v227, v60, v61
    v_exp_f32 v62, v182
    s_nop 0
    v_add_f32 v49, v49, v62
    v_exp_f32 v63, v183
    s_nop 0
    v_add_f32 v49, v49, v63
    v_cvt_pk_bf16_f32 v231, v62, v63
    v_exp_f32 v56, v168
    v_exp_f32 v57, v169
    s_nop 0
    v_cvt_pk_bf16_f32 v232, v56, v57
    v_exp_f32 v58, v172
    s_nop 0
    v_add_f32 v51, v55, v58
    v_exp_f32 v59, v173
    s_nop 0
    v_add_f32 v51, v51, v59
    v_cvt_pk_bf16_f32 v236, v58, v59
    v_exp_f32 v60, v170
    v_exp_f32 v61, v171
    s_nop 0
    v_cvt_pk_bf16_f32 v233, v60, v61
    v_exp_f32 v62, v174
    s_nop 0
    v_add_f32 v51, v51, v62
    v_exp_f32 v63, v175
    s_nop 0
    v_add_f32 v51, v51, v63
    v_cvt_pk_bf16_f32 v237, v62, v63
    v_exp_f32 v56, v184
    v_exp_f32 v57, v185
    s_nop 0
    v_cvt_pk_bf16_f32 v234, v56, v57
    v_exp_f32 v58, v188
    s_nop 0
    v_add_f32 v51, v51, v58
    v_exp_f32 v59, v189
    s_nop 0
    v_add_f32 v51, v51, v59
    v_cvt_pk_bf16_f32 v238, v58, v59
    v_exp_f32 v60, v186
    v_exp_f32 v61, v187
    s_nop 0
    v_cvt_pk_bf16_f32 v235, v60, v61
    v_exp_f32 v62, v190
    s_nop 0
    v_add_f32 v51, v51, v62
    v_exp_f32 v63, v191
    s_nop 0
    v_add_f32 v51, v51, v63
    v_cvt_pk_bf16_f32 v239, v62, v63
    v_exp_f32 v56, v192
    v_exp_f32 v57, v193
    s_nop 0
    v_cvt_pk_bf16_f32 v16, v56, v57
    v_exp_f32 v58, v196
    s_nop 0
    v_add_f32 v49, v49, v58
    v_exp_f32 v59, v197
    s_nop 0
    v_add_f32 v49, v49, v59
    v_cvt_pk_bf16_f32 v20, v58, v59
    v_exp_f32 v60, v194
    v_exp_f32 v61, v195
    s_nop 0
    v_cvt_pk_bf16_f32 v17, v60, v61
    v_exp_f32 v62, v198
    s_nop 0
    v_add_f32 v49, v49, v62
    v_exp_f32 v63, v199
    s_nop 0
    v_add_f32 v49, v49, v63
    v_cvt_pk_bf16_f32 v21, v62, v63
    v_exp_f32 v56, v208
    v_exp_f32 v57, v209
    s_nop 0
    v_cvt_pk_bf16_f32 v18, v56, v57
    v_exp_f32 v58, v212
    s_nop 0
    v_add_f32 v49, v49, v58
    v_exp_f32 v59, v213
    s_nop 0
    v_add_f32 v49, v49, v59
    v_cvt_pk_bf16_f32 v22, v58, v59
    v_exp_f32 v60, v210
    v_exp_f32 v61, v211
    s_nop 0
    v_cvt_pk_bf16_f32 v19, v60, v61
    v_exp_f32 v62, v214
    s_nop 0
    v_add_f32 v49, v49, v62
    v_exp_f32 v63, v215
    s_nop 0
    v_add_f32 v49, v49, v63
    v_cvt_pk_bf16_f32 v23, v62, v63
    v_exp_f32 v56, v200
    v_exp_f32 v57, v201
    s_nop 0
    v_cvt_pk_bf16_f32 v24, v56, v57
    v_exp_f32 v58, v204
    s_nop 0
    v_add_f32 v51, v51, v58
    v_exp_f32 v59, v205
    s_nop 0
    v_add_f32 v51, v51, v59
    v_cvt_pk_bf16_f32 v28, v58, v59
    v_exp_f32 v60, v202
    v_exp_f32 v61, v203
    s_nop 0
    v_cvt_pk_bf16_f32 v25, v60, v61
    v_exp_f32 v62, v206
    s_nop 0
    v_add_f32 v51, v51, v62
    v_exp_f32 v63, v207
    s_nop 0
    v_add_f32 v51, v51, v63
    v_cvt_pk_bf16_f32 v29, v62, v63
    v_exp_f32 v56, v216
    v_exp_f32 v57, v217
    s_nop 0
    v_cvt_pk_bf16_f32 v26, v56, v57
    v_exp_f32 v58, v220
    s_nop 0
    v_add_f32 v51, v51, v58
    v_exp_f32 v59, v221
    s_nop 0
    v_add_f32 v51, v51, v59
    v_cvt_pk_bf16_f32 v30, v58, v59
    v_exp_f32 v60, v218
    v_exp_f32 v61, v219
    s_nop 0
    v_cvt_pk_bf16_f32 v27, v60, v61
    v_exp_f32 v62, v222
    s_nop 0
    v_add_f32 v51, v51, v62
    v_exp_f32 v63, v223
    s_nop 0
    v_add_f32 v51, v51, v63
    v_cvt_pk_bf16_f32 v31, v62, v63
    v_mfma_f32_16x16x32_bf16 v[72:75], v[10:13], v[224:227], 0
    v_mfma_f32_16x16x32_bf16 v[72:75], v[10:13], v[16:19], v[72:75]
    s_nop 7
    v_add_f32 v48, v52, v72
    v_mfma_f32_16x16x32_bf16 v[72:75], v[10:13], v[232:235], 0
    v_mfma_f32_16x16x32_bf16 v[72:75], v[10:13], v[24:27], v[72:75]
    s_nop 7
    v_add_f32 v50, v54, v72
    v_exp_f32 v56, v96
    v_exp_f32 v57, v97
    v_exp_f32 v58, v100
    v_exp_f32 v59, v101
    v_cvt_pk_bf16_f32 v240, v56, v57
    s_nop 3
    s_setpc_b64 s[50:51]
L_rare1:
    s_nop 15
    v_max3_f32 v64, v96, v97, v98
    v_max3_f32 v64, v64, v99, v112
    v_max3_f32 v64, v64, v113, v114
    v_max3_f32 v64, v64, v115, v128
    v_max3_f32 v64, v64, v129, v130
    v_max3_f32 v64, v64, v131, v144
    v_max3_f32 v64, v64, v145, v146
    v_max_f32 v64, v64, v147
    v_log_f32 v68, v48
    s_nop 0
    v_max_f32 v64, v64, v68
    v_add_f32 v64, 0x42cc0000, v64
    v_max_f32 v64, 0, v64
    v_max3_f32 v65, v100, v101, v102
    v_max3_f32 v65, v65, v103, v116
    v_max3_f32 v65, v65, v117, v118
    v_max3_f32 v65, v65, v119, v132
    v_max3_f32 v65, v65, v133, v134
    v_max3_f32 v65, v65, v135, v148
    v_max3_f32 v65, v65, v149, v150
    v_max_f32 v65, v65, v151
    v_log_f32 v68, v49
    s_nop 0
    v_max_f32 v65, v65, v68
    v_add_f32 v65, 0x42cc0000, v65
    v_max_f32 v65, 0, v65
    v_max3_f32 v66, v104, v105, v106
    v_max3_f32 v66, v66, v107, v120
    v_max3_f32 v66, v66, v121, v122
    v_max3_f32 v66, v66, v123, v136
    v_max3_f32 v66, v66, v137, v138
    v_max3_f32 v66, v66, v139, v152
    v_max3_f32 v66, v66, v153, v154
    v_max_f32 v66, v66, v155
    v_log_f32 v68, v50
    s_nop 0
    v_max_f32 v66, v66, v68
    v_add_f32 v66, 0x42cc0000, v66
    v_max_f32 v66, 0, v66
    v_max3_f32 v67, v108, v109, v110
    v_max3_f32 v67, v67, v111, v124
    v_max3_f32 v67, v67, v125, v126
    v_max3_f32 v67, v67, v127, v140
    v_max3_f32 v67, v67, v141, v142
    v_max3_f32 v67, v67, v143, v156
    v_max3_f32 v67, v67, v157, v158
    v_max_f32 v67, v67, v159
    v_log_f32 v68, v51
    s_nop 0
    v_max_f32 v67, v67, v68
    v_add_f32 v67, 0x42cc0000, v67
    v_max_f32 v67, 0, v67
    v_mov_b32 v68, v64
    v_mov_b32 v69, v65
    v_mov_b32 v70, v66
    v_mov_b32 v71, v67
    v_permlane32_swap_b32 v64, v68
    v_permlane32_swap_b32 v65, v69
    v_permlane32_swap_b32 v66, v70
    v_permlane32_swap_b32 v67, v71
    v_max_f32 v64, v64, v68
    v_max_f32 v65, v65, v69
    v_max_f32 v66, v66, v70
    v_max_f32 v67, v67, v71
    v_mov_b32 v68, v64
    v_mov_b32 v69, v65
    v_mov_b32 v70, v66
    v_mov_b32 v71, v67
    v_permlane16_swap_b32 v64, v68
    v_permlane16_swap_b32 v65, v69
    v_permlane16_swap_b32 v66, v70
    v_permlane16_swap_b32 v67, v71
    v_max_f32 v64, v64, v68
    v_max_f32 v65, v65, v69
    v_max_f32 v66, v66, v70
    v_max_f32 v67, v67, v71
    v_sub_f32 v68, 0, v64
    v_exp_f32 v68, v68
    v_sub_f32 v69, 0, v65
    v_exp_f32 v69, v69
    v_sub_f32 v70, 0, v66
    v_exp_f32 v70, v70
    v_sub_f32 v71, 0, v67
    v_exp_f32 v71, v71
    s_setreg_imm32_b32 hwreg(HW_REG_MODE, 4, 2), 3
    s_nop 1
    v_mul_f32 v48, v48, v68
    v_sub_f32 v32, v32, v64
    v_sub_f32 v33, v33, v64
    v_sub_f32 v34, v34, v64
    v_sub_f32 v35, v35, v64
    v_sub_f32 v160, v160, v64
    v_sub_f32 v161, v161, v64
    v_sub_f32 v162, v162, v64
    v_sub_f32 v163, v163, v64
    v_sub_f32 v176, v176, v64
    v_sub_f32 v177, v177, v64
    v_sub_f32 v178, v178, v64
    v_sub_f32 v179, v179, v64
    v_sub_f32 v192, v192, v64
    v_sub_f32 v193, v193, v64
    v_sub_f32 v194, v194, v64
    v_sub_f32 v195, v195, v64
    v_sub_f32 v208, v208, v64
    v_sub_f32 v209, v209, v64
    v_sub_f32 v210, v210, v64
    v_sub_f32 v211, v211, v64
    v_sub_f32 v96, v96, v64
    v_sub_f32 v97, v97, v64
    v_sub_f32 v98, v98, v64
    v_sub_f32 v99, v99, v64
    v_sub_f32 v112, v112, v64
    v_sub_f32 v113, v113, v64
    v_sub_f32 v114, v114, v64
    v_sub_f32 v115, v115, v64
    v_sub_f32 v128, v128, v64
    v_sub_f32 v129, v129, v64
    v_sub_f32 v130, v130, v64
    v_sub_f32 v131, v131, v64
    v_sub_f32 v144, v144, v64
    v_sub_f32 v145, v145, v64
    v_sub_f32 v146, v146, v64
    v_sub_f32 v147, v147, v64
    v_accvgpr_read_b32 v56, a128
    v_accvgpr_read_b32 v57, a129
    v_accvgpr_read_b32 v58, a130
    v_accvgpr_read_b32 v59, a131
    v_mul_f32 v56, v56, v68
    v_mul_f32 v57, v57, v68
    v_mul_f32 v58, v58, v68
    v_mul_f32 v59, v59, v68
    v_accvgpr_write_b32 a128, v56
    v_accvgpr_write_b32 a129, v57
    v_accvgpr_write_b32 a130, v58
    v_accvgpr_write_b32 a131, v59
    v_accvgpr_read_b32 v56, a144
    v_accvgpr_read_b32 v57, a145
    v_accvgpr_read_b32 v58, a146
    v_accvgpr_read_b32 v59, a147
    v_mul_f32 v56, v56, v68
    v_mul_f32 v57, v57, v68
    v_mul_f32 v58, v58, v68
    v_mul_f32 v59, v59, v68
    v_accvgpr_write_b32 a144, v56
    v_accvgpr_write_b32 a145, v57
    v_accvgpr_write_b32 a146, v58
    v_accvgpr_write_b32 a147, v59
    v_accvgpr_read_b32 v56, a160
    v_accvgpr_read_b32 v57, a161
    v_accvgpr_read_b32 v58, a162
    v_accvgpr_read_b32 v59, a163
    v_mul_f32 v56, v56, v68
    v_mul_f32 v57, v57, v68
    v_mul_f32 v58, v58, v68
    v_mul_f32 v59, v59, v68
    v_accvgpr_write_b32 a160, v56
    v_accvgpr_write_b32 a161, v57
    v_accvgpr_write_b32 a162, v58
    v_accvgpr_write_b32 a163, v59
    v_accvgpr_read_b32 v56, a176
    v_accvgpr_read_b32 v57, a177
    v_accvgpr_read_b32 v58, a178
    v_accvgpr_read_b32 v59, a179
    v_mul_f32 v56, v56, v68
    v_mul_f32 v57, v57, v68
    v_mul_f32 v58, v58, v68
    v_mul_f32 v59, v59, v68
    v_accvgpr_write_b32 a176, v56
    v_accvgpr_write_b32 a177, v57
    v_accvgpr_write_b32 a178, v58
    v_accvgpr_write_b32 a179, v59
    v_accvgpr_read_b32 v56, a192
    v_accvgpr_read_b32 v57, a193
    v_accvgpr_read_b32 v58, a194
    v_accvgpr_read_b32 v59, a195
    v_mul_f32 v56, v56, v68
    v_mul_f32 v57, v57, v68
    v_mul_f32 v58, v58, v68
    v_mul_f32 v59, v59, v68
    v_accvgpr_write_b32 a192, v56
    v_accvgpr_write_b32 a193, v57
    v_accvgpr_write_b32 a194, v58
    v_accvgpr_write_b32 a195, v59
    v_accvgpr_read_b32 v56, a208
    v_accvgpr_read_b32 v57, a209
    v_accvgpr_read_b32 v58, a210
    v_accvgpr_read_b32 v59, a211
    v_mul_f32 v56, v56, v68
    v_mul_f32 v57, v57, v68
    v_mul_f32 v58, v58, v68
    v_mul_f32 v59, v59, v68
    v_accvgpr_write_b32 a208, v56
    v_accvgpr_write_b32 a209, v57
    v_accvgpr_write_b32 a210, v58
    v_accvgpr_write_b32 a211, v59
    v_accvgpr_read_b32 v56, a224
    v_accvgpr_read_b32 v57, a225
    v_accvgpr_read_b32 v58, a226
    v_accvgpr_read_b32 v59, a227
    v_mul_f32 v56, v56, v68
    v_mul_f32 v57, v57, v68
    v_mul_f32 v58, v58, v68
    v_mul_f32 v59, v59, v68
    v_accvgpr_write_b32 a224, v56
    v_accvgpr_write_b32 a225, v57
    v_accvgpr_write_b32 a226, v58
    v_accvgpr_write_b32 a227, v59
    v_accvgpr_read_b32 v56, a240
    v_accvgpr_read_b32 v57, a241
    v_accvgpr_read_b32 v58, a242
    v_accvgpr_read_b32 v59, a243
    v_mul_f32 v56, v56, v68
    v_mul_f32 v57, v57, v68
    v_mul_f32 v58, v58, v68
    v_mul_f32 v59, v59, v68
    v_accvgpr_write_b32 a240, v56
    v_accvgpr_write_b32 a241, v57
    v_accvgpr_write_b32 a242, v58
    v_accvgpr_write_b32 a243, v59
    v_mul_f32 v49, v49, v69
    v_sub_f32 v36, v36, v65
    v_sub_f32 v37, v37, v65
    v_sub_f32 v38, v38, v65
    v_sub_f32 v39, v39, v65
    v_sub_f32 v164, v164, v65
    v_sub_f32 v165, v165, v65
    v_sub_f32 v166, v166, v65
    v_sub_f32 v167, v167, v65
    v_sub_f32 v180, v180, v65
    v_sub_f32 v181, v181, v65
    v_sub_f32 v182, v182, v65
    v_sub_f32 v183, v183, v65
    v_sub_f32 v196, v196, v65
    v_sub_f32 v197, v197, v65
    v_sub_f32 v198, v198, v65
    v_sub_f32 v199, v199, v65
    v_sub_f32 v212, v212, v65
    v_sub_f32 v213, v213, v65
    v_sub_f32 v214, v214, v65
    v_sub_f32 v215, v215, v65
    v_sub_f32 v100, v100, v65
    v_sub_f32 v101, v101, v65
    v_sub_f32 v102, v102, v65
    v_sub_f32 v103, v103, v65
    v_sub_f32 v116, v116, v65
    v_sub_f32 v117, v117, v65
    v_sub_f32 v118, v118, v65
    v_sub_f32 v119, v119, v65
    v_sub_f32 v132, v132, v65
    v_sub_f32 v133, v133, v65
    v_sub_f32 v134, v134, v65
    v_sub_f32 v135, v135, v65
    v_sub_f32 v148, v148, v65
    v_sub_f32 v149, v149, v65
    v_sub_f32 v150, v150, v65
    v_sub_f32 v151, v151, v65
    v_accvgpr_read_b32 v56, a132
    v_accvgpr_read_b32 v57, a133
    v_accvgpr_read_b32 v58, a134
    v_accvgpr_read_b32 v59, a135
    v_mul_f32 v56, v56, v69
    v_mul_f32 v57, v57, v69
    v_mul_f32 v58, v58, v69
    v_mul_f32 v59, v59, v69
    v_accvgpr_write_b32 a132, v56
    v_accvgpr_write_b32 a133, v57
    v_accvgpr_write_b32 a134, v58
    v_accvgpr_write_b32 a135, v59
    v_accvgpr_read_b32 v56, a148
    v_accvgpr_read_b32 v57, a149
    v_accvgpr_read_b32 v58, a150
    v_accvgpr_read_b32 v59, a151
    v_mul_f32 v56, v56, v69
    v_mul_f32 v57, v57, v69
    v_mul_f32 v58, v58, v69
    v_mul_f32 v59, v59, v69
    v_accvgpr_write_b32 a148, v56
    v_accvgpr_write_b32 a149, v57
    v_accvgpr_write_b32 a150, v58
    v_accvgpr_write_b32 a151, v59
    v_accvgpr_read_b32 v56, a164
    v_accvgpr_read_b32 v57, a165
    v_accvgpr_read_b32 v58, a166
    v_accvgpr_read_b32 v59, a167
    v_mul_f32 v56, v56, v69
    v_mul_f32 v57, v57, v69
    v_mul_f32 v58, v58, v69
    v_mul_f32 v59, v59, v69
    v_accvgpr_write_b32 a164, v56
    v_accvgpr_write_b32 a165, v57
    v_accvgpr_write_b32 a166, v58
    v_accvgpr_write_b32 a167, v59
    v_accvgpr_read_b32 v56, a180
    v_accvgpr_read_b32 v57, a181
    v_accvgpr_read_b32 v58, a182
    v_accvgpr_read_b32 v59, a183
    v_mul_f32 v56, v56, v69
    v_mul_f32 v57, v57, v69
    v_mul_f32 v58, v58, v69
    v_mul_f32 v59, v59, v69
    v_accvgpr_write_b32 a180, v56
    v_accvgpr_write_b32 a181, v57
    v_accvgpr_write_b32 a182, v58
    v_accvgpr_write_b32 a183, v59
    v_accvgpr_read_b32 v56, a196
    v_accvgpr_read_b32 v57, a197
    v_accvgpr_read_b32 v58, a198
    v_accvgpr_read_b32 v59, a199
    v_mul_f32 v56, v56, v69
    v_mul_f32 v57, v57, v69
    v_mul_f32 v58, v58, v69
    v_mul_f32 v59, v59, v69
    v_accvgpr_write_b32 a196, v56
    v_accvgpr_write_b32 a197, v57
    v_accvgpr_write_b32 a198, v58
    v_accvgpr_write_b32 a199, v59
    v_accvgpr_read_b32 v56, a212
    v_accvgpr_read_b32 v57, a213
    v_accvgpr_read_b32 v58, a214
    v_accvgpr_read_b32 v59, a215
    v_mul_f32 v56, v56, v69
    v_mul_f32 v57, v57, v69
    v_mul_f32 v58, v58, v69
    v_mul_f32 v59, v59, v69
    v_accvgpr_write_b32 a212, v56
    v_accvgpr_write_b32 a213, v57
    v_accvgpr_write_b32 a214, v58
    v_accvgpr_write_b32 a215, v59
    v_accvgpr_read_b32 v56, a228
    v_accvgpr_read_b32 v57, a229
    v_accvgpr_read_b32 v58, a230
    v_accvgpr_read_b32 v59, a231
    v_mul_f32 v56, v56, v69
    v_mul_f32 v57, v57, v69
    v_mul_f32 v58, v58, v69
    v_mul_f32 v59, v59, v69
    v_accvgpr_write_b32 a228, v56
    v_accvgpr_write_b32 a229, v57
    v_accvgpr_write_b32 a230, v58
    v_accvgpr_write_b32 a231, v59
    v_accvgpr_read_b32 v56, a244
    v_accvgpr_read_b32 v57, a245
    v_accvgpr_read_b32 v58, a246
    v_accvgpr_read_b32 v59, a247
    v_mul_f32 v56, v56, v69
    v_mul_f32 v57, v57, v69
    v_mul_f32 v58, v58, v69
    v_mul_f32 v59, v59, v69
    v_accvgpr_write_b32 a244, v56
    v_accvgpr_write_b32 a245, v57
    v_accvgpr_write_b32 a246, v58
    v_accvgpr_write_b32 a247, v59
    v_mul_f32 v50, v50, v70
    v_sub_f32 v40, v40, v66
    v_sub_f32 v41, v41, v66
    v_sub_f32 v42, v42, v66
    v_sub_f32 v43, v43, v66
    v_sub_f32 v168, v168, v66
    v_sub_f32 v169, v169, v66
    v_sub_f32 v170, v170, v66
    v_sub_f32 v171, v171, v66
    v_sub_f32 v184, v184, v66
    v_sub_f32 v185, v185, v66
    v_sub_f32 v186, v186, v66
    v_sub_f32 v187, v187, v66
    v_sub_f32 v200, v200, v66
    v_sub_f32 v201, v201, v66
    v_sub_f32 v202, v202, v66
    v_sub_f32 v203, v203, v66
    v_sub_f32 v216, v216, v66
    v_sub_f32 v217, v217, v66
    v_sub_f32 v218, v218, v66
    v_sub_f32 v219, v219, v66
    v_sub_f32 v104, v104, v66
    v_sub_f32 v105, v105, v66
    v_sub_f32 v106, v106, v66
    v_sub_f32 v107, v107, v66
    v_sub_f32 v120, v120, v66
    v_sub_f32 v121, v121, v66
    v_sub_f32 v122, v122, v66
    v_sub_f32 v123, v123, v66
    v_sub_f32 v136, v136, v66
    v_sub_f32 v137, v137, v66
    v_sub_f32 v138, v138, v66
    v_sub_f32 v139, v139, v66
    v_sub_f32 v152, v152, v66
    v_sub_f32 v153, v153, v66
    v_sub_f32 v154, v154, v66
    v_sub_f32 v155, v155, v66
    v_accvgpr_read_b32 v56, a136
    v_accvgpr_read_b32 v57, a137
    v_accvgpr_read_b32 v58, a138
    v_accvgpr_read_b32 v59, a139
    v_mul_f32 v56, v56, v70
    v_mul_f32 v57, v57, v70
    v_mul_f32 v58, v58, v70
    v_mul_f32 v59, v59, v70
    v_accvgpr_write_b32 a136, v56
    v_accvgpr_write_b32 a137, v57
    v_accvgpr_write_b32 a138, v58
    v_accvgpr_write_b32 a139, v59
    v_accvgpr_read_b32 v56, a152
    v_accvgpr_read_b32 v57, a153
    v_accvgpr_read_b32 v58, a154
    v_accvgpr_read_b32 v59, a155
    v_mul_f32 v56, v56, v70
    v_mul_f32 v57, v57, v70
    v_mul_f32 v58, v58, v70
    v_mul_f32 v59, v59, v70
    v_accvgpr_write_b32 a152, v56
    v_accvgpr_write_b32 a153, v57
    v_accvgpr_write_b32 a154, v58
    v_accvgpr_write_b32 a155, v59
    v_accvgpr_read_b32 v56, a168
    v_accvgpr_read_b32 v57, a169
    v_accvgpr_read_b32 v58, a170
    v_accvgpr_read_b32 v59, a171
    v_mul_f32 v56, v56, v70
    v_mul_f32 v57, v57, v70
    v_mul_f32 v58, v58, v70
    v_mul_f32 v59, v59, v70
    v_accvgpr_write_b32 a168, v56
    v_accvgpr_write_b32 a169, v57
    v_accvgpr_write_b32 a170, v58
    v_accvgpr_write_b32 a171, v59
    v_accvgpr_read_b32 v56, a184
    v_accvgpr_read_b32 v57, a185
    v_accvgpr_read_b32 v58, a186
    v_accvgpr_read_b32 v59, a187
    v_mul_f32 v56, v56, v70
    v_mul_f32 v57, v57, v70
    v_mul_f32 v58, v58, v70
    v_mul_f32 v59, v59, v70
    v_accvgpr_write_b32 a184, v56
    v_accvgpr_write_b32 a185, v57
    v_accvgpr_write_b32 a186, v58
    v_accvgpr_write_b32 a187, v59
    v_accvgpr_read_b32 v56, a200
    v_accvgpr_read_b32 v57, a201
    v_accvgpr_read_b32 v58, a202
    v_accvgpr_read_b32 v59, a203
    v_mul_f32 v56, v56, v70
    v_mul_f32 v57, v57, v70
    v_mul_f32 v58, v58, v70
    v_mul_f32 v59, v59, v70
    v_accvgpr_write_b32 a200, v56
    v_accvgpr_write_b32 a201, v57
    v_accvgpr_write_b32 a202, v58
    v_accvgpr_write_b32 a203, v59
    v_accvgpr_read_b32 v56, a216
    v_accvgpr_read_b32 v57, a217
    v_accvgpr_read_b32 v58, a218
    v_accvgpr_read_b32 v59, a219
    v_mul_f32 v56, v56, v70
    v_mul_f32 v57, v57, v70
    v_mul_f32 v58, v58, v70
    v_mul_f32 v59, v59, v70
    v_accvgpr_write_b32 a216, v56
    v_accvgpr_write_b32 a217, v57
    v_accvgpr_write_b32 a218, v58
    v_accvgpr_write_b32 a219, v59
    v_accvgpr_read_b32 v56, a232
    v_accvgpr_read_b32 v57, a233
    v_accvgpr_read_b32 v58, a234
    v_accvgpr_read_b32 v59, a235
    v_mul_f32 v56, v56, v70
    v_mul_f32 v57, v57, v70
    v_mul_f32 v58, v58, v70
    v_mul_f32 v59, v59, v70
    v_accvgpr_write_b32 a232, v56
    v_accvgpr_write_b32 a233, v57
    v_accvgpr_write_b32 a234, v58
    v_accvgpr_write_b32 a235, v59
    v_accvgpr_read_b32 v56, a248
    v_accvgpr_read_b32 v57, a249
    v_accvgpr_read_b32 v58, a250
    v_accvgpr_read_b32 v59, a251
    v_mul_f32 v56, v56, v70
    v_mul_f32 v57, v57, v70
    v_mul_f32 v58, v58, v70
    v_mul_f32 v59, v59, v70
    v_accvgpr_write_b32 a248, v56
    v_accvgpr_write_b32 a249, v57
    v_accvgpr_write_b32 a250, v58
    v_accvgpr_write_b32 a251, v59
    v_mul_f32 v51, v51, v71
    v_sub_f32 v44, v44, v67
    v_sub_f32 v45, v45, v67
    v_sub_f32 v46, v46, v67
    v_sub_f32 v47, v47, v67
    v_sub_f32 v172, v172, v67
    v_sub_f32 v173, v173, v67
    v_sub_f32 v174, v174, v67
    v_sub_f32 v175, v175, v67
    v_sub_f32 v188, v188, v67
    v_sub_f32 v189, v189, v67
    v_sub_f32 v190, v190, v67
    v_sub_f32 v191, v191, v67
    v_sub_f32 v204, v204, v67
    v_sub_f32 v205, v205, v67
    v_sub_f32 v206, v206, v67
    v_sub_f32 v207, v207, v67
    v_sub_f32 v220, v220, v67
    v_sub_f32 v221, v221, v67
    v_sub_f32 v222, v222, v67
    v_sub_f32 v223, v223, v67
    v_sub_f32 v108, v108, v67
    v_sub_f32 v109, v109, v67
    v_sub_f32 v110, v110, v67
    v_sub_f32 v111, v111, v67
    v_sub_f32 v124, v124, v67
    v_sub_f32 v125, v125, v67
    v_sub_f32 v126, v126, v67
    v_sub_f32 v127, v127, v67
    v_sub_f32 v140, v140, v67
    v_sub_f32 v141, v141, v67
    v_sub_f32 v142, v142, v67
    v_sub_f32 v143, v143, v67
    v_sub_f32 v156, v156, v67
    v_sub_f32 v157, v157, v67
    v_sub_f32 v158, v158, v67
    v_sub_f32 v159, v159, v67
    v_accvgpr_read_b32 v56, a140
    v_accvgpr_read_b32 v57, a141
    v_accvgpr_read_b32 v58, a142
    v_accvgpr_read_b32 v59, a143
    v_mul_f32 v56, v56, v71
    v_mul_f32 v57, v57, v71
    v_mul_f32 v58, v58, v71
    v_mul_f32 v59, v59, v71
    v_accvgpr_write_b32 a140, v56
    v_accvgpr_write_b32 a141, v57
    v_accvgpr_write_b32 a142, v58
    v_accvgpr_write_b32 a143, v59
    v_accvgpr_read_b32 v56, a156
    v_accvgpr_read_b32 v57, a157
    v_accvgpr_read_b32 v58, a158
    v_accvgpr_read_b32 v59, a159
    v_mul_f32 v56, v56, v71
    v_mul_f32 v57, v57, v71
    v_mul_f32 v58, v58, v71
    v_mul_f32 v59, v59, v71
    v_accvgpr_write_b32 a156, v56
    v_accvgpr_write_b32 a157, v57
    v_accvgpr_write_b32 a158, v58
    v_accvgpr_write_b32 a159, v59
    v_accvgpr_read_b32 v56, a172
    v_accvgpr_read_b32 v57, a173
    v_accvgpr_read_b32 v58, a174
    v_accvgpr_read_b32 v59, a175
    v_mul_f32 v56, v56, v71
    v_mul_f32 v57, v57, v71
    v_mul_f32 v58, v58, v71
    v_mul_f32 v59, v59, v71
    v_accvgpr_write_b32 a172, v56
    v_accvgpr_write_b32 a173, v57
    v_accvgpr_write_b32 a174, v58
    v_accvgpr_write_b32 a175, v59
    v_accvgpr_read_b32 v56, a188
    v_accvgpr_read_b32 v57, a189
    v_accvgpr_read_b32 v58, a190
    v_accvgpr_read_b32 v59, a191
    v_mul_f32 v56, v56, v71
    v_mul_f32 v57, v57, v71
    v_mul_f32 v58, v58, v71
    v_mul_f32 v59, v59, v71
    v_accvgpr_write_b32 a188, v56
    v_accvgpr_write_b32 a189, v57
    v_accvgpr_write_b32 a190, v58
    v_accvgpr_write_b32 a191, v59
    v_accvgpr_read_b32 v56, a204
    v_accvgpr_read_b32 v57, a205
    v_accvgpr_read_b32 v58, a206
    v_accvgpr_read_b32 v59, a207
    v_mul_f32 v56, v56, v71
    v_mul_f32 v57, v57, v71
    v_mul_f32 v58, v58, v71
    v_mul_f32 v59, v59, v71
    v_accvgpr_write_b32 a204, v56
    v_accvgpr_write_b32 a205, v57
    v_accvgpr_write_b32 a206, v58
    v_accvgpr_write_b32 a207, v59
    v_accvgpr_read_b32 v56, a220
    v_accvgpr_read_b32 v57, a221
    v_accvgpr_read_b32 v58, a222
    v_accvgpr_read_b32 v59, a223
    v_mul_f32 v56, v56, v71
    v_mul_f32 v57, v57, v71
    v_mul_f32 v58, v58, v71
    v_mul_f32 v59, v59, v71
    v_accvgpr_write_b32 a220, v56
    v_accvgpr_write_b32 a221, v57
    v_accvgpr_write_b32 a222, v58
    v_accvgpr_write_b32 a223, v59
    v_accvgpr_read_b32 v56, a236
    v_accvgpr_read_b32 v57, a237
    v_accvgpr_read_b32 v58, a238
    v_accvgpr_read_b32 v59, a239
    v_mul_f32 v56, v56, v71
    v_mul_f32 v57, v57, v71
    v_mul_f32 v58, v58, v71
    v_mul_f32 v59, v59, v71
    v_accvgpr_write_b32 a236, v56
    v_accvgpr_write_b32 a237, v57
    v_accvgpr_write_b32 a238, v58
    v_accvgpr_write_b32 a239, v59
    v_accvgpr_read_b32 v56, a252
    v_accvgpr_read_b32 v57, a253
    v_accvgpr_read_b32 v58, a254
    v_accvgpr_read_b32 v59, a255
    v_mul_f32 v56, v56, v71
    v_mul_f32 v57, v57, v71
    v_mul_f32 v58, v58, v71
    v_mul_f32 v59, v59, v71
    v_accvgpr_write_b32 a252, v56
    v_accvgpr_write_b32 a253, v57
    v_accvgpr_write_b32 a254, v58
    v_accvgpr_write_b32 a255, v59
    s_setreg_imm32_b32 hwreg(HW_REG_MODE, 4, 2), 0
    s_nop 1
    v_exp_f32 v56, v96
    v_exp_f32 v57, v97
    s_nop 0
    v_cvt_pk_bf16_f32 v240, v56, v57
    v_exp_f32 v58, v100
    s_nop 0
    v_add_f32 v53, v49, v58
    v_exp_f32 v59, v101
    s_nop 0
    v_add_f32 v53, v53, v59
    v_cvt_pk_bf16_f32 v244, v58, v59
    v_exp_f32 v60, v98
    v_exp_f32 v61, v99
    s_nop 0
    v_cvt_pk_bf16_f32 v241, v60, v61
    v_exp_f32 v62, v102
    s_nop 0
    v_add_f32 v53, v53, v62
    v_exp_f32 v63, v103
    s_nop 0
    v_add_f32 v53, v53, v63
    v_cvt_pk_bf16_f32 v245, v62, v63
    v_exp_f32 v56, v112
    v_exp_f32 v57, v113
    s_nop 0
    v_cvt_pk_bf16_f32 v242, v56, v57
    v_exp_f32 v58, v116
    s_nop 0
    v_add_f32 v53, v53, v58
    v_exp_f32 v59, v117
    s_nop 0
    v_add_f32 v53, v53, v59
    v_cvt_pk_bf16_f32 v246, v58, v59
    v_exp_f32 v60, v114
    v_exp_f32 v61, v115
    s_nop 0
    v_cvt_pk_bf16_f32 v243, v60, v61
    v_exp_f32 v62, v118
    s_nop 0
    v_add_f32 v53, v53, v62
    v_exp_f32 v63, v119
    s_nop 0
    v_add_f32 v53, v53, v63
    v_cvt_pk_bf16_f32 v247, v62, v63
    v_exp_f32 v56, v104
    v_exp_f32 v57, v105
    s_nop 0
    v_cvt_pk_bf16_f32 v248, v56, v57
    v_exp_f32 v58, v108
    s_nop 0
    v_add_f32 v55, v51, v58
    v_exp_f32 v59, v109
    s_nop 0
    v_add_f32 v55, v55, v59
    v_cvt_pk_bf16_f32 v252, v58, v59
    v_exp_f32 v60, v106
    v_exp_f32 v61, v107
    s_nop 0
    v_cvt_pk_bf16_f32 v249, v60, v61
    v_exp_f32 v62, v110
    s_nop 0
    v_add_f32 v55, v55, v62
    v_exp_f32 v63, v111
    s_nop 0
    v_add_f32 v55, v55, v63
    v_cvt_pk_bf16_f32 v253, v62, v63
    v_exp_f32 v56, v120
    v_exp_f32 v57, v121
    s_nop 0
    v_cvt_pk_bf16_f32 v250, v56, v57
    v_exp_f32 v58, v124
    s_nop 0
    v_add_f32 v55, v55, v58
    v_exp_f32 v59, v125
    s_nop 0
    v_add_f32 v55, v55, v59
    v_cvt_pk_bf16_f32 v254, v58, v59
    v_exp_f32 v60, v122
    v_exp_f32 v61, v123
    s_nop 0
    v_cvt_pk_bf16_f32 v251, v60, v61
    v_exp_f32 v62, v126
    s_nop 0
    v_add_f32 v55, v55, v62
    v_exp_f32 v63, v127
    s_nop 0
    v_add_f32 v55, v55, v63
    v_cvt_pk_bf16_f32 v255, v62, v63
    v_exp_f32 v56, v128
    v_exp_f32 v57, v129
    s_nop 0
    v_cvt_pk_bf16_f32 v16, v56, v57
    v_exp_f32 v58, v132
    s_nop 0
    v_add_f32 v53, v53, v58
    v_exp_f32 v59, v133
    s_nop 0
    v_add_f32 v53, v53, v59
    v_cvt_pk_bf16_f32 v20, v58, v59
    v_exp_f32 v60, v130
    v_exp_f32 v61, v131
    s_nop 0
    v_cvt_pk_bf16_f32 v17, v60, v61
    v_exp_f32 v62, v134
    s_nop 0
    v_add_f32 v53, v53, v62
    v_exp_f32 v63, v135
    s_nop 0
    v_add_f32 v53, v53, v63
    v_cvt_pk_bf16_f32 v21, v62, v63
    v_exp_f32 v56, v144
    v_exp_f32 v57, v145
    s_nop 0
    v_cvt_pk_bf16_f32 v18, v56, v57
    v_exp_f32 v58, v148
    s_nop 0
    v_add_f32 v53, v53, v58
    v_exp_f32 v59, v149
    s_nop 0
    v_add_f32 v53, v53, v59
    v_cvt_pk_bf16_f32 v22, v58, v59
    v_exp_f32 v60, v146
    v_exp_f32 v61, v147
    s_nop 0
    v_cvt_pk_bf16_f32 v19, v60, v61
    v_exp_f32 v62, v150
    s_nop 0
    v_add_f32 v53, v53, v62
    v_exp_f32 v63, v151
    s_nop 0
    v_add_f32 v53, v53, v63
    v_cvt_pk_bf16_f32 v23, v62, v63
    v_exp_f32 v56, v136
    v_exp_f32 v57, v137
    s_nop 0
    v_cvt_pk_bf16_f32 v24, v56, v57
    v_exp_f32 v58, v140
    s_nop 0
    v_add_f32 v55, v55, v58
    v_exp_f32 v59, v141
    s_nop 0
    v_add_f32 v55, v55, v59
    v_cvt_pk_bf16_f32 v28, v58, v59
    v_exp_f32 v60, v138
    v_exp_f32 v61, v139
    s_nop 0
    v_cvt_pk_bf16_f32 v25, v60, v61
    v_exp_f32 v62, v142
    s_nop 0
    v_add_f32 v55, v55, v62
    v_exp_f32 v63, v143
    s_nop 0
    v_add_f32 v55, v55, v63
    v_cvt_pk_bf16_f32 v29, v62, v63
    v_exp_f32 v56, v152
    v_exp_f32 v57, v153
    s_nop 0
    v_cvt_pk_bf16_f32 v26, v56, v57
    v_exp_f32 v58, v156
    s_nop 0
    v_add_f32 v55, v55, v58
    v_exp_f32 v59, v157
    s_nop 0
    v_add_f32 v55, v55, v59
    v_cvt_pk_bf16_f32 v30, v58, v59
    v_exp_f32 v60, v154
    v_exp_f32 v61, v155
    s_nop 0
    v_cvt_pk_bf16_f32 v27, v60, v61
    v_exp_f32 v62, v158
    s_nop 0
    v_add_f32 v55, v55, v62
    v_exp_f32 v63, v159
    s_nop 0
    v_add_f32 v55, v55, v63
    v_cvt_pk_bf16_f32 v31, v62, v63
    v_mfma_f32_16x16x32_bf16 v[72:75], v[10:13], v[240:243], 0
    v_mfma_f32_16x16x32_bf16 v[72:75], v[10:13], v[16:19], v[72:75]
    s_nop 7
    v_add_f32 v52, v48, v72
    v_mfma_f32_16x16x32_bf16 v[72:75], v[10:13], v[248:251], 0
    v_mfma_f32_16x16x32_bf16 v[72:75], v[10:13], v[24:27], v[72:75]
    s_nop 7
    v_add_f32 v54, v50, v72
    v_exp_f32 v56, v160
    v_exp_f32 v57, v161
    v_exp_f32 v58, v164
    v_exp_f32 v59, v165
    v_cvt_pk_bf16_f32 v224, v56, v57
    s_nop 3
    s_setpc_b64 s[50:51]
L_rareZ:
    s_nop 15
    v_max3_f32 v64, v96, v97, v98
    v_max3_f32 v64, v64, v99, v112
    v_max3_f32 v64, v64, v113, v114
    v_max3_f32 v64, v64, v115, v128
    v_max3_f32 v64, v64, v129, v130
    v_max3_f32 v64, v64, v131, v144
    v_max3_f32 v64, v64, v145, v146
    v_max_f32 v64, v64, v147
    v_log_f32 v68, v48
    s_nop 0
    v_max_f32 v64, v64, v68
    v_add_f32 v64, 0x42cc0000, v64
    v_max_f32 v64, 0, v64
    v_max3_f32 v65, v100, v101, v102
    v_max3_f32 v65, v65, v103, v116
    v_max3_f32 v65, v65, v117, v118
    v_max3_f32 v65, v65, v119, v132
    v_max3_f32 v65, v65, v133, v134
    v_max3_f32 v65, v65, v135, v148
    v_max3_f32 v65, v65, v149, v150
    v_max_f32 v65, v65, v151
    v_log_f32 v68, v49
    s_nop 0
    v_max_f32 v65, v65, v68
    v_add_f32 v65, 0x42cc0000, v65
    v_max_f32 v65, 0, v65
    v_max3_f32 v66, v104, v105, v106
    v_max3_f32 v66, v66, v107, v120
    v_max3_f32 v66, v66, v121, v122
    v_max3_f32 v66, v66, v123, v136
    v_max3_f32 v66, v66, v137, v138
    v_max3_f32 v66, v66, v139, v152
    v_max3_f32 v66, v66, v153, v154
    v_max_f32 v66, v66, v155
    v_log_f32 v68, v50
    s_nop 0
    v_max_f32 v66, v66, v68
    v_add_f32 v66, 0x42cc0000, v66
    v_max_f32 v66, 0, v66
    v_max3_f32 v67, v108, v109, v110
    v_max3_f32 v67, v67, v111, v124
    v_max3_f32 v67, v67, v125, v126
    v_max3_f32 v67, v67, v127, v140
    v_max3_f32 v67, v67, v141, v142
    v_max3_f32 v67, v67, v143, v156
    v_max3_f32 v67, v67, v157, v158
    v_max_f32 v67, v67, v159
    v_log_f32 v68, v51
    s_nop 0
    v_max_f32 v67, v67, v68
    v_add_f32 v67, 0x42cc0000, v67
    v_max_f32 v67, 0, v67
    v_mov_b32 v68, v64
    v_mov_b32 v69, v65
    v_mov_b32 v70, v66
    v_mov_b32 v71, v67
    v_permlane32_swap_b32 v64, v68
    v_permlane32_swap_b32 v65, v69
    v_permlane32_swap_b32 v66, v70
    v_permlane32_swap_b32 v67, v71
    v_max_f32 v64, v64, v68
    v_max_f32 v65, v65, v69
    v_max_f32 v66, v66, v70
    v_max_f32 v67, v67, v71
    v_mov_b32 v68, v64
    v_mov_b32 v69, v65
    v_mov_b32 v70, v66
    v_mov_b32 v71, v67
    v_permlane16_swap_b32 v64, v68
    v_permlane16_swap_b32 v65, v69
    v_permlane16_swap_b32 v66, v70
    v_permlane16_swap_b32 v67, v71
    v_max_f32 v64, v64, v68
    v_max_f32 v65, v65, v69
    v_max_f32 v66, v66, v70
    v_max_f32 v67, v67, v71
    v_sub_f32 v68, 0, v64
    v_exp_f32 v68, v68
    v_sub_f32 v69, 0, v65
    v_exp_f32 v69, v69
    v_sub_f32 v70, 0, v66
    v_exp_f32 v70, v70
    v_sub_f32 v71, 0, v67
    v_exp_f32 v71, v71
    s_setreg_imm32_b32 hwreg(HW_REG_MODE, 4, 2), 3
    s_nop 1
    v_mul_f32 v48, v48, v68
    v_sub_f32 v96, v96, v64
    v_sub_f32 v97, v97, v64
    v_sub_f32 v98, v98, v64
    v_sub_f32 v99, v99, v64
    v_sub_f32 v112, v112, v64
    v_sub_f32 v113, v113, v64
    v_sub_f32 v114, v114, v64
    v_sub_f32 v115, v115, v64
    v_sub_f32 v128, v128, v64
    v_sub_f32 v129, v129, v64
    v_sub_f32 v130, v130, v64
    v_sub_f32 v131, v131, v64
    v_sub_f32 v144, v144, v64
    v_sub_f32 v145, v145, v64
    v_sub_f32 v146, v146, v64
    v_sub_f32 v147, v147, v64
    v_accvgpr_read_b32 v56, a128
    v_accvgpr_read_b32 v57, a129
    v_accvgpr_read_b32 v58, a130
    v_accvgpr_read_b32 v59, a131
    v_mul_f32 v56, v56, v68
    v_mul_f32 v57, v57, v68
    v_mul_f32 v58, v58, v68
    v_mul_f32 v59, v59, v68
    v_accvgpr_write_b32 a128, v56
    v_accvgpr_write_b32 a129, v57
    v_accvgpr_write_b32 a130, v58
    v_accvgpr_write_b32 a131, v59
    v_accvgpr_read_b32 v56, a144
    v_accvgpr_read_b32 v57, a145
    v_accvgpr_read_b32 v58, a146
    v_accvgpr_read_b32 v59, a147
    v_mul_f32 v56, v56, v68
    v_mul_f32 v57, v57, v68
    v_mul_f32 v58, v58, v68
    v_mul_f32 v59, v59, v68
    v_accvgpr_write_b32 a144, v56
    v_accvgpr_write_b32 a145, v57
    v_accvgpr_write_b32 a146, v58
    v_accvgpr_write_b32 a147, v59
    v_accvgpr_read_b32 v56, a160
    v_accvgpr_read_b32 v57, a161
    v_accvgpr_read_b32 v58, a162
    v_accvgpr_read_b32 v59, a163
    v_mul_f32 v56, v56, v68
    v_mul_f32 v57, v57, v68
    v_mul_f32 v58, v58, v68
    v_mul_f32 v59, v59, v68
    v_accvgpr_write_b32 a160, v56
    v_accvgpr_write_b32 a161, v57
    v_accvgpr_write_b32 a162, v58
    v_accvgpr_write_b32 a163, v59
    v_accvgpr_read_b32 v56, a176
    v_accvgpr_read_b32 v57, a177
    v_accvgpr_read_b32 v58, a178
    v_accvgpr_read_b32 v59, a179
    v_mul_f32 v56, v56, v68
    v_mul_f32 v57, v57, v68
    v_mul_f32 v58, v58, v68
    v_mul_f32 v59, v59, v68
    v_accvgpr_write_b32 a176, v56
    v_accvgpr_write_b32 a177, v57
    v_accvgpr_write_b32 a178, v58
    v_accvgpr_write_b32 a179, v59
    v_accvgpr_read_b32 v56, a192
    v_accvgpr_read_b32 v57, a193
    v_accvgpr_read_b32 v58, a194
    v_accvgpr_read_b32 v59, a195
    v_mul_f32 v56, v56, v68
    v_mul_f32 v57, v57, v68
    v_mul_f32 v58, v58, v68
    v_mul_f32 v59, v59, v68
    v_accvgpr_write_b32 a192, v56
    v_accvgpr_write_b32 a193, v57
    v_accvgpr_write_b32 a194, v58
    v_accvgpr_write_b32 a195, v59
    v_accvgpr_read_b32 v56, a208
    v_accvgpr_read_b32 v57, a209
    v_accvgpr_read_b32 v58, a210
    v_accvgpr_read_b32 v59, a211
    v_mul_f32 v56, v56, v68
    v_mul_f32 v57, v57, v68
    v_mul_f32 v58, v58, v68
    v_mul_f32 v59, v59, v68
    v_accvgpr_write_b32 a208, v56
    v_accvgpr_write_b32 a209, v57
    v_accvgpr_write_b32 a210, v58
    v_accvgpr_write_b32 a211, v59
    v_accvgpr_read_b32 v56, a224
    v_accvgpr_read_b32 v57, a225
    v_accvgpr_read_b32 v58, a226
    v_accvgpr_read_b32 v59, a227
    v_mul_f32 v56, v56, v68
    v_mul_f32 v57, v57, v68
    v_mul_f32 v58, v58, v68
    v_mul_f32 v59, v59, v68
    v_accvgpr_write_b32 a224, v56
    v_accvgpr_write_b32 a225, v57
    v_accvgpr_write_b32 a226, v58
    v_accvgpr_write_b32 a227, v59
    v_accvgpr_read_b32 v56, a240
    v_accvgpr_read_b32 v57, a241
    v_accvgpr_read_b32 v58, a242
    v_accvgpr_read_b32 v59, a243
    v_mul_f32 v56, v56, v68
    v_mul_f32 v57, v57, v68
    v_mul_f32 v58, v58, v68
    v_mul_f32 v59, v59, v68
    v_accvgpr_write_b32 a240, v56
    v_accvgpr_write_b32 a241, v57
    v_accvgpr_write_b32 a242, v58
    v_accvgpr_write_b32 a243, v59
    v_mul_f32 v49, v49, v69
    v_sub_f32 v100, v100, v65
    v_sub_f32 v101, v101, v65
    v_sub_f32 v102, v102, v65
    v_sub_f32 v103, v103, v65
    v_sub_f32 v116, v116, v65
    v_sub_f32 v117, v117, v65
    v_sub_f32 v118, v118, v65
    v_sub_f32 v119, v119, v65
    v_sub_f32 v132, v132, v65
    v_sub_f32 v133, v133, v65
    v_sub_f32 v134, v134, v65
    v_sub_f32 v135, v135, v65
    v_sub_f32 v148, v148, v65
    v_sub_f32 v149, v149, v65
    v_sub_f32 v150, v150, v65
    v_sub_f32 v151, v151, v65
    v_accvgpr_read_b32 v56, a132
    v_accvgpr_read_b32 v57, a133
    v_accvgpr_read_b32 v58, a134
    v_accvgpr_read_b32 v59, a135
    v_mul_f32 v56, v56, v69
    v_mul_f32 v57, v57, v69
    v_mul_f32 v58, v58, v69
    v_mul_f32 v59, v59, v69
    v_accvgpr_write_b32 a132, v56
    v_accvgpr_write_b32 a133, v57
    v_accvgpr_write_b32 a134, v58
    v_accvgpr_write_b32 a135, v59
    v_accvgpr_read_b32 v56, a148
    v_accvgpr_read_b32 v57, a149
    v_accvgpr_read_b32 v58, a150
    v_accvgpr_read_b32 v59, a151
    v_mul_f32 v56, v56, v69
    v_mul_f32 v57, v57, v69
    v_mul_f32 v58, v58, v69
    v_mul_f32 v59, v59, v69
    v_accvgpr_write_b32 a148, v56
    v_accvgpr_write_b32 a149, v57
    v_accvgpr_write_b32 a150, v58
    v_accvgpr_write_b32 a151, v59
    v_accvgpr_read_b32 v56, a164
    v_accvgpr_read_b32 v57, a165
    v_accvgpr_read_b32 v58, a166
    v_accvgpr_read_b32 v59, a167
    v_mul_f32 v56, v56, v69
    v_mul_f32 v57, v57, v69
    v_mul_f32 v58, v58, v69
    v_mul_f32 v59, v59, v69
    v_accvgpr_write_b32 a164, v56
    v_accvgpr_write_b32 a165, v57
    v_accvgpr_write_b32 a166, v58
    v_accvgpr_write_b32 a167, v59
    v_accvgpr_read_b32 v56, a180
    v_accvgpr_read_b32 v57, a181
    v_accvgpr_read_b32 v58, a182
    v_accvgpr_read_b32 v59, a183
    v_mul_f32 v56, v56, v69
    v_mul_f32 v57, v57, v69
    v_mul_f32 v58, v58, v69
    v_mul_f32 v59, v59, v69
    v_accvgpr_write_b32 a180, v56
    v_accvgpr_write_b32 a181, v57
    v_accvgpr_write_b32 a182, v58
    v_accvgpr_write_b32 a183, v59
    v_accvgpr_read_b32 v56, a196
    v_accvgpr_read_b32 v57, a197
    v_accvgpr_read_b32 v58, a198
    v_accvgpr_read_b32 v59, a199
    v_mul_f32 v56, v56, v69
    v_mul_f32 v57, v57, v69
    v_mul_f32 v58, v58, v69
    v_mul_f32 v59, v59, v69
    v_accvgpr_write_b32 a196, v56
    v_accvgpr_write_b32 a197, v57
    v_accvgpr_write_b32 a198, v58
    v_accvgpr_write_b32 a199, v59
    v_accvgpr_read_b32 v56, a212
    v_accvgpr_read_b32 v57, a213
    v_accvgpr_read_b32 v58, a214
    v_accvgpr_read_b32 v59, a215
    v_mul_f32 v56, v56, v69
    v_mul_f32 v57, v57, v69
    v_mul_f32 v58, v58, v69
    v_mul_f32 v59, v59, v69
    v_accvgpr_write_b32 a212, v56
    v_accvgpr_write_b32 a213, v57
    v_accvgpr_write_b32 a214, v58
    v_accvgpr_write_b32 a215, v59
    v_accvgpr_read_b32 v56, a228
    v_accvgpr_read_b32 v57, a229
    v_accvgpr_read_b32 v58, a230
    v_accvgpr_read_b32 v59, a231
    v_mul_f32 v56, v56, v69
    v_mul_f32 v57, v57, v69
    v_mul_f32 v58, v58, v69
    v_mul_f32 v59, v59, v69
    v_accvgpr_write_b32 a228, v56
    v_accvgpr_write_b32 a229, v57
    v_accvgpr_write_b32 a230, v58
    v_accvgpr_write_b32 a231, v59
    v_accvgpr_read_b32 v56, a244
    v_accvgpr_read_b32 v57, a245
    v_accvgpr_read_b32 v58, a246
    v_accvgpr_read_b32 v59, a247
    v_mul_f32 v56, v56, v69
    v_mul_f32 v57, v57, v69
    v_mul_f32 v58, v58, v69
    v_mul_f32 v59, v59, v69
    v_accvgpr_write_b32 a244, v56
    v_accvgpr_write_b32 a245, v57
    v_accvgpr_write_b32 a246, v58
    v_accvgpr_write_b32 a247, v59
    v_mul_f32 v50, v50, v70
    v_sub_f32 v104, v104, v66
    v_sub_f32 v105, v105, v66
    v_sub_f32 v106, v106, v66
    v_sub_f32 v107, v107, v66
    v_sub_f32 v120, v120, v66
    v_sub_f32 v121, v121, v66
    v_sub_f32 v122, v122, v66
    v_sub_f32 v123, v123, v66
    v_sub_f32 v136, v136, v66
    v_sub_f32 v137, v137, v66
    v_sub_f32 v138, v138, v66
    v_sub_f32 v139, v139, v66
    v_sub_f32 v152, v152, v66
    v_sub_f32 v153, v153, v66
    v_sub_f32 v154, v154, v66
    v_sub_f32 v155, v155, v66
    v_accvgpr_read_b32 v56, a136
    v_accvgpr_read_b32 v57, a137
    v_accvgpr_read_b32 v58, a138
    v_accvgpr_read_b32 v59, a139
    v_mul_f32 v56, v56, v70
    v_mul_f32 v57, v57, v70
    v_mul_f32 v58, v58, v70
    v_mul_f32 v59, v59, v70
    v_accvgpr_write_b32 a136, v56
    v_accvgpr_write_b32 a137, v57
    v_accvgpr_write_b32 a138, v58
    v_accvgpr_write_b32 a139, v59
    v_accvgpr_read_b32 v56, a152
    v_accvgpr_read_b32 v57, a153
    v_accvgpr_read_b32 v58, a154
    v_accvgpr_read_b32 v59, a155
    v_mul_f32 v56, v56, v70
    v_mul_f32 v57, v57, v70
    v_mul_f32 v58, v58, v70
    v_mul_f32 v59, v59, v70
    v_accvgpr_write_b32 a152, v56
    v_accvgpr_write_b32 a153, v57
    v_accvgpr_write_b32 a154, v58
    v_accvgpr_write_b32 a155, v59
    v_accvgpr_read_b32 v56, a168
    v_accvgpr_read_b32 v57, a169
    v_accvgpr_read_b32 v58, a170
    v_accvgpr_read_b32 v59, a171
    v_mul_f32 v56, v56, v70
    v_mul_f32 v57, v57, v70
    v_mul_f32 v58, v58, v70
    v_mul_f32 v59, v59, v70
    v_accvgpr_write_b32 a168, v56
    v_accvgpr_write_b32 a169, v57
    v_accvgpr_write_b32 a170, v58
    v_accvgpr_write_b32 a171, v59
    v_accvgpr_read_b32 v56, a184
    v_accvgpr_read_b32 v57, a185
    v_accvgpr_read_b32 v58, a186
    v_accvgpr_read_b32 v59, a187
    v_mul_f32 v56, v56, v70
    v_mul_f32 v57, v57, v70
    v_mul_f32 v58, v58, v70
    v_mul_f32 v59, v59, v70
    v_accvgpr_write_b32 a184, v56
    v_accvgpr_write_b32 a185, v57
    v_accvgpr_write_b32 a186, v58
    v_accvgpr_write_b32 a187, v59
    v_accvgpr_read_b32 v56, a200
    v_accvgpr_read_b32 v57, a201
    v_accvgpr_read_b32 v58, a202
    v_accvgpr_read_b32 v59, a203
    v_mul_f32 v56, v56, v70
    v_mul_f32 v57, v57, v70
    v_mul_f32 v58, v58, v70
    v_mul_f32 v59, v59, v70
    v_accvgpr_write_b32 a200, v56
    v_accvgpr_write_b32 a201, v57
    v_accvgpr_write_b32 a202, v58
    v_accvgpr_write_b32 a203, v59
    v_accvgpr_read_b32 v56, a216
    v_accvgpr_read_b32 v57, a217
    v_accvgpr_read_b32 v58, a218
    v_accvgpr_read_b32 v59, a219
    v_mul_f32 v56, v56, v70
    v_mul_f32 v57, v57, v70
    v_mul_f32 v58, v58, v70
    v_mul_f32 v59, v59, v70
    v_accvgpr_write_b32 a216, v56
    v_accvgpr_write_b32 a217, v57
    v_accvgpr_write_b32 a218, v58
    v_accvgpr_write_b32 a219, v59
    v_accvgpr_read_b32 v56, a232
    v_accvgpr_read_b32 v57, a233
    v_accvgpr_read_b32 v58, a234
    v_accvgpr_read_b32 v59, a235
    v_mul_f32 v56, v56, v70
    v_mul_f32 v57, v57, v70
    v_mul_f32 v58, v58, v70
    v_mul_f32 v59, v59, v70
    v_accvgpr_write_b32 a232, v56
    v_accvgpr_write_b32 a233, v57
    v_accvgpr_write_b32 a234, v58
    v_accvgpr_write_b32 a235, v59
    v_accvgpr_read_b32 v56, a248
    v_accvgpr_read_b32 v57, a249
    v_accvgpr_read_b32 v58, a250
    v_accvgpr_read_b32 v59, a251
    v_mul_f32 v56, v56, v70
    v_mul_f32 v57, v57, v70
    v_mul_f32 v58, v58, v70
    v_mul_f32 v59, v59, v70
    v_accvgpr_write_b32 a248, v56
    v_accvgpr_write_b32 a249, v57
    v_accvgpr_write_b32 a250, v58
    v_accvgpr_write_b32 a251, v59
    v_mul_f32 v51, v51, v71
    v_sub_f32 v108, v108, v67
    v_sub_f32 v109, v109, v67
    v_sub_f32 v110, v110, v67
    v_sub_f32 v111, v111, v67
    v_sub_f32 v124, v124, v67
    v_sub_f32 v125, v125, v67
    v_sub_f32 v126, v126, v67
    v_sub_f32 v127, v127, v67
    v_sub_f32 v140, v140, v67
    v_sub_f32 v141, v141, v67
    v_sub_f32 v142, v142, v67
    v_sub_f32 v143, v143, v67
    v_sub_f32 v156, v156, v67
    v_sub_f32 v157, v157, v67
    v_sub_f32 v158, v158, v67
    v_sub_f32 v159, v159, v67
    v_accvgpr_read_b32 v56, a140
    v_accvgpr_read_b32 v57, a141
    v_accvgpr_read_b32 v58, a142
    v_accvgpr_read_b32 v59, a143
    v_mul_f32 v56, v56, v71
    v_mul_f32 v57, v57, v71
    v_mul_f32 v58, v58, v71
    v_mul_f32 v59, v59, v71
    v_accvgpr_write_b32 a140, v56
    v_accvgpr_write_b32 a141, v57
    v_accvgpr_write_b32 a142, v58
    v_accvgpr_write_b32 a143, v59
    v_accvgpr_read_b32 v56, a156
    v_accvgpr_read_b32 v57, a157
    v_accvgpr_read_b32 v58, a158
    v_accvgpr_read_b32 v59, a159
    v_mul_f32 v56, v56, v71
    v_mul_f32 v57, v57, v71
    v_mul_f32 v58, v58, v71
    v_mul_f32 v59, v59, v71
    v_accvgpr_write_b32 a156, v56
    v_accvgpr_write_b32 a157, v57
    v_accvgpr_write_b32 a158, v58
    v_accvgpr_write_b32 a159, v59
    v_accvgpr_read_b32 v56, a172
    v_accvgpr_read_b32 v57, a173
    v_accvgpr_read_b32 v58, a174
    v_accvgpr_read_b32 v59, a175
    v_mul_f32 v56, v56, v71
    v_mul_f32 v57, v57, v71
    v_mul_f32 v58, v58, v71
    v_mul_f32 v59, v59, v71
    v_accvgpr_write_b32 a172, v56
    v_accvgpr_write_b32 a173, v57
    v_accvgpr_write_b32 a174, v58
    v_accvgpr_write_b32 a175, v59
    v_accvgpr_read_b32 v56, a188
    v_accvgpr_read_b32 v57, a189
    v_accvgpr_read_b32 v58, a190
    v_accvgpr_read_b32 v59, a191
    v_mul_f32 v56, v56, v71
    v_mul_f32 v57, v57, v71
    v_mul_f32 v58, v58, v71
    v_mul_f32 v59, v59, v71
    v_accvgpr_write_b32 a188, v56
    v_accvgpr_write_b32 a189, v57
    v_accvgpr_write_b32 a190, v58
    v_accvgpr_write_b32 a191, v59
    v_accvgpr_read_b32 v56, a204
    v_accvgpr_read_b32 v57, a205
    v_accvgpr_read_b32 v58, a206
    v_accvgpr_read_b32 v59, a207
    v_mul_f32 v56, v56, v71
    v_mul_f32 v57, v57, v71
    v_mul_f32 v58, v58, v71
    v_mul_f32 v59, v59, v71
    v_accvgpr_write_b32 a204, v56
    v_accvgpr_write_b32 a205, v57
    v_accvgpr_write_b32 a206, v58
    v_accvgpr_write_b32 a207, v59
    v_accvgpr_read_b32 v56, a220
    v_accvgpr_read_b32 v57, a221
    v_accvgpr_read_b32 v58, a222
    v_accvgpr_read_b32 v59, a223
    v_mul_f32 v56, v56, v71
    v_mul_f32 v57, v57, v71
    v_mul_f32 v58, v58, v71
    v_mul_f32 v59, v59, v71
    v_accvgpr_write_b32 a220, v56
    v_accvgpr_write_b32 a221, v57
    v_accvgpr_write_b32 a222, v58
    v_accvgpr_write_b32 a223, v59
    v_accvgpr_read_b32 v56, a236
    v_accvgpr_read_b32 v57, a237
    v_accvgpr_read_b32 v58, a238
    v_accvgpr_read_b32 v59, a239
    v_mul_f32 v56, v56, v71
    v_mul_f32 v57, v57, v71
    v_mul_f32 v58, v58, v71
    v_mul_f32 v59, v59, v71
    v_accvgpr_write_b32 a236, v56
    v_accvgpr_write_b32 a237, v57
    v_accvgpr_write_b32 a238, v58
    v_accvgpr_write_b32 a239, v59
    v_accvgpr_read_b32 v56, a252
    v_accvgpr_read_b32 v57, a253
    v_accvgpr_read_b32 v58, a254
    v_accvgpr_read_b32 v59, a255
    v_mul_f32 v56, v56, v71
    v_mul_f32 v57, v57, v71
    v_mul_f32 v58, v58, v71
    v_mul_f32 v59, v59, v71
    v_accvgpr_write_b32 a252, v56
    v_accvgpr_write_b32 a253, v57
    v_accvgpr_write_b32 a254, v58
    v_accvgpr_write_b32 a255, v59
    s_setreg_imm32_b32 hwreg(HW_REG_MODE, 4, 2), 0
    s_nop 1
    v_exp_f32 v56, v96
    v_exp_f32 v57, v97
    s_nop 0
    v_cvt_pk_bf16_f32 v240, v56, v57
    v_exp_f32 v58, v100
    s_nop 0
    v_add_f32 v53, v49, v58
    v_exp_f32 v59, v101
    s_nop 0
    v_add_f32 v53, v53, v59
    v_cvt_pk_bf16_f32 v244, v58, v59
    v_exp_f32 v60, v98
    v_exp_f32 v61, v99
    s_nop 0
    v_cvt_pk_bf16_f32 v241, v60, v61
    v_exp_f32 v62, v102
    s_nop 0
    v_add_f32 v53, v53, v62
    v_exp_f32 v63, v103
    s_nop 0
    v_add_f32 v53, v53, v63
    v_cvt_pk_bf16_f32 v245, v62, v63
    v_exp_f32 v56, v112
    v_exp_f32 v57, v113
    s_nop 0
    v_cvt_pk_bf16_f32 v242, v56, v57
    v_exp_f32 v58, v116
    s_nop 0
    v_add_f32 v53, v53, v58
    v_exp_f32 v59, v117
    s_nop 0
    v_add_f32 v53, v53, v59
    v_cvt_pk_bf16_f32 v246, v58, v59
    v_exp_f32 v60, v114
    v_exp_f32 v61, v115
    s_nop 0
    v_cvt_pk_bf16_f32 v243, v60, v61
    v_exp_f32 v62, v118
    s_nop 0
    v_add_f32 v53, v53, v62
    v_exp_f32 v63, v119
    s_nop 0
    v_add_f32 v53, v53, v63
    v_cvt_pk_bf16_f32 v247, v62, v63
    v_exp_f32 v56, v104
    v_exp_f32 v57, v105
    s_nop 0
    v_cvt_pk_bf16_f32 v248, v56, v57
    v_exp_f32 v58, v108
    s_nop 0
    v_add_f32 v55, v51, v58
    v_exp_f32 v59, v109
    s_nop 0
    v_add_f32 v55, v55, v59
    v_cvt_pk_bf16_f32 v252, v58, v59
    v_exp_f32 v60, v106
    v_exp_f32 v61, v107
    s_nop 0
    v_cvt_pk_bf16_f32 v249, v60, v61
    v_exp_f32 v62, v110
    s_nop 0
    v_add_f32 v55, v55, v62
    v_exp_f32 v63, v111
    s_nop 0
    v_add_f32 v55, v55, v63
    v_cvt_pk_bf16_f32 v253, v62, v63
    v_exp_f32 v56, v120
    v_exp_f32 v57, v121
    s_nop 0
    v_cvt_pk_bf16_f32 v250, v56, v57
    v_exp_f32 v58, v124
    s_nop 0
    v_add_f32 v55, v55, v58
    v_exp_f32 v59, v125
    s_nop 0
    v_add_f32 v55, v55, v59
    v_cvt_pk_bf16_f32 v254, v58, v59
    v_exp_f32 v60, v122
    v_exp_f32 v61, v123
    s_nop 0
    v_cvt_pk_bf16_f32 v251, v60, v61
    v_exp_f32 v62, v126
    s_nop 0
    v_add_f32 v55, v55, v62
    v_exp_f32 v63, v127
    s_nop 0
    v_add_f32 v55, v55, v63
    v_cvt_pk_bf16_f32 v255, v62, v63
    v_exp_f32 v56, v128
    v_exp_f32 v57, v129
    s_nop 0
    v_cvt_pk_bf16_f32 v16, v56, v57
    v_exp_f32 v58, v132
    s_nop 0
    v_add_f32 v53, v53, v58
    v_exp_f32 v59, v133
    s_nop 0
    v_add_f32 v53, v53, v59
    v_cvt_pk_bf16_f32 v20, v58, v59
    v_exp_f32 v60, v130
    v_exp_f32 v61, v131
    s_nop 0
    v_cvt_pk_bf16_f32 v17, v60, v61
    v_exp_f32 v62, v134
    s_nop 0
    v_add_f32 v53, v53, v62
    v_exp_f32 v63, v135
    s_nop 0
    v_add_f32 v53, v53, v63
    v_cvt_pk_bf16_f32 v21, v62, v63
    v_exp_f32 v56, v144
    v_exp_f32 v57, v145
    s_nop 0
    v_cvt_pk_bf16_f32 v18, v56, v57
    v_exp_f32 v58, v148
    s_nop 0
    v_add_f32 v53, v53, v58
    v_exp_f32 v59, v149
    s_nop 0
    v_add_f32 v53, v53, v59
    v_cvt_pk_bf16_f32 v22, v58, v59
    v_exp_f32 v60, v146
    v_exp_f32 v61, v147
    s_nop 0
    v_cvt_pk_bf16_f32 v19, v60, v61
    v_exp_f32 v62, v150
    s_nop 0
    v_add_f32 v53, v53, v62
    v_exp_f32 v63, v151
    s_nop 0
    v_add_f32 v53, v53, v63
    v_cvt_pk_bf16_f32 v23, v62, v63
    v_exp_f32 v56, v136
    v_exp_f32 v57, v137
    s_nop 0
    v_cvt_pk_bf16_f32 v24, v56, v57
    v_exp_f32 v58, v140
    s_nop 0
    v_add_f32 v55, v55, v58
    v_exp_f32 v59, v141
    s_nop 0
    v_add_f32 v55, v55, v59
    v_cvt_pk_bf16_f32 v28, v58, v59
    v_exp_f32 v60, v138
    v_exp_f32 v61, v139
    s_nop 0
    v_cvt_pk_bf16_f32 v25, v60, v61
    v_exp_f32 v62, v142
    s_nop 0
    v_add_f32 v55, v55, v62
    v_exp_f32 v63, v143
    s_nop 0
    v_add_f32 v55, v55, v63
    v_cvt_pk_bf16_f32 v29, v62, v63
    v_exp_f32 v56, v152
    v_exp_f32 v57, v153
    s_nop 0
    v_cvt_pk_bf16_f32 v26, v56, v57
    v_exp_f32 v58, v156
    s_nop 0
    v_add_f32 v55, v55, v58
    v_exp_f32 v59, v157
    s_nop 0
    v_add_f32 v55, v55, v59
    v_cvt_pk_bf16_f32 v30, v58, v59
    v_exp_f32 v60, v154
    v_exp_f32 v61, v155
    s_nop 0
    v_cvt_pk_bf16_f32 v27, v60, v61
    v_exp_f32 v62, v158
    s_nop 0
    v_add_f32 v55, v55, v62
    v_exp_f32 v63, v159
    s_nop 0
    v_add_f32 v55, v55, v63
    v_cvt_pk_bf16_f32 v31, v62, v63
    v_mfma_f32_16x16x32_bf16 v[72:75], v[10:13], v[240:243], 0
    v_mfma_f32_16x16x32_bf16 v[72:75], v[10:13], v[16:19], v[72:75]
    s_nop 7
    v_add_f32 v52, v48, v72
    v_mfma_f32_16x16x32_bf16 v[72:75], v[10:13], v[248:251], 0
    v_mfma_f32_16x16x32_bf16 v[72:75], v[10:13], v[24:27], v[72:75]
    s_nop 7
    v_add_f32 v54, v50, v72
    s_nop 3
    s_setpc_b64 s[50:51]
L_code_end:
    s_endpgm
.section .rodata,"a"
.p2align 6
.amdhsa_kernel recurrent_scan__gqa_block_cached__glu_gated_geglu__prompt_kernel
  .amdhsa_next_free_vgpr 512
  .amdhsa_next_free_sgpr 102
  .amdhsa_accum_offset 256
  .amdhsa_group_segment_fixed_size 0
  .amdhsa_kernarg_size 96
  .amdhsa_user_sgpr_count 2
  .amdhsa_user_sgpr_kernarg_segment_ptr 1
  .amdhsa_system_sgpr_workgroup_id_x 1
.end_amdhsa_kernel
```
